```python
import torch

def _softmax(x, axis=-1):
    return torch.softmax(x, dim=axis)
def _gelu(x):
    return torch.nn.functional.gelu(x, approximate="tanh")
def _silu(x):
    return torch.nn.functional.silu(x)
def _sigmoid(x):
    return torch.sigmoid(x)
def _layernorm(x, axis=-1, eps=1e-5):
    m = x.mean(dim=axis, keepdim=True)
    v = x.var(dim=axis, keepdim=True, unbiased=False)
    return (x - m) / torch.sqrt(v + eps)
def _scatter_add(tgt, idx, src, axis=0):
    return tgt.clone().index_add_(axis, idx, src)
def _segment_sum(src, seg, n):
    out = torch.zeros((n,) + src.shape[1:], dtype=src.dtype)
    return out.index_add_(0, seg, src)
def _pad(x, pw):
    flat = tuple(v for pair in reversed(pw) for v in pair)
    return torch.nn.functional.pad(x, flat)

kernel_name = 'gated_mix__linear_kernel_hedgehog__dense_activation_mish__prompt'

def setup_inputs():

    _w = (lambda a: (lambda t: t.to(torch.bfloat16) if t.is_floating_point() else t)(torch.as_tensor(a)))
    def _A_setup():
        B, S, D, H = 1, 2048, 1024, 32
        Dh = D // H
        return {
            "x": _w((lambda *s: torch.randn(*s, dtype=torch.bfloat16) * 0.05)(B, S, D)),
            "wqkv": _w((lambda *s: torch.randn(*s, dtype=torch.bfloat16) * 0.8)(D, 3 * D)),
            "w_phi": _w((lambda *s: torch.randn(*s, dtype=torch.bfloat16) * 0.8)(H, Dh, Dh) * (Dh ** -0.5)),
            "wo": _w((lambda *s: torch.randn(*s, dtype=torch.bfloat16) * 0.05)(D, D)),
        }
    _A_in = _A_setup()

    def _B_setup():
        B, S, D, F = 1, 2048, 1024, 3584
        return {
            "x": _w((lambda *s: torch.randn(*s, dtype=torch.bfloat16) * 0.05)(B, S, D)),
            "w1": _w((lambda *s: torch.randn(*s, dtype=torch.bfloat16) * 12.8)(D, F) * (D ** -0.5)),
            "b1": _w((lambda *s: torch.randn(*s, dtype=torch.bfloat16) * 0.2)(F)),
            "w2": _w((lambda *s: torch.randn(*s, dtype=torch.bfloat16) * 0.1)(F, D) * (F ** -0.5)),
        }
    _B_in = _B_setup()

    return {
        "A_x": _A_in["x"],
        "A_wqkv": _A_in["wqkv"],
        "A_w_phi": _A_in["w_phi"],
        "A_wo": _A_in["wo"],
        "B_x": _B_in["x"],
        "B_w1": _B_in["w1"],
        "B_b1": _B_in["b1"],
        "B_w2": _B_in["w2"],
        "gate_w": _w((lambda *s: torch.randn(*s, dtype=torch.bfloat16) * 0.05)(1024) * 16.0),
    }

def reference(A_x, A_wqkv, A_w_phi, A_wo, B_x, B_w1, B_b1, B_w2, gate_w):
    def _A_ref(x, wqkv, w_phi, wo):
        B, S, D = x.shape
        H = 32; Dh = D // H
        qkv = (lambda x, *d: x.permute(*d))((x @ wqkv).reshape(B, S, 3, H, Dh), 2, 0, 3, 1, 4)
        q, k, v = qkv[0], qkv[1], qkv[2]
        pq = torch.einsum("bhsd,hdf->bhsf", q, w_phi)
        pk = torch.einsum("bhsd,hdf->bhsf", k, w_phi)
        phi_q = torch.concatenate([_softmax(pq, axis=-1), _softmax(-pq, axis=-1)], axis=-1)
        phi_k = torch.concatenate([_softmax(pk, axis=-1), _softmax(-pk, axis=-1)], axis=-1)
        kv = torch.einsum("bhsf,bhsd->bhfd", phi_k, v)
        z  = torch.einsum("bhsf->bhf", phi_k)
        num = torch.einsum("bhqf,bhfd->bhqd", phi_q, kv)
        den = torch.einsum("bhqf,bhf->bhq", phi_q, z)[..., None] + 1e-6
        o = num / den
        return (lambda x, *d: x.permute(*d))(o, 0, 2, 1, 3).reshape(B, S, D) @ wo

    def _B_ref(x, w1, b1, w2):
        h = torch.einsum("bsd,df->bsf", x, w1) + b1
        sp = torch.log1p(torch.exp(-torch.abs(h))) + torch.where(h > 0, h, torch.zeros_like(h))
        act = h * torch.tanh(sp)
        return torch.einsum("bsf,fd->bsd", act, w2)

    x = A_x
    g = _sigmoid((x * gate_w).sum(-1, keepdims=True))
    a = _A_ref(x, A_wqkv, A_w_phi, A_wo)
    b = _B_ref(x, B_w1, B_b1, B_w2)
    return g * a + (1 - g) * b
```

```asm
; @launch grid=(256,1,1) block=(256,1,1) lds=163840
.amdgcn_target "amdgcn-amd-amdhsa--gfx950"
.text
.globl gated_mix__linear_kernel_hedgehog__dense_activation_mish__prompt_kernel
.p2align 12
.p2align 8
.type gated_mix__linear_kernel_hedgehog__dense_activation_mish__prompt_kernel,@function
gated_mix__linear_kernel_hedgehog__dense_activation_mish__prompt_kernel:
    s_getpc_b64 s[84:85]
    s_lshr_b32 s3, s2, 8
    s_cbranch_scc1 L_exit0
    s_load_dwordx4 s[4:7], s[0:1], 0
    s_load_dwordx4 s[88:91], s[0:1], 40
    s_bitcmp1_b32 s2, 0
    s_cselect_b32 s44, L_qkv-gated_mix__linear_kernel_hedgehog__dense_activation_mish__prompt_kernel-4, 0
    s_lshr_b32 s26, s2, 3
    v_lshl_add_u32 v18, s26, 8, v0
    v_mad_u32_u24 v18, v18, 6, s44
    global_load_ubyte v31, v18, s[84:85]
    v_lshrrev_b32 v2, 6, v0
    v_and_b32 v1, 63, v0
    v_readfirstlane_b32 s28, v2
    v_lshrrev_b32 v18, 3, v1
    v_lshrrev_b32 v19, 4, v1
    v_and_b32 v20, 7, v1
    v_xor_b32 v19, v19, v20
    s_and_b32 s26, s26, 7
    s_lshl2_add_u32 s44, s26, s28
    s_lshl_b32 s32, s44, 17
    s_add_u32 s45, s28, 4
    s_lshl_b32 m0, s45, 13
    v_lshlrev_b32 v19, 4, v19
    v_lshl_add_u32 v2, v18, 11, v19
    v_xor_b32 v19, 64, v2
    s_movk_i32 s46, 15360
    v_add_u32 v3, s46, v19
    s_movk_i32 s46, 30720
    v_add_u32 v4, s46, v2
    v_add_u32 v5, s46, v3
    s_bitcmp1_b32 s2, 0
    s_waitcnt lgkmcnt(0)
    s_cselect_b64 s[8:9], s[6:7], s[88:89]
    s_lshl_b32 s6, 1, 22
    s_lshl_b32 s7, 1, 17
    buffer_load_dwordx4 v2, s[4:7], s32 offen offset:0 lds
    buffer_load_dwordx4 v3, s[4:7], s32 offen offset:1024 lds
    buffer_load_dwordx4 v4, s[4:7], s32 offen offset:2048 lds
    buffer_load_dwordx4 v5, s[4:7], s32 offen offset:3072 lds
    s_addk_i32 m0, 4096
    s_bitset1_b32 s32, 16
    buffer_load_dwordx4 v2, s[4:7], s32 offen offset:0 lds
    buffer_load_dwordx4 v3, s[4:7], s32 offen offset:1024 lds
    buffer_load_dwordx4 v4, s[4:7], s32 offen offset:2048 lds
    buffer_load_dwordx4 v5, s[4:7], s32 offen offset:3072 lds
    s_bitcmp1_b32 s2, 0
    s_cbranch_scc1 L_qkv
    s_branch L_ffn
L_tramp:
    s_setpc_b64 s[86:87]
L_ffn:
    s_load_dwordx2 s[68:69], s[0:1], 24
    s_load_dwordx2 s[64:65], s[0:1], 56
    s_load_dwordx2 s[72:73], s[0:1], 72
    s_load_dwordx2 s[24:25], s[0:1], 80
    s_load_dwordx2 s[12:13], s[0:1], 88
    s_bfe_u32 s45, s2, 0x20001
    s_lshr_b32 s44, s2, 6
    s_lshl2_add_u32 s27, s45, s44
    s_lshr_b32 s29, s28, 1
    s_and_b32 s30, s28, 1
    s_mov_b32 s33, 0
    s_mov_b32 s10, 0x700000
    s_mov_b32 s11, 0x20000
    s_mov_b64 s[92:93], s[90:91]
    s_mov_b32 s94, 0x1c00
    s_mov_b32 s95, 0x20000
    v_lshrrev_b32 v18, 4, v1
    v_lshlrev_b32 v18, 3, v18
    s_mul_i32 s44, s27, 448
    s_lshl_b32 s45, s30, 8
    s_add_u32 s45, s45, s44
    s_lshl_b32 s46, s30, 5
    s_add_u32 s46, s46, s44
    buffer_load_dwordx2 v[60:61], v18, s[92:95], s45 offen offset:0
    buffer_load_dwordx2 v[64:65], v18, s[92:95], s45 offen offset:32
    buffer_load_dwordx2 v[68:69], v18, s[92:95], s45 offen offset:64
    buffer_load_dwordx2 v[72:73], v18, s[92:95], s45 offen offset:96
    buffer_load_dwordx2 v[76:77], v18, s[92:95], s45 offen offset:128
    buffer_load_dwordx2 v[80:81], v18, s[92:95], s45 offen offset:160
    buffer_load_dwordx2 v[84:85], v18, s[92:95], s46 offen offset:192
    s_mul_i32 s44, s28, 114688
    s_mul_i32 s45, s27, 448
    s_add_u32 s44, s44, s45
    s_mul_i32 s42, s28, 7168
    s_add_u32 m0, s42, 0
    v_add_u32 v18, 0, v1
    v_mul_u32_u24 v19, 2341, v18
    v_lshrrev_b32 v19, 16, v19
    v_mul_u32_u24 v20, 28, v19
    v_sub_u32 v18, v18, v20
    v_lshrrev_b32 v20, 2, v19
    v_and_b32 v20, 2, v20
    v_xor_b32 v18, v18, v20
    v_lshlrev_b32 v18, 4, v18
    v_mul_u32_u24 v19, 7168, v19
    v_add3_u32 v6, v18, v19, s44
    buffer_load_dwordx4 v6, s[8:11], s33 offen offset:0 lds
    v_add_u32 v18, 64, v1
    v_mul_u32_u24 v19, 2341, v18
    v_lshrrev_b32 v19, 16, v19
    v_mul_u32_u24 v20, 28, v19
    v_sub_u32 v18, v18, v20
    v_lshrrev_b32 v20, 2, v19
    v_and_b32 v20, 2, v20
    v_xor_b32 v18, v18, v20
    v_lshlrev_b32 v18, 4, v18
    v_mul_u32_u24 v19, 7168, v19
    v_add3_u32 v7, v18, v19, s44
    v_subrev_u32 v7, 1024, v7
    buffer_load_dwordx4 v7, s[8:11], s33 offen offset:1024 lds
    v_add_u32 v18, 128, v1
    v_mul_u32_u24 v19, 2341, v18
    v_lshrrev_b32 v19, 16, v19
    v_mul_u32_u24 v20, 28, v19
    v_sub_u32 v18, v18, v20
    v_lshrrev_b32 v20, 2, v19
    v_and_b32 v20, 2, v20
    v_xor_b32 v18, v18, v20
    v_lshlrev_b32 v18, 4, v18
    v_mul_u32_u24 v19, 7168, v19
    v_add3_u32 v8, v18, v19, s44
    v_subrev_u32 v8, 2048, v8
    buffer_load_dwordx4 v8, s[8:11], s33 offen offset:2048 lds
    v_add_u32 v18, 192, v1
    v_mul_u32_u24 v19, 2341, v18
    v_lshrrev_b32 v19, 16, v19
    v_mul_u32_u24 v20, 28, v19
    v_sub_u32 v18, v18, v20
    v_lshrrev_b32 v20, 2, v19
    v_and_b32 v20, 2, v20
    v_xor_b32 v18, v18, v20
    v_lshlrev_b32 v18, 4, v18
    v_mul_u32_u24 v19, 7168, v19
    v_add3_u32 v9, v18, v19, s44
    v_subrev_u32 v9, 3072, v9
    buffer_load_dwordx4 v9, s[8:11], s33 offen offset:3072 lds
    s_add_u32 m0, s42, 4096
    v_add_u32 v18, 256, v1
    v_mul_u32_u24 v19, 2341, v18
    v_lshrrev_b32 v19, 16, v19
    v_mul_u32_u24 v20, 28, v19
    v_sub_u32 v18, v18, v20
    v_lshrrev_b32 v20, 2, v19
    v_and_b32 v20, 2, v20
    v_xor_b32 v18, v18, v20
    v_lshlrev_b32 v18, 4, v18
    v_mul_u32_u24 v19, 7168, v19
    v_add3_u32 v10, v18, v19, s44
    buffer_load_dwordx4 v10, s[8:11], s33 offen offset:0 lds
    v_add_u32 v18, 320, v1
    v_mul_u32_u24 v19, 2341, v18
    v_lshrrev_b32 v19, 16, v19
    v_mul_u32_u24 v20, 28, v19
    v_sub_u32 v18, v18, v20
    v_lshrrev_b32 v20, 2, v19
    v_and_b32 v20, 2, v20
    v_xor_b32 v18, v18, v20
    v_lshlrev_b32 v18, 4, v18
    v_mul_u32_u24 v19, 7168, v19
    v_add3_u32 v11, v18, v19, s44
    v_subrev_u32 v11, 1024, v11
    buffer_load_dwordx4 v11, s[8:11], s33 offen offset:1024 lds
    v_add_u32 v18, 384, v1
    v_mul_u32_u24 v19, 2341, v18
    v_lshrrev_b32 v19, 16, v19
    v_mul_u32_u24 v20, 28, v19
    v_sub_u32 v18, v18, v20
    v_lshrrev_b32 v20, 2, v19
    v_and_b32 v20, 2, v20
    v_xor_b32 v18, v18, v20
    v_lshlrev_b32 v18, 4, v18
    v_mul_u32_u24 v19, 7168, v19
    v_add3_u32 v12, v18, v19, s44
    v_subrev_u32 v12, 2048, v12
    buffer_load_dwordx4 v12, s[8:11], s33 offen offset:2048 lds
    s_add_u32 s33, s33, 458752
    s_add_u32 m0, s42, 126976
    s_nop 0
    buffer_load_dwordx4 v6, s[8:11], s33 offen offset:0 lds
    buffer_load_dwordx4 v7, s[8:11], s33 offen offset:1024 lds
    buffer_load_dwordx4 v8, s[8:11], s33 offen offset:2048 lds
    buffer_load_dwordx4 v9, s[8:11], s33 offen offset:3072 lds
    s_add_u32 m0, s42, 131072
    s_nop 0
    buffer_load_dwordx4 v10, s[8:11], s33 offen offset:0 lds
    buffer_load_dwordx4 v11, s[8:11], s33 offen offset:1024 lds
    buffer_load_dwordx4 v12, s[8:11], s33 offen offset:2048 lds
    s_add_u32 s33, s33, 458752
    s_lshl_b32 s40, s28, 13
    s_add_u32 s41, s40, 4096
    s_add_u32 s32, s32, 128
    s_sub_u32 s31, s32, 0x10000
    s_lshl2_add_u32 s3, s2, s28
    s_lshl_b32 s53, s3, 12
    s_movk_i32 s38, 256
    v_and_b32 v18, 1, v1
    v_lshlrev_b32 v18, 7, v18
    v_bfe_u32 v19, v1, 1, 1
    v_lshl_add_u32 v28, v19, 11, v18
    s_mov_b64 s[20:21], s[4:5]
    s_mov_b64 s[22:23], s[6:7]
    s_mov_b64 s[16:17], s[8:9]
    s_mov_b64 s[18:19], s[10:11]
    buffer_load_dword v31, v28, s[20:23], s53 offen
    s_add_u32 s53, s53, s38
    s_lshr_b32 s44, s2, 3
    s_lshl2_add_u32 s44, s44, s28
    s_add_u32 s44, s44, 128
    s_mul_i32 s44, s44, 7168
    s_lshr_b32 s45, s27, 2
    s_mul_i32 s45, s45, 1792
    s_add_u32 s52, s44, s45
    s_mov_b32 s37, 917504
    v_min_u32 v18, 13, v1
    v_lshlrev_b32 v29, 7, v18
    s_waitcnt lgkmcnt(0)
    s_mov_b32 s14, 0x3400000
    s_mov_b32 s15, 0x20000
    v_and_b32 v18, 15, v1
    v_lshrrev_b32 v19, 4, v1
    v_lshrrev_b32 v20, 1, v18
    v_xor_b32 v20, v20, v19
    v_lshlrev_b32 v20, 4, v20
    v_lshl_add_u32 v20, v18, 7, v20
    s_lshl_b32 s44, s29, 14
    s_add_u32 s44, s44, 0x8000
    v_add_u32 v13, s44, v20
    v_xor_b32 v14, 64, v13
    v_bfe_u32 v18, v1, 2, 2
    v_lshl_add_u32 v20, v19, 3, v18
    v_mul_u32_u24 v20, 448, v20
    v_and_b32 v21, 3, v1
    v_lshl_add_u32 v20, v21, 3, v20
    v_and_b32 v19, 1, v19
    s_lshl_b32 s44, s30, 8
    v_lshlrev_b32 v21, 5, v19
    v_add3_u32 v15, v20, v21, s44
    v_sub_u32 v22, v20, v21
    v_add_u32 v16, s44, v22
    s_add_u32 s44, s30, 6
    v_xor_b32 v21, s44, v19
    v_lshl_add_u32 v17, v21, 5, v20
    s_and_b32 s56, s2, 4
    s_lshr_b32 s44, s2, 6
    s_add_u32 s56, s56, s44
    s_and_b32 s58, s2, 3
    s_bfe_u32 s57, s2, 0x30003
    s_lshl_b32 s59, s56, 1
    s_lshr_b32 s44, s58, 1
    s_add_u32 s59, s59, s44
    s_lshl_b32 s59, s59, 2
    s_add_u32 s59, s59, s28
    s_mul_i32 s44, s58, 1835008
    s_mul_i32 s60, s29, 262144
    s_add_u32 s60, s60, s44
    s_mul_i32 s61, s29, 458752
    s_add_u32 s61, s61, s44
    s_mul_i32 s62, s29, 65536
    s_add_u32 s62, s62, s44
    s_lshl_b32 s63, s28, 12
    s_lshr_b32 s44, s2, 3
    s_lshl2_add_u32 s44, s44, s28
    s_mul_i32 s45, s44, 384
    s_add_u32 s45, s45, L_ffn-gated_mix__linear_kernel_hedgehog__dense_activation_mish__prompt_kernel
    v_min_u32 v18, 2, v1
    v_lshl_add_u32 v30, v18, 7, s45
    v_min_u32 v30, L_end-gated_mix__linear_kernel_hedgehog__dense_activation_mish__prompt_kernel-8, v30
    s_mov_b32 s66, 0x700000
    s_mov_b32 s67, 0x20000
    s_mov_b32 s70, 0x200000
    s_mov_b32 s71, 0x20000
    s_mov_b32 s74, 0x400000
    s_mov_b32 s75, 0x20000
    s_mov_b64 exec, 0
    s_cmp_eq_u32 s29, 1
    s_cbranch_scc1 L_hb1
    s_cmp_eq_u32 s30, 1
    s_cbranch_scc1 L_ha1
    s_call_b64 s[86:87], L_pg1
    s_branch L_hd1
L_ha1:
    s_call_b64 s[86:87], L_pg2
    s_branch L_hd1
L_hb1:
    s_cmp_eq_u32 s30, 1
    s_cbranch_scc1 L_hc1
    s_call_b64 s[86:87], L_pg3
    s_branch L_hd1
L_hc1:
    s_call_b64 s[86:87], L_pg4
L_hd1:
    s_mov_b64 exec, -1
    s_waitcnt vmcnt(15)
    v_lshlrev_b32 v228, 16, v60
    v_and_b32 v229, 0xffff0000, v60
    v_lshlrev_b32 v230, 16, v61
    v_and_b32 v231, 0xffff0000, v61
    v_mov_b64 v[200:201], v[228:229]
    v_mov_b64 v[202:203], v[230:231]
    v_lshlrev_b32 v232, 16, v64
    v_and_b32 v233, 0xffff0000, v64
    v_lshlrev_b32 v234, 16, v65
    v_and_b32 v235, 0xffff0000, v65
    v_mov_b64 v[204:205], v[232:233]
    v_mov_b64 v[206:207], v[234:235]
    v_lshlrev_b32 v236, 16, v68
    v_and_b32 v237, 0xffff0000, v68
    v_lshlrev_b32 v238, 16, v69
    v_and_b32 v239, 0xffff0000, v69
    v_mov_b64 v[208:209], v[236:237]
    v_mov_b64 v[210:211], v[238:239]
    v_lshlrev_b32 v240, 16, v72
    v_and_b32 v241, 0xffff0000, v72
    v_lshlrev_b32 v242, 16, v73
    v_and_b32 v243, 0xffff0000, v73
    v_mov_b64 v[212:213], v[240:241]
    v_mov_b64 v[214:215], v[242:243]
    v_lshlrev_b32 v244, 16, v76
    v_and_b32 v245, 0xffff0000, v76
    v_lshlrev_b32 v246, 16, v77
    v_and_b32 v247, 0xffff0000, v77
    v_mov_b64 v[216:217], v[244:245]
    v_mov_b64 v[218:219], v[246:247]
    v_lshlrev_b32 v248, 16, v80
    v_and_b32 v249, 0xffff0000, v80
    v_lshlrev_b32 v250, 16, v81
    v_and_b32 v251, 0xffff0000, v81
    v_mov_b64 v[220:221], v[248:249]
    v_mov_b64 v[222:223], v[250:251]
    v_lshlrev_b32 v252, 16, v84
    v_and_b32 v253, 0xffff0000, v84
    v_lshlrev_b32 v254, 16, v85
    v_and_b32 v255, 0xffff0000, v85
    v_mov_b64 v[224:225], v[252:253]
    v_mov_b64 v[226:227], v[254:255]
    buffer_load_dword v31, v29, s[16:19], s52 offen
    s_add_u32 s52, s52, s37
    buffer_load_dword v31, v28, s[20:23], s53 offen
    s_add_u32 s53, s53, s38
    s_mov_b32 s35, 0x10000
    s_waitcnt vmcnt(10) lgkmcnt(0)
    s_barrier
    ds_read_b64_tr_b16 a[0:1], v15 offset:0
    ds_read_b64_tr_b16 a[2:3], v15 offset:1792
    ds_read_b64_tr_b16 a[4:5], v15 offset:14336
    ds_read_b64_tr_b16 a[6:7], v15 offset:16128
    ds_read_b128 a[112:115], v13 offset:0
    ds_read_b128 a[116:119], v14 offset:0
    ds_read_b64_tr_b16 a[8:9], v16 offset:32
    ds_read_b64_tr_b16 a[10:11], v16 offset:1824
    ds_read_b64_tr_b16 a[12:13], v16 offset:14368
    ds_read_b64_tr_b16 a[14:15], v16 offset:16160
    ds_read_b64_tr_b16 a[16:17], v15 offset:64
    ds_read_b64_tr_b16 a[18:19], v15 offset:1856
    ds_read_b64_tr_b16 a[20:21], v15 offset:14400
    ds_read_b64_tr_b16 a[22:23], v15 offset:16192
    ds_read_b64_tr_b16 a[24:25], v16 offset:96
    ds_read_b64_tr_b16 a[26:27], v16 offset:1888
    ds_read_b64_tr_b16 a[28:29], v16 offset:14432
    ds_read_b64_tr_b16 a[30:31], v16 offset:16224
    ds_read_b64_tr_b16 a[32:33], v15 offset:128
    ds_read_b64_tr_b16 a[34:35], v15 offset:1920
    ds_read_b64_tr_b16 a[36:37], v15 offset:14464
    ds_read_b64_tr_b16 a[38:39], v15 offset:16256
    ds_read_b64_tr_b16 a[40:41], v16 offset:160
    ds_read_b64_tr_b16 a[42:43], v16 offset:1952
    ds_read_b64_tr_b16 a[44:45], v16 offset:14496
    ds_read_b64_tr_b16 a[46:47], v16 offset:16288
    ds_read_b64_tr_b16 a[48:49], v17 offset:0
    ds_read_b64_tr_b16 a[50:51], v17 offset:1792
    ds_read_b64_tr_b16 a[52:53], v17 offset:14336
    ds_read_b64_tr_b16 a[54:55], v17 offset:16128
    ds_read_b128 a[120:123], v13 offset:2048
    ds_read_b128 a[124:127], v14 offset:2048
    v_add_u32 v15, 98304, v15
    v_add_u32 v16, 98304, v16
    v_add_u32 v17, 98304, v17
    s_waitcnt lgkmcnt(14)
    v_mfma_f32_16x16x32_bf16 v[32:35], a[0:3], a[112:115], v[228:231]
    s_add_u32 m0, s35, s40
    v_mfma_f32_16x16x32_bf16 v[32:35], a[4:7], a[116:119], v[32:35]
    buffer_load_dwordx4 v2, s[4:7], s31 offen offset:0 lds
    v_mfma_f32_16x16x32_bf16 v[36:39], a[12:15], a[116:119], v[232:235]
    v_mfma_f32_16x16x32_bf16 v[36:39], a[8:11], a[112:115], v[36:39]
    buffer_load_dwordx4 v3, s[4:7], s31 offen offset:1024 lds
    v_mfma_f32_16x16x32_bf16 v[40:43], a[16:19], a[112:115], v[236:239]
    v_mfma_f32_16x16x32_bf16 v[40:43], a[20:23], a[116:119], v[40:43]
    v_mfma_f32_16x16x32_bf16 v[44:47], a[28:31], a[116:119], v[240:243]
    v_mfma_f32_16x16x32_bf16 v[44:47], a[24:27], a[112:115], v[44:47]
    s_waitcnt lgkmcnt(10)
    buffer_load_dwordx4 v4, s[4:7], s31 offen offset:2048 lds
    v_mfma_f32_16x16x32_bf16 v[48:51], a[32:35], a[112:115], v[244:247]
    v_mfma_f32_16x16x32_bf16 v[48:51], a[36:39], a[116:119], v[48:51]
    s_waitcnt lgkmcnt(6)
    buffer_load_dwordx4 v5, s[4:7], s31 offen offset:3072 lds
    v_mfma_f32_16x16x32_bf16 v[52:55], a[44:47], a[116:119], v[248:251]
    ds_read_b128 a[128:131], v13 offset:4096
    s_add_u32 m0, s35, s41
    v_mfma_f32_16x16x32_bf16 v[52:55], a[40:43], a[112:115], v[52:55]
    s_waitcnt lgkmcnt(3)
    buffer_load_dwordx4 v2, s[4:7], s32 offen offset:0 lds
    v_mfma_f32_16x16x32_bf16 v[56:59], a[48:51], a[112:115], v[252:255]
    ds_read_b128 a[132:135], v14 offset:4096
    v_mfma_f32_16x16x32_bf16 v[56:59], a[52:55], a[116:119], v[56:59]
    s_waitcnt lgkmcnt(2)
    v_mfma_f32_16x16x32_bf16 v[84:87], a[52:55], a[124:127], v[252:255]
    ds_read_b128 a[136:139], v13 offset:6144
    v_mfma_f32_16x16x32_bf16 v[84:87], a[48:51], a[120:123], v[84:87]
    buffer_load_dwordx4 v3, s[4:7], s32 offen offset:1024 lds
    v_mfma_f32_16x16x32_bf16 v[80:83], a[40:43], a[120:123], v[248:251]
    ds_read_b128 a[140:143], v14 offset:6144
    v_mfma_f32_16x16x32_bf16 v[80:83], a[44:47], a[124:127], v[80:83]
    buffer_load_dwordx4 v4, s[4:7], s32 offen offset:2048 lds
    s_mov_b64 exec, 0
    s_cmp_eq_u32 s29, 1
    s_cbranch_scc1 L_hb2
    s_cmp_eq_u32 s30, 1
    s_cbranch_scc1 L_ha2
    s_call_b64 s[86:87], L_pg5
    s_branch L_hd2
L_ha2:
    s_call_b64 s[86:87], L_pg6
    s_branch L_hd2
L_hb2:
    s_cmp_eq_u32 s30, 1
    s_cbranch_scc1 L_hc2
    s_call_b64 s[86:87], L_pg7
    s_branch L_hd2
L_hc2:
    s_call_b64 s[86:87], L_pg8
L_hd2:
    s_mov_b64 exec, -1
    v_mfma_f32_16x16x32_bf16 v[76:79], a[36:39], a[124:127], v[244:247]
    v_mfma_f32_16x16x32_bf16 v[76:79], a[32:35], a[120:123], v[76:79]
    v_mfma_f32_16x16x32_bf16 v[72:75], a[24:27], a[120:123], v[240:243]
    v_mfma_f32_16x16x32_bf16 v[72:75], a[28:31], a[124:127], v[72:75]
    buffer_load_dwordx4 v5, s[4:7], s32 offen offset:3072 lds
    v_mfma_f32_16x16x32_bf16 v[68:71], a[20:23], a[124:127], v[236:239]
    s_add_u32 s31, s31, 128
    s_add_u32 s32, s32, 128
    s_mov_b32 s35, 0
    s_add_u32 m0, s42, 98304
    v_mfma_f32_16x16x32_bf16 v[68:71], a[16:19], a[120:123], v[68:71]
    buffer_load_dwordx4 v6, s[8:11], s33 offen offset:0 lds
    v_mfma_f32_16x16x32_bf16 v[64:67], a[8:11], a[120:123], v[232:235]
    v_mfma_f32_16x16x32_bf16 v[64:67], a[12:15], a[124:127], v[64:67]
    buffer_load_dwordx4 v7, s[8:11], s33 offen offset:1024 lds
    v_mfma_f32_16x16x32_bf16 v[60:63], a[4:7], a[124:127], v[228:231]
    v_mfma_f32_16x16x32_bf16 v[60:63], a[0:3], a[120:123], v[60:63]
    s_waitcnt lgkmcnt(2)
    v_mfma_f32_16x16x32_bf16 v[88:91], a[0:3], a[128:131], v[228:231]
    ds_read_b128 a[112:115], v13 offset:8192
    v_mfma_f32_16x16x32_bf16 v[88:91], a[4:7], a[132:135], v[88:91]
    buffer_load_dwordx4 v8, s[8:11], s33 offen offset:2048 lds
    v_mfma_f32_16x16x32_bf16 v[92:95], a[12:15], a[132:135], v[232:235]
    ds_read_b128 a[116:119], v14 offset:8192
    v_mfma_f32_16x16x32_bf16 v[92:95], a[8:11], a[128:131], v[92:95]
    buffer_load_dwordx4 v9, s[8:11], s33 offen offset:3072 lds
    s_mov_b64 exec, 0
    s_cmp_eq_u32 s29, 1
    s_cbranch_scc1 L_hb3
    s_cmp_eq_u32 s30, 1
    s_cbranch_scc1 L_ha3
    s_call_b64 s[86:87], L_pg9
    s_branch L_hd3
L_ha3:
    s_call_b64 s[86:87], L_pg10
    s_branch L_hd3
L_hb3:
    s_cmp_eq_u32 s30, 1
    s_cbranch_scc1 L_hc3
    s_nop 0
    s_branch L_hd3
L_hc3:
    s_nop 0
L_hd3:
    s_mov_b64 exec, -1
    v_mfma_f32_16x16x32_bf16 v[96:99], a[16:19], a[128:131], v[236:239]
    s_add_u32 m0, s42, 102400
    v_mfma_f32_16x16x32_bf16 v[96:99], a[20:23], a[132:135], v[96:99]
    buffer_load_dwordx4 v10, s[8:11], s33 offen offset:0 lds
    v_mfma_f32_16x16x32_bf16 v[100:103], a[28:31], a[132:135], v[240:243]
    v_mfma_f32_16x16x32_bf16 v[100:103], a[24:27], a[128:131], v[100:103]
    v_mfma_f32_16x16x32_bf16 v[104:107], a[32:35], a[128:131], v[244:247]
    v_mfma_f32_16x16x32_bf16 v[104:107], a[36:39], a[132:135], v[104:107]
    buffer_load_dwordx4 v11, s[8:11], s33 offen offset:1024 lds
    v_mfma_f32_16x16x32_bf16 v[108:111], a[44:47], a[132:135], v[248:251]
    v_mfma_f32_16x16x32_bf16 v[108:111], a[40:43], a[128:131], v[108:111]
    buffer_load_dwordx4 v12, s[8:11], s33 offen offset:2048 lds
    v_mfma_f32_16x16x32_bf16 v[112:115], a[48:51], a[128:131], v[252:255]
    s_add_u32 s33, s33, 458752
    v_mfma_f32_16x16x32_bf16 v[112:115], a[52:55], a[132:135], v[112:115]
    s_waitcnt lgkmcnt(2)
    s_waitcnt vmcnt(17)
    s_barrier
    v_mfma_f32_16x16x32_bf16 v[140:143], a[52:55], a[140:143], v[252:255]
    ds_read_b128 a[120:123], v13 offset:10240
    s_add_u32 m0, s35, s40
    v_mfma_f32_16x16x32_bf16 v[140:143], a[48:51], a[136:139], v[140:143]
    ds_read_b64_tr_b16 a[56:57], v15 offset:28672
    buffer_load_dwordx4 v2, s[4:7], s31 offen offset:0 lds
    v_mfma_f32_16x16x32_bf16 v[136:139], a[40:43], a[136:139], v[248:251]
    ds_read_b128 a[124:127], v14 offset:10240
    v_mfma_f32_16x16x32_bf16 v[136:139], a[44:47], a[140:143], v[136:139]
    ds_read_b64_tr_b16 a[58:59], v15 offset:30464
    v_mfma_f32_16x16x32_bf16 v[132:135], a[36:39], a[140:143], v[244:247]
    ds_read_b64_tr_b16 a[60:61], v15 offset:43008
    v_mfma_f32_16x16x32_bf16 v[132:135], a[32:35], a[136:139], v[132:135]
    ds_read_b64_tr_b16 a[62:63], v15 offset:44800
    v_mfma_f32_16x16x32_bf16 v[128:131], a[24:27], a[136:139], v[240:243]
    ds_read_b64_tr_b16 a[64:65], v16 offset:28704
    v_mfma_f32_16x16x32_bf16 v[128:131], a[28:31], a[140:143], v[128:131]
    ds_read_b64_tr_b16 a[66:67], v16 offset:30496
    buffer_load_dwordx4 v3, s[4:7], s31 offen offset:1024 lds
    v_mfma_f32_16x16x32_bf16 v[124:127], a[20:23], a[140:143], v[236:239]
    ds_read_b64_tr_b16 a[68:69], v16 offset:43040
    v_mfma_f32_16x16x32_bf16 v[124:127], a[16:19], a[136:139], v[124:127]
    v_mfma_f32_16x16x32_bf16 v[120:123], a[8:11], a[136:139], v[232:235]
    ds_read_b64_tr_b16 a[70:71], v16 offset:44832
    v_mfma_f32_16x16x32_bf16 v[120:123], a[12:15], a[140:143], v[120:123]
    ds_read_b64_tr_b16 a[72:73], v15 offset:28736
    buffer_load_dwordx4 v4, s[4:7], s31 offen offset:2048 lds
    v_mfma_f32_16x16x32_bf16 v[116:119], a[4:7], a[140:143], v[228:231]
    ds_read_b64_tr_b16 a[74:75], v15 offset:30528
    v_mfma_f32_16x16x32_bf16 v[116:119], a[0:3], a[136:139], v[116:119]
    s_waitcnt lgkmcnt(12)
    ds_read_b64_tr_b16 a[76:77], v15 offset:43072
    v_mfma_f32_16x16x32_bf16 v[144:147], a[0:3], a[112:115], v[228:231]
    ds_read_b128 a[128:131], v13 offset:12288
    v_mfma_f32_16x16x32_bf16 v[144:147], a[4:7], a[116:119], v[144:147]
    ds_read_b64_tr_b16 a[78:79], v15 offset:44864
    v_mfma_f32_16x16x32_bf16 v[148:151], a[12:15], a[116:119], v[232:235]
    ds_read_b128 a[132:135], v14 offset:12288
    v_mfma_f32_16x16x32_bf16 v[148:151], a[8:11], a[112:115], v[148:151]
    ds_read_b64_tr_b16 a[80:81], v16 offset:28768
    buffer_load_dwordx4 v5, s[4:7], s31 offen offset:3072 lds
    v_mfma_f32_16x16x32_bf16 v[152:155], a[16:19], a[112:115], v[236:239]
    ds_read_b64_tr_b16 a[82:83], v16 offset:30560
    v_mfma_f32_16x16x32_bf16 v[152:155], a[20:23], a[116:119], v[152:155]
    v_mfma_f32_16x16x32_bf16 v[156:159], a[28:31], a[116:119], v[240:243]
    ds_read_b64_tr_b16 a[84:85], v16 offset:43104
    s_add_u32 m0, s35, s41
    v_mfma_f32_16x16x32_bf16 v[156:159], a[24:27], a[112:115], v[156:159]
    ds_read_b64_tr_b16 a[86:87], v16 offset:44896
    buffer_load_dwordx4 v2, s[4:7], s32 offen offset:0 lds
    v_mfma_f32_16x16x32_bf16 v[160:163], a[32:35], a[112:115], v[244:247]
    ds_read_b64_tr_b16 a[88:89], v15 offset:28800
    v_mfma_f32_16x16x32_bf16 v[160:163], a[36:39], a[116:119], v[160:163]
    ds_read_b64_tr_b16 a[90:91], v15 offset:30592
    v_mfma_f32_16x16x32_bf16 v[164:167], a[44:47], a[116:119], v[248:251]
    ds_read_b64_tr_b16 a[92:93], v15 offset:43136
L_pg1:
    s_cbranch_execz L_tramp
    v_mfma_f32_16x16x32_bf16 v[164:167], a[40:43], a[112:115], v[164:167]
    ds_read_b64_tr_b16 a[94:95], v15 offset:44928
    v_mfma_f32_16x16x32_bf16 v[168:171], a[48:51], a[112:115], v[252:255]
    ds_read_b64_tr_b16 a[96:97], v16 offset:28832
    v_mfma_f32_16x16x32_bf16 v[168:171], a[52:55], a[116:119], v[168:171]
    s_waitcnt lgkmcnt(14)
    buffer_load_dwordx4 v3, s[4:7], s32 offen offset:1024 lds
    v_mfma_f32_16x16x32_bf16 v[196:199], a[52:55], a[124:127], v[252:255]
    ds_read_b128 a[136:139], v13 offset:14336
    v_mfma_f32_16x16x32_bf16 v[196:199], a[48:51], a[120:123], v[196:199]
    ds_read_b64_tr_b16 a[98:99], v16 offset:30624
    v_mfma_f32_16x16x32_bf16 v[192:195], a[40:43], a[120:123], v[248:251]
    ds_read_b128 a[140:143], v14 offset:14336
    v_mfma_f32_16x16x32_bf16 v[192:195], a[44:47], a[124:127], v[192:195]
    ds_read_b64_tr_b16 a[100:101], v16 offset:43168
    buffer_load_dwordx4 v4, s[4:7], s32 offen offset:2048 lds
    v_mfma_f32_16x16x32_bf16 v[188:191], a[36:39], a[124:127], v[244:247]
    ds_read_b64_tr_b16 a[102:103], v16 offset:44960
    v_mfma_f32_16x16x32_bf16 v[188:191], a[32:35], a[120:123], v[188:191]
    ds_read_b64_tr_b16 a[104:105], v17 offset:28672
    v_mfma_f32_16x16x32_bf16 v[184:187], a[24:27], a[120:123], v[240:243]
    ds_read_b64_tr_b16 a[106:107], v17 offset:30464
    v_mfma_f32_16x16x32_bf16 v[184:187], a[28:31], a[124:127], v[184:187]
    ds_read_b64_tr_b16 a[108:109], v17 offset:43008
    v_mfma_f32_16x16x32_bf16 v[180:183], a[20:23], a[124:127], v[236:239]
    ds_read_b64_tr_b16 a[110:111], v17 offset:44800
    v_mfma_f32_16x16x32_bf16 v[180:183], a[16:19], a[120:123], v[180:183]
    buffer_load_dwordx4 v5, s[4:7], s32 offen offset:3072 lds
    v_mfma_f32_16x16x32_bf16 v[176:179], a[8:11], a[120:123], v[232:235]
    s_add_u32 s31, s31, 128
    s_add_u32 s32, s32, 128
    s_mov_b32 s35, 0x8000
    s_mov_b32 s34, 0x10000
    v_mfma_f32_16x16x32_bf16 v[176:179], a[12:15], a[124:127], v[176:179]
    v_add_u32 v13, 0x8000, v13
    v_mfma_f32_16x16x32_bf16 v[172:175], a[4:7], a[124:127], v[228:231]
    v_add_u32 v14, 0x8000, v14
    v_mfma_f32_16x16x32_bf16 v[172:175], a[0:3], a[120:123], v[172:175]
    s_mov_b32 s39, 0
    s_mov_b32 s43, 3
    s_waitcnt vmcnt(8)
    s_waitcnt lgkmcnt(0)
    s_barrier
.p2align 6
L_loopF:
    v_mfma_f32_16x16x32_bf16 v[200:203], a[0:3], a[128:131], v[200:203]
    ds_read_b128 a[112:115], v13 offset:0
    s_add_u32 m0, s42, 126976
    v_mfma_f32_16x16x32_bf16 v[200:203], a[4:7], a[132:135], v[200:203]
    buffer_load_dwordx4 v6, s[8:11], s33 offen offset:0 lds
    v_mfma_f32_16x16x32_bf16 v[204:207], a[12:15], a[132:135], v[204:207]
    ds_read_b128 a[116:119], v14 offset:0
    v_mfma_f32_16x16x32_bf16 v[204:207], a[8:11], a[128:131], v[204:207]
    v_mfma_f32_16x16x32_bf16 v[208:211], a[16:19], a[128:131], v[208:211]
    v_mfma_f32_16x16x32_bf16 v[208:211], a[20:23], a[132:135], v[208:211]
    buffer_load_dwordx4 v7, s[8:11], s33 offen offset:1024 lds
    v_mfma_f32_16x16x32_bf16 v[212:215], a[28:31], a[132:135], v[212:215]
    v_mfma_f32_16x16x32_bf16 v[212:215], a[24:27], a[128:131], v[212:215]
    v_mfma_f32_16x16x32_bf16 v[216:219], a[32:35], a[128:131], v[216:219]
    v_mfma_f32_16x16x32_bf16 v[216:219], a[36:39], a[132:135], v[216:219]
    buffer_load_dwordx4 v8, s[8:11], s33 offen offset:2048 lds
    v_mfma_f32_16x16x32_bf16 v[220:223], a[44:47], a[132:135], v[220:223]
    v_mfma_f32_16x16x32_bf16 v[220:223], a[40:43], a[128:131], v[220:223]
    v_mfma_f32_16x16x32_bf16 v[224:227], a[48:51], a[128:131], v[224:227]
    v_mfma_f32_16x16x32_bf16 v[224:227], a[52:55], a[132:135], v[224:227]
    buffer_load_dwordx4 v9, s[8:11], s33 offen offset:3072 lds
    v_mfma_f32_16x16x32_bf16 v[252:255], a[52:55], a[140:143], v[252:255]
    ds_read_b128 a[120:123], v13 offset:2048
    v_mfma_f32_16x16x32_bf16 v[252:255], a[48:51], a[136:139], v[252:255]
    v_mfma_f32_16x16x32_bf16 v[248:251], a[40:43], a[136:139], v[248:251]
    ds_read_b128 a[124:127], v14 offset:2048
    v_mfma_f32_16x16x32_bf16 v[248:251], a[44:47], a[140:143], v[248:251]
    v_mfma_f32_16x16x32_bf16 v[244:247], a[36:39], a[140:143], v[244:247]
    s_add_u32 m0, s42, 131072
    v_mfma_f32_16x16x32_bf16 v[244:247], a[32:35], a[136:139], v[244:247]
    buffer_load_dwordx4 v10, s[8:11], s33 offen offset:0 lds
    v_mfma_f32_16x16x32_bf16 v[240:243], a[24:27], a[136:139], v[240:243]
    v_mfma_f32_16x16x32_bf16 v[240:243], a[28:31], a[140:143], v[240:243]
    v_mfma_f32_16x16x32_bf16 v[236:239], a[20:23], a[140:143], v[236:239]
    v_mfma_f32_16x16x32_bf16 v[236:239], a[16:19], a[136:139], v[236:239]
    buffer_load_dwordx4 v11, s[8:11], s33 offen offset:1024 lds
    v_mfma_f32_16x16x32_bf16 v[232:235], a[8:11], a[136:139], v[232:235]
    v_mfma_f32_16x16x32_bf16 v[232:235], a[12:15], a[140:143], v[232:235]
    v_mfma_f32_16x16x32_bf16 v[228:231], a[4:7], a[140:143], v[228:231]
    v_mfma_f32_16x16x32_bf16 v[228:231], a[0:3], a[136:139], v[228:231]
    s_waitcnt lgkmcnt(2)
    buffer_load_dwordx4 v12, s[8:11], s33 offen offset:2048 lds
    v_mfma_f32_16x16x32_bf16 v[32:35], a[56:59], a[112:115], v[32:35]
    ds_read_b128 a[128:131], v13 offset:4096
    s_add_u32 s33, s33, 458752
    v_mfma_f32_16x16x32_bf16 v[32:35], a[60:63], a[116:119], v[32:35]
    ds_read_b64_tr_b16 a[0:1], v15 offset:0
    v_mfma_f32_16x16x32_bf16 v[36:39], a[68:71], a[116:119], v[36:39]
    ds_read_b128 a[132:135], v14 offset:4096
    v_mfma_f32_16x16x32_bf16 v[36:39], a[64:67], a[112:115], v[36:39]
    buffer_load_dword v31, v29, s[16:19], s52 offen
    v_mfma_f32_16x16x32_bf16 v[40:43], a[72:75], a[112:115], v[40:43]
    ds_read_b64_tr_b16 a[2:3], v15 offset:1792
    s_add_u32 s52, s52, s37
    v_mfma_f32_16x16x32_bf16 v[40:43], a[76:79], a[116:119], v[40:43]
    v_mfma_f32_16x16x32_bf16 v[44:47], a[84:87], a[116:119], v[44:47]
    ds_read_b64_tr_b16 a[4:5], v15 offset:14336
    v_mfma_f32_16x16x32_bf16 v[44:47], a[80:83], a[112:115], v[44:47]
    buffer_load_dword v31, v28, s[20:23], s53 offen
    v_mfma_f32_16x16x32_bf16 v[48:51], a[88:91], a[112:115], v[48:51]
    ds_read_b64_tr_b16 a[6:7], v15 offset:16128
    s_add_u32 s53, s53, s38
    v_mfma_f32_16x16x32_bf16 v[48:51], a[92:95], a[116:119], v[48:51]
    v_mfma_f32_16x16x32_bf16 v[52:55], a[100:103], a[116:119], v[52:55]
    ds_read_b64_tr_b16 a[8:9], v16 offset:32
    v_mfma_f32_16x16x32_bf16 v[52:55], a[96:99], a[112:115], v[52:55]
    v_mfma_f32_16x16x32_bf16 v[56:59], a[104:107], a[112:115], v[56:59]
    ds_read_b64_tr_b16 a[10:11], v16 offset:1824
    s_add_u32 m0, s35, s40
    v_mfma_f32_16x16x32_bf16 v[56:59], a[108:111], a[116:119], v[56:59]
    s_waitcnt lgkmcnt(8)
    ds_read_b64_tr_b16 a[12:13], v16 offset:14368
    buffer_load_dwordx4 v2, s[4:7], s31 offen offset:0 lds
    v_mfma_f32_16x16x32_bf16 v[84:87], a[108:111], a[124:127], v[84:87]
    ds_read_b128 a[136:139], v13 offset:6144
    v_mfma_f32_16x16x32_bf16 v[84:87], a[104:107], a[120:123], v[84:87]
    v_mfma_f32_16x16x32_bf16 v[80:83], a[96:99], a[120:123], v[80:83]
    ds_read_b128 a[140:143], v14 offset:6144
    v_mfma_f32_16x16x32_bf16 v[80:83], a[100:103], a[124:127], v[80:83]
    v_mfma_f32_16x16x32_bf16 v[76:79], a[92:95], a[124:127], v[76:79]
    ds_read_b64_tr_b16 a[14:15], v16 offset:16160
    v_mfma_f32_16x16x32_bf16 v[76:79], a[88:91], a[120:123], v[76:79]
    v_mfma_f32_16x16x32_bf16 v[72:75], a[80:83], a[120:123], v[72:75]
    ds_read_b64_tr_b16 a[16:17], v15 offset:64
    v_mfma_f32_16x16x32_bf16 v[72:75], a[84:87], a[124:127], v[72:75]
    buffer_load_dwordx4 v3, s[4:7], s31 offen offset:1024 lds
    v_mfma_f32_16x16x32_bf16 v[68:71], a[76:79], a[124:127], v[68:71]
    ds_read_b64_tr_b16 a[18:19], v15 offset:1856
    v_mfma_f32_16x16x32_bf16 v[68:71], a[72:75], a[120:123], v[68:71]
    v_mfma_f32_16x16x32_bf16 v[64:67], a[64:67], a[120:123], v[64:67]
    ds_read_b64_tr_b16 a[20:21], v15 offset:14400
    v_mfma_f32_16x16x32_bf16 v[64:67], a[68:71], a[124:127], v[64:67]
    v_mfma_f32_16x16x32_bf16 v[60:63], a[60:63], a[124:127], v[60:63]
    ds_read_b64_tr_b16 a[22:23], v15 offset:16192
    v_mfma_f32_16x16x32_bf16 v[60:63], a[56:59], a[120:123], v[60:63]
    s_waitcnt lgkmcnt(13)
    v_mfma_f32_16x16x32_bf16 v[88:91], a[56:59], a[128:131], v[88:91]
    ds_read_b128 a[112:115], v13 offset:8192
    v_mfma_f32_16x16x32_bf16 v[88:91], a[60:63], a[132:135], v[88:91]
    ds_read_b64_tr_b16 a[24:25], v16 offset:96
    buffer_load_dwordx4 v4, s[4:7], s31 offen offset:2048 lds
    v_mfma_f32_16x16x32_bf16 v[92:95], a[68:71], a[132:135], v[92:95]
    ds_read_b128 a[116:119], v14 offset:8192
    v_mfma_f32_16x16x32_bf16 v[92:95], a[64:67], a[128:131], v[92:95]
    v_mfma_f32_16x16x32_bf16 v[96:99], a[72:75], a[128:131], v[96:99]
    ds_read_b64_tr_b16 a[26:27], v16 offset:1888
    v_mfma_f32_16x16x32_bf16 v[96:99], a[76:79], a[132:135], v[96:99]
    v_mfma_f32_16x16x32_bf16 v[100:103], a[84:87], a[132:135], v[100:103]
    ds_read_b64_tr_b16 a[28:29], v16 offset:14432
    v_mfma_f32_16x16x32_bf16 v[100:103], a[80:83], a[128:131], v[100:103]
    v_mfma_f32_16x16x32_bf16 v[104:107], a[88:91], a[128:131], v[104:107]
    ds_read_b64_tr_b16 a[30:31], v16 offset:16224
    v_mfma_f32_16x16x32_bf16 v[104:107], a[92:95], a[132:135], v[104:107]
    buffer_load_dwordx4 v5, s[4:7], s31 offen offset:3072 lds
    v_mfma_f32_16x16x32_bf16 v[108:111], a[100:103], a[132:135], v[108:111]
    ds_read_b64_tr_b16 a[32:33], v15 offset:128
    v_mfma_f32_16x16x32_bf16 v[108:111], a[96:99], a[128:131], v[108:111]
    v_mfma_f32_16x16x32_bf16 v[112:115], a[104:107], a[128:131], v[112:115]
    ds_read_b64_tr_b16 a[34:35], v15 offset:1920
    v_mfma_f32_16x16x32_bf16 v[112:115], a[108:111], a[132:135], v[112:115]
    s_waitcnt lgkmcnt(13)
    ds_read_b64_tr_b16 a[36:37], v15 offset:14464
    v_mfma_f32_16x16x32_bf16 v[140:143], a[108:111], a[140:143], v[140:143]
    ds_read_b128 a[120:123], v13 offset:10240
    v_mfma_f32_16x16x32_bf16 v[140:143], a[104:107], a[136:139], v[140:143]
    v_mfma_f32_16x16x32_bf16 v[136:139], a[96:99], a[136:139], v[136:139]
    ds_read_b128 a[124:127], v14 offset:10240
    v_mfma_f32_16x16x32_bf16 v[136:139], a[100:103], a[140:143], v[136:139]
    v_mfma_f32_16x16x32_bf16 v[132:135], a[92:95], a[140:143], v[132:135]
    ds_read_b64_tr_b16 a[38:39], v15 offset:16256
    s_add_u32 m0, s35, s41
    v_mfma_f32_16x16x32_bf16 v[132:135], a[88:91], a[136:139], v[132:135]
    buffer_load_dwordx4 v2, s[4:7], s32 offen offset:0 lds
    v_mfma_f32_16x16x32_bf16 v[128:131], a[80:83], a[136:139], v[128:131]
    ds_read_b64_tr_b16 a[40:41], v16 offset:160
    v_mfma_f32_16x16x32_bf16 v[128:131], a[84:87], a[140:143], v[128:131]
    v_mfma_f32_16x16x32_bf16 v[124:127], a[76:79], a[140:143], v[124:127]
    ds_read_b64_tr_b16 a[42:43], v16 offset:1952
    v_mfma_f32_16x16x32_bf16 v[124:127], a[72:75], a[136:139], v[124:127]
    v_mfma_f32_16x16x32_bf16 v[120:123], a[64:67], a[136:139], v[120:123]
    ds_read_b64_tr_b16 a[44:45], v16 offset:14496
    v_mfma_f32_16x16x32_bf16 v[120:123], a[68:71], a[140:143], v[120:123]
    v_mfma_f32_16x16x32_bf16 v[116:119], a[60:63], a[140:143], v[116:119]
    ds_read_b64_tr_b16 a[46:47], v16 offset:16288
    v_mfma_f32_16x16x32_bf16 v[116:119], a[56:59], a[136:139], v[116:119]
    s_waitcnt lgkmcnt(13)
    buffer_load_dwordx4 v3, s[4:7], s32 offen offset:1024 lds
    v_mfma_f32_16x16x32_bf16 v[144:147], a[56:59], a[112:115], v[144:147]
    ds_read_b128 a[128:131], v13 offset:12288
    v_mfma_f32_16x16x32_bf16 v[144:147], a[60:63], a[116:119], v[144:147]
    ds_read_b64_tr_b16 a[48:49], v17 offset:0
    v_mfma_f32_16x16x32_bf16 v[148:151], a[68:71], a[116:119], v[148:151]
    ds_read_b128 a[132:135], v14 offset:12288
    v_mfma_f32_16x16x32_bf16 v[148:151], a[64:67], a[112:115], v[148:151]
    v_mfma_f32_16x16x32_bf16 v[152:155], a[72:75], a[112:115], v[152:155]
    ds_read_b64_tr_b16 a[50:51], v17 offset:1792
    v_mfma_f32_16x16x32_bf16 v[152:155], a[76:79], a[116:119], v[152:155]
    v_mfma_f32_16x16x32_bf16 v[156:159], a[84:87], a[116:119], v[156:159]
    ds_read_b64_tr_b16 a[52:53], v17 offset:14336
    v_mfma_f32_16x16x32_bf16 v[156:159], a[80:83], a[112:115], v[156:159]
    buffer_load_dwordx4 v4, s[4:7], s32 offen offset:2048 lds
    v_mfma_f32_16x16x32_bf16 v[160:163], a[88:91], a[112:115], v[160:163]
    ds_read_b64_tr_b16 a[54:55], v17 offset:16128
    v_mfma_f32_16x16x32_bf16 v[160:163], a[92:95], a[116:119], v[160:163]
    v_mfma_f32_16x16x32_bf16 v[164:167], a[100:103], a[116:119], v[164:167]
    v_mfma_f32_16x16x32_bf16 v[164:167], a[96:99], a[112:115], v[164:167]
    v_mfma_f32_16x16x32_bf16 v[168:171], a[104:107], a[112:115], v[168:171]
    v_mfma_f32_16x16x32_bf16 v[168:171], a[108:111], a[116:119], v[168:171]
    s_waitcnt lgkmcnt(11)
    v_mfma_f32_16x16x32_bf16 v[196:199], a[108:111], a[124:127], v[196:199]
    ds_read_b128 a[136:139], v13 offset:14336
    v_mfma_f32_16x16x32_bf16 v[196:199], a[104:107], a[120:123], v[196:199]
    buffer_load_dwordx4 v5, s[4:7], s32 offen offset:3072 lds
    v_mfma_f32_16x16x32_bf16 v[192:195], a[96:99], a[120:123], v[192:195]
    ds_read_b128 a[140:143], v14 offset:14336
    s_add_u32 s31, s31, 128
    s_add_u32 s32, s32, 128
    v_mfma_f32_16x16x32_bf16 v[192:195], a[100:103], a[124:127], v[192:195]
    v_mfma_f32_16x16x32_bf16 v[188:191], a[92:95], a[124:127], v[188:191]
    s_add_u32 s46, s34, 0x8000
    s_cmp_eq_u32 s46, 0x18000
    s_cselect_b32 s46, 0, s46
    v_mfma_f32_16x16x32_bf16 v[188:191], a[88:91], a[120:123], v[188:191]
    s_sub_u32 s36, s46, s34
    s_mov_b32 s35, s34
    v_mfma_f32_16x16x32_bf16 v[184:187], a[80:83], a[120:123], v[184:187]
    s_mov_b32 s34, s46
    v_add_u32 v13, s36, v13
    v_mfma_f32_16x16x32_bf16 v[184:187], a[84:87], a[124:127], v[184:187]
    v_add_u32 v14, s36, v14
    v_mfma_f32_16x16x32_bf16 v[180:183], a[76:79], a[124:127], v[180:183]
    v_mfma_f32_16x16x32_bf16 v[180:183], a[72:75], a[120:123], v[180:183]
    v_mfma_f32_16x16x32_bf16 v[176:179], a[64:67], a[120:123], v[176:179]
    v_mfma_f32_16x16x32_bf16 v[176:179], a[68:71], a[124:127], v[176:179]
    v_mfma_f32_16x16x32_bf16 v[172:175], a[60:63], a[124:127], v[172:175]
    v_mfma_f32_16x16x32_bf16 v[172:175], a[56:59], a[120:123], v[172:175]
    s_waitcnt vmcnt(10) lgkmcnt(0)
    s_barrier
    v_mfma_f32_16x16x32_bf16 v[200:203], a[56:59], a[128:131], v[200:203]
    ds_read_b128 a[112:115], v13 offset:0
    s_add_u32 m0, s42, 98304
    v_mfma_f32_16x16x32_bf16 v[200:203], a[60:63], a[132:135], v[200:203]
    buffer_load_dwordx4 v6, s[8:11], s33 offen offset:0 lds
    v_mfma_f32_16x16x32_bf16 v[204:207], a[68:71], a[132:135], v[204:207]
    ds_read_b128 a[116:119], v14 offset:0
    v_mfma_f32_16x16x32_bf16 v[204:207], a[64:67], a[128:131], v[204:207]
    v_mfma_f32_16x16x32_bf16 v[208:211], a[72:75], a[128:131], v[208:211]
    v_mfma_f32_16x16x32_bf16 v[208:211], a[76:79], a[132:135], v[208:211]
    buffer_load_dwordx4 v7, s[8:11], s33 offen offset:1024 lds
    v_mfma_f32_16x16x32_bf16 v[212:215], a[84:87], a[132:135], v[212:215]
    v_mfma_f32_16x16x32_bf16 v[212:215], a[80:83], a[128:131], v[212:215]
    v_mfma_f32_16x16x32_bf16 v[216:219], a[88:91], a[128:131], v[216:219]
    v_mfma_f32_16x16x32_bf16 v[216:219], a[92:95], a[132:135], v[216:219]
    buffer_load_dwordx4 v8, s[8:11], s33 offen offset:2048 lds
    v_mfma_f32_16x16x32_bf16 v[220:223], a[100:103], a[132:135], v[220:223]
    v_mfma_f32_16x16x32_bf16 v[220:223], a[96:99], a[128:131], v[220:223]
    v_mfma_f32_16x16x32_bf16 v[224:227], a[104:107], a[128:131], v[224:227]
    v_mfma_f32_16x16x32_bf16 v[224:227], a[108:111], a[132:135], v[224:227]
    buffer_load_dwordx4 v9, s[8:11], s33 offen offset:3072 lds
    v_mfma_f32_16x16x32_bf16 v[252:255], a[108:111], a[140:143], v[252:255]
    ds_read_b128 a[120:123], v13 offset:2048
    v_mfma_f32_16x16x32_bf16 v[252:255], a[104:107], a[136:139], v[252:255]
    v_mfma_f32_16x16x32_bf16 v[248:251], a[96:99], a[136:139], v[248:251]
    ds_read_b128 a[124:127], v14 offset:2048
    v_mfma_f32_16x16x32_bf16 v[248:251], a[100:103], a[140:143], v[248:251]
    v_mfma_f32_16x16x32_bf16 v[244:247], a[92:95], a[140:143], v[244:247]
    s_add_u32 m0, s42, 102400
    v_mfma_f32_16x16x32_bf16 v[244:247], a[88:91], a[136:139], v[244:247]
    buffer_load_dwordx4 v10, s[8:11], s33 offen offset:0 lds
    v_mfma_f32_16x16x32_bf16 v[240:243], a[80:83], a[136:139], v[240:243]
    v_mfma_f32_16x16x32_bf16 v[240:243], a[84:87], a[140:143], v[240:243]
    v_mfma_f32_16x16x32_bf16 v[236:239], a[76:79], a[140:143], v[236:239]
    v_mfma_f32_16x16x32_bf16 v[236:239], a[72:75], a[136:139], v[236:239]
    buffer_load_dwordx4 v11, s[8:11], s33 offen offset:1024 lds
    v_mfma_f32_16x16x32_bf16 v[232:235], a[64:67], a[136:139], v[232:235]
    v_mfma_f32_16x16x32_bf16 v[232:235], a[68:71], a[140:143], v[232:235]
    v_mfma_f32_16x16x32_bf16 v[228:231], a[60:63], a[140:143], v[228:231]
    v_mfma_f32_16x16x32_bf16 v[228:231], a[56:59], a[136:139], v[228:231]
    s_waitcnt lgkmcnt(2)
    buffer_load_dwordx4 v12, s[8:11], s33 offen offset:2048 lds
    v_mfma_f32_16x16x32_bf16 v[32:35], a[0:3], a[112:115], v[32:35]
    ds_read_b128 a[128:131], v13 offset:4096
    s_add_u32 s33, s33, 458752
    v_mfma_f32_16x16x32_bf16 v[32:35], a[4:7], a[116:119], v[32:35]
    ds_read_b64_tr_b16 a[56:57], v15 offset:28672
    v_mfma_f32_16x16x32_bf16 v[36:39], a[12:15], a[116:119], v[36:39]
    ds_read_b128 a[132:135], v14 offset:4096
    v_mfma_f32_16x16x32_bf16 v[36:39], a[8:11], a[112:115], v[36:39]
    buffer_load_dword v31, v29, s[16:19], s52 offen
    v_mfma_f32_16x16x32_bf16 v[40:43], a[16:19], a[112:115], v[40:43]
    ds_read_b64_tr_b16 a[58:59], v15 offset:30464
    s_add_u32 s52, s52, s37
    v_mfma_f32_16x16x32_bf16 v[40:43], a[20:23], a[116:119], v[40:43]
    v_mfma_f32_16x16x32_bf16 v[44:47], a[28:31], a[116:119], v[44:47]
    ds_read_b64_tr_b16 a[60:61], v15 offset:43008
    v_mfma_f32_16x16x32_bf16 v[44:47], a[24:27], a[112:115], v[44:47]
    buffer_load_dword v31, v28, s[20:23], s53 offen
    v_mfma_f32_16x16x32_bf16 v[48:51], a[32:35], a[112:115], v[48:51]
    ds_read_b64_tr_b16 a[62:63], v15 offset:44800
    s_add_u32 s53, s53, s38
    v_mfma_f32_16x16x32_bf16 v[48:51], a[36:39], a[116:119], v[48:51]
    v_mfma_f32_16x16x32_bf16 v[52:55], a[44:47], a[116:119], v[52:55]
    ds_read_b64_tr_b16 a[64:65], v16 offset:28704
    v_mfma_f32_16x16x32_bf16 v[52:55], a[40:43], a[112:115], v[52:55]
    v_mfma_f32_16x16x32_bf16 v[56:59], a[48:51], a[112:115], v[56:59]
    ds_read_b64_tr_b16 a[66:67], v16 offset:30496
    s_add_u32 m0, s35, s40
    v_mfma_f32_16x16x32_bf16 v[56:59], a[52:55], a[116:119], v[56:59]
    s_waitcnt lgkmcnt(8)
    ds_read_b64_tr_b16 a[68:69], v16 offset:43040
    buffer_load_dwordx4 v2, s[4:7], s31 offen offset:0 lds
    v_mfma_f32_16x16x32_bf16 v[84:87], a[52:55], a[124:127], v[84:87]
    ds_read_b128 a[136:139], v13 offset:6144
    v_mfma_f32_16x16x32_bf16 v[84:87], a[48:51], a[120:123], v[84:87]
    v_mfma_f32_16x16x32_bf16 v[80:83], a[40:43], a[120:123], v[80:83]
    ds_read_b128 a[140:143], v14 offset:6144
    v_mfma_f32_16x16x32_bf16 v[80:83], a[44:47], a[124:127], v[80:83]
    v_mfma_f32_16x16x32_bf16 v[76:79], a[36:39], a[124:127], v[76:79]
    ds_read_b64_tr_b16 a[70:71], v16 offset:44832
    v_mfma_f32_16x16x32_bf16 v[76:79], a[32:35], a[120:123], v[76:79]
    v_mfma_f32_16x16x32_bf16 v[72:75], a[24:27], a[120:123], v[72:75]
    ds_read_b64_tr_b16 a[72:73], v15 offset:28736
    v_mfma_f32_16x16x32_bf16 v[72:75], a[28:31], a[124:127], v[72:75]
    buffer_load_dwordx4 v3, s[4:7], s31 offen offset:1024 lds
    v_mfma_f32_16x16x32_bf16 v[68:71], a[20:23], a[124:127], v[68:71]
    ds_read_b64_tr_b16 a[74:75], v15 offset:30528
    v_mfma_f32_16x16x32_bf16 v[68:71], a[16:19], a[120:123], v[68:71]
    v_mfma_f32_16x16x32_bf16 v[64:67], a[8:11], a[120:123], v[64:67]
    ds_read_b64_tr_b16 a[76:77], v15 offset:43072
    v_mfma_f32_16x16x32_bf16 v[64:67], a[12:15], a[124:127], v[64:67]
    v_mfma_f32_16x16x32_bf16 v[60:63], a[4:7], a[124:127], v[60:63]
    ds_read_b64_tr_b16 a[78:79], v15 offset:44864
    v_mfma_f32_16x16x32_bf16 v[60:63], a[0:3], a[120:123], v[60:63]
    s_waitcnt lgkmcnt(13)
    v_mfma_f32_16x16x32_bf16 v[88:91], a[0:3], a[128:131], v[88:91]
    ds_read_b128 a[112:115], v13 offset:8192
    v_mfma_f32_16x16x32_bf16 v[88:91], a[4:7], a[132:135], v[88:91]
    ds_read_b64_tr_b16 a[80:81], v16 offset:28768
    buffer_load_dwordx4 v4, s[4:7], s31 offen offset:2048 lds
    v_mfma_f32_16x16x32_bf16 v[92:95], a[12:15], a[132:135], v[92:95]
    ds_read_b128 a[116:119], v14 offset:8192
    v_mfma_f32_16x16x32_bf16 v[92:95], a[8:11], a[128:131], v[92:95]
    v_mfma_f32_16x16x32_bf16 v[96:99], a[16:19], a[128:131], v[96:99]
    ds_read_b64_tr_b16 a[82:83], v16 offset:30560
    v_mfma_f32_16x16x32_bf16 v[96:99], a[20:23], a[132:135], v[96:99]
    v_mfma_f32_16x16x32_bf16 v[100:103], a[28:31], a[132:135], v[100:103]
    ds_read_b64_tr_b16 a[84:85], v16 offset:43104
    v_mfma_f32_16x16x32_bf16 v[100:103], a[24:27], a[128:131], v[100:103]
    v_mfma_f32_16x16x32_bf16 v[104:107], a[32:35], a[128:131], v[104:107]
    ds_read_b64_tr_b16 a[86:87], v16 offset:44896
    v_mfma_f32_16x16x32_bf16 v[104:107], a[36:39], a[132:135], v[104:107]
    buffer_load_dwordx4 v5, s[4:7], s31 offen offset:3072 lds
    v_mfma_f32_16x16x32_bf16 v[108:111], a[44:47], a[132:135], v[108:111]
    ds_read_b64_tr_b16 a[88:89], v15 offset:28800
    v_mfma_f32_16x16x32_bf16 v[108:111], a[40:43], a[128:131], v[108:111]
    v_mfma_f32_16x16x32_bf16 v[112:115], a[48:51], a[128:131], v[112:115]
    ds_read_b64_tr_b16 a[90:91], v15 offset:30592
    v_mfma_f32_16x16x32_bf16 v[112:115], a[52:55], a[132:135], v[112:115]
    s_waitcnt lgkmcnt(13)
    ds_read_b64_tr_b16 a[92:93], v15 offset:43136
    v_mfma_f32_16x16x32_bf16 v[140:143], a[52:55], a[140:143], v[140:143]
    ds_read_b128 a[120:123], v13 offset:10240
    v_mfma_f32_16x16x32_bf16 v[140:143], a[48:51], a[136:139], v[140:143]
    v_mfma_f32_16x16x32_bf16 v[136:139], a[40:43], a[136:139], v[136:139]
    ds_read_b128 a[124:127], v14 offset:10240
    v_mfma_f32_16x16x32_bf16 v[136:139], a[44:47], a[140:143], v[136:139]
    v_mfma_f32_16x16x32_bf16 v[132:135], a[36:39], a[140:143], v[132:135]
    ds_read_b64_tr_b16 a[94:95], v15 offset:44928
    s_add_u32 m0, s35, s41
    v_mfma_f32_16x16x32_bf16 v[132:135], a[32:35], a[136:139], v[132:135]
    buffer_load_dwordx4 v2, s[4:7], s32 offen offset:0 lds
    v_mfma_f32_16x16x32_bf16 v[128:131], a[24:27], a[136:139], v[128:131]
    ds_read_b64_tr_b16 a[96:97], v16 offset:28832
    v_mfma_f32_16x16x32_bf16 v[128:131], a[28:31], a[140:143], v[128:131]
    v_mfma_f32_16x16x32_bf16 v[124:127], a[20:23], a[140:143], v[124:127]
    ds_read_b64_tr_b16 a[98:99], v16 offset:30624
    v_mfma_f32_16x16x32_bf16 v[124:127], a[16:19], a[136:139], v[124:127]
    v_mfma_f32_16x16x32_bf16 v[120:123], a[8:11], a[136:139], v[120:123]
    ds_read_b64_tr_b16 a[100:101], v16 offset:43168
    v_mfma_f32_16x16x32_bf16 v[120:123], a[12:15], a[140:143], v[120:123]
    v_mfma_f32_16x16x32_bf16 v[116:119], a[4:7], a[140:143], v[116:119]
    ds_read_b64_tr_b16 a[102:103], v16 offset:44960
    v_mfma_f32_16x16x32_bf16 v[116:119], a[0:3], a[136:139], v[116:119]
    s_waitcnt lgkmcnt(13)
    buffer_load_dwordx4 v3, s[4:7], s32 offen offset:1024 lds
    v_mfma_f32_16x16x32_bf16 v[144:147], a[0:3], a[112:115], v[144:147]
    ds_read_b128 a[128:131], v13 offset:12288
    v_mfma_f32_16x16x32_bf16 v[144:147], a[4:7], a[116:119], v[144:147]
    ds_read_b64_tr_b16 a[104:105], v17 offset:28672
    v_mfma_f32_16x16x32_bf16 v[148:151], a[12:15], a[116:119], v[148:151]
    ds_read_b128 a[132:135], v14 offset:12288
    v_mfma_f32_16x16x32_bf16 v[148:151], a[8:11], a[112:115], v[148:151]
    v_mfma_f32_16x16x32_bf16 v[152:155], a[16:19], a[112:115], v[152:155]
    ds_read_b64_tr_b16 a[106:107], v17 offset:30464
    v_mfma_f32_16x16x32_bf16 v[152:155], a[20:23], a[116:119], v[152:155]
    v_mfma_f32_16x16x32_bf16 v[156:159], a[28:31], a[116:119], v[156:159]
    ds_read_b64_tr_b16 a[108:109], v17 offset:43008
    v_mfma_f32_16x16x32_bf16 v[156:159], a[24:27], a[112:115], v[156:159]
    buffer_load_dwordx4 v4, s[4:7], s32 offen offset:2048 lds
    v_mfma_f32_16x16x32_bf16 v[160:163], a[32:35], a[112:115], v[160:163]
    ds_read_b64_tr_b16 a[110:111], v17 offset:44800
    v_mfma_f32_16x16x32_bf16 v[160:163], a[36:39], a[116:119], v[160:163]
    v_mfma_f32_16x16x32_bf16 v[164:167], a[44:47], a[116:119], v[164:167]
    v_mfma_f32_16x16x32_bf16 v[164:167], a[40:43], a[112:115], v[164:167]
    v_mfma_f32_16x16x32_bf16 v[168:171], a[48:51], a[112:115], v[168:171]
    v_mfma_f32_16x16x32_bf16 v[168:171], a[52:55], a[116:119], v[168:171]
    s_waitcnt lgkmcnt(11)
    v_mfma_f32_16x16x32_bf16 v[196:199], a[52:55], a[124:127], v[196:199]
    ds_read_b128 a[136:139], v13 offset:14336
    v_mfma_f32_16x16x32_bf16 v[196:199], a[48:51], a[120:123], v[196:199]
    buffer_load_dwordx4 v5, s[4:7], s32 offen offset:3072 lds
    v_mfma_f32_16x16x32_bf16 v[192:195], a[40:43], a[120:123], v[192:195]
    ds_read_b128 a[140:143], v14 offset:14336
    s_add_u32 s31, s31, 128
    s_add_u32 s32, s32, 128
    v_mfma_f32_16x16x32_bf16 v[192:195], a[44:47], a[124:127], v[192:195]
    v_mfma_f32_16x16x32_bf16 v[188:191], a[36:39], a[124:127], v[188:191]
    s_add_u32 s46, s34, 0x8000
    s_cmp_eq_u32 s46, 0x18000
    s_cselect_b32 s46, 0, s46
    v_mfma_f32_16x16x32_bf16 v[188:191], a[32:35], a[120:123], v[188:191]
    s_sub_u32 s36, s46, s34
    s_mov_b32 s35, s34
    v_mfma_f32_16x16x32_bf16 v[184:187], a[24:27], a[120:123], v[184:187]
    s_mov_b32 s34, s46
    v_add_u32 v13, s36, v13
    v_mfma_f32_16x16x32_bf16 v[184:187], a[28:31], a[124:127], v[184:187]
    v_add_u32 v14, s36, v14
    v_mfma_f32_16x16x32_bf16 v[180:183], a[20:23], a[124:127], v[180:183]
    v_mfma_f32_16x16x32_bf16 v[180:183], a[16:19], a[120:123], v[180:183]
    v_mfma_f32_16x16x32_bf16 v[176:179], a[8:11], a[120:123], v[176:179]
    v_mfma_f32_16x16x32_bf16 v[176:179], a[12:15], a[124:127], v[176:179]
    s_add_u32 s39, s39, 1
    v_mfma_f32_16x16x32_bf16 v[172:175], a[4:7], a[124:127], v[172:175]
    s_cmp_lt_u32 s39, s43
    v_mfma_f32_16x16x32_bf16 v[172:175], a[0:3], a[120:123], v[172:175]
    s_waitcnt vmcnt(10) lgkmcnt(0)
    s_barrier
    s_cbranch_scc1 L_loopF
    s_cmp_eq_u32 s39, 6
    s_cbranch_scc1 L_doneF
    s_mov_b32 s43, 6
    s_mov_b64 s[16:17], s[64:65]
    s_mov_b32 s18, s66
    s_mov_b64 s[20:21], s[68:69]
    s_mov_b32 s22, s70
    s_lshr_b32 s44, s2, 0
    s_lshl2_add_u32 s44, s44, s28
    s_lshl_b32 s52, s44, 10
    s_mul_i32 s53, s44, 384
    s_mov_b32 s37, 0x100000
    s_mov_b32 s38, 0x60000
    v_lshlrev_b32 v29, 4, v1
    v_min_u32 v28, 2, v1
    v_lshlrev_b32 v28, 7, v28
    global_load_dword v31, v30, s[84:85]
    s_branch L_loopF
L_doneF:
    v_mfma_f32_16x16x32_bf16 v[200:203], a[0:3], a[128:131], v[200:203]
    ds_read_b128 a[112:115], v13 offset:0
    s_add_u32 m0, s42, 126976
    v_mfma_f32_16x16x32_bf16 v[200:203], a[4:7], a[132:135], v[200:203]
    buffer_load_dwordx4 v6, s[8:11], s33 offen offset:0 lds
    s_lshl_b32 s44, s30, 15
    s_lshl_b32 s45, s57, 8
    s_add_u32 s44, s44, s45
    v_mfma_f32_16x16x32_bf16 v[204:207], a[12:15], a[132:135], v[204:207]
    ds_read_b128 a[116:119], v14 offset:0
    v_mfma_f32_16x16x32_bf16 v[204:207], a[8:11], a[128:131], v[204:207]
    v_mfma_f32_16x16x32_bf16 v[208:211], a[16:19], a[128:131], v[208:211]
    v_mfma_f32_16x16x32_bf16 v[208:211], a[20:23], a[132:135], v[208:211]
    buffer_load_dwordx4 v7, s[8:11], s33 offen offset:1024 lds
    v_mfma_f32_16x16x32_bf16 v[212:215], a[28:31], a[132:135], v[212:215]
    v_mfma_f32_16x16x32_bf16 v[212:215], a[24:27], a[128:131], v[212:215]
    v_mfma_f32_16x16x32_bf16 v[216:219], a[32:35], a[128:131], v[216:219]
    v_mfma_f32_16x16x32_bf16 v[216:219], a[36:39], a[132:135], v[216:219]
    buffer_load_dwordx4 v8, s[8:11], s33 offen offset:2048 lds
    v_mfma_f32_16x16x32_bf16 v[220:223], a[44:47], a[132:135], v[220:223]
    v_lshrrev_b32 v22, 4, v1
    v_mfma_f32_16x16x32_bf16 v[220:223], a[40:43], a[128:131], v[220:223]
    v_mfma_f32_16x16x32_bf16 v[224:227], a[48:51], a[128:131], v[224:227]
    v_mfma_f32_16x16x32_bf16 v[224:227], a[52:55], a[132:135], v[224:227]
    buffer_load_dwordx4 v9, s[8:11], s33 offen offset:3072 lds
    v_mfma_f32_16x16x32_bf16 v[252:255], a[52:55], a[140:143], v[252:255]
    ds_read_b128 a[120:123], v13 offset:2048
    v_mfma_f32_16x16x32_bf16 v[252:255], a[48:51], a[136:139], v[252:255]
    v_mfma_f32_16x16x32_bf16 v[248:251], a[40:43], a[136:139], v[248:251]
    ds_read_b128 a[124:127], v14 offset:2048
    v_mfma_f32_16x16x32_bf16 v[248:251], a[44:47], a[140:143], v[248:251]
    v_mfma_f32_16x16x32_bf16 v[244:247], a[36:39], a[140:143], v[244:247]
    s_add_u32 m0, s42, 131072
    v_mfma_f32_16x16x32_bf16 v[244:247], a[32:35], a[136:139], v[244:247]
    buffer_load_dwordx4 v10, s[8:11], s33 offen offset:0 lds
    v_lshlrev_b32 v23, 1, v22
    v_mfma_f32_16x16x32_bf16 v[240:243], a[24:27], a[136:139], v[240:243]
    v_mfma_f32_16x16x32_bf16 v[240:243], a[28:31], a[140:143], v[240:243]
    v_mfma_f32_16x16x32_bf16 v[236:239], a[20:23], a[140:143], v[236:239]
    v_mfma_f32_16x16x32_bf16 v[236:239], a[16:19], a[136:139], v[236:239]
    buffer_load_dwordx4 v11, s[8:11], s33 offen offset:1024 lds
    v_mfma_f32_16x16x32_bf16 v[232:235], a[8:11], a[136:139], v[232:235]
    v_mfma_f32_16x16x32_bf16 v[232:235], a[12:15], a[140:143], v[232:235]
    v_mfma_f32_16x16x32_bf16 v[228:231], a[4:7], a[140:143], v[228:231]
    v_mfma_f32_16x16x32_bf16 v[228:231], a[0:3], a[136:139], v[228:231]
    s_waitcnt lgkmcnt(2)
    buffer_load_dwordx4 v12, s[8:11], s33 offen offset:2048 lds
    v_mfma_f32_16x16x32_bf16 v[32:35], a[56:59], a[112:115], v[32:35]
    ds_read_b128 a[128:131], v13 offset:4096
    s_add_u32 s33, s33, 458752
    v_and_b32 v24, 15, v1
    v_mfma_f32_16x16x32_bf16 v[32:35], a[60:63], a[116:119], v[32:35]
    ds_read_b64_tr_b16 a[0:1], v15 offset:0
    v_mfma_f32_16x16x32_bf16 v[36:39], a[68:71], a[116:119], v[36:39]
    ds_read_b128 a[132:135], v14 offset:4096
    v_mfma_f32_16x16x32_bf16 v[36:39], a[64:67], a[112:115], v[36:39]
    buffer_load_dword v31, v29, s[16:19], s52 offen
    v_mfma_f32_16x16x32_bf16 v[40:43], a[72:75], a[112:115], v[40:43]
    ds_read_b64_tr_b16 a[2:3], v15 offset:1792
    s_add_u32 s52, s52, s37
    v_mfma_f32_16x16x32_bf16 v[40:43], a[76:79], a[116:119], v[40:43]
    v_mfma_f32_16x16x32_bf16 v[44:47], a[84:87], a[116:119], v[44:47]
    ds_read_b64_tr_b16 a[4:5], v15 offset:14336
    v_mfma_f32_16x16x32_bf16 v[44:47], a[80:83], a[112:115], v[44:47]
    buffer_load_dword v31, v28, s[20:23], s53 offen
    v_mfma_f32_16x16x32_bf16 v[48:51], a[88:91], a[112:115], v[48:51]
    ds_read_b64_tr_b16 a[6:7], v15 offset:16128
    s_add_u32 s53, s53, s38
    v_mfma_f32_16x16x32_bf16 v[48:51], a[92:95], a[116:119], v[48:51]
    v_xor_b32 v23, v23, v24
    v_mfma_f32_16x16x32_bf16 v[52:55], a[100:103], a[116:119], v[52:55]
    ds_read_b64_tr_b16 a[8:9], v16 offset:32
    v_mfma_f32_16x16x32_bf16 v[52:55], a[96:99], a[112:115], v[52:55]
    v_mfma_f32_16x16x32_bf16 v[56:59], a[104:107], a[112:115], v[56:59]
    ds_read_b64_tr_b16 a[10:11], v16 offset:1824
    s_add_u32 m0, s35, s40
    v_mfma_f32_16x16x32_bf16 v[56:59], a[108:111], a[116:119], v[56:59]
    s_waitcnt lgkmcnt(8)
    ds_read_b64_tr_b16 a[12:13], v16 offset:14368
    buffer_load_dwordx4 v2, s[4:7], s31 offen offset:0 lds
L_pg2:
    s_cbranch_execz L_tramp
    v_mfma_f32_16x16x32_bf16 v[84:87], a[108:111], a[124:127], v[84:87]
    ds_read_b128 a[136:139], v13 offset:6144
    v_mfma_f32_16x16x32_bf16 v[84:87], a[104:107], a[120:123], v[84:87]
    v_mfma_f32_16x16x32_bf16 v[80:83], a[96:99], a[120:123], v[80:83]
    ds_read_b128 a[140:143], v14 offset:6144
    v_mfma_f32_16x16x32_bf16 v[80:83], a[100:103], a[124:127], v[80:83]
    v_mfma_f32_16x16x32_bf16 v[76:79], a[92:95], a[124:127], v[76:79]
    ds_read_b64_tr_b16 a[14:15], v16 offset:16160
    v_lshlrev_b32 v23, 4, v23
    v_mfma_f32_16x16x32_bf16 v[76:79], a[88:91], a[120:123], v[76:79]
    v_mfma_f32_16x16x32_bf16 v[72:75], a[80:83], a[120:123], v[72:75]
    ds_read_b64_tr_b16 a[16:17], v15 offset:64
    v_mfma_f32_16x16x32_bf16 v[72:75], a[84:87], a[124:127], v[72:75]
    buffer_load_dwordx4 v3, s[4:7], s31 offen offset:1024 lds
    v_mfma_f32_16x16x32_bf16 v[68:71], a[76:79], a[124:127], v[68:71]
    ds_read_b64_tr_b16 a[18:19], v15 offset:1856
    v_mfma_f32_16x16x32_bf16 v[68:71], a[72:75], a[120:123], v[68:71]
    v_mfma_f32_16x16x32_bf16 v[64:67], a[64:67], a[120:123], v[64:67]
    ds_read_b64_tr_b16 a[20:21], v15 offset:14400
    v_mfma_f32_16x16x32_bf16 v[64:67], a[68:71], a[124:127], v[64:67]
    v_mfma_f32_16x16x32_bf16 v[60:63], a[60:63], a[124:127], v[60:63]
    ds_read_b64_tr_b16 a[22:23], v15 offset:16192
    v_mfma_f32_16x16x32_bf16 v[60:63], a[56:59], a[120:123], v[60:63]
    s_waitcnt lgkmcnt(13)
    v_lshl_add_u32 v23, v22, 11, v23
    v_mfma_f32_16x16x32_bf16 v[88:91], a[56:59], a[128:131], v[88:91]
    ds_read_b128 a[112:115], v13 offset:8192
    v_mfma_f32_16x16x32_bf16 v[88:91], a[60:63], a[132:135], v[88:91]
    ds_read_b64_tr_b16 a[24:25], v16 offset:96
    buffer_load_dwordx4 v4, s[4:7], s31 offen offset:2048 lds
    v_mfma_f32_16x16x32_bf16 v[92:95], a[68:71], a[132:135], v[92:95]
    ds_read_b128 a[116:119], v14 offset:8192
    v_mfma_f32_16x16x32_bf16 v[92:95], a[64:67], a[128:131], v[92:95]
    v_mfma_f32_16x16x32_bf16 v[96:99], a[72:75], a[128:131], v[96:99]
    ds_read_b64_tr_b16 a[26:27], v16 offset:1888
    v_mfma_f32_16x16x32_bf16 v[96:99], a[76:79], a[132:135], v[96:99]
    v_mfma_f32_16x16x32_bf16 v[100:103], a[84:87], a[132:135], v[100:103]
    ds_read_b64_tr_b16 a[28:29], v16 offset:14432
    v_mfma_f32_16x16x32_bf16 v[100:103], a[80:83], a[128:131], v[100:103]
    v_mfma_f32_16x16x32_bf16 v[104:107], a[88:91], a[128:131], v[104:107]
    ds_read_b64_tr_b16 a[30:31], v16 offset:16224
    v_add_u32 v18, s44, v23
    v_mfma_f32_16x16x32_bf16 v[104:107], a[92:95], a[132:135], v[104:107]
    buffer_load_dwordx4 v5, s[4:7], s31 offen offset:3072 lds
    v_mfma_f32_16x16x32_bf16 v[108:111], a[100:103], a[132:135], v[108:111]
    ds_read_b64_tr_b16 a[32:33], v15 offset:128
    v_mfma_f32_16x16x32_bf16 v[108:111], a[96:99], a[128:131], v[108:111]
    v_mfma_f32_16x16x32_bf16 v[112:115], a[104:107], a[128:131], v[112:115]
    ds_read_b64_tr_b16 a[34:35], v15 offset:1920
    v_mfma_f32_16x16x32_bf16 v[112:115], a[108:111], a[132:135], v[112:115]
    s_waitcnt lgkmcnt(13)
    ds_read_b64_tr_b16 a[36:37], v15 offset:14464
    v_mfma_f32_16x16x32_bf16 v[140:143], a[108:111], a[140:143], v[140:143]
    ds_read_b128 a[120:123], v13 offset:10240
    v_mfma_f32_16x16x32_bf16 v[140:143], a[104:107], a[136:139], v[140:143]
    v_mfma_f32_16x16x32_bf16 v[136:139], a[96:99], a[136:139], v[136:139]
    ds_read_b128 a[124:127], v14 offset:10240
    v_mfma_f32_16x16x32_bf16 v[136:139], a[100:103], a[140:143], v[136:139]
    v_xor_b32 v23, 128, v18
    v_mfma_f32_16x16x32_bf16 v[132:135], a[92:95], a[140:143], v[132:135]
    ds_read_b64_tr_b16 a[38:39], v15 offset:16256
    s_add_u32 m0, s35, s41
    v_mfma_f32_16x16x32_bf16 v[132:135], a[88:91], a[136:139], v[132:135]
    buffer_load_dwordx4 v2, s[4:7], s32 offen offset:0 lds
    v_mfma_f32_16x16x32_bf16 v[128:131], a[80:83], a[136:139], v[128:131]
    ds_read_b64_tr_b16 a[40:41], v16 offset:160
    v_mfma_f32_16x16x32_bf16 v[128:131], a[84:87], a[140:143], v[128:131]
    v_mfma_f32_16x16x32_bf16 v[124:127], a[76:79], a[140:143], v[124:127]
    ds_read_b64_tr_b16 a[42:43], v16 offset:1952
    v_mfma_f32_16x16x32_bf16 v[124:127], a[72:75], a[136:139], v[124:127]
    v_mfma_f32_16x16x32_bf16 v[120:123], a[64:67], a[136:139], v[120:123]
    ds_read_b64_tr_b16 a[44:45], v16 offset:14496
    v_mfma_f32_16x16x32_bf16 v[120:123], a[68:71], a[140:143], v[120:123]
    v_mfma_f32_16x16x32_bf16 v[116:119], a[60:63], a[140:143], v[116:119]
    ds_read_b64_tr_b16 a[46:47], v16 offset:16288
    v_add_u32 v19, 7168, v23
    v_mfma_f32_16x16x32_bf16 v[116:119], a[56:59], a[136:139], v[116:119]
    s_waitcnt lgkmcnt(13)
    buffer_load_dwordx4 v3, s[4:7], s32 offen offset:1024 lds
    v_mfma_f32_16x16x32_bf16 v[144:147], a[56:59], a[112:115], v[144:147]
    ds_read_b128 a[128:131], v13 offset:12288
    v_mfma_f32_16x16x32_bf16 v[144:147], a[60:63], a[116:119], v[144:147]
    ds_read_b64_tr_b16 a[48:49], v17 offset:0
    v_mfma_f32_16x16x32_bf16 v[148:151], a[68:71], a[116:119], v[148:151]
    ds_read_b128 a[132:135], v14 offset:12288
    v_mfma_f32_16x16x32_bf16 v[148:151], a[64:67], a[112:115], v[148:151]
    v_mfma_f32_16x16x32_bf16 v[152:155], a[72:75], a[112:115], v[152:155]
    ds_read_b64_tr_b16 a[50:51], v17 offset:1792
    v_mfma_f32_16x16x32_bf16 v[152:155], a[76:79], a[116:119], v[152:155]
    v_mfma_f32_16x16x32_bf16 v[156:159], a[84:87], a[116:119], v[156:159]
    ds_read_b64_tr_b16 a[52:53], v17 offset:14336
    v_mfma_f32_16x16x32_bf16 v[156:159], a[80:83], a[112:115], v[156:159]
    buffer_load_dwordx4 v4, s[4:7], s32 offen offset:2048 lds
    v_add_u32 v20, 14336, v18
    v_mfma_f32_16x16x32_bf16 v[160:163], a[88:91], a[112:115], v[160:163]
    ds_read_b64_tr_b16 a[54:55], v17 offset:16128
    v_mfma_f32_16x16x32_bf16 v[160:163], a[92:95], a[116:119], v[160:163]
    v_mfma_f32_16x16x32_bf16 v[164:167], a[100:103], a[116:119], v[164:167]
    v_mfma_f32_16x16x32_bf16 v[164:167], a[96:99], a[112:115], v[164:167]
    v_mfma_f32_16x16x32_bf16 v[168:171], a[104:107], a[112:115], v[168:171]
    v_mfma_f32_16x16x32_bf16 v[168:171], a[108:111], a[116:119], v[168:171]
    s_waitcnt lgkmcnt(11)
    v_mfma_f32_16x16x32_bf16 v[196:199], a[108:111], a[124:127], v[196:199]
    ds_read_b128 a[136:139], v13 offset:14336
    v_mfma_f32_16x16x32_bf16 v[196:199], a[104:107], a[120:123], v[196:199]
    buffer_load_dwordx4 v5, s[4:7], s32 offen offset:3072 lds
    v_mfma_f32_16x16x32_bf16 v[192:195], a[96:99], a[120:123], v[192:195]
    ds_read_b128 a[140:143], v14 offset:14336
    s_add_u32 s31, s31, 128
    s_add_u32 s32, s32, 128
    v_add_u32 v21, 21504, v23
    v_mfma_f32_16x16x32_bf16 v[192:195], a[100:103], a[124:127], v[192:195]
    v_mfma_f32_16x16x32_bf16 v[188:191], a[92:95], a[124:127], v[188:191]
    s_add_u32 s46, s34, 0x8000
    s_cmp_eq_u32 s46, 0x18000
    s_cselect_b32 s46, 0, s46
    v_mfma_f32_16x16x32_bf16 v[188:191], a[88:91], a[120:123], v[188:191]
    s_sub_u32 s36, s46, s34
    s_mov_b32 s35, s34
    v_mfma_f32_16x16x32_bf16 v[184:187], a[80:83], a[120:123], v[184:187]
    s_mov_b32 s34, s46
    v_add_u32 v13, s36, v13
    v_mfma_f32_16x16x32_bf16 v[184:187], a[84:87], a[124:127], v[184:187]
    v_add_u32 v14, s36, v14
    v_mfma_f32_16x16x32_bf16 v[180:183], a[76:79], a[124:127], v[180:183]
    v_mfma_f32_16x16x32_bf16 v[180:183], a[72:75], a[120:123], v[180:183]
    v_mfma_f32_16x16x32_bf16 v[176:179], a[64:67], a[120:123], v[176:179]
    v_mfma_f32_16x16x32_bf16 v[176:179], a[68:71], a[124:127], v[176:179]
    v_mfma_f32_16x16x32_bf16 v[172:175], a[60:63], a[124:127], v[172:175]
    v_mfma_f32_16x16x32_bf16 v[172:175], a[56:59], a[120:123], v[172:175]
    s_waitcnt vmcnt(10) lgkmcnt(0)
    s_barrier
    v_mov_b64 v[2:3], v[18:19]
    v_mov_b64 v[4:5], v[20:21]
    v_mfma_f32_16x16x32_bf16 v[200:203], a[56:59], a[128:131], v[200:203]
    ds_read_b128 a[112:115], v13 offset:0
    v_mov_b32 v11, 0
    v_mfma_f32_16x16x32_bf16 v[200:203], a[60:63], a[132:135], v[200:203]
    s_mul_i32 s44, s30, 24576
    v_mfma_f32_16x16x32_bf16 v[204:207], a[68:71], a[132:135], v[204:207]
    ds_read_b128 a[116:119], v14 offset:0
    v_subrev_u32 v18, s44, v18
    v_mfma_f32_16x16x32_bf16 v[204:207], a[64:67], a[128:131], v[204:207]
    global_load_dword v31, v30, s[84:85]
    s_sub_u32 s44, s44, 8192
    v_mfma_f32_16x16x32_bf16 v[208:211], a[72:75], a[128:131], v[208:211]
    v_subrev_u32 v19, s44, v19
    v_mfma_f32_16x16x32_bf16 v[208:211], a[76:79], a[132:135], v[208:211]
    s_sub_u32 s44, s44, 8192
    v_mfma_f32_16x16x32_bf16 v[212:215], a[84:87], a[132:135], v[212:215]
    v_mfma_f32_16x16x32_bf16 v[212:215], a[80:83], a[128:131], v[212:215]
    global_load_dword v29, v11, s[24:25] sc1
    v_subrev_u32 v20, s44, v20
    v_mfma_f32_16x16x32_bf16 v[216:219], a[88:91], a[128:131], v[216:219]
    s_sub_u32 s44, s44, 8192
    v_mfma_f32_16x16x32_bf16 v[216:219], a[92:95], a[132:135], v[216:219]
    v_subrev_u32 v21, s44, v21
    v_mfma_f32_16x16x32_bf16 v[220:223], a[100:103], a[132:135], v[220:223]
    s_sub_u32 s44, s44, 8192
    v_mfma_f32_16x16x32_bf16 v[220:223], a[96:99], a[128:131], v[220:223]
    v_add_u32 v12, 40, v1
    v_mfma_f32_16x16x32_bf16 v[224:227], a[104:107], a[128:131], v[224:227]
    s_add_u32 m0, s63, 65536
    s_add_u32 s47, s60, 0xe0000
    v_and_b32 v12, 64, v12
    v_mfma_f32_16x16x32_bf16 v[224:227], a[108:111], a[132:135], v[224:227]
    buffer_load_dwordx4 v2, s[64:67], s47 offen offset:0 lds
    v_mfma_f32_16x16x32_bf16 v[252:255], a[108:111], a[140:143], v[252:255]
    ds_read_b128 a[120:123], v13 offset:2048
    v_lshlrev_b32 v12, 1, v12
    v_mfma_f32_16x16x32_bf16 v[252:255], a[104:107], a[136:139], v[252:255]
    v_lshl_add_u32 v12, v1, 4, v12
    v_mfma_f32_16x16x32_bf16 v[248:251], a[96:99], a[136:139], v[248:251]
    ds_read_b128 a[124:127], v14 offset:2048
    v_lshrrev_b32 v22, 2, v1
    v_mfma_f32_16x16x32_bf16 v[248:251], a[100:103], a[140:143], v[248:251]
    buffer_load_dwordx4 v3, s[64:67], s47 offen offset:1024 lds
    v_and_b32 v23, 3, v1
    v_mfma_f32_16x16x32_bf16 v[244:247], a[92:95], a[140:143], v[244:247]
    v_lshlrev_b32 v23, 3, v23
    v_mfma_f32_16x16x32_bf16 v[244:247], a[88:91], a[136:139], v[244:247]
    v_mfma_f32_16x16x32_bf16 v[240:243], a[80:83], a[136:139], v[240:243]
    v_lshl_add_u32 v23, v22, 8, v23
    v_mfma_f32_16x16x32_bf16 v[240:243], a[84:87], a[140:143], v[240:243]
    s_and_b32 s37, s58, 1
    v_mfma_f32_16x16x32_bf16 v[236:239], a[76:79], a[140:143], v[236:239]
    s_lshl_b32 s45, s37, 2
    v_mfma_f32_16x16x32_bf16 v[236:239], a[72:75], a[136:139], v[236:239]
    buffer_load_dwordx4 v4, s[64:67], s47 offen offset:2048 lds
    v_and_b32 v22, 7, v22
    v_mfma_f32_16x16x32_bf16 v[232:235], a[64:67], a[136:139], v[232:235]
    v_xor_b32 v22, s45, v22
    v_mfma_f32_16x16x32_bf16 v[232:235], a[68:71], a[140:143], v[232:235]
    v_lshl_add_u32 v10, v22, 5, v23
    v_mfma_f32_16x16x32_bf16 v[228:231], a[60:63], a[140:143], v[228:231]
    v_mfma_f32_16x16x32_bf16 v[228:231], a[56:59], a[136:139], v[228:231]
    s_waitcnt lgkmcnt(2)
    buffer_load_dwordx4 v5, s[64:67], s47 offen offset:3072 lds
    s_mov_b32 s48, 0xbfb8aa3b
    v_mfma_f32_16x16x32_bf16 v[32:35], a[0:3], a[112:115], v[32:35]
    ds_read_b128 a[128:131], v13 offset:4096
    s_mov_b32 s50, 0x3fb504f3
    v_mfma_f32_16x16x32_bf16 v[32:35], a[4:7], a[116:119], v[32:35]
    s_and_b32 s44, s27, 3
    v_mfma_f32_16x16x32_bf16 v[36:39], a[12:15], a[116:119], v[36:39]
    ds_read_b128 a[132:135], v14 offset:4096
    s_lshl_b32 s45, s44, 1
    v_mfma_f32_16x16x32_bf16 v[36:39], a[8:11], a[112:115], v[36:39]
    s_add_u32 s45, s45, s30
    v_mfma_f32_16x16x32_bf16 v[40:43], a[16:19], a[112:115], v[40:43]
    ds_read_b64_tr_b16 a[56:57], v15 offset:28672
    ds_read_b64_tr_b16 a[58:59], v15 offset:30464
    ds_read_b64_tr_b16 a[60:61], v15 offset:43008
    ds_read_b64_tr_b16 a[62:63], v15 offset:44800
    s_add_u32 m0, s63, 81920
    s_add_u32 s47, s60, 0x150000
    v_mfma_f32_16x16x32_bf16 v[40:43], a[20:23], a[116:119], v[40:43]
    buffer_load_dwordx4 v2, s[64:67], s47 offen offset:0 lds
    s_lshl_b32 s41, s44, 2
    v_mfma_f32_16x16x32_bf16 v[44:47], a[28:31], a[116:119], v[44:47]
    ds_read_b64_tr_b16 a[64:65], v16 offset:28704
    ds_read_b64_tr_b16 a[66:67], v16 offset:30496
    s_add_u32 s41, s41, s28
    v_mfma_f32_16x16x32_bf16 v[44:47], a[24:27], a[112:115], v[44:47]
    s_lshl_b32 s41, s41, 2
    v_mfma_f32_16x16x32_bf16 v[48:51], a[32:35], a[112:115], v[48:51]
    ds_read_b64_tr_b16 a[68:69], v16 offset:43040
    ds_read_b64_tr_b16 a[70:71], v16 offset:44832
    s_mul_i32 s46, s44, 4096
    v_mfma_f32_16x16x32_bf16 v[48:51], a[36:39], a[116:119], v[48:51]
    buffer_load_dwordx4 v3, s[64:67], s47 offen offset:1024 lds
    s_mul_i32 s31, s30, 2048
    v_mfma_f32_16x16x32_bf16 v[52:55], a[44:47], a[116:119], v[52:55]
    ds_read_b64_tr_b16 a[72:73], v15 offset:28736
    ds_read_b64_tr_b16 a[74:75], v15 offset:30528
    s_add_u32 s46, s46, s31
    v_mfma_f32_16x16x32_bf16 v[52:55], a[40:43], a[112:115], v[52:55]
    v_mfma_f32_16x16x32_bf16 v[56:59], a[48:51], a[112:115], v[56:59]
    ds_read_b64_tr_b16 a[76:77], v15 offset:43072
    ds_read_b64_tr_b16 a[78:79], v15 offset:44864
    v_add_u32 v6, s46, v12
    v_mfma_f32_16x16x32_bf16 v[56:59], a[52:55], a[116:119], v[56:59]
    s_waitcnt vmcnt(8)
    s_barrier
    s_waitcnt lgkmcnt(14)
    s_mul_i32 s46, s45, 4096
    v_mfma_f32_16x16x32_bf16 v[84:87], a[52:55], a[124:127], v[84:87]
    ds_read_b128 a[136:139], v13 offset:32768
    s_add_u32 s46, s46, 24576
    v_mfma_f32_16x16x32_bf16 v[84:87], a[48:51], a[120:123], v[84:87]
    buffer_load_dwordx4 v4, s[64:67], s47 offen offset:2048 lds
    v_add_u32 v7, s46, v12
    v_mfma_f32_16x16x32_bf16 v[80:83], a[40:43], a[120:123], v[80:83]
    ds_read_b128 a[140:143], v14 offset:32768
    s_lshl_b32 s46, s30, 5
    v_mfma_f32_16x16x32_bf16 v[80:83], a[44:47], a[124:127], v[80:83]
    v_mfma_f32_16x16x32_bf16 v[76:79], a[36:39], a[124:127], v[76:79]
    ds_read_b64_tr_b16 a[80:81], v16 offset:28768
    ds_read_b64_tr_b16 a[82:83], v16 offset:30560
    v_lshrrev_b32 v25, 5, v1
    v_mfma_f32_16x16x32_bf16 v[76:79], a[32:35], a[120:123], v[76:79]
    buffer_load_dwordx4 v5, s[64:67], s47 offen offset:3072 lds
    v_lshl_add_u32 v25, v25, 4, s46
    v_mfma_f32_16x16x32_bf16 v[72:75], a[24:27], a[120:123], v[72:75]
    ds_read_b64_tr_b16 a[84:85], v16 offset:43104
    ds_read_b64_tr_b16 a[86:87], v16 offset:44896
    v_and_or_b32 v25, v1, 15, v25
    v_mfma_f32_16x16x32_bf16 v[72:75], a[28:31], a[124:127], v[72:75]
    v_add_u32 v8, 40, v25
    v_mfma_f32_16x16x32_bf16 v[68:71], a[20:23], a[124:127], v[68:71]
    ds_read_b64_tr_b16 a[88:89], v15 offset:28800
    ds_read_b64_tr_b16 a[90:91], v15 offset:30592
    v_and_b32 v8, 64, v8
    v_mfma_f32_16x16x32_bf16 v[68:71], a[16:19], a[120:123], v[68:71]
    v_lshlrev_b32 v8, 1, v8
    v_mfma_f32_16x16x32_bf16 v[64:67], a[8:11], a[120:123], v[64:67]
    ds_read_b64_tr_b16 a[92:93], v15 offset:43136
    ds_read_b64_tr_b16 a[94:95], v15 offset:44928
    s_add_u32 m0, s63, 98304
    s_add_u32 s47, s61, 0x30000
    v_mfma_f32_16x16x32_bf16 v[64:67], a[12:15], a[124:127], v[64:67]
    buffer_load_dwordx4 v18, s[64:67], s47 offen offset:0 lds
    v_lshl_add_u32 v8, v25, 4, v8
    v_mfma_f32_16x16x32_bf16 v[60:63], a[4:7], a[124:127], v[60:63]
    ds_read_b64_tr_b16 a[96:97], v16 offset:28832
    ds_read_b64_tr_b16 a[98:99], v16 offset:30624
    s_lshr_b32 s46, s44, 1
    v_mfma_f32_16x16x32_bf16 v[60:63], a[0:3], a[120:123], v[60:63]
    s_waitcnt lgkmcnt(14)
    s_add_u32 s46, s46, 4
    v_mfma_f32_16x16x32_bf16 v[88:91], a[0:3], a[128:131], v[88:91]
    ds_read_b128 a[112:115], v13 offset:34816
    s_mul_i32 s46, s46, 4096
    v_mfma_f32_16x16x32_bf16 v[88:91], a[4:7], a[132:135], v[88:91]
    buffer_load_dwordx4 v19, s[64:67], s47 offen offset:1024 lds
    s_and_b32 s31, s44, 1
    v_mfma_f32_16x16x32_bf16 v[92:95], a[12:15], a[132:135], v[92:95]
    ds_read_b128 a[116:119], v14 offset:34816
    v_mfma_f32_16x16x32_bf16 v[92:95], a[8:11], a[128:131], v[92:95]
    s_mul_i32 s31, s31, 2048
    v_mfma_f32_16x16x32_bf16 v[96:99], a[16:19], a[128:131], v[96:99]
    ds_read_b64_tr_b16 a[100:101], v16 offset:43168
    ds_read_b64_tr_b16 a[102:103], v16 offset:44960
    s_add_u32 s46, s46, s31
    v_mfma_f32_16x16x32_bf16 v[96:99], a[20:23], a[132:135], v[96:99]
    v_bfe_u32 v25, v1, 4, 1
    v_mfma_f32_16x16x32_bf16 v[100:103], a[28:31], a[132:135], v[100:103]
    ds_read_b64_tr_b16 a[104:105], v17 offset:28672
    ds_read_b64_tr_b16 a[106:107], v17 offset:30464
    v_mul_u32_u24 v25, 295936, v25
    v_mfma_f32_16x16x32_bf16 v[100:103], a[24:27], a[128:131], v[100:103]
    buffer_load_dwordx4 v20, s[64:67], s47 offen offset:2048 lds
    v_add3_u32 v8, v8, v25, s46
    v_mfma_f32_16x16x32_bf16 v[104:107], a[32:35], a[128:131], v[104:107]
    ds_read_b64_tr_b16 a[108:109], v17 offset:43008
    ds_read_b64_tr_b16 a[110:111], v17 offset:44800
    s_mul_i32 s46, s26, 4734976
    v_mfma_f32_16x16x32_bf16 v[104:107], a[36:39], a[132:135], v[104:107]
    v_mfma_f32_16x16x32_bf16 v[108:111], a[44:47], a[132:135], v[108:111]
    s_mul_i32 s31, s29, 2367488
    v_mfma_f32_16x16x32_bf16 v[108:111], a[40:43], a[128:131], v[108:111]
    buffer_load_dwordx4 v21, s[64:67], s47 offen offset:3072 lds
    s_add_u32 s31, s31, s46
    v_mfma_f32_16x16x32_bf16 v[112:115], a[48:51], a[128:131], v[112:115]
    s_lshr_b32 s44, s27, 2
    v_mfma_f32_16x16x32_bf16 v[112:115], a[52:55], a[132:135], v[112:115]
    s_waitcnt lgkmcnt(0)
    s_barrier
    s_mul_i32 s45, s44, 57344
    v_mfma_f32_16x16x32_bf16 v[32:35], a[56:59], a[136:139], v[32:35]
    ds_read_b128 a[120:123], v13 offset:36864
    s_add_u32 m0, s63, 114688
    s_add_u32 s47, s61, 0x110000
    s_add_u32 s31, s31, s45
    v_mfma_f32_16x16x32_bf16 v[32:35], a[60:63], a[140:143], v[32:35]
    buffer_load_dwordx4 v18, s[64:67], s47 offen offset:0 lds
    v_mfma_f32_16x16x32_bf16 v[36:39], a[68:71], a[140:143], v[36:39]
    ds_read_b128 a[124:127], v14 offset:36864
    v_mfma_f32_16x16x32_bf16 v[36:39], a[64:67], a[136:139], v[36:39]
    v_mfma_f32_16x16x32_bf16 v[40:43], a[72:75], a[136:139], v[40:43]
    s_waitcnt vmcnt(13)
    v_cmp_eq_u32 vcc, 1, v29
    v_mfma_f32_16x16x32_bf16 v[40:43], a[76:79], a[140:143], v[40:43]
    buffer_load_dwordx4 v19, s[64:67], s47 offen offset:1024 lds
    v_mfma_f32_16x16x32_bf16 v[44:47], a[84:87], a[140:143], v[44:47]
    s_bcnt1_i32_b32 s78, vcc_lo
    v_mfma_f32_16x16x32_bf16 v[44:47], a[80:83], a[136:139], v[44:47]
    buffer_load_dwordx4 v20, s[64:67], s47 offen offset:2048 lds
    v_mfma_f32_16x16x32_bf16 v[48:51], a[88:91], a[136:139], v[48:51]
    s_cmp_lt_u32 s78, 1
    s_cbranch_scc1 L_spin4
L_got4:
    v_mfma_f32_16x16x32_bf16 v[48:51], a[92:95], a[140:143], v[48:51]
    v_mfma_f32_16x16x32_bf16 v[52:55], a[100:103], a[140:143], v[52:55]
    v_mov_b32 v15, 1
    v_mfma_f32_16x16x32_bf16 v[52:55], a[96:99], a[136:139], v[52:55]
    buffer_load_dwordx4 v21, s[64:67], s47 offen offset:3072 lds
    v_mfma_f32_16x16x32_bf16 v[56:59], a[104:107], a[136:139], v[56:59]
    v_mfma_f32_16x16x32_bf16 v[56:59], a[108:111], a[140:143], v[56:59]
    v_mfma_f32_16x16x32_bf16 v[84:87], a[108:111], a[116:119], v[84:87]
    ds_read_b128 a[128:131], v13 offset:6144
    v_mfma_f32_16x16x32_bf16 v[84:87], a[104:107], a[112:115], v[84:87]
    v_mfma_f32_16x16x32_bf16 v[80:83], a[96:99], a[112:115], v[80:83]
    ds_read_b128 a[132:135], v14 offset:6144
    v_mfma_f32_16x16x32_bf16 v[80:83], a[100:103], a[116:119], v[80:83]
    v_fma_f32 v16, v32, s48, 0.5
    v_fma_f32 v17, v33, s48, 0.5
    v_mfma_f32_16x16x32_bf16 v[76:79], a[92:95], a[116:119], v[76:79]
    s_add_u32 m0, s63, 131072
    s_add_u32 s47, s62, 0x10000
    s_mul_i32 s44, s58, 57344
    v_fma_f32 v18, v34, s48, 0.5
    v_fma_f32 v19, v35, s48, 0.5
    v_mfma_f32_16x16x32_bf16 v[76:79], a[88:91], a[112:115], v[76:79]
    buffer_load_dwordx4 v2, s[64:67], s47 offen offset:0 lds
    v_fma_f32 v20, v36, s48, 0.5
    v_fma_f32 v21, v37, s48, 0.5
    v_mfma_f32_16x16x32_bf16 v[72:75], a[80:83], a[112:115], v[72:75]
    v_fma_f32 v22, v38, s48, 0.5
    v_fma_f32 v23, v39, s48, 0.5
    v_mfma_f32_16x16x32_bf16 v[72:75], a[84:87], a[116:119], v[72:75]
    v_exp_f32 v16, v16
    v_mfma_f32_16x16x32_bf16 v[68:71], a[76:79], a[116:119], v[68:71]
    v_exp_f32 v17, v17
    v_mfma_f32_16x16x32_bf16 v[68:71], a[72:75], a[112:115], v[68:71]
    v_exp_f32 v18, v18
    v_mfma_f32_16x16x32_bf16 v[64:67], a[64:67], a[112:115], v[64:67]
    s_mul_i32 s42, s56, 4734976
    v_exp_f32 v19, v19
    v_mfma_f32_16x16x32_bf16 v[64:67], a[68:71], a[116:119], v[64:67]
    v_exp_f32 v20, v20
    v_mfma_f32_16x16x32_bf16 v[60:63], a[60:63], a[116:119], v[60:63]
    v_exp_f32 v21, v21
    v_mfma_f32_16x16x32_bf16 v[60:63], a[56:59], a[112:115], v[60:63]
    s_waitcnt lgkmcnt(2)
    v_exp_f32 v22, v22
    v_mfma_f32_16x16x32_bf16 v[88:91], a[56:59], a[120:123], v[88:91]
    ds_read_b128 a[136:139], v13 offset:38912
    v_exp_f32 v23, v23
    v_mfma_f32_16x16x32_bf16 v[88:91], a[60:63], a[124:127], v[88:91]
    v_fma_f32 v24, v16, s50, 1.0
    v_fma_f32 v25, v17, s50, 1.0
    v_mfma_f32_16x16x32_bf16 v[92:95], a[68:71], a[124:127], v[92:95]
    ds_read_b128 a[140:143], v14 offset:38912
    v_fma_f32 v26, v18, s50, 1.0
    v_fma_f32 v27, v19, s50, 1.0
    v_mfma_f32_16x16x32_bf16 v[92:95], a[64:67], a[120:123], v[92:95]
    v_fma_f32 v28, v20, s50, 1.0
    v_fma_f32 v29, v21, s50, 1.0
    v_mfma_f32_16x16x32_bf16 v[96:99], a[72:75], a[120:123], v[96:99]
    v_fma_f32 v30, v22, s50, 1.0
    v_fma_f32 v31, v23, s50, 1.0
    v_mfma_f32_16x16x32_bf16 v[96:99], a[76:79], a[124:127], v[96:99]
    v_fma_f32 v16, v16, v16, v24
    v_fma_f32 v17, v17, v17, v25
    v_mfma_f32_16x16x32_bf16 v[100:103], a[84:87], a[124:127], v[100:103]
    s_add_u32 s44, s44, s42
    v_fma_f32 v18, v18, v18, v26
    v_fma_f32 v19, v19, v19, v27
    v_mfma_f32_16x16x32_bf16 v[100:103], a[80:83], a[120:123], v[100:103]
    buffer_load_dwordx4 v3, s[64:67], s47 offen offset:1024 lds
    v_fma_f32 v20, v20, v20, v28
    v_fma_f32 v21, v21, v21, v29
    v_mfma_f32_16x16x32_bf16 v[104:107], a[88:91], a[120:123], v[104:107]
    v_fma_f32 v22, v22, v22, v30
    v_fma_f32 v23, v23, v23, v31
    v_mfma_f32_16x16x32_bf16 v[104:107], a[92:95], a[124:127], v[104:107]
    v_rcp_f32 v16, v16
    v_mfma_f32_16x16x32_bf16 v[108:111], a[100:103], a[124:127], v[108:111]
    v_rcp_f32 v17, v17
    v_mfma_f32_16x16x32_bf16 v[108:111], a[96:99], a[120:123], v[108:111]
    v_rcp_f32 v18, v18
    v_mfma_f32_16x16x32_bf16 v[112:115], a[104:107], a[120:123], v[112:115]
    s_and_b32 s42, s59, 7
    v_rcp_f32 v19, v19
    v_mfma_f32_16x16x32_bf16 v[112:115], a[108:111], a[124:127], v[112:115]
    s_waitcnt lgkmcnt(2)
    v_rcp_f32 v20, v20
    v_mfma_f32_16x16x32_bf16 v[140:143], a[52:55], a[132:135], v[140:143]
    ds_read_b128 a[112:115], v13 offset:8192
    v_rcp_f32 v21, v21
    v_mfma_f32_16x16x32_bf16 v[140:143], a[48:51], a[128:131], v[140:143]
    v_rcp_f32 v22, v22
    v_mfma_f32_16x16x32_bf16 v[136:139], a[40:43], a[128:131], v[136:139]
    ds_read_b128 a[116:119], v14 offset:8192
    v_rcp_f32 v23, v23
    v_mfma_f32_16x16x32_bf16 v[136:139], a[44:47], a[132:135], v[136:139]
    v_mul_f32_e64 v16, v24, v16 clamp
    v_mul_f32_e64 v17, v25, v17 clamp
    v_mfma_f32_16x16x32_bf16 v[132:135], a[36:39], a[132:135], v[132:135]
    v_mul_f32_e64 v18, v26, v18 clamp
    v_mul_f32_e64 v19, v27, v19 clamp
    v_mfma_f32_16x16x32_bf16 v[132:135], a[32:35], a[128:131], v[132:135]
    v_mul_f32_e64 v20, v28, v20 clamp
    v_mul_f32_e64 v21, v29, v21 clamp
    v_mfma_f32_16x16x32_bf16 v[128:131], a[24:27], a[128:131], v[128:131]
    v_mul_f32_e64 v22, v30, v22 clamp
    v_mul_f32_e64 v23, v31, v23 clamp
    v_mfma_f32_16x16x32_bf16 v[128:131], a[28:31], a[132:135], v[128:131]
    buffer_load_dwordx4 v4, s[64:67], s47 offen offset:2048 lds
    v_mul_f32 v16, v32, v16
    v_mul_f32 v17, v33, v17
    v_mfma_f32_16x16x32_bf16 v[124:127], a[20:23], a[132:135], v[124:127]
    s_xor_b32 s43, s42, 4
    v_mul_f32 v18, v34, v18
    v_mul_f32 v19, v35, v19
    v_mfma_f32_16x16x32_bf16 v[124:127], a[16:19], a[128:131], v[124:127]
    v_mul_f32 v20, v36, v20
    v_mul_f32 v21, v37, v21
    v_mfma_f32_16x16x32_bf16 v[120:123], a[8:11], a[128:131], v[120:123]
    v_mul_f32 v22, v38, v22
    v_mul_f32 v23, v39, v23
    v_mfma_f32_16x16x32_bf16 v[120:123], a[12:15], a[132:135], v[120:123]
    v_cvt_pk_bf16_f32 v32, v16, v17
    v_cvt_pk_bf16_f32 v33, v18, v19
    v_mfma_f32_16x16x32_bf16 v[116:119], a[4:7], a[132:135], v[116:119]
    v_cvt_pk_bf16_f32 v34, v20, v21
    v_cvt_pk_bf16_f32 v35, v22, v23
    v_mfma_f32_16x16x32_bf16 v[116:119], a[0:3], a[128:131], v[116:119]
    s_waitcnt lgkmcnt(2)
    v_fma_f32 v16, v60, s48, 0.5
    v_fma_f32 v17, v61, s48, 0.5
    v_mfma_f32_16x16x32_bf16 v[140:143], a[108:111], a[140:143], v[140:143]
    ds_read_b128 a[120:123], v13 offset:40960
    v_fma_f32 v18, v62, s48, 0.5
    v_fma_f32 v19, v63, s48, 0.5
    v_mfma_f32_16x16x32_bf16 v[140:143], a[104:107], a[136:139], v[140:143]
    v_fma_f32 v20, v64, s48, 0.5
    v_fma_f32 v21, v65, s48, 0.5
    v_mfma_f32_16x16x32_bf16 v[136:139], a[96:99], a[136:139], v[136:139]
    ds_read_b128 a[124:127], v14 offset:40960
    s_add_u32 s54, s31, 0x0
    buffer_store_dwordx4 v[32:35], v6, s[12:15], s54 offen offset:0 sc1
    v_fma_f32 v22, v66, s48, 0.5
    v_fma_f32 v23, v67, s48, 0.5
    v_mfma_f32_16x16x32_bf16 v[136:139], a[100:103], a[140:143], v[136:139]
    v_exp_f32 v16, v16
    v_mfma_f32_16x16x32_bf16 v[132:135], a[92:95], a[140:143], v[132:135]
    s_mul_i32 s42, s42, 591872
    v_exp_f32 v17, v17
    v_mfma_f32_16x16x32_bf16 v[132:135], a[88:91], a[136:139], v[132:135]
    v_exp_f32 v18, v18
    v_mfma_f32_16x16x32_bf16 v[128:131], a[80:83], a[136:139], v[128:131]
    v_exp_f32 v19, v19
    v_mfma_f32_16x16x32_bf16 v[128:131], a[84:87], a[140:143], v[128:131]
    v_exp_f32 v20, v20
    v_mfma_f32_16x16x32_bf16 v[124:127], a[76:79], a[140:143], v[124:127]
    v_exp_f32 v21, v21
    v_mfma_f32_16x16x32_bf16 v[124:127], a[72:75], a[136:139], v[124:127]
    buffer_load_dwordx4 v5, s[64:67], s47 offen offset:3072 lds
    v_exp_f32 v22, v22
    v_mfma_f32_16x16x32_bf16 v[120:123], a[64:67], a[136:139], v[120:123]
    s_mul_i32 s43, s43, 591872
    v_exp_f32 v23, v23
    v_mfma_f32_16x16x32_bf16 v[120:123], a[68:71], a[140:143], v[120:123]
    v_fma_f32 v24, v16, s50, 1.0
    v_fma_f32 v25, v17, s50, 1.0
    v_mfma_f32_16x16x32_bf16 v[116:119], a[60:63], a[140:143], v[116:119]
    v_fma_f32 v26, v18, s50, 1.0
    v_fma_f32 v27, v19, s50, 1.0
    v_mfma_f32_16x16x32_bf16 v[116:119], a[56:59], a[136:139], v[116:119]
    s_waitcnt lgkmcnt(2)
    v_fma_f32 v28, v20, s50, 1.0
    v_fma_f32 v29, v21, s50, 1.0
    v_mfma_f32_16x16x32_bf16 v[144:147], a[0:3], a[112:115], v[144:147]
    ds_read_b128 a[128:131], v13 offset:10240
    v_fma_f32 v30, v22, s50, 1.0
    v_fma_f32 v31, v23, s50, 1.0
    v_mfma_f32_16x16x32_bf16 v[144:147], a[4:7], a[116:119], v[144:147]
    v_fma_f32 v16, v16, v16, v24
    v_fma_f32 v17, v17, v17, v25
    v_mfma_f32_16x16x32_bf16 v[148:151], a[12:15], a[116:119], v[148:151]
    ds_read_b128 a[132:135], v14 offset:10240
    v_fma_f32 v18, v18, v18, v26
    v_fma_f32 v19, v19, v19, v27
    v_mfma_f32_16x16x32_bf16 v[148:151], a[8:11], a[112:115], v[148:151]
    v_fma_f32 v20, v20, v20, v28
    v_fma_f32 v21, v21, v21, v29
    v_mfma_f32_16x16x32_bf16 v[152:155], a[16:19], a[112:115], v[152:155]
    v_fma_f32 v22, v22, v22, v30
    v_fma_f32 v23, v23, v23, v31
    v_mfma_f32_16x16x32_bf16 v[152:155], a[20:23], a[116:119], v[152:155]
    v_rcp_f32 v16, v16
    v_mfma_f32_16x16x32_bf16 v[156:159], a[28:31], a[116:119], v[156:159]
    v_rcp_f32 v17, v17
    v_mfma_f32_16x16x32_bf16 v[156:159], a[24:27], a[112:115], v[156:159]
    v_rcp_f32 v18, v18
    v_mfma_f32_16x16x32_bf16 v[160:163], a[32:35], a[112:115], v[160:163]
    s_add_u32 s42, s42, s44
    v_rcp_f32 v19, v19
    v_mfma_f32_16x16x32_bf16 v[160:163], a[36:39], a[116:119], v[160:163]
    v_rcp_f32 v20, v20
    v_mfma_f32_16x16x32_bf16 v[164:167], a[44:47], a[116:119], v[164:167]
    s_add_u32 m0, s63, 147456
    s_add_u32 s47, s62, 0x50000
    v_rcp_f32 v21, v21
    v_mfma_f32_16x16x32_bf16 v[164:167], a[40:43], a[112:115], v[164:167]
    buffer_load_dwordx4 v2, s[64:67], s47 offen offset:0 lds
    v_rcp_f32 v22, v22
    v_mfma_f32_16x16x32_bf16 v[168:171], a[48:51], a[112:115], v[168:171]
    v_rcp_f32 v23, v23
    v_mfma_f32_16x16x32_bf16 v[168:171], a[52:55], a[116:119], v[168:171]
    s_waitcnt lgkmcnt(2)
    v_mul_f32_e64 v16, v24, v16 clamp
    v_mul_f32_e64 v17, v25, v17 clamp
    v_mfma_f32_16x16x32_bf16 v[144:147], a[56:59], a[120:123], v[144:147]
    ds_read_b128 a[136:139], v13 offset:43008
    v_mul_f32_e64 v18, v26, v18 clamp
    v_mul_f32_e64 v19, v27, v19 clamp
    v_mfma_f32_16x16x32_bf16 v[144:147], a[60:63], a[124:127], v[144:147]
L_pg3:
    s_cbranch_execz L_tramp
    v_mul_f32_e64 v20, v28, v20 clamp
    v_mul_f32_e64 v21, v29, v21 clamp
    v_mfma_f32_16x16x32_bf16 v[148:151], a[68:71], a[124:127], v[148:151]
    ds_read_b128 a[140:143], v14 offset:43008
    v_mul_f32_e64 v22, v30, v22 clamp
    v_mul_f32_e64 v23, v31, v23 clamp
    v_mfma_f32_16x16x32_bf16 v[148:151], a[64:67], a[120:123], v[148:151]
    v_mul_f32 v16, v60, v16
    v_mul_f32 v17, v61, v17
    v_mfma_f32_16x16x32_bf16 v[152:155], a[72:75], a[120:123], v[152:155]
    s_add_u32 s43, s43, s44
    v_mul_f32 v18, v62, v18
    v_mul_f32 v19, v63, v19
    v_mfma_f32_16x16x32_bf16 v[152:155], a[76:79], a[124:127], v[152:155]
    v_mul_f32 v20, v64, v20
    v_mul_f32 v21, v65, v21
    v_mfma_f32_16x16x32_bf16 v[156:159], a[84:87], a[124:127], v[156:159]
    v_mul_f32 v22, v66, v22
    v_mul_f32 v23, v67, v23
    v_mfma_f32_16x16x32_bf16 v[156:159], a[80:83], a[120:123], v[156:159]
    v_cvt_pk_bf16_f32 v60, v16, v17
    v_cvt_pk_bf16_f32 v61, v18, v19
    v_mfma_f32_16x16x32_bf16 v[160:163], a[88:91], a[120:123], v[160:163]
    v_cvt_pk_bf16_f32 v62, v20, v21
    v_cvt_pk_bf16_f32 v63, v22, v23
    v_mfma_f32_16x16x32_bf16 v[160:163], a[92:95], a[124:127], v[160:163]
    v_fma_f32 v16, v56, s48, 0.5
    v_fma_f32 v17, v57, s48, 0.5
    v_mfma_f32_16x16x32_bf16 v[164:167], a[100:103], a[124:127], v[164:167]
    s_lshl_b32 s38, s56, 2
    v_fma_f32 v18, v58, s48, 0.5
    v_fma_f32 v19, v59, s48, 0.5
    v_mfma_f32_16x16x32_bf16 v[164:167], a[96:99], a[120:123], v[164:167]
    buffer_load_dwordx4 v3, s[64:67], s47 offen offset:1024 lds
    v_fma_f32 v20, v84, s48, 0.5
    v_fma_f32 v21, v85, s48, 0.5
    v_mfma_f32_16x16x32_bf16 v[168:171], a[104:107], a[120:123], v[168:171]
    s_add_u32 s54, s31, 0x48400
    buffer_store_dwordx4 v[60:63], v6, s[12:15], s54 offen offset:0 sc1
    v_fma_f32 v22, v86, s48, 0.5
    v_fma_f32 v23, v87, s48, 0.5
    v_mfma_f32_16x16x32_bf16 v[168:171], a[108:111], a[124:127], v[168:171]
    s_waitcnt lgkmcnt(2)
    v_exp_f32 v16, v16
    v_mfma_f32_16x16x32_bf16 v[196:199], a[52:55], a[132:135], v[196:199]
    ds_read_b128 a[112:115], v13 offset:12288
    v_exp_f32 v17, v17
    v_mfma_f32_16x16x32_bf16 v[196:199], a[48:51], a[128:131], v[196:199]
    v_exp_f32 v18, v18
    v_mfma_f32_16x16x32_bf16 v[192:195], a[40:43], a[128:131], v[192:195]
    ds_read_b128 a[116:119], v14 offset:12288
    v_exp_f32 v19, v19
    v_mfma_f32_16x16x32_bf16 v[192:195], a[44:47], a[132:135], v[192:195]
    v_exp_f32 v20, v20
    v_mfma_f32_16x16x32_bf16 v[188:191], a[36:39], a[132:135], v[188:191]
    v_exp_f32 v21, v21
    v_mfma_f32_16x16x32_bf16 v[188:191], a[32:35], a[128:131], v[188:191]
    v_exp_f32 v22, v22
    v_mfma_f32_16x16x32_bf16 v[184:187], a[24:27], a[128:131], v[184:187]
    s_add_u32 s38, s38, s58
    v_exp_f32 v23, v23
    v_mfma_f32_16x16x32_bf16 v[184:187], a[28:31], a[132:135], v[184:187]
    v_fma_f32 v24, v16, s50, 1.0
    v_fma_f32 v25, v17, s50, 1.0
    v_mfma_f32_16x16x32_bf16 v[180:183], a[20:23], a[132:135], v[180:183]
    v_fma_f32 v26, v18, s50, 1.0
    v_fma_f32 v27, v19, s50, 1.0
    v_mfma_f32_16x16x32_bf16 v[180:183], a[16:19], a[128:131], v[180:183]
    v_fma_f32 v28, v20, s50, 1.0
    v_fma_f32 v29, v21, s50, 1.0
    v_mfma_f32_16x16x32_bf16 v[176:179], a[8:11], a[128:131], v[176:179]
    v_fma_f32 v30, v22, s50, 1.0
    v_fma_f32 v31, v23, s50, 1.0
    v_mfma_f32_16x16x32_bf16 v[176:179], a[12:15], a[132:135], v[176:179]
    v_fma_f32 v16, v16, v16, v24
    v_fma_f32 v17, v17, v17, v25
    v_mfma_f32_16x16x32_bf16 v[172:175], a[4:7], a[132:135], v[172:175]
    s_lshl_b32 s38, s38, 7
    v_fma_f32 v18, v18, v18, v26
    v_fma_f32 v19, v19, v19, v27
    v_mfma_f32_16x16x32_bf16 v[172:175], a[0:3], a[128:131], v[172:175]
    s_waitcnt lgkmcnt(2)
    buffer_load_dwordx4 v4, s[64:67], s47 offen offset:2048 lds
    v_fma_f32 v20, v20, v20, v28
    v_fma_f32 v21, v21, v21, v29
    v_mfma_f32_16x16x32_bf16 v[196:199], a[108:111], a[140:143], v[196:199]
    ds_read_b128 a[120:123], v13 offset:45056
    v_fma_f32 v22, v22, v22, v30
    v_fma_f32 v23, v23, v23, v31
    v_mfma_f32_16x16x32_bf16 v[196:199], a[104:107], a[136:139], v[196:199]
    v_rcp_f32 v16, v16
    v_mfma_f32_16x16x32_bf16 v[192:195], a[96:99], a[136:139], v[192:195]
    ds_read_b128 a[124:127], v14 offset:45056
    v_rcp_f32 v17, v17
    v_mfma_f32_16x16x32_bf16 v[192:195], a[100:103], a[140:143], v[192:195]
    v_rcp_f32 v18, v18
    v_mfma_f32_16x16x32_bf16 v[188:191], a[92:95], a[140:143], v[188:191]
    v_rcp_f32 v19, v19
    v_mfma_f32_16x16x32_bf16 v[188:191], a[88:91], a[136:139], v[188:191]
    v_rcp_f32 v20, v20
    v_mfma_f32_16x16x32_bf16 v[184:187], a[80:83], a[136:139], v[184:187]
    v_rcp_f32 v21, v21
    v_mfma_f32_16x16x32_bf16 v[184:187], a[84:87], a[140:143], v[184:187]
    v_rcp_f32 v22, v22
    v_mfma_f32_16x16x32_bf16 v[180:183], a[76:79], a[140:143], v[180:183]
    s_add_u32 s38, s38, 0x2522000
    v_rcp_f32 v23, v23
    v_mfma_f32_16x16x32_bf16 v[180:183], a[72:75], a[136:139], v[180:183]
    v_mul_f32_e64 v16, v24, v16 clamp
    v_mul_f32_e64 v17, v25, v17 clamp
    v_mfma_f32_16x16x32_bf16 v[176:179], a[64:67], a[136:139], v[176:179]
    v_mul_f32_e64 v18, v26, v18 clamp
    v_mul_f32_e64 v19, v27, v19 clamp
    v_mfma_f32_16x16x32_bf16 v[176:179], a[68:71], a[140:143], v[176:179]
    v_mul_f32_e64 v20, v28, v20 clamp
    v_mul_f32_e64 v21, v29, v21 clamp
    v_mfma_f32_16x16x32_bf16 v[172:175], a[60:63], a[140:143], v[172:175]
    v_mul_f32_e64 v22, v30, v22 clamp
    v_mul_f32_e64 v23, v31, v23 clamp
    v_mfma_f32_16x16x32_bf16 v[172:175], a[56:59], a[136:139], v[172:175]
    s_waitcnt lgkmcnt(2)
    v_mul_f32 v16, v56, v16
    v_mul_f32 v17, v57, v17
    v_mfma_f32_16x16x32_bf16 v[200:203], a[0:3], a[112:115], v[200:203]
    ds_read_b128 a[128:131], v13 offset:14336
    v_mul_f32 v18, v58, v18
    v_mul_f32 v19, v59, v19
    v_mfma_f32_16x16x32_bf16 v[200:203], a[4:7], a[116:119], v[200:203]
    buffer_load_dwordx4 v5, s[64:67], s47 offen offset:3072 lds
    v_mul_f32 v20, v84, v20
    v_mul_f32 v21, v85, v21
    v_mfma_f32_16x16x32_bf16 v[204:207], a[12:15], a[116:119], v[204:207]
    ds_read_b128 a[132:135], v14 offset:14336
    v_mul_f32 v22, v86, v22
    v_mul_f32 v23, v87, v23
    v_mfma_f32_16x16x32_bf16 v[204:207], a[8:11], a[112:115], v[204:207]
    v_cvt_pk_bf16_f32 v56, v16, v17
    v_cvt_pk_bf16_f32 v57, v18, v19
    v_mfma_f32_16x16x32_bf16 v[208:211], a[16:19], a[112:115], v[208:211]
    v_cvt_pk_bf16_f32 v58, v20, v21
    v_cvt_pk_bf16_f32 v59, v22, v23
    v_mfma_f32_16x16x32_bf16 v[208:211], a[20:23], a[116:119], v[208:211]
    v_fma_f32 v16, v88, s48, 0.5
    v_fma_f32 v17, v89, s48, 0.5
    v_mfma_f32_16x16x32_bf16 v[212:215], a[28:31], a[116:119], v[212:215]
    s_add_u32 s39, s38, 4096
    v_fma_f32 v18, v90, s48, 0.5
    v_fma_f32 v19, v91, s48, 0.5
    v_mfma_f32_16x16x32_bf16 v[212:215], a[24:27], a[112:115], v[212:215]
    v_fma_f32 v20, v92, s48, 0.5
    v_mfma_f32_16x16x32_bf16 v[216:219], a[32:35], a[112:115], v[216:219]
    v_permlane16_swap_b32 v56, v58
    v_mfma_f32_16x16x32_bf16 v[216:219], a[36:39], a[116:119], v[216:219]
    v_permlane16_swap_b32 v57, v59
    v_mfma_f32_16x16x32_bf16 v[220:223], a[44:47], a[116:119], v[220:223]
    s_add_u32 s54, s31, 0x0
    buffer_store_dwordx4 v[56:59], v8, s[12:15], s54 offen sc1
    v_fma_f32 v21, v93, s48, 0.5
    v_fma_f32 v22, v94, s48, 0.5
    v_mfma_f32_16x16x32_bf16 v[220:223], a[40:43], a[112:115], v[220:223]
    v_fma_f32 v23, v95, s48, 0.5
    v_mfma_f32_16x16x32_bf16 v[224:227], a[48:51], a[112:115], v[224:227]
    s_lshr_b32 s44, s27, 2
    v_exp_f32 v16, v16
    v_mfma_f32_16x16x32_bf16 v[224:227], a[52:55], a[116:119], v[224:227]
    s_waitcnt lgkmcnt(2)
    v_exp_f32 v17, v17
    v_mfma_f32_16x16x32_bf16 v[200:203], a[56:59], a[120:123], v[200:203]
    ds_read_b128 a[136:139], v13 offset:47104
    v_exp_f32 v18, v18
    v_mfma_f32_16x16x32_bf16 v[200:203], a[60:63], a[124:127], v[200:203]
    v_exp_f32 v19, v19
    v_mfma_f32_16x16x32_bf16 v[204:207], a[68:71], a[124:127], v[204:207]
    ds_read_b128 a[140:143], v14 offset:47104
    v_exp_f32 v20, v20
    v_mfma_f32_16x16x32_bf16 v[204:207], a[64:67], a[120:123], v[204:207]
    v_exp_f32 v21, v21
    v_mfma_f32_16x16x32_bf16 v[208:211], a[72:75], a[120:123], v[208:211]
    v_exp_f32 v22, v22
    v_mfma_f32_16x16x32_bf16 v[208:211], a[76:79], a[124:127], v[208:211]
    v_exp_f32 v23, v23
    v_mfma_f32_16x16x32_bf16 v[212:215], a[84:87], a[124:127], v[212:215]
    v_fma_f32 v24, v16, s50, 1.0
    v_fma_f32 v25, v17, s50, 1.0
    v_mfma_f32_16x16x32_bf16 v[212:215], a[80:83], a[120:123], v[212:215]
    v_fma_f32 v26, v18, s50, 1.0
    v_fma_f32 v27, v19, s50, 1.0
    v_mfma_f32_16x16x32_bf16 v[216:219], a[88:91], a[120:123], v[216:219]
    s_lshl2_add_u32 s45, s26, s44
    v_fma_f32 v28, v20, s50, 1.0
    v_fma_f32 v29, v21, s50, 1.0
    v_mfma_f32_16x16x32_bf16 v[216:219], a[92:95], a[124:127], v[216:219]
    v_fma_f32 v30, v22, s50, 1.0
    v_fma_f32 v31, v23, s50, 1.0
    v_mfma_f32_16x16x32_bf16 v[220:223], a[100:103], a[124:127], v[220:223]
    v_fma_f32 v16, v16, v16, v24
    v_fma_f32 v17, v17, v17, v25
    v_mfma_f32_16x16x32_bf16 v[220:223], a[96:99], a[120:123], v[220:223]
    v_fma_f32 v18, v18, v18, v26
    v_fma_f32 v19, v19, v19, v27
    v_mfma_f32_16x16x32_bf16 v[224:227], a[104:107], a[120:123], v[224:227]
    v_fma_f32 v20, v20, v20, v28
    v_fma_f32 v21, v21, v21, v29
    v_mfma_f32_16x16x32_bf16 v[224:227], a[108:111], a[124:127], v[224:227]
    s_waitcnt lgkmcnt(0)
    s_barrier
    v_fma_f32 v22, v22, v22, v30
    v_fma_f32 v23, v23, v23, v31
    v_mfma_f32_16x16x32_bf16 v[252:255], a[52:55], a[132:135], v[252:255]
    s_add_u32 m0, s63, 32768
    s_add_u32 s47, s60, 0x0
    v_rcp_f32 v16, v16
    v_mfma_f32_16x16x32_bf16 v[252:255], a[48:51], a[128:131], v[252:255]
    buffer_load_dwordx4 v2, s[64:67], s47 offen offset:0 lds
    v_rcp_f32 v17, v17
    v_mfma_f32_16x16x32_bf16 v[248:251], a[40:43], a[128:131], v[248:251]
    v_rcp_f32 v18, v18
    v_mfma_f32_16x16x32_bf16 v[248:251], a[44:47], a[132:135], v[248:251]
    v_rcp_f32 v19, v19
    v_mfma_f32_16x16x32_bf16 v[244:247], a[36:39], a[132:135], v[244:247]
    s_lshl_b32 s45, s45, 7
    v_rcp_f32 v20, v20
    v_mfma_f32_16x16x32_bf16 v[244:247], a[32:35], a[128:131], v[244:247]
    buffer_load_dwordx4 v3, s[64:67], s47 offen offset:1024 lds
    v_rcp_f32 v21, v21
    v_mfma_f32_16x16x32_bf16 v[240:243], a[24:27], a[128:131], v[240:243]
    v_rcp_f32 v22, v22
    v_mfma_f32_16x16x32_bf16 v[240:243], a[28:31], a[132:135], v[240:243]
    v_rcp_f32 v23, v23
    v_mfma_f32_16x16x32_bf16 v[236:239], a[20:23], a[132:135], v[236:239]
    v_mul_f32_e64 v16, v24, v16 clamp
    v_mul_f32_e64 v17, v25, v17 clamp
    v_mfma_f32_16x16x32_bf16 v[236:239], a[16:19], a[128:131], v[236:239]
    buffer_load_dwordx4 v4, s[64:67], s47 offen offset:2048 lds
    v_mul_f32_e64 v18, v26, v18 clamp
    v_mul_f32_e64 v19, v27, v19 clamp
    v_mfma_f32_16x16x32_bf16 v[232:235], a[8:11], a[128:131], v[232:235]
    s_add_u32 s32, s45, 0x2522000
    v_mul_f32_e64 v20, v28, v20 clamp
    v_mul_f32_e64 v21, v29, v21 clamp
    v_mfma_f32_16x16x32_bf16 v[232:235], a[12:15], a[132:135], v[232:235]
    buffer_load_dwordx4 v5, s[64:67], s47 offen offset:3072 lds
    v_mul_f32_e64 v22, v30, v22 clamp
    v_mul_f32_e64 v23, v31, v23 clamp
    v_mfma_f32_16x16x32_bf16 v[228:231], a[4:7], a[132:135], v[228:231]
    v_mul_f32 v16, v88, v16
    v_mul_f32 v17, v89, v17
    v_mfma_f32_16x16x32_bf16 v[228:231], a[0:3], a[128:131], v[228:231]
    v_mul_f32 v18, v90, v18
    v_mul_f32 v19, v91, v19
    v_mfma_f32_16x16x32_bf16 v[252:255], a[108:111], a[140:143], v[252:255]
    s_add_u32 m0, s63, 49152
    s_add_u32 s47, s60, 0x70000
    v_mul_f32 v20, v92, v20
    v_mul_f32 v21, v93, v21
    v_mfma_f32_16x16x32_bf16 v[252:255], a[104:107], a[136:139], v[252:255]
    buffer_load_dwordx4 v2, s[64:67], s47 offen offset:0 lds
    v_mul_f32 v22, v94, v22
    v_mul_f32 v23, v95, v23
    v_mfma_f32_16x16x32_bf16 v[248:251], a[96:99], a[136:139], v[248:251]
    v_cvt_pk_bf16_f32 v88, v16, v17
    v_cvt_pk_bf16_f32 v89, v18, v19
    v_mfma_f32_16x16x32_bf16 v[248:251], a[100:103], a[140:143], v[248:251]
    v_cvt_pk_bf16_f32 v90, v20, v21
    v_cvt_pk_bf16_f32 v91, v22, v23
    v_mfma_f32_16x16x32_bf16 v[244:247], a[92:95], a[140:143], v[244:247]
    v_mfma_f32_16x16x32_bf16 v[244:247], a[88:91], a[136:139], v[244:247]
    buffer_load_dwordx4 v3, s[64:67], s47 offen offset:1024 lds
    v_mfma_f32_16x16x32_bf16 v[240:243], a[80:83], a[136:139], v[240:243]
    s_add_u32 s51, s45, 0x2523000
    v_mfma_f32_16x16x32_bf16 v[240:243], a[84:87], a[140:143], v[240:243]
    v_mfma_f32_16x16x32_bf16 v[236:239], a[76:79], a[140:143], v[236:239]
    v_mfma_f32_16x16x32_bf16 v[236:239], a[72:75], a[136:139], v[236:239]
    buffer_load_dwordx4 v4, s[64:67], s47 offen offset:2048 lds
    v_mfma_f32_16x16x32_bf16 v[232:235], a[64:67], a[136:139], v[232:235]
    v_mfma_f32_16x16x32_bf16 v[232:235], a[68:71], a[140:143], v[232:235]
    v_mfma_f32_16x16x32_bf16 v[228:231], a[60:63], a[140:143], v[228:231]
    v_mfma_f32_16x16x32_bf16 v[228:231], a[56:59], a[136:139], v[228:231]
    buffer_load_dwordx4 v5, s[64:67], s47 offen offset:3072 lds
    v_and_b32 v14, 31, v1
    v_lshlrev_b32 v14, 2, v14
    v_pk_fma_f32 v[16:17], v[116:117], s[48:49], 0.5 op_sel_hi:[1,0,0]
    v_pk_fma_f32 v[18:19], v[118:119], s[48:49], 0.5 op_sel_hi:[1,0,0]
    v_pk_fma_f32 v[20:21], v[120:121], s[48:49], 0.5 op_sel_hi:[1,0,0]
    v_pk_fma_f32 v[22:23], v[122:123], s[48:49], 0.5 op_sel_hi:[1,0,0]
    v_exp_f32 v16, v16
    s_add_u32 s54, s31, 0x90800
    buffer_store_dwordx4 v[88:91], v6, s[12:15], s54 offen offset:0 sc1
    v_exp_f32 v17, v17
    v_exp_f32 v18, v18
    v_exp_f32 v19, v19
    v_exp_f32 v20, v20
    v_exp_f32 v21, v21
    v_exp_f32 v22, v22
    v_exp_f32 v23, v23
    v_pk_fma_f32 v[24:25], v[16:17], s[50:51], 1.0 op_sel_hi:[1,0,0]
    v_pk_fma_f32 v[26:27], v[18:19], s[50:51], 1.0 op_sel_hi:[1,0,0]
    v_pk_fma_f32 v[28:29], v[20:21], s[50:51], 1.0 op_sel_hi:[1,0,0]
    v_pk_fma_f32 v[30:31], v[22:23], s[50:51], 1.0 op_sel_hi:[1,0,0]
    v_pk_fma_f32 v[16:17], v[16:17], v[16:17], v[24:25]
    v_pk_fma_f32 v[18:19], v[18:19], v[18:19], v[26:27]
    v_pk_fma_f32 v[20:21], v[20:21], v[20:21], v[28:29]
    v_pk_fma_f32 v[22:23], v[22:23], v[22:23], v[30:31]
    v_rcp_f32 v16, v16
    v_rcp_f32 v17, v17
    v_rcp_f32 v18, v18
    v_rcp_f32 v19, v19
    v_rcp_f32 v20, v20
    v_rcp_f32 v21, v21
    v_rcp_f32 v22, v22
    v_rcp_f32 v23, v23
    v_pk_mul_f32 v[16:17], v[24:25], v[16:17] clamp
    v_pk_mul_f32 v[18:19], v[26:27], v[18:19] clamp
    v_pk_mul_f32 v[20:21], v[28:29], v[20:21] clamp
    v_pk_mul_f32 v[22:23], v[30:31], v[22:23] clamp
    v_pk_mul_f32 v[16:17], v[116:117], v[16:17]
    v_pk_mul_f32 v[18:19], v[118:119], v[18:19]
    v_pk_mul_f32 v[20:21], v[120:121], v[20:21]
    v_pk_mul_f32 v[22:23], v[122:123], v[22:23]
    v_cvt_pk_bf16_f32 v116, v16, v17
    v_cvt_pk_bf16_f32 v117, v18, v19
    v_cvt_pk_bf16_f32 v118, v20, v21
    v_cvt_pk_bf16_f32 v119, v22, v23
    v_pk_fma_f32 v[16:17], v[112:113], s[48:49], 0.5 op_sel_hi:[1,0,0]
    v_pk_fma_f32 v[18:19], v[114:115], s[48:49], 0.5 op_sel_hi:[1,0,0]
    v_pk_fma_f32 v[20:21], v[140:141], s[48:49], 0.5 op_sel_hi:[1,0,0]
    v_pk_fma_f32 v[22:23], v[142:143], s[48:49], 0.5 op_sel_hi:[1,0,0]
    v_exp_f32 v16, v16
    s_add_u32 s54, s31, 0xd8c00
    buffer_store_dwordx4 v[116:119], v6, s[12:15], s54 offen offset:0 sc1
    v_exp_f32 v17, v17
    v_exp_f32 v18, v18
    v_exp_f32 v19, v19
    v_exp_f32 v20, v20
    v_exp_f32 v21, v21
    v_exp_f32 v22, v22
    v_exp_f32 v23, v23
    v_pk_fma_f32 v[24:25], v[16:17], s[50:51], 1.0 op_sel_hi:[1,0,0]
    v_pk_fma_f32 v[26:27], v[18:19], s[50:51], 1.0 op_sel_hi:[1,0,0]
    v_pk_fma_f32 v[28:29], v[20:21], s[50:51], 1.0 op_sel_hi:[1,0,0]
    v_pk_fma_f32 v[30:31], v[22:23], s[50:51], 1.0 op_sel_hi:[1,0,0]
    v_pk_fma_f32 v[16:17], v[16:17], v[16:17], v[24:25]
    v_pk_fma_f32 v[18:19], v[18:19], v[18:19], v[26:27]
    v_pk_fma_f32 v[20:21], v[20:21], v[20:21], v[28:29]
    v_pk_fma_f32 v[22:23], v[22:23], v[22:23], v[30:31]
    v_rcp_f32 v16, v16
    v_rcp_f32 v17, v17
    v_rcp_f32 v18, v18
    v_rcp_f32 v19, v19
    v_rcp_f32 v20, v20
    v_rcp_f32 v21, v21
    v_rcp_f32 v22, v22
    v_rcp_f32 v23, v23
    v_pk_mul_f32 v[16:17], v[24:25], v[16:17] clamp
    v_pk_mul_f32 v[18:19], v[26:27], v[18:19] clamp
    v_pk_mul_f32 v[20:21], v[28:29], v[20:21] clamp
    v_pk_mul_f32 v[22:23], v[30:31], v[22:23] clamp
    v_pk_mul_f32 v[16:17], v[112:113], v[16:17]
    v_pk_mul_f32 v[18:19], v[114:115], v[18:19]
    v_pk_mul_f32 v[20:21], v[140:141], v[20:21]
    v_pk_mul_f32 v[22:23], v[142:143], v[22:23]
    v_cvt_pk_bf16_f32 v112, v16, v17
    v_cvt_pk_bf16_f32 v113, v18, v19
    v_cvt_pk_bf16_f32 v114, v20, v21
    v_cvt_pk_bf16_f32 v115, v22, v23
    v_pk_fma_f32 v[16:17], v[144:145], s[48:49], 0.5 op_sel_hi:[1,0,0]
    v_pk_fma_f32 v[18:19], v[146:147], s[48:49], 0.5 op_sel_hi:[1,0,0]
    v_pk_fma_f32 v[20:21], v[148:149], s[48:49], 0.5 op_sel_hi:[1,0,0]
    v_pk_fma_f32 v[22:23], v[150:151], s[48:49], 0.5 op_sel_hi:[1,0,0]
    v_exp_f32 v16, v16
    v_permlane16_swap_b32 v112, v114
    v_permlane16_swap_b32 v113, v115
    s_add_u32 s54, s31, 0x90800
    buffer_store_dwordx4 v[112:115], v8, s[12:15], s54 offen sc1
    v_exp_f32 v17, v17
    v_exp_f32 v18, v18
    v_exp_f32 v19, v19
    v_exp_f32 v20, v20
    v_exp_f32 v21, v21
    v_exp_f32 v22, v22
    v_exp_f32 v23, v23
    v_pk_fma_f32 v[24:25], v[16:17], s[50:51], 1.0 op_sel_hi:[1,0,0]
    v_pk_fma_f32 v[26:27], v[18:19], s[50:51], 1.0 op_sel_hi:[1,0,0]
    v_pk_fma_f32 v[28:29], v[20:21], s[50:51], 1.0 op_sel_hi:[1,0,0]
    v_pk_fma_f32 v[30:31], v[22:23], s[50:51], 1.0 op_sel_hi:[1,0,0]
    v_pk_fma_f32 v[16:17], v[16:17], v[16:17], v[24:25]
    v_pk_fma_f32 v[18:19], v[18:19], v[18:19], v[26:27]
    v_pk_fma_f32 v[20:21], v[20:21], v[20:21], v[28:29]
    v_pk_fma_f32 v[22:23], v[22:23], v[22:23], v[30:31]
    v_rcp_f32 v16, v16
    v_rcp_f32 v17, v17
    v_rcp_f32 v18, v18
    v_rcp_f32 v19, v19
    v_rcp_f32 v20, v20
    v_rcp_f32 v21, v21
    v_rcp_f32 v22, v22
    v_rcp_f32 v23, v23
    v_pk_mul_f32 v[16:17], v[24:25], v[16:17] clamp
    v_pk_mul_f32 v[18:19], v[26:27], v[18:19] clamp
    v_pk_mul_f32 v[20:21], v[28:29], v[20:21] clamp
    v_pk_mul_f32 v[22:23], v[30:31], v[22:23] clamp
    v_pk_mul_f32 v[16:17], v[144:145], v[16:17]
    v_pk_mul_f32 v[18:19], v[146:147], v[18:19]
    v_pk_mul_f32 v[20:21], v[148:149], v[20:21]
    v_pk_mul_f32 v[22:23], v[150:151], v[22:23]
    v_cvt_pk_bf16_f32 v144, v16, v17
    v_cvt_pk_bf16_f32 v145, v18, v19
    v_cvt_pk_bf16_f32 v146, v20, v21
    v_cvt_pk_bf16_f32 v147, v22, v23
    v_pk_fma_f32 v[16:17], v[172:173], s[48:49], 0.5 op_sel_hi:[1,0,0]
    v_pk_fma_f32 v[18:19], v[174:175], s[48:49], 0.5 op_sel_hi:[1,0,0]
    v_pk_fma_f32 v[20:21], v[176:177], s[48:49], 0.5 op_sel_hi:[1,0,0]
    v_pk_fma_f32 v[22:23], v[178:179], s[48:49], 0.5 op_sel_hi:[1,0,0]
    v_exp_f32 v16, v16
    s_add_u32 s54, s31, 0x121000
    buffer_store_dwordx4 v[144:147], v6, s[12:15], s54 offen offset:0 sc1
    v_exp_f32 v17, v17
    v_exp_f32 v18, v18
    v_exp_f32 v19, v19
    v_exp_f32 v20, v20
    v_exp_f32 v21, v21
    v_exp_f32 v22, v22
    v_exp_f32 v23, v23
    v_pk_fma_f32 v[24:25], v[16:17], s[50:51], 1.0 op_sel_hi:[1,0,0]
    v_pk_fma_f32 v[26:27], v[18:19], s[50:51], 1.0 op_sel_hi:[1,0,0]
    v_pk_fma_f32 v[28:29], v[20:21], s[50:51], 1.0 op_sel_hi:[1,0,0]
    v_pk_fma_f32 v[30:31], v[22:23], s[50:51], 1.0 op_sel_hi:[1,0,0]
    v_pk_fma_f32 v[16:17], v[16:17], v[16:17], v[24:25]
    v_pk_fma_f32 v[18:19], v[18:19], v[18:19], v[26:27]
    v_pk_fma_f32 v[20:21], v[20:21], v[20:21], v[28:29]
    v_pk_fma_f32 v[22:23], v[22:23], v[22:23], v[30:31]
    v_rcp_f32 v16, v16
    v_rcp_f32 v17, v17
    v_rcp_f32 v18, v18
    v_rcp_f32 v19, v19
    v_rcp_f32 v20, v20
    v_rcp_f32 v21, v21
    v_rcp_f32 v22, v22
    v_rcp_f32 v23, v23
    v_pk_mul_f32 v[16:17], v[24:25], v[16:17] clamp
    v_pk_mul_f32 v[18:19], v[26:27], v[18:19] clamp
    v_pk_mul_f32 v[20:21], v[28:29], v[20:21] clamp
    v_pk_mul_f32 v[22:23], v[30:31], v[22:23] clamp
    v_pk_mul_f32 v[16:17], v[172:173], v[16:17]
    v_pk_mul_f32 v[18:19], v[174:175], v[18:19]
    v_pk_mul_f32 v[20:21], v[176:177], v[20:21]
    v_pk_mul_f32 v[22:23], v[178:179], v[22:23]
    v_cvt_pk_bf16_f32 v172, v16, v17
    v_cvt_pk_bf16_f32 v173, v18, v19
    v_cvt_pk_bf16_f32 v174, v20, v21
    v_cvt_pk_bf16_f32 v175, v22, v23
    v_pk_fma_f32 v[16:17], v[168:169], s[48:49], 0.5 op_sel_hi:[1,0,0]
    v_pk_fma_f32 v[18:19], v[170:171], s[48:49], 0.5 op_sel_hi:[1,0,0]
    v_pk_fma_f32 v[20:21], v[196:197], s[48:49], 0.5 op_sel_hi:[1,0,0]
    v_pk_fma_f32 v[22:23], v[198:199], s[48:49], 0.5 op_sel_hi:[1,0,0]
    v_exp_f32 v16, v16
    s_add_u32 s54, s31, 0x169400
    buffer_store_dwordx4 v[172:175], v6, s[12:15], s54 offen offset:0 sc1
    v_exp_f32 v17, v17
    v_exp_f32 v18, v18
    v_exp_f32 v19, v19
    v_exp_f32 v20, v20
    v_exp_f32 v21, v21
    v_exp_f32 v22, v22
    v_exp_f32 v23, v23
    v_pk_fma_f32 v[24:25], v[16:17], s[50:51], 1.0 op_sel_hi:[1,0,0]
    v_pk_fma_f32 v[26:27], v[18:19], s[50:51], 1.0 op_sel_hi:[1,0,0]
    v_pk_fma_f32 v[28:29], v[20:21], s[50:51], 1.0 op_sel_hi:[1,0,0]
    v_pk_fma_f32 v[30:31], v[22:23], s[50:51], 1.0 op_sel_hi:[1,0,0]
    v_pk_fma_f32 v[16:17], v[16:17], v[16:17], v[24:25]
    v_pk_fma_f32 v[18:19], v[18:19], v[18:19], v[26:27]
    v_pk_fma_f32 v[20:21], v[20:21], v[20:21], v[28:29]
    v_pk_fma_f32 v[22:23], v[22:23], v[22:23], v[30:31]
    v_rcp_f32 v16, v16
    v_rcp_f32 v17, v17
    v_rcp_f32 v18, v18
    v_rcp_f32 v19, v19
    v_rcp_f32 v20, v20
    v_rcp_f32 v21, v21
    v_rcp_f32 v22, v22
    v_rcp_f32 v23, v23
    v_pk_mul_f32 v[16:17], v[24:25], v[16:17] clamp
    v_pk_mul_f32 v[18:19], v[26:27], v[18:19] clamp
    v_pk_mul_f32 v[20:21], v[28:29], v[20:21] clamp
    v_pk_mul_f32 v[22:23], v[30:31], v[22:23] clamp
    v_pk_mul_f32 v[16:17], v[168:169], v[16:17]
    v_pk_mul_f32 v[18:19], v[170:171], v[18:19]
    v_pk_mul_f32 v[20:21], v[196:197], v[20:21]
    v_pk_mul_f32 v[22:23], v[198:199], v[22:23]
    v_cvt_pk_bf16_f32 v168, v16, v17
    v_cvt_pk_bf16_f32 v169, v18, v19
    v_cvt_pk_bf16_f32 v170, v20, v21
    v_cvt_pk_bf16_f32 v171, v22, v23
    v_pk_fma_f32 v[16:17], v[200:201], s[48:49], 0.5 op_sel_hi:[1,0,0]
    v_pk_fma_f32 v[18:19], v[202:203], s[48:49], 0.5 op_sel_hi:[1,0,0]
    v_pk_fma_f32 v[20:21], v[204:205], s[48:49], 0.5 op_sel_hi:[1,0,0]
    v_pk_fma_f32 v[22:23], v[206:207], s[48:49], 0.5 op_sel_hi:[1,0,0]
    v_exp_f32 v16, v16
    v_permlane16_swap_b32 v168, v170
    v_permlane16_swap_b32 v169, v171
    s_add_u32 s54, s31, 0x121000
    buffer_store_dwordx4 v[168:171], v8, s[12:15], s54 offen sc1
    v_exp_f32 v17, v17
    v_exp_f32 v18, v18
    v_exp_f32 v19, v19
    v_exp_f32 v20, v20
    v_exp_f32 v21, v21
    v_exp_f32 v22, v22
    v_exp_f32 v23, v23
    v_pk_fma_f32 v[24:25], v[16:17], s[50:51], 1.0 op_sel_hi:[1,0,0]
    v_pk_fma_f32 v[26:27], v[18:19], s[50:51], 1.0 op_sel_hi:[1,0,0]
    v_pk_fma_f32 v[28:29], v[20:21], s[50:51], 1.0 op_sel_hi:[1,0,0]
    v_pk_fma_f32 v[30:31], v[22:23], s[50:51], 1.0 op_sel_hi:[1,0,0]
    v_pk_fma_f32 v[16:17], v[16:17], v[16:17], v[24:25]
    v_pk_fma_f32 v[18:19], v[18:19], v[18:19], v[26:27]
    v_pk_fma_f32 v[20:21], v[20:21], v[20:21], v[28:29]
    v_pk_fma_f32 v[22:23], v[22:23], v[22:23], v[30:31]
    v_rcp_f32 v16, v16
    v_rcp_f32 v17, v17
    v_rcp_f32 v18, v18
    v_rcp_f32 v19, v19
    v_rcp_f32 v20, v20
    v_rcp_f32 v21, v21
    v_rcp_f32 v22, v22
    v_rcp_f32 v23, v23
    v_pk_mul_f32 v[16:17], v[24:25], v[16:17] clamp
    v_pk_mul_f32 v[18:19], v[26:27], v[18:19] clamp
    v_pk_mul_f32 v[20:21], v[28:29], v[20:21] clamp
    v_pk_mul_f32 v[22:23], v[30:31], v[22:23] clamp
    v_pk_mul_f32 v[16:17], v[200:201], v[16:17]
    v_pk_mul_f32 v[18:19], v[202:203], v[18:19]
    v_pk_mul_f32 v[20:21], v[204:205], v[20:21]
    v_pk_mul_f32 v[22:23], v[206:207], v[22:23]
    v_cvt_pk_bf16_f32 v200, v16, v17
    v_cvt_pk_bf16_f32 v201, v18, v19
    v_cvt_pk_bf16_f32 v202, v20, v21
    v_cvt_pk_bf16_f32 v203, v22, v23
    v_pk_fma_f32 v[16:17], v[228:229], s[48:49], 0.5 op_sel_hi:[1,0,0]
    v_pk_fma_f32 v[18:19], v[230:231], s[48:49], 0.5 op_sel_hi:[1,0,0]
    v_pk_fma_f32 v[20:21], v[232:233], s[48:49], 0.5 op_sel_hi:[1,0,0]
    v_pk_fma_f32 v[22:23], v[234:235], s[48:49], 0.5 op_sel_hi:[1,0,0]
    v_exp_f32 v16, v16
    s_add_u32 s54, s31, 0x1b1800
    buffer_store_dwordx4 v[200:203], v6, s[12:15], s54 offen offset:0 sc1
    v_exp_f32 v17, v17
    v_exp_f32 v18, v18
    v_exp_f32 v19, v19
    v_exp_f32 v20, v20
    v_exp_f32 v21, v21
    v_exp_f32 v22, v22
    v_exp_f32 v23, v23
    v_pk_fma_f32 v[24:25], v[16:17], s[50:51], 1.0 op_sel_hi:[1,0,0]
    v_pk_fma_f32 v[26:27], v[18:19], s[50:51], 1.0 op_sel_hi:[1,0,0]
    v_pk_fma_f32 v[28:29], v[20:21], s[50:51], 1.0 op_sel_hi:[1,0,0]
    v_pk_fma_f32 v[30:31], v[22:23], s[50:51], 1.0 op_sel_hi:[1,0,0]
    v_pk_fma_f32 v[16:17], v[16:17], v[16:17], v[24:25]
    v_pk_fma_f32 v[18:19], v[18:19], v[18:19], v[26:27]
    v_pk_fma_f32 v[20:21], v[20:21], v[20:21], v[28:29]
    v_pk_fma_f32 v[22:23], v[22:23], v[22:23], v[30:31]
    v_rcp_f32 v16, v16
    v_rcp_f32 v17, v17
    v_rcp_f32 v18, v18
    v_rcp_f32 v19, v19
    v_rcp_f32 v20, v20
    v_rcp_f32 v21, v21
    v_rcp_f32 v22, v22
    v_rcp_f32 v23, v23
    v_pk_mul_f32 v[16:17], v[24:25], v[16:17] clamp
    v_pk_mul_f32 v[18:19], v[26:27], v[18:19] clamp
    v_pk_mul_f32 v[20:21], v[28:29], v[20:21] clamp
    v_pk_mul_f32 v[22:23], v[30:31], v[22:23] clamp
    v_pk_mul_f32 v[16:17], v[228:229], v[16:17]
    v_pk_mul_f32 v[18:19], v[230:231], v[18:19]
    v_pk_mul_f32 v[20:21], v[232:233], v[20:21]
    v_pk_mul_f32 v[22:23], v[234:235], v[22:23]
    v_cvt_pk_bf16_f32 v228, v16, v17
    v_cvt_pk_bf16_f32 v229, v18, v19
    v_cvt_pk_bf16_f32 v230, v20, v21
    v_cvt_pk_bf16_f32 v231, v22, v23
    v_pk_fma_f32 v[16:17], v[224:225], s[48:49], 0.5 op_sel_hi:[1,0,0]
    v_pk_fma_f32 v[18:19], v[226:227], s[48:49], 0.5 op_sel_hi:[1,0,0]
    v_pk_fma_f32 v[20:21], v[252:253], s[48:49], 0.5 op_sel_hi:[1,0,0]
    v_pk_fma_f32 v[22:23], v[254:255], s[48:49], 0.5 op_sel_hi:[1,0,0]
    v_exp_f32 v16, v16
    s_add_u32 s54, s31, 0x1f9c00
    buffer_store_dwordx4 v[228:231], v6, s[12:15], s54 offen offset:0 sc1
    v_exp_f32 v17, v17
    v_exp_f32 v18, v18
    v_exp_f32 v19, v19
    v_exp_f32 v20, v20
    v_exp_f32 v21, v21
    v_exp_f32 v22, v22
    v_exp_f32 v23, v23
    v_pk_fma_f32 v[24:25], v[16:17], s[50:51], 1.0 op_sel_hi:[1,0,0]
    v_pk_fma_f32 v[26:27], v[18:19], s[50:51], 1.0 op_sel_hi:[1,0,0]
    v_pk_fma_f32 v[28:29], v[20:21], s[50:51], 1.0 op_sel_hi:[1,0,0]
    v_pk_fma_f32 v[30:31], v[22:23], s[50:51], 1.0 op_sel_hi:[1,0,0]
    v_pk_fma_f32 v[16:17], v[16:17], v[16:17], v[24:25]
    v_pk_fma_f32 v[18:19], v[18:19], v[18:19], v[26:27]
    v_pk_fma_f32 v[20:21], v[20:21], v[20:21], v[28:29]
    v_pk_fma_f32 v[22:23], v[22:23], v[22:23], v[30:31]
    v_rcp_f32 v16, v16
    v_rcp_f32 v17, v17
    v_rcp_f32 v18, v18
    v_rcp_f32 v19, v19
    v_rcp_f32 v20, v20
    v_rcp_f32 v21, v21
    v_rcp_f32 v22, v22
    v_rcp_f32 v23, v23
    v_pk_mul_f32 v[16:17], v[24:25], v[16:17] clamp
    v_pk_mul_f32 v[18:19], v[26:27], v[18:19] clamp
    v_pk_mul_f32 v[20:21], v[28:29], v[20:21] clamp
    v_pk_mul_f32 v[22:23], v[30:31], v[22:23] clamp
    v_pk_mul_f32 v[16:17], v[224:225], v[16:17]
    v_pk_mul_f32 v[18:19], v[226:227], v[18:19]
L_pg4:
    s_cbranch_execz L_tramp
    v_pk_mul_f32 v[20:21], v[252:253], v[20:21]
    v_pk_mul_f32 v[22:23], v[254:255], v[22:23]
    v_cvt_pk_bf16_f32 v224, v16, v17
    v_cvt_pk_bf16_f32 v225, v18, v19
    v_cvt_pk_bf16_f32 v226, v20, v21
    v_cvt_pk_bf16_f32 v227, v22, v23
    v_pk_fma_f32 v[16:17], v[40:41], s[48:49], 0.5 op_sel_hi:[1,0,0]
    v_pk_fma_f32 v[18:19], v[42:43], s[48:49], 0.5 op_sel_hi:[1,0,0]
    v_pk_fma_f32 v[20:21], v[44:45], s[48:49], 0.5 op_sel_hi:[1,0,0]
    v_pk_fma_f32 v[22:23], v[46:47], s[48:49], 0.5 op_sel_hi:[1,0,0]
    v_exp_f32 v16, v16
    v_permlane16_swap_b32 v224, v226
    v_permlane16_swap_b32 v225, v227
    s_add_u32 s54, s31, 0x1b1800
    buffer_store_dwordx4 v[224:227], v8, s[12:15], s54 offen sc1
    v_exp_f32 v17, v17
    v_exp_f32 v18, v18
    v_exp_f32 v19, v19
    v_exp_f32 v20, v20
    v_exp_f32 v21, v21
    v_exp_f32 v22, v22
    v_exp_f32 v23, v23
    v_pk_fma_f32 v[24:25], v[16:17], s[50:51], 1.0 op_sel_hi:[1,0,0]
    v_pk_fma_f32 v[26:27], v[18:19], s[50:51], 1.0 op_sel_hi:[1,0,0]
    v_pk_fma_f32 v[28:29], v[20:21], s[50:51], 1.0 op_sel_hi:[1,0,0]
    v_pk_fma_f32 v[30:31], v[22:23], s[50:51], 1.0 op_sel_hi:[1,0,0]
    v_pk_fma_f32 v[16:17], v[16:17], v[16:17], v[24:25]
    v_pk_fma_f32 v[18:19], v[18:19], v[18:19], v[26:27]
    v_pk_fma_f32 v[20:21], v[20:21], v[20:21], v[28:29]
    v_pk_fma_f32 v[22:23], v[22:23], v[22:23], v[30:31]
    v_rcp_f32 v16, v16
    v_rcp_f32 v17, v17
    v_rcp_f32 v18, v18
    v_rcp_f32 v19, v19
    v_rcp_f32 v20, v20
    v_rcp_f32 v21, v21
    v_rcp_f32 v22, v22
    v_rcp_f32 v23, v23
    v_pk_mul_f32 v[16:17], v[24:25], v[16:17] clamp
    v_pk_mul_f32 v[18:19], v[26:27], v[18:19] clamp
    v_pk_mul_f32 v[20:21], v[28:29], v[20:21] clamp
    v_pk_mul_f32 v[22:23], v[30:31], v[22:23] clamp
    v_pk_mul_f32 v[16:17], v[40:41], v[16:17]
    v_pk_mul_f32 v[18:19], v[42:43], v[18:19]
    v_pk_mul_f32 v[20:21], v[44:45], v[20:21]
    v_pk_mul_f32 v[22:23], v[46:47], v[22:23]
    v_cvt_pk_bf16_f32 v40, v16, v17
    v_cvt_pk_bf16_f32 v41, v18, v19
    v_cvt_pk_bf16_f32 v42, v20, v21
    v_cvt_pk_bf16_f32 v43, v22, v23
    v_pk_fma_f32 v[16:17], v[48:49], s[48:49], 0.5 op_sel_hi:[1,0,0]
    v_pk_fma_f32 v[18:19], v[50:51], s[48:49], 0.5 op_sel_hi:[1,0,0]
    v_pk_fma_f32 v[20:21], v[52:53], s[48:49], 0.5 op_sel_hi:[1,0,0]
    v_pk_fma_f32 v[22:23], v[54:55], s[48:49], 0.5 op_sel_hi:[1,0,0]
    v_exp_f32 v16, v16
    s_add_u32 s54, s31, 0x0
    buffer_store_dwordx4 v[40:43], v7, s[12:15], s54 offen offset:0 sc1
    v_exp_f32 v17, v17
    v_exp_f32 v18, v18
    v_exp_f32 v19, v19
    v_exp_f32 v20, v20
    v_exp_f32 v21, v21
    v_exp_f32 v22, v22
    v_exp_f32 v23, v23
    v_pk_fma_f32 v[24:25], v[16:17], s[50:51], 1.0 op_sel_hi:[1,0,0]
    v_pk_fma_f32 v[26:27], v[18:19], s[50:51], 1.0 op_sel_hi:[1,0,0]
    v_pk_fma_f32 v[28:29], v[20:21], s[50:51], 1.0 op_sel_hi:[1,0,0]
    v_pk_fma_f32 v[30:31], v[22:23], s[50:51], 1.0 op_sel_hi:[1,0,0]
    v_pk_fma_f32 v[16:17], v[16:17], v[16:17], v[24:25]
    v_pk_fma_f32 v[18:19], v[18:19], v[18:19], v[26:27]
    v_pk_fma_f32 v[20:21], v[20:21], v[20:21], v[28:29]
    v_pk_fma_f32 v[22:23], v[22:23], v[22:23], v[30:31]
    v_rcp_f32 v16, v16
    v_rcp_f32 v17, v17
    v_rcp_f32 v18, v18
    v_rcp_f32 v19, v19
    v_rcp_f32 v20, v20
    v_rcp_f32 v21, v21
    v_rcp_f32 v22, v22
    v_rcp_f32 v23, v23
    v_pk_mul_f32 v[16:17], v[24:25], v[16:17] clamp
    v_pk_mul_f32 v[18:19], v[26:27], v[18:19] clamp
    v_pk_mul_f32 v[20:21], v[28:29], v[20:21] clamp
    v_pk_mul_f32 v[22:23], v[30:31], v[22:23] clamp
    v_pk_mul_f32 v[16:17], v[48:49], v[16:17]
    v_pk_mul_f32 v[18:19], v[50:51], v[18:19]
    v_pk_mul_f32 v[20:21], v[52:53], v[20:21]
    v_pk_mul_f32 v[22:23], v[54:55], v[22:23]
    v_cvt_pk_bf16_f32 v48, v16, v17
    v_cvt_pk_bf16_f32 v49, v18, v19
    v_cvt_pk_bf16_f32 v50, v20, v21
    v_cvt_pk_bf16_f32 v51, v22, v23
    v_pk_fma_f32 v[16:17], v[68:69], s[48:49], 0.5 op_sel_hi:[1,0,0]
    v_pk_fma_f32 v[18:19], v[70:71], s[48:49], 0.5 op_sel_hi:[1,0,0]
    v_pk_fma_f32 v[20:21], v[72:73], s[48:49], 0.5 op_sel_hi:[1,0,0]
    v_pk_fma_f32 v[22:23], v[74:75], s[48:49], 0.5 op_sel_hi:[1,0,0]
    v_exp_f32 v16, v16
    buffer_store_dwordx4 v[48:51], v7, s[12:15], s54 offen offset:2048 sc1
    v_exp_f32 v17, v17
    v_exp_f32 v18, v18
    v_exp_f32 v19, v19
    v_exp_f32 v20, v20
    v_exp_f32 v21, v21
    v_exp_f32 v22, v22
    v_exp_f32 v23, v23
    v_pk_fma_f32 v[24:25], v[16:17], s[50:51], 1.0 op_sel_hi:[1,0,0]
    v_pk_fma_f32 v[26:27], v[18:19], s[50:51], 1.0 op_sel_hi:[1,0,0]
    v_pk_fma_f32 v[28:29], v[20:21], s[50:51], 1.0 op_sel_hi:[1,0,0]
    v_pk_fma_f32 v[30:31], v[22:23], s[50:51], 1.0 op_sel_hi:[1,0,0]
    v_pk_fma_f32 v[16:17], v[16:17], v[16:17], v[24:25]
    v_pk_fma_f32 v[18:19], v[18:19], v[18:19], v[26:27]
    v_pk_fma_f32 v[20:21], v[20:21], v[20:21], v[28:29]
    v_pk_fma_f32 v[22:23], v[22:23], v[22:23], v[30:31]
    v_rcp_f32 v16, v16
    v_rcp_f32 v17, v17
    v_rcp_f32 v18, v18
    v_rcp_f32 v19, v19
    v_rcp_f32 v20, v20
    v_rcp_f32 v21, v21
    v_rcp_f32 v22, v22
    v_rcp_f32 v23, v23
    v_pk_mul_f32 v[16:17], v[24:25], v[16:17] clamp
    v_pk_mul_f32 v[18:19], v[26:27], v[18:19] clamp
    v_pk_mul_f32 v[20:21], v[28:29], v[20:21] clamp
    v_pk_mul_f32 v[22:23], v[30:31], v[22:23] clamp
    v_pk_mul_f32 v[16:17], v[68:69], v[16:17]
    v_pk_mul_f32 v[18:19], v[70:71], v[18:19]
    v_pk_mul_f32 v[20:21], v[72:73], v[20:21]
    v_pk_mul_f32 v[22:23], v[74:75], v[22:23]
    v_cvt_pk_bf16_f32 v68, v16, v17
    v_cvt_pk_bf16_f32 v69, v18, v19
    v_cvt_pk_bf16_f32 v70, v20, v21
    v_cvt_pk_bf16_f32 v71, v22, v23
    v_pk_fma_f32 v[16:17], v[76:77], s[48:49], 0.5 op_sel_hi:[1,0,0]
    v_pk_fma_f32 v[18:19], v[78:79], s[48:49], 0.5 op_sel_hi:[1,0,0]
    v_pk_fma_f32 v[20:21], v[80:81], s[48:49], 0.5 op_sel_hi:[1,0,0]
    v_pk_fma_f32 v[22:23], v[82:83], s[48:49], 0.5 op_sel_hi:[1,0,0]
    v_exp_f32 v16, v16
    s_add_u32 s54, s31, 0x48400
    buffer_store_dwordx4 v[68:71], v7, s[12:15], s54 offen offset:0 sc1
    v_exp_f32 v17, v17
    v_exp_f32 v18, v18
    v_exp_f32 v19, v19
    v_exp_f32 v20, v20
    v_exp_f32 v21, v21
    v_exp_f32 v22, v22
    v_exp_f32 v23, v23
    v_pk_fma_f32 v[24:25], v[16:17], s[50:51], 1.0 op_sel_hi:[1,0,0]
    v_pk_fma_f32 v[26:27], v[18:19], s[50:51], 1.0 op_sel_hi:[1,0,0]
    v_pk_fma_f32 v[28:29], v[20:21], s[50:51], 1.0 op_sel_hi:[1,0,0]
    v_pk_fma_f32 v[30:31], v[22:23], s[50:51], 1.0 op_sel_hi:[1,0,0]
    v_pk_fma_f32 v[16:17], v[16:17], v[16:17], v[24:25]
    v_pk_fma_f32 v[18:19], v[18:19], v[18:19], v[26:27]
    v_pk_fma_f32 v[20:21], v[20:21], v[20:21], v[28:29]
    v_pk_fma_f32 v[22:23], v[22:23], v[22:23], v[30:31]
    v_rcp_f32 v16, v16
    v_rcp_f32 v17, v17
    s_waitcnt vmcnt(3)
    s_add_u32 s78, s32, s41
    s_mov_b64 exec, 1
    buffer_store_dword v15, v11, s[12:15], s78 offen sc1
    s_mov_b64 exec, -1
    v_rcp_f32 v18, v18
    v_rcp_f32 v19, v19
    v_rcp_f32 v20, v20
    v_rcp_f32 v21, v21
    v_rcp_f32 v22, v22
    v_rcp_f32 v23, v23
    v_pk_mul_f32 v[16:17], v[24:25], v[16:17] clamp
    v_pk_mul_f32 v[18:19], v[26:27], v[18:19] clamp
    v_pk_mul_f32 v[20:21], v[28:29], v[20:21] clamp
    v_pk_mul_f32 v[22:23], v[30:31], v[22:23] clamp
    v_pk_mul_f32 v[16:17], v[76:77], v[16:17]
    v_pk_mul_f32 v[18:19], v[78:79], v[18:19]
    v_pk_mul_f32 v[20:21], v[80:81], v[20:21]
    v_pk_mul_f32 v[22:23], v[82:83], v[22:23]
    v_cvt_pk_bf16_f32 v76, v16, v17
    v_cvt_pk_bf16_f32 v77, v18, v19
    v_cvt_pk_bf16_f32 v78, v20, v21
    v_cvt_pk_bf16_f32 v79, v22, v23
    v_pk_fma_f32 v[16:17], v[96:97], s[48:49], 0.5 op_sel_hi:[1,0,0]
    v_pk_fma_f32 v[18:19], v[98:99], s[48:49], 0.5 op_sel_hi:[1,0,0]
    v_pk_fma_f32 v[20:21], v[100:101], s[48:49], 0.5 op_sel_hi:[1,0,0]
    v_pk_fma_f32 v[22:23], v[102:103], s[48:49], 0.5 op_sel_hi:[1,0,0]
    v_exp_f32 v16, v16
    buffer_store_dwordx4 v[76:79], v7, s[12:15], s54 offen offset:2048 sc1
    v_exp_f32 v17, v17
    v_exp_f32 v18, v18
    v_exp_f32 v19, v19
    v_exp_f32 v20, v20
    v_exp_f32 v21, v21
    v_exp_f32 v22, v22
    v_exp_f32 v23, v23
    v_pk_fma_f32 v[24:25], v[16:17], s[50:51], 1.0 op_sel_hi:[1,0,0]
    v_pk_fma_f32 v[26:27], v[18:19], s[50:51], 1.0 op_sel_hi:[1,0,0]
    v_pk_fma_f32 v[28:29], v[20:21], s[50:51], 1.0 op_sel_hi:[1,0,0]
    v_pk_fma_f32 v[30:31], v[22:23], s[50:51], 1.0 op_sel_hi:[1,0,0]
    v_pk_fma_f32 v[16:17], v[16:17], v[16:17], v[24:25]
    v_pk_fma_f32 v[18:19], v[18:19], v[18:19], v[26:27]
    v_pk_fma_f32 v[20:21], v[20:21], v[20:21], v[28:29]
    v_pk_fma_f32 v[22:23], v[22:23], v[22:23], v[30:31]
    v_rcp_f32 v16, v16
    v_rcp_f32 v17, v17
    v_rcp_f32 v18, v18
    v_rcp_f32 v19, v19
    v_rcp_f32 v20, v20
    v_rcp_f32 v21, v21
    v_rcp_f32 v22, v22
    v_rcp_f32 v23, v23
    v_pk_mul_f32 v[16:17], v[24:25], v[16:17] clamp
    v_pk_mul_f32 v[18:19], v[26:27], v[18:19] clamp
    v_pk_mul_f32 v[20:21], v[28:29], v[20:21] clamp
    v_pk_mul_f32 v[22:23], v[30:31], v[22:23] clamp
    v_pk_mul_f32 v[16:17], v[96:97], v[16:17]
    v_pk_mul_f32 v[18:19], v[98:99], v[18:19]
    v_pk_mul_f32 v[20:21], v[100:101], v[20:21]
    v_pk_mul_f32 v[22:23], v[102:103], v[22:23]
    v_cvt_pk_bf16_f32 v96, v16, v17
    v_cvt_pk_bf16_f32 v97, v18, v19
    v_cvt_pk_bf16_f32 v98, v20, v21
    v_cvt_pk_bf16_f32 v99, v22, v23
    v_pk_fma_f32 v[16:17], v[104:105], s[48:49], 0.5 op_sel_hi:[1,0,0]
    v_pk_fma_f32 v[18:19], v[106:107], s[48:49], 0.5 op_sel_hi:[1,0,0]
    v_pk_fma_f32 v[20:21], v[108:109], s[48:49], 0.5 op_sel_hi:[1,0,0]
    v_pk_fma_f32 v[22:23], v[110:111], s[48:49], 0.5 op_sel_hi:[1,0,0]
    v_exp_f32 v16, v16
    s_add_u32 s54, s31, 0x90800
    buffer_store_dwordx4 v[96:99], v7, s[12:15], s54 offen offset:0 sc1
    v_exp_f32 v17, v17
    v_exp_f32 v18, v18
    v_exp_f32 v19, v19
    v_exp_f32 v20, v20
    v_exp_f32 v21, v21
    v_exp_f32 v22, v22
    v_exp_f32 v23, v23
    v_pk_fma_f32 v[24:25], v[16:17], s[50:51], 1.0 op_sel_hi:[1,0,0]
    v_pk_fma_f32 v[26:27], v[18:19], s[50:51], 1.0 op_sel_hi:[1,0,0]
    v_pk_fma_f32 v[28:29], v[20:21], s[50:51], 1.0 op_sel_hi:[1,0,0]
    v_pk_fma_f32 v[30:31], v[22:23], s[50:51], 1.0 op_sel_hi:[1,0,0]
    v_pk_fma_f32 v[16:17], v[16:17], v[16:17], v[24:25]
    v_pk_fma_f32 v[18:19], v[18:19], v[18:19], v[26:27]
    v_pk_fma_f32 v[20:21], v[20:21], v[20:21], v[28:29]
    v_pk_fma_f32 v[22:23], v[22:23], v[22:23], v[30:31]
    v_rcp_f32 v16, v16
    v_rcp_f32 v17, v17
    v_rcp_f32 v18, v18
    v_rcp_f32 v19, v19
    v_rcp_f32 v20, v20
    v_rcp_f32 v21, v21
    v_rcp_f32 v22, v22
    v_rcp_f32 v23, v23
    v_pk_mul_f32 v[16:17], v[24:25], v[16:17] clamp
    v_pk_mul_f32 v[18:19], v[26:27], v[18:19] clamp
    v_pk_mul_f32 v[20:21], v[28:29], v[20:21] clamp
    v_pk_mul_f32 v[22:23], v[30:31], v[22:23] clamp
    v_pk_mul_f32 v[16:17], v[104:105], v[16:17]
    v_pk_mul_f32 v[18:19], v[106:107], v[18:19]
    v_pk_mul_f32 v[20:21], v[108:109], v[20:21]
    v_pk_mul_f32 v[22:23], v[110:111], v[22:23]
    v_cvt_pk_bf16_f32 v104, v16, v17
    v_cvt_pk_bf16_f32 v105, v18, v19
    v_cvt_pk_bf16_f32 v106, v20, v21
    v_cvt_pk_bf16_f32 v107, v22, v23
    v_pk_fma_f32 v[16:17], v[124:125], s[48:49], 0.5 op_sel_hi:[1,0,0]
    v_pk_fma_f32 v[18:19], v[126:127], s[48:49], 0.5 op_sel_hi:[1,0,0]
    v_pk_fma_f32 v[20:21], v[128:129], s[48:49], 0.5 op_sel_hi:[1,0,0]
    v_pk_fma_f32 v[22:23], v[130:131], s[48:49], 0.5 op_sel_hi:[1,0,0]
    v_exp_f32 v16, v16
    buffer_store_dwordx4 v[104:107], v7, s[12:15], s54 offen offset:2048 sc1
    v_exp_f32 v17, v17
    v_exp_f32 v18, v18
    v_exp_f32 v19, v19
    v_exp_f32 v20, v20
    v_exp_f32 v21, v21
    v_exp_f32 v22, v22
    v_exp_f32 v23, v23
    v_pk_fma_f32 v[24:25], v[16:17], s[50:51], 1.0 op_sel_hi:[1,0,0]
    v_pk_fma_f32 v[26:27], v[18:19], s[50:51], 1.0 op_sel_hi:[1,0,0]
    v_pk_fma_f32 v[28:29], v[20:21], s[50:51], 1.0 op_sel_hi:[1,0,0]
    v_pk_fma_f32 v[30:31], v[22:23], s[50:51], 1.0 op_sel_hi:[1,0,0]
    v_pk_fma_f32 v[16:17], v[16:17], v[16:17], v[24:25]
    v_pk_fma_f32 v[18:19], v[18:19], v[18:19], v[26:27]
    v_pk_fma_f32 v[20:21], v[20:21], v[20:21], v[28:29]
    v_pk_fma_f32 v[22:23], v[22:23], v[22:23], v[30:31]
    v_rcp_f32 v16, v16
    v_rcp_f32 v17, v17
    v_rcp_f32 v18, v18
    v_rcp_f32 v19, v19
    v_rcp_f32 v20, v20
    v_rcp_f32 v21, v21
    v_rcp_f32 v22, v22
    v_rcp_f32 v23, v23
    v_pk_mul_f32 v[16:17], v[24:25], v[16:17] clamp
    v_pk_mul_f32 v[18:19], v[26:27], v[18:19] clamp
    v_pk_mul_f32 v[20:21], v[28:29], v[20:21] clamp
    v_pk_mul_f32 v[22:23], v[30:31], v[22:23] clamp
    v_pk_mul_f32 v[16:17], v[124:125], v[16:17]
    v_pk_mul_f32 v[18:19], v[126:127], v[18:19]
    v_pk_mul_f32 v[20:21], v[128:129], v[20:21]
    v_pk_mul_f32 v[22:23], v[130:131], v[22:23]
    v_cvt_pk_bf16_f32 v124, v16, v17
    v_cvt_pk_bf16_f32 v125, v18, v19
    v_cvt_pk_bf16_f32 v126, v20, v21
    v_cvt_pk_bf16_f32 v127, v22, v23
    v_pk_fma_f32 v[16:17], v[132:133], s[48:49], 0.5 op_sel_hi:[1,0,0]
    v_pk_fma_f32 v[18:19], v[134:135], s[48:49], 0.5 op_sel_hi:[1,0,0]
    v_pk_fma_f32 v[20:21], v[136:137], s[48:49], 0.5 op_sel_hi:[1,0,0]
    v_pk_fma_f32 v[22:23], v[138:139], s[48:49], 0.5 op_sel_hi:[1,0,0]
    v_exp_f32 v16, v16
    s_add_u32 s54, s31, 0xd8c00
    buffer_store_dwordx4 v[124:127], v7, s[12:15], s54 offen offset:0 sc1
    v_exp_f32 v17, v17
    v_exp_f32 v18, v18
    v_exp_f32 v19, v19
    v_exp_f32 v20, v20
    v_exp_f32 v21, v21
    v_exp_f32 v22, v22
    v_exp_f32 v23, v23
    v_pk_fma_f32 v[24:25], v[16:17], s[50:51], 1.0 op_sel_hi:[1,0,0]
    v_pk_fma_f32 v[26:27], v[18:19], s[50:51], 1.0 op_sel_hi:[1,0,0]
    v_pk_fma_f32 v[28:29], v[20:21], s[50:51], 1.0 op_sel_hi:[1,0,0]
    v_pk_fma_f32 v[30:31], v[22:23], s[50:51], 1.0 op_sel_hi:[1,0,0]
    v_pk_fma_f32 v[16:17], v[16:17], v[16:17], v[24:25]
    v_pk_fma_f32 v[18:19], v[18:19], v[18:19], v[26:27]
    v_pk_fma_f32 v[20:21], v[20:21], v[20:21], v[28:29]
    v_pk_fma_f32 v[22:23], v[22:23], v[22:23], v[30:31]
    v_rcp_f32 v16, v16
    v_rcp_f32 v17, v17
    v_rcp_f32 v18, v18
    v_rcp_f32 v19, v19
    v_rcp_f32 v20, v20
    v_rcp_f32 v21, v21
    v_rcp_f32 v22, v22
    v_rcp_f32 v23, v23
    v_pk_mul_f32 v[16:17], v[24:25], v[16:17] clamp
    v_pk_mul_f32 v[18:19], v[26:27], v[18:19] clamp
    v_pk_mul_f32 v[20:21], v[28:29], v[20:21] clamp
    v_pk_mul_f32 v[22:23], v[30:31], v[22:23] clamp
    v_pk_mul_f32 v[16:17], v[132:133], v[16:17]
    v_pk_mul_f32 v[18:19], v[134:135], v[18:19]
    v_pk_mul_f32 v[20:21], v[136:137], v[20:21]
    v_pk_mul_f32 v[22:23], v[138:139], v[22:23]
    v_cvt_pk_bf16_f32 v132, v16, v17
    v_cvt_pk_bf16_f32 v133, v18, v19
    v_cvt_pk_bf16_f32 v134, v20, v21
    v_cvt_pk_bf16_f32 v135, v22, v23
    v_pk_fma_f32 v[16:17], v[152:153], s[48:49], 0.5 op_sel_hi:[1,0,0]
    v_pk_fma_f32 v[18:19], v[154:155], s[48:49], 0.5 op_sel_hi:[1,0,0]
    v_pk_fma_f32 v[20:21], v[156:157], s[48:49], 0.5 op_sel_hi:[1,0,0]
    v_pk_fma_f32 v[22:23], v[158:159], s[48:49], 0.5 op_sel_hi:[1,0,0]
    v_exp_f32 v16, v16
    buffer_store_dwordx4 v[132:135], v7, s[12:15], s54 offen offset:2048 sc1
    v_exp_f32 v17, v17
    v_exp_f32 v18, v18
    v_exp_f32 v19, v19
    v_exp_f32 v20, v20
    v_exp_f32 v21, v21
    v_exp_f32 v22, v22
    v_exp_f32 v23, v23
    v_pk_fma_f32 v[24:25], v[16:17], s[50:51], 1.0 op_sel_hi:[1,0,0]
    v_pk_fma_f32 v[26:27], v[18:19], s[50:51], 1.0 op_sel_hi:[1,0,0]
    v_pk_fma_f32 v[28:29], v[20:21], s[50:51], 1.0 op_sel_hi:[1,0,0]
    v_pk_fma_f32 v[30:31], v[22:23], s[50:51], 1.0 op_sel_hi:[1,0,0]
    v_pk_fma_f32 v[16:17], v[16:17], v[16:17], v[24:25]
    v_pk_fma_f32 v[18:19], v[18:19], v[18:19], v[26:27]
    v_pk_fma_f32 v[20:21], v[20:21], v[20:21], v[28:29]
    v_pk_fma_f32 v[22:23], v[22:23], v[22:23], v[30:31]
    v_rcp_f32 v16, v16
    v_rcp_f32 v17, v17
    buffer_load_dword v9, v14, s[12:15], s38 offen offset:0 sc1
    v_rcp_f32 v18, v18
    v_rcp_f32 v19, v19
    v_rcp_f32 v20, v20
    v_rcp_f32 v21, v21
    v_rcp_f32 v22, v22
    v_rcp_f32 v23, v23
    v_pk_mul_f32 v[16:17], v[24:25], v[16:17] clamp
    v_pk_mul_f32 v[18:19], v[26:27], v[18:19] clamp
    v_pk_mul_f32 v[20:21], v[28:29], v[20:21] clamp
    v_pk_mul_f32 v[22:23], v[30:31], v[22:23] clamp
    v_pk_mul_f32 v[16:17], v[152:153], v[16:17]
    v_pk_mul_f32 v[18:19], v[154:155], v[18:19]
    v_pk_mul_f32 v[20:21], v[156:157], v[20:21]
    v_pk_mul_f32 v[22:23], v[158:159], v[22:23]
    v_cvt_pk_bf16_f32 v152, v16, v17
    v_cvt_pk_bf16_f32 v153, v18, v19
    v_cvt_pk_bf16_f32 v154, v20, v21
    v_cvt_pk_bf16_f32 v155, v22, v23
    v_pk_fma_f32 v[16:17], v[160:161], s[48:49], 0.5 op_sel_hi:[1,0,0]
    v_pk_fma_f32 v[18:19], v[162:163], s[48:49], 0.5 op_sel_hi:[1,0,0]
    v_pk_fma_f32 v[20:21], v[164:165], s[48:49], 0.5 op_sel_hi:[1,0,0]
    v_pk_fma_f32 v[22:23], v[166:167], s[48:49], 0.5 op_sel_hi:[1,0,0]
    v_exp_f32 v16, v16
    s_add_u32 s54, s31, 0x121000
    buffer_store_dwordx4 v[152:155], v7, s[12:15], s54 offen offset:0 sc1
    v_exp_f32 v17, v17
    v_exp_f32 v18, v18
    v_exp_f32 v19, v19
    v_exp_f32 v20, v20
    v_exp_f32 v21, v21
    v_exp_f32 v22, v22
    v_exp_f32 v23, v23
    v_pk_fma_f32 v[24:25], v[16:17], s[50:51], 1.0 op_sel_hi:[1,0,0]
    v_pk_fma_f32 v[26:27], v[18:19], s[50:51], 1.0 op_sel_hi:[1,0,0]
    v_pk_fma_f32 v[28:29], v[20:21], s[50:51], 1.0 op_sel_hi:[1,0,0]
    v_pk_fma_f32 v[30:31], v[22:23], s[50:51], 1.0 op_sel_hi:[1,0,0]
    v_pk_fma_f32 v[16:17], v[16:17], v[16:17], v[24:25]
    v_pk_fma_f32 v[18:19], v[18:19], v[18:19], v[26:27]
    v_pk_fma_f32 v[20:21], v[20:21], v[20:21], v[28:29]
    v_pk_fma_f32 v[22:23], v[22:23], v[22:23], v[30:31]
    v_rcp_f32 v16, v16
    v_rcp_f32 v17, v17
    v_rcp_f32 v18, v18
    v_rcp_f32 v19, v19
    v_rcp_f32 v20, v20
    v_rcp_f32 v21, v21
    v_rcp_f32 v22, v22
    v_rcp_f32 v23, v23
    v_pk_mul_f32 v[16:17], v[24:25], v[16:17] clamp
    v_pk_mul_f32 v[18:19], v[26:27], v[18:19] clamp
    v_pk_mul_f32 v[20:21], v[28:29], v[20:21] clamp
    v_pk_mul_f32 v[22:23], v[30:31], v[22:23] clamp
    v_pk_mul_f32 v[16:17], v[160:161], v[16:17]
    v_pk_mul_f32 v[18:19], v[162:163], v[18:19]
    v_pk_mul_f32 v[20:21], v[164:165], v[20:21]
    v_pk_mul_f32 v[22:23], v[166:167], v[22:23]
    v_cvt_pk_bf16_f32 v160, v16, v17
    v_cvt_pk_bf16_f32 v161, v18, v19
    v_cvt_pk_bf16_f32 v162, v20, v21
    v_cvt_pk_bf16_f32 v163, v22, v23
    v_pk_fma_f32 v[16:17], v[180:181], s[48:49], 0.5 op_sel_hi:[1,0,0]
    v_pk_fma_f32 v[18:19], v[182:183], s[48:49], 0.5 op_sel_hi:[1,0,0]
    v_pk_fma_f32 v[20:21], v[184:185], s[48:49], 0.5 op_sel_hi:[1,0,0]
    v_pk_fma_f32 v[22:23], v[186:187], s[48:49], 0.5 op_sel_hi:[1,0,0]
    v_exp_f32 v16, v16
    buffer_store_dwordx4 v[160:163], v7, s[12:15], s54 offen offset:2048 sc1
    v_exp_f32 v17, v17
    v_exp_f32 v18, v18
    v_exp_f32 v19, v19
    v_exp_f32 v20, v20
    v_exp_f32 v21, v21
    v_exp_f32 v22, v22
    v_exp_f32 v23, v23
    v_pk_fma_f32 v[24:25], v[16:17], s[50:51], 1.0 op_sel_hi:[1,0,0]
    v_pk_fma_f32 v[26:27], v[18:19], s[50:51], 1.0 op_sel_hi:[1,0,0]
    v_pk_fma_f32 v[28:29], v[20:21], s[50:51], 1.0 op_sel_hi:[1,0,0]
    v_pk_fma_f32 v[30:31], v[22:23], s[50:51], 1.0 op_sel_hi:[1,0,0]
    v_pk_fma_f32 v[16:17], v[16:17], v[16:17], v[24:25]
    v_pk_fma_f32 v[18:19], v[18:19], v[18:19], v[26:27]
    v_pk_fma_f32 v[20:21], v[20:21], v[20:21], v[28:29]
    v_pk_fma_f32 v[22:23], v[22:23], v[22:23], v[30:31]
    v_rcp_f32 v16, v16
    v_rcp_f32 v17, v17
    v_rcp_f32 v18, v18
    v_rcp_f32 v19, v19
    v_rcp_f32 v20, v20
    v_rcp_f32 v21, v21
    v_rcp_f32 v22, v22
    v_rcp_f32 v23, v23
    v_pk_mul_f32 v[16:17], v[24:25], v[16:17] clamp
    v_pk_mul_f32 v[18:19], v[26:27], v[18:19] clamp
    v_pk_mul_f32 v[20:21], v[28:29], v[20:21] clamp
    v_pk_mul_f32 v[22:23], v[30:31], v[22:23] clamp
    v_pk_mul_f32 v[16:17], v[180:181], v[16:17]
    v_pk_mul_f32 v[18:19], v[182:183], v[18:19]
    v_pk_mul_f32 v[20:21], v[184:185], v[20:21]
    v_pk_mul_f32 v[22:23], v[186:187], v[22:23]
    v_cvt_pk_bf16_f32 v180, v16, v17
    v_cvt_pk_bf16_f32 v181, v18, v19
    v_cvt_pk_bf16_f32 v182, v20, v21
    v_cvt_pk_bf16_f32 v183, v22, v23
    s_waitcnt vmcnt(2)
    v_cmp_eq_u32 vcc, 1, v9
    s_nop 0
    s_bcnt1_i32_b32 s78, vcc_lo
    s_cmp_ge_u32 s78, 16
    s_cbranch_scc1 L_got5
    s_mov_b32 s79, 0
L_spinl5:
    buffer_load_dword v9, v14, s[12:15], s38 offen offset:0 sc1
    s_waitcnt vmcnt(0)
    v_cmp_eq_u32 vcc, 1, v9
    s_nop 0
    s_bcnt1_i32_b32 s78, vcc_lo
    s_add_u32 s79, s79, 1
    s_cmp_ge_u32 s78, 16
    s_cbranch_scc1 L_got5
    s_cmp_lt_u32 s79, 0x80000
    s_cbranch_scc1 L_spinl5
L_got5:
    v_add_u32 v13, 295936, v12
    v_pk_fma_f32 v[16:17], v[188:189], s[48:49], 0.5 op_sel_hi:[1,0,0]
    v_pk_fma_f32 v[18:19], v[190:191], s[48:49], 0.5 op_sel_hi:[1,0,0]
    buffer_load_dwordx4 a[0:3], v12, s[12:15], s43 offen offset:0 sc1
    v_pk_fma_f32 v[20:21], v[192:193], s[48:49], 0.5 op_sel_hi:[1,0,0]
    v_pk_fma_f32 v[22:23], v[194:195], s[48:49], 0.5 op_sel_hi:[1,0,0]
    v_exp_f32 v16, v16
    s_add_u32 s54, s31, 0x169400
    buffer_store_dwordx4 v[180:183], v7, s[12:15], s54 offen offset:0 sc1
    v_exp_f32 v17, v17
    buffer_load_dwordx4 a[4:7], v12, s[12:15], s43 offen offset:2048 sc1
    v_exp_f32 v18, v18
    v_exp_f32 v19, v19
    v_exp_f32 v20, v20
    v_exp_f32 v21, v21
    v_exp_f32 v22, v22
    buffer_load_dwordx4 a[8:11], v13, s[12:15], s43 offen offset:0 sc1
    v_exp_f32 v23, v23
    v_pk_fma_f32 v[24:25], v[16:17], s[50:51], 1.0 op_sel_hi:[1,0,0]
    v_pk_fma_f32 v[26:27], v[18:19], s[50:51], 1.0 op_sel_hi:[1,0,0]
    v_pk_fma_f32 v[28:29], v[20:21], s[50:51], 1.0 op_sel_hi:[1,0,0]
    buffer_load_dwordx4 a[12:15], v13, s[12:15], s43 offen offset:2048 sc1
    s_add_u32 s43, s43, 4096
    v_pk_fma_f32 v[30:31], v[22:23], s[50:51], 1.0 op_sel_hi:[1,0,0]
    v_pk_fma_f32 v[16:17], v[16:17], v[16:17], v[24:25]
    v_pk_fma_f32 v[18:19], v[18:19], v[18:19], v[26:27]
    v_pk_fma_f32 v[20:21], v[20:21], v[20:21], v[28:29]
    v_pk_fma_f32 v[22:23], v[22:23], v[22:23], v[30:31]
    buffer_load_dwordx4 a[16:19], v12, s[12:15], s42 offen offset:0 sc1
    v_rcp_f32 v16, v16
    v_rcp_f32 v17, v17
    v_rcp_f32 v18, v18
    v_rcp_f32 v19, v19
    buffer_load_dwordx4 a[20:23], v12, s[12:15], s42 offen offset:2048 sc1
    v_rcp_f32 v20, v20
    v_rcp_f32 v21, v21
    v_rcp_f32 v22, v22
    v_rcp_f32 v23, v23
    v_pk_mul_f32 v[16:17], v[24:25], v[16:17] clamp
    buffer_load_dwordx4 a[24:27], v13, s[12:15], s42 offen offset:0 sc1
    v_pk_mul_f32 v[18:19], v[26:27], v[18:19] clamp
    v_pk_mul_f32 v[20:21], v[28:29], v[20:21] clamp
    v_pk_mul_f32 v[22:23], v[30:31], v[22:23] clamp
    v_pk_mul_f32 v[16:17], v[188:189], v[16:17]
    buffer_load_dwordx4 a[28:31], v13, s[12:15], s42 offen offset:2048 sc1
    s_add_u32 s42, s42, 4096
    v_pk_mul_f32 v[18:19], v[190:191], v[18:19]
    v_pk_mul_f32 v[20:21], v[192:193], v[20:21]
    v_pk_mul_f32 v[22:23], v[194:195], v[22:23]
    v_cvt_pk_bf16_f32 v188, v16, v17
    v_cvt_pk_bf16_f32 v189, v18, v19
    v_cvt_pk_bf16_f32 v190, v20, v21
    v_cvt_pk_bf16_f32 v191, v22, v23
    v_pk_fma_f32 v[16:17], v[208:209], s[48:49], 0.5 op_sel_hi:[1,0,0]
    v_pk_fma_f32 v[18:19], v[210:211], s[48:49], 0.5 op_sel_hi:[1,0,0]
    v_pk_fma_f32 v[20:21], v[212:213], s[48:49], 0.5 op_sel_hi:[1,0,0]
    v_pk_fma_f32 v[22:23], v[214:215], s[48:49], 0.5 op_sel_hi:[1,0,0]
    v_exp_f32 v16, v16
    buffer_store_dwordx4 v[188:191], v7, s[12:15], s54 offen offset:2048 sc1
    v_exp_f32 v17, v17
    v_exp_f32 v18, v18
    v_exp_f32 v19, v19
    v_exp_f32 v20, v20
    v_exp_f32 v21, v21
    v_exp_f32 v22, v22
    v_exp_f32 v23, v23
    v_pk_fma_f32 v[24:25], v[16:17], s[50:51], 1.0 op_sel_hi:[1,0,0]
    v_pk_fma_f32 v[26:27], v[18:19], s[50:51], 1.0 op_sel_hi:[1,0,0]
    v_pk_fma_f32 v[28:29], v[20:21], s[50:51], 1.0 op_sel_hi:[1,0,0]
    v_pk_fma_f32 v[30:31], v[22:23], s[50:51], 1.0 op_sel_hi:[1,0,0]
    v_pk_fma_f32 v[16:17], v[16:17], v[16:17], v[24:25]
    v_pk_fma_f32 v[18:19], v[18:19], v[18:19], v[26:27]
    v_pk_fma_f32 v[20:21], v[20:21], v[20:21], v[28:29]
    v_pk_fma_f32 v[22:23], v[22:23], v[22:23], v[30:31]
    v_rcp_f32 v16, v16
    v_rcp_f32 v17, v17
    v_rcp_f32 v18, v18
    v_rcp_f32 v19, v19
    v_rcp_f32 v20, v20
    v_rcp_f32 v21, v21
    v_rcp_f32 v22, v22
    v_rcp_f32 v23, v23
    v_pk_mul_f32 v[16:17], v[24:25], v[16:17] clamp
    v_pk_mul_f32 v[18:19], v[26:27], v[18:19] clamp
    v_pk_mul_f32 v[20:21], v[28:29], v[20:21] clamp
    v_pk_mul_f32 v[22:23], v[30:31], v[22:23] clamp
    v_pk_mul_f32 v[16:17], v[208:209], v[16:17]
    v_pk_mul_f32 v[18:19], v[210:211], v[18:19]
    v_pk_mul_f32 v[20:21], v[212:213], v[20:21]
    v_pk_mul_f32 v[22:23], v[214:215], v[22:23]
    v_cvt_pk_bf16_f32 v208, v16, v17
    v_cvt_pk_bf16_f32 v209, v18, v19
    v_cvt_pk_bf16_f32 v210, v20, v21
    v_cvt_pk_bf16_f32 v211, v22, v23
    v_pk_fma_f32 v[16:17], v[216:217], s[48:49], 0.5 op_sel_hi:[1,0,0]
    v_pk_fma_f32 v[18:19], v[218:219], s[48:49], 0.5 op_sel_hi:[1,0,0]
    v_pk_fma_f32 v[20:21], v[220:221], s[48:49], 0.5 op_sel_hi:[1,0,0]
    v_pk_fma_f32 v[22:23], v[222:223], s[48:49], 0.5 op_sel_hi:[1,0,0]
    v_exp_f32 v16, v16
    s_add_u32 s54, s31, 0x1b1800
    buffer_store_dwordx4 v[208:211], v7, s[12:15], s54 offen offset:0 sc1
    v_exp_f32 v17, v17
    v_exp_f32 v18, v18
    v_exp_f32 v19, v19
    v_exp_f32 v20, v20
    v_exp_f32 v21, v21
    v_exp_f32 v22, v22
    v_exp_f32 v23, v23
    v_pk_fma_f32 v[24:25], v[16:17], s[50:51], 1.0 op_sel_hi:[1,0,0]
    v_pk_fma_f32 v[26:27], v[18:19], s[50:51], 1.0 op_sel_hi:[1,0,0]
    v_pk_fma_f32 v[28:29], v[20:21], s[50:51], 1.0 op_sel_hi:[1,0,0]
    v_pk_fma_f32 v[30:31], v[22:23], s[50:51], 1.0 op_sel_hi:[1,0,0]
    v_pk_fma_f32 v[16:17], v[16:17], v[16:17], v[24:25]
    v_pk_fma_f32 v[18:19], v[18:19], v[18:19], v[26:27]
    v_pk_fma_f32 v[20:21], v[20:21], v[20:21], v[28:29]
    v_pk_fma_f32 v[22:23], v[22:23], v[22:23], v[30:31]
    v_rcp_f32 v16, v16
    v_rcp_f32 v17, v17
    v_rcp_f32 v18, v18
    v_rcp_f32 v19, v19
    v_rcp_f32 v20, v20
    v_rcp_f32 v21, v21
    v_rcp_f32 v22, v22
    v_rcp_f32 v23, v23
    v_pk_mul_f32 v[16:17], v[24:25], v[16:17] clamp
    v_pk_mul_f32 v[18:19], v[26:27], v[18:19] clamp
    v_pk_mul_f32 v[20:21], v[28:29], v[20:21] clamp
    v_pk_mul_f32 v[22:23], v[30:31], v[22:23] clamp
    v_pk_mul_f32 v[16:17], v[216:217], v[16:17]
    v_pk_mul_f32 v[18:19], v[218:219], v[18:19]
    v_pk_mul_f32 v[20:21], v[220:221], v[20:21]
    v_pk_mul_f32 v[22:23], v[222:223], v[22:23]
    v_cvt_pk_bf16_f32 v216, v16, v17
    v_cvt_pk_bf16_f32 v217, v18, v19
    v_cvt_pk_bf16_f32 v218, v20, v21
    v_cvt_pk_bf16_f32 v219, v22, v23
    v_pk_fma_f32 v[16:17], v[236:237], s[48:49], 0.5 op_sel_hi:[1,0,0]
    v_pk_fma_f32 v[18:19], v[238:239], s[48:49], 0.5 op_sel_hi:[1,0,0]
    v_pk_fma_f32 v[20:21], v[240:241], s[48:49], 0.5 op_sel_hi:[1,0,0]
    v_pk_fma_f32 v[22:23], v[242:243], s[48:49], 0.5 op_sel_hi:[1,0,0]
    v_exp_f32 v16, v16
    buffer_store_dwordx4 v[216:219], v7, s[12:15], s54 offen offset:2048 sc1
    v_exp_f32 v17, v17
    v_exp_f32 v18, v18
    v_exp_f32 v19, v19
    v_exp_f32 v20, v20
    v_exp_f32 v21, v21
    v_exp_f32 v22, v22
    v_exp_f32 v23, v23
    v_pk_fma_f32 v[24:25], v[16:17], s[50:51], 1.0 op_sel_hi:[1,0,0]
    v_pk_fma_f32 v[26:27], v[18:19], s[50:51], 1.0 op_sel_hi:[1,0,0]
L_pg5:
    s_cbranch_execz L_tramp
    v_pk_fma_f32 v[28:29], v[20:21], s[50:51], 1.0 op_sel_hi:[1,0,0]
    v_pk_fma_f32 v[30:31], v[22:23], s[50:51], 1.0 op_sel_hi:[1,0,0]
    v_pk_fma_f32 v[16:17], v[16:17], v[16:17], v[24:25]
    v_pk_fma_f32 v[18:19], v[18:19], v[18:19], v[26:27]
    v_pk_fma_f32 v[20:21], v[20:21], v[20:21], v[28:29]
    v_pk_fma_f32 v[22:23], v[22:23], v[22:23], v[30:31]
    v_rcp_f32 v16, v16
    v_rcp_f32 v17, v17
    v_rcp_f32 v18, v18
    v_rcp_f32 v19, v19
    v_rcp_f32 v20, v20
    v_rcp_f32 v21, v21
    v_rcp_f32 v22, v22
    v_rcp_f32 v23, v23
    v_pk_mul_f32 v[16:17], v[24:25], v[16:17] clamp
    v_pk_mul_f32 v[18:19], v[26:27], v[18:19] clamp
    v_pk_mul_f32 v[20:21], v[28:29], v[20:21] clamp
    v_pk_mul_f32 v[22:23], v[30:31], v[22:23] clamp
    v_pk_mul_f32 v[16:17], v[236:237], v[16:17]
    v_pk_mul_f32 v[18:19], v[238:239], v[18:19]
    v_pk_mul_f32 v[20:21], v[240:241], v[20:21]
    v_pk_mul_f32 v[22:23], v[242:243], v[22:23]
    v_cvt_pk_bf16_f32 v236, v16, v17
    v_cvt_pk_bf16_f32 v237, v18, v19
    v_cvt_pk_bf16_f32 v238, v20, v21
    v_cvt_pk_bf16_f32 v239, v22, v23
    v_pk_fma_f32 v[16:17], v[244:245], s[48:49], 0.5 op_sel_hi:[1,0,0]
    v_pk_fma_f32 v[18:19], v[246:247], s[48:49], 0.5 op_sel_hi:[1,0,0]
    v_pk_fma_f32 v[20:21], v[248:249], s[48:49], 0.5 op_sel_hi:[1,0,0]
    v_pk_fma_f32 v[22:23], v[250:251], s[48:49], 0.5 op_sel_hi:[1,0,0]
    v_exp_f32 v16, v16
    s_add_u32 s54, s31, 0x1f9c00
    buffer_store_dwordx4 v[236:239], v7, s[12:15], s54 offen offset:0 sc1
    v_exp_f32 v17, v17
    v_exp_f32 v18, v18
    v_exp_f32 v19, v19
    v_exp_f32 v20, v20
    v_exp_f32 v21, v21
    v_exp_f32 v22, v22
    v_exp_f32 v23, v23
    v_pk_fma_f32 v[24:25], v[16:17], s[50:51], 1.0 op_sel_hi:[1,0,0]
    v_pk_fma_f32 v[26:27], v[18:19], s[50:51], 1.0 op_sel_hi:[1,0,0]
    v_pk_fma_f32 v[28:29], v[20:21], s[50:51], 1.0 op_sel_hi:[1,0,0]
    v_pk_fma_f32 v[30:31], v[22:23], s[50:51], 1.0 op_sel_hi:[1,0,0]
    v_pk_fma_f32 v[16:17], v[16:17], v[16:17], v[24:25]
    v_pk_fma_f32 v[18:19], v[18:19], v[18:19], v[26:27]
    v_pk_fma_f32 v[20:21], v[20:21], v[20:21], v[28:29]
    v_pk_fma_f32 v[22:23], v[22:23], v[22:23], v[30:31]
    v_rcp_f32 v16, v16
    v_rcp_f32 v17, v17
    v_rcp_f32 v18, v18
    v_rcp_f32 v19, v19
    v_rcp_f32 v20, v20
    v_rcp_f32 v21, v21
    v_rcp_f32 v22, v22
    v_rcp_f32 v23, v23
    v_pk_mul_f32 v[16:17], v[24:25], v[16:17] clamp
    v_pk_mul_f32 v[18:19], v[26:27], v[18:19] clamp
    v_pk_mul_f32 v[20:21], v[28:29], v[20:21] clamp
    v_pk_mul_f32 v[22:23], v[30:31], v[22:23] clamp
    v_pk_mul_f32 v[16:17], v[244:245], v[16:17]
    v_pk_mul_f32 v[18:19], v[246:247], v[18:19]
    v_pk_mul_f32 v[20:21], v[248:249], v[20:21]
    v_pk_mul_f32 v[22:23], v[250:251], v[22:23]
    v_cvt_pk_bf16_f32 v244, v16, v17
    v_cvt_pk_bf16_f32 v245, v18, v19
    v_cvt_pk_bf16_f32 v246, v20, v21
    v_cvt_pk_bf16_f32 v247, v22, v23
    buffer_store_dwordx4 v[244:247], v7, s[12:15], s54 offen offset:2048 sc1
    s_waitcnt vmcnt(5)
L_phase2F:
    v_xor_b32 v24, 0, v10
    v_xor_b32 v25, 32, v10
    v_xor_b32 v26, 64, v10
    v_xor_b32 v27, 96, v10
    v_xor_b32 v28, 128, v10
    v_xor_b32 v29, 160, v10
    v_xor_b32 v30, 192, v10
    v_xor_b32 v31, 224, v10
    s_barrier
    ds_read_b64_tr_b16 a[96:97], v24 offset:32768
    ds_read_b64_tr_b16 a[98:99], v24 offset:36864
    ds_read_b64_tr_b16 a[100:101], v24 offset:40960
    ds_read_b64_tr_b16 a[102:103], v24 offset:45056
    ds_read_b64_tr_b16 a[104:105], v25 offset:32768
    ds_read_b64_tr_b16 a[106:107], v25 offset:36864
    ds_read_b64_tr_b16 a[108:109], v25 offset:40960
    ds_read_b64_tr_b16 a[110:111], v25 offset:45056
    s_waitcnt lgkmcnt(4)
    v_mfma_f32_16x16x32_bf16 v[96:99], a[96:99], a[0:3], 0
    ds_read_b64_tr_b16 a[128:129], v26 offset:32768
    v_mfma_f32_16x16x32_bf16 v[96:99], a[100:103], a[4:7], v[96:99]
    buffer_load_dwordx4 a[32:35], v12, s[12:15], s43 offen offset:0 sc1
    v_mfma_f32_16x16x32_bf16 v[100:103], a[100:103], a[12:15], 0
    ds_read_b64_tr_b16 a[130:131], v26 offset:36864
    v_mfma_f32_16x16x32_bf16 v[100:103], a[96:99], a[8:11], v[100:103]
    v_add_u32 v32, 0x10000, v24
    v_mfma_f32_16x16x32_bf16 v[64:67], a[96:99], a[16:19], 0
    ds_read_b64_tr_b16 a[132:133], v26 offset:40960
    v_mfma_f32_16x16x32_bf16 v[64:67], a[100:103], a[20:23], v[64:67]
    buffer_load_dwordx4 a[36:39], v12, s[12:15], s43 offen offset:2048 sc1
    v_mfma_f32_16x16x32_bf16 v[68:71], a[100:103], a[28:31], 0
    ds_read_b64_tr_b16 a[134:135], v26 offset:45056
    v_mfma_f32_16x16x32_bf16 v[68:71], a[96:99], a[24:27], v[68:71]
    s_waitcnt lgkmcnt(4)
    v_add_u32 v33, 0x10000, v25
    v_mfma_f32_16x16x32_bf16 v[76:79], a[104:107], a[24:27], 0
    ds_read_b64_tr_b16 a[136:137], v27 offset:32768
    v_mfma_f32_16x16x32_bf16 v[76:79], a[108:111], a[28:31], v[76:79]
    v_mfma_f32_16x16x32_bf16 v[72:75], a[108:111], a[20:23], 0
    ds_read_b64_tr_b16 a[138:139], v27 offset:36864
    v_mfma_f32_16x16x32_bf16 v[72:75], a[104:107], a[16:19], v[72:75]
    buffer_load_dwordx4 a[40:43], v13, s[12:15], s43 offen offset:0 sc1
    v_add_u32 v34, 0x10000, v26
    v_mfma_f32_16x16x32_bf16 v[108:111], a[104:107], a[8:11], 0
    ds_read_b64_tr_b16 a[140:141], v27 offset:40960
    v_mfma_f32_16x16x32_bf16 v[108:111], a[108:111], a[12:15], v[108:111]
    v_mfma_f32_16x16x32_bf16 v[104:107], a[108:111], a[4:7], 0
    ds_read_b64_tr_b16 a[142:143], v27 offset:45056
    v_mfma_f32_16x16x32_bf16 v[104:107], a[104:107], a[0:3], v[104:107]
    v_add_u32 v35, 0x10000, v27
    s_waitcnt lgkmcnt(4)
    v_mfma_f32_16x16x32_bf16 v[112:115], a[128:131], a[0:3], 0
    ds_read_b64_tr_b16 a[96:97], v28 offset:32768
    v_mfma_f32_16x16x32_bf16 v[112:115], a[132:135], a[4:7], v[112:115]
    buffer_load_dwordx4 a[44:47], v13, s[12:15], s43 offen offset:2048 sc1
    s_add_u32 s43, s43, 4096
    v_mfma_f32_16x16x32_bf16 v[116:119], a[132:135], a[12:15], 0
    ds_read_b64_tr_b16 a[98:99], v28 offset:36864
    v_mfma_f32_16x16x32_bf16 v[116:119], a[128:131], a[8:11], v[116:119]
    v_add_u32 v36, 0x10000, v28
    v_mfma_f32_16x16x32_bf16 v[80:83], a[128:131], a[16:19], 0
    ds_read_b64_tr_b16 a[100:101], v28 offset:40960
    v_mfma_f32_16x16x32_bf16 v[80:83], a[132:135], a[20:23], v[80:83]
    buffer_load_dwordx4 a[48:51], v12, s[12:15], s42 offen offset:0 sc1
    v_mfma_f32_16x16x32_bf16 v[84:87], a[132:135], a[28:31], 0
    ds_read_b64_tr_b16 a[102:103], v28 offset:45056
    v_mfma_f32_16x16x32_bf16 v[84:87], a[128:131], a[24:27], v[84:87]
    s_waitcnt lgkmcnt(4)
    v_add_u32 v37, 0x10000, v29
    v_mfma_f32_16x16x32_bf16 v[92:95], a[136:139], a[24:27], 0
    ds_read_b64_tr_b16 a[104:105], v29 offset:32768
    v_mfma_f32_16x16x32_bf16 v[92:95], a[140:143], a[28:31], v[92:95]
    buffer_load_dwordx4 a[52:55], v12, s[12:15], s42 offen offset:2048 sc1
    v_mfma_f32_16x16x32_bf16 v[88:91], a[140:143], a[20:23], 0
    ds_read_b64_tr_b16 a[106:107], v29 offset:36864
    v_mfma_f32_16x16x32_bf16 v[88:91], a[136:139], a[16:19], v[88:91]
    v_add_u32 v38, 0x10000, v30
    v_mfma_f32_16x16x32_bf16 v[124:127], a[136:139], a[8:11], 0
    ds_read_b64_tr_b16 a[108:109], v29 offset:40960
    v_mfma_f32_16x16x32_bf16 v[124:127], a[140:143], a[12:15], v[124:127]
    buffer_load_dwordx4 a[56:59], v13, s[12:15], s42 offen offset:0 sc1
    v_mfma_f32_16x16x32_bf16 v[120:123], a[140:143], a[4:7], 0
    ds_read_b64_tr_b16 a[110:111], v29 offset:45056
    v_mfma_f32_16x16x32_bf16 v[120:123], a[136:139], a[0:3], v[120:123]
    v_add_u32 v39, 0x10000, v31
    s_waitcnt lgkmcnt(4)
    v_mfma_f32_16x16x32_bf16 v[160:163], a[96:99], a[0:3], 0
    ds_read_b64_tr_b16 a[128:129], v30 offset:32768
    v_mfma_f32_16x16x32_bf16 v[160:163], a[100:103], a[4:7], v[160:163]
    buffer_load_dwordx4 a[60:63], v13, s[12:15], s42 offen offset:2048 sc1
    s_add_u32 s42, s42, 4096
    v_mfma_f32_16x16x32_bf16 v[164:167], a[100:103], a[12:15], 0
    ds_read_b64_tr_b16 a[130:131], v30 offset:36864
    v_mfma_f32_16x16x32_bf16 v[164:167], a[96:99], a[8:11], v[164:167]
    v_lshlrev_b32 v7, 2, v1
    v_mfma_f32_16x16x32_bf16 v[128:131], a[96:99], a[16:19], 0
    ds_read_b64_tr_b16 a[132:133], v30 offset:40960
    v_mfma_f32_16x16x32_bf16 v[128:131], a[100:103], a[20:23], v[128:131]
    buffer_load_dwordx4 a[64:67], v12, s[12:15], s43 offen offset:0 sc1
    v_mfma_f32_16x16x32_bf16 v[132:135], a[100:103], a[28:31], 0
    ds_read_b64_tr_b16 a[134:135], v30 offset:45056
    v_mfma_f32_16x16x32_bf16 v[132:135], a[96:99], a[24:27], v[132:135]
    s_waitcnt lgkmcnt(4)
    s_lshr_b32 s40, s59, 2
    v_mfma_f32_16x16x32_bf16 v[140:143], a[104:107], a[24:27], 0
    ds_read_b64_tr_b16 a[136:137], v31 offset:32768
    v_mfma_f32_16x16x32_bf16 v[140:143], a[108:111], a[28:31], v[140:143]
    v_mfma_f32_16x16x32_bf16 v[136:139], a[108:111], a[20:23], 0
    ds_read_b64_tr_b16 a[138:139], v31 offset:36864
    v_mfma_f32_16x16x32_bf16 v[136:139], a[104:107], a[16:19], v[136:139]
    buffer_load_dwordx4 a[68:71], v12, s[12:15], s43 offen offset:2048 sc1
    s_lshl_b32 s40, s40, 7
    v_mfma_f32_16x16x32_bf16 v[172:175], a[104:107], a[8:11], 0
    ds_read_b64_tr_b16 a[140:141], v31 offset:40960
    v_mfma_f32_16x16x32_bf16 v[172:175], a[108:111], a[12:15], v[172:175]
    v_mfma_f32_16x16x32_bf16 v[168:171], a[108:111], a[4:7], 0
    ds_read_b64_tr_b16 a[142:143], v31 offset:45056
    v_mfma_f32_16x16x32_bf16 v[168:171], a[104:107], a[0:3], v[168:171]
    s_add_u32 s40, s40, 0x2524000
    s_barrier
    s_waitcnt lgkmcnt(4)
    v_mfma_f32_16x16x32_bf16 v[176:179], a[128:131], a[0:3], 0
    ds_read_b64_tr_b16 a[96:97], v24 offset:49152
    v_mfma_f32_16x16x32_bf16 v[176:179], a[132:135], a[4:7], v[176:179]
    buffer_load_dwordx4 a[72:75], v13, s[12:15], s43 offen offset:0 sc1
    v_mfma_f32_16x16x32_bf16 v[180:183], a[132:135], a[12:15], 0
    ds_read_b64_tr_b16 a[98:99], v24 offset:53248
    s_waitcnt vmcnt(11)
    s_add_u32 s78, s51, s41
    s_mov_b64 exec, 1
    buffer_store_dword v15, v11, s[12:15], s78 offen sc1
    s_mov_b64 exec, -1
    v_mfma_f32_16x16x32_bf16 v[180:183], a[128:131], a[8:11], v[180:183]
    s_lshl_b32 s99, s56, 8
    v_mfma_f32_16x16x32_bf16 v[144:147], a[128:131], a[16:19], 0
    ds_read_b64_tr_b16 a[100:101], v24 offset:57344
    v_mfma_f32_16x16x32_bf16 v[144:147], a[132:135], a[20:23], v[144:147]
    buffer_load_dwordx4 a[76:79], v13, s[12:15], s43 offen offset:2048 sc1
    s_add_u32 s43, s43, 4096
    v_mfma_f32_16x16x32_bf16 v[148:151], a[132:135], a[28:31], 0
    ds_read_b64_tr_b16 a[102:103], v24 offset:61440
    v_mfma_f32_16x16x32_bf16 v[148:151], a[128:131], a[24:27], v[148:151]
    s_waitcnt lgkmcnt(4)
    s_add_u32 s99, s99, 0x2525000
    v_mfma_f32_16x16x32_bf16 v[156:159], a[136:139], a[24:27], 0
    ds_read_b64_tr_b16 a[104:105], v25 offset:49152
    v_mfma_f32_16x16x32_bf16 v[156:159], a[140:143], a[28:31], v[156:159]
    buffer_load_dwordx4 a[80:83], v12, s[12:15], s42 offen offset:0 sc1
    v_mfma_f32_16x16x32_bf16 v[152:155], a[140:143], a[20:23], 0
    ds_read_b64_tr_b16 a[106:107], v25 offset:53248
    v_mfma_f32_16x16x32_bf16 v[152:155], a[136:139], a[16:19], v[152:155]
    s_lshl3_add_u32 s98, s58, s29
    v_mfma_f32_16x16x32_bf16 v[188:191], a[136:139], a[8:11], 0
    ds_read_b64_tr_b16 a[108:109], v25 offset:57344
    v_mfma_f32_16x16x32_bf16 v[188:191], a[140:143], a[12:15], v[188:191]
    buffer_load_dwordx4 a[84:87], v12, s[12:15], s42 offen offset:2048 sc1
    v_mfma_f32_16x16x32_bf16 v[184:187], a[140:143], a[4:7], 0
    ds_read_b64_tr_b16 a[110:111], v25 offset:61440
    v_mfma_f32_16x16x32_bf16 v[184:187], a[136:139], a[0:3], v[184:187]
    s_add_u32 s98, s98, 0
    s_waitcnt vmcnt(7) lgkmcnt(4)
    v_mfma_f32_16x16x32_bf16 v[96:99], a[96:99], a[32:35], v[96:99]
    ds_read_b64_tr_b16 a[128:129], v26 offset:49152
    v_mfma_f32_16x16x32_bf16 v[96:99], a[100:103], a[36:39], v[96:99]
    buffer_load_dwordx4 a[88:91], v13, s[12:15], s42 offen offset:0 sc1
    v_mfma_f32_16x16x32_bf16 v[100:103], a[100:103], a[44:47], v[100:103]
    ds_read_b64_tr_b16 a[130:131], v26 offset:53248
    v_mfma_f32_16x16x32_bf16 v[100:103], a[96:99], a[40:43], v[100:103]
    s_lshl_b32 s98, s98, 16
    v_mfma_f32_16x16x32_bf16 v[64:67], a[96:99], a[48:51], v[64:67]
    ds_read_b64_tr_b16 a[132:133], v26 offset:57344
    v_mfma_f32_16x16x32_bf16 v[64:67], a[100:103], a[52:55], v[64:67]
    buffer_load_dwordx4 a[92:95], v13, s[12:15], s42 offen offset:2048 sc1
    s_add_u32 s42, s42, 4096
    v_mfma_f32_16x16x32_bf16 v[68:71], a[100:103], a[60:63], v[68:71]
    ds_read_b64_tr_b16 a[134:135], v26 offset:61440
    v_mfma_f32_16x16x32_bf16 v[68:71], a[96:99], a[56:59], v[68:71]
    s_waitcnt lgkmcnt(4)
    s_lshl_b32 s44, s56, 3
    v_mfma_f32_16x16x32_bf16 v[76:79], a[104:107], a[56:59], v[76:79]
    ds_read_b64_tr_b16 a[136:137], v27 offset:49152
    v_mfma_f32_16x16x32_bf16 v[76:79], a[108:111], a[60:63], v[76:79]
    v_mfma_f32_16x16x32_bf16 v[72:75], a[108:111], a[52:55], v[72:75]
    ds_read_b64_tr_b16 a[138:139], v27 offset:53248
    v_mfma_f32_16x16x32_bf16 v[72:75], a[104:107], a[48:51], v[72:75]
    buffer_load_dwordx4 a[160:163], v12, s[12:15], s43 offen offset:0 sc1
    s_add_u32 s44, s44, s57
    v_mfma_f32_16x16x32_bf16 v[108:111], a[104:107], a[40:43], v[108:111]
    ds_read_b64_tr_b16 a[140:141], v27 offset:57344
    v_mfma_f32_16x16x32_bf16 v[108:111], a[108:111], a[44:47], v[108:111]
    v_mfma_f32_16x16x32_bf16 v[104:107], a[108:111], a[36:39], v[104:107]
    ds_read_b64_tr_b16 a[142:143], v27 offset:61440
    v_mfma_f32_16x16x32_bf16 v[104:107], a[104:107], a[32:35], v[104:107]
    s_lshl_b32 s44, s44, 2
    s_waitcnt lgkmcnt(4)
    v_mfma_f32_16x16x32_bf16 v[112:115], a[128:131], a[32:35], v[112:115]
    ds_read_b64_tr_b16 a[96:97], v28 offset:49152
    v_mfma_f32_16x16x32_bf16 v[112:115], a[132:135], a[36:39], v[112:115]
    buffer_load_dwordx4 a[164:167], v12, s[12:15], s43 offen offset:2048 sc1
    v_mfma_f32_16x16x32_bf16 v[116:119], a[132:135], a[44:47], v[116:119]
    ds_read_b64_tr_b16 a[98:99], v28 offset:53248
    v_mfma_f32_16x16x32_bf16 v[116:119], a[128:131], a[40:43], v[116:119]
    s_add_u32 s44, s44, s58
    v_mfma_f32_16x16x32_bf16 v[80:83], a[128:131], a[48:51], v[80:83]
    ds_read_b64_tr_b16 a[100:101], v28 offset:57344
    v_mfma_f32_16x16x32_bf16 v[80:83], a[132:135], a[52:55], v[80:83]
    buffer_load_dwordx4 a[168:171], v13, s[12:15], s43 offen offset:0 sc1
    v_mfma_f32_16x16x32_bf16 v[84:87], a[132:135], a[60:63], v[84:87]
    ds_read_b64_tr_b16 a[102:103], v28 offset:61440
    v_mfma_f32_16x16x32_bf16 v[84:87], a[128:131], a[56:59], v[84:87]
    s_waitcnt lgkmcnt(4)
    s_lshl_b32 s44, s44, 2
    v_mfma_f32_16x16x32_bf16 v[92:95], a[136:139], a[56:59], v[92:95]
    ds_read_b64_tr_b16 a[104:105], v29 offset:49152
    v_mfma_f32_16x16x32_bf16 v[92:95], a[140:143], a[60:63], v[92:95]
    v_mfma_f32_16x16x32_bf16 v[88:91], a[140:143], a[52:55], v[88:91]
    ds_read_b64_tr_b16 a[106:107], v29 offset:53248
    v_mfma_f32_16x16x32_bf16 v[88:91], a[136:139], a[48:51], v[88:91]
    buffer_load_dwordx4 a[172:175], v13, s[12:15], s43 offen offset:2048 sc1
    s_add_u32 s43, s43, 4096
    s_add_u32 s44, s44, s28
    v_mfma_f32_16x16x32_bf16 v[124:127], a[136:139], a[40:43], v[124:127]
    ds_read_b64_tr_b16 a[108:109], v29 offset:57344
    v_mfma_f32_16x16x32_bf16 v[124:127], a[140:143], a[44:47], v[124:127]
    v_mfma_f32_16x16x32_bf16 v[120:123], a[140:143], a[36:39], v[120:123]
    ds_read_b64_tr_b16 a[110:111], v29 offset:61440
    v_mfma_f32_16x16x32_bf16 v[120:123], a[136:139], a[32:35], v[120:123]
    s_lshl_b32 s34, s44, 12
    s_waitcnt lgkmcnt(4)
    v_mfma_f32_16x16x32_bf16 v[160:163], a[96:99], a[32:35], v[160:163]
    ds_read_b64_tr_b16 a[128:129], v30 offset:49152
    v_mfma_f32_16x16x32_bf16 v[160:163], a[100:103], a[36:39], v[160:163]
    buffer_load_dwordx4 a[176:179], v12, s[12:15], s42 offen offset:0 sc1
    v_mfma_f32_16x16x32_bf16 v[164:167], a[100:103], a[44:47], v[164:167]
    ds_read_b64_tr_b16 a[130:131], v30 offset:53248
    v_mfma_f32_16x16x32_bf16 v[164:167], a[96:99], a[40:43], v[164:167]
    s_lshl_b32 s35, s44, 8
    v_mfma_f32_16x16x32_bf16 v[128:131], a[96:99], a[48:51], v[128:131]
    ds_read_b64_tr_b16 a[132:133], v30 offset:57344
    v_mfma_f32_16x16x32_bf16 v[128:131], a[100:103], a[52:55], v[128:131]
    v_mfma_f32_16x16x32_bf16 v[132:135], a[100:103], a[60:63], v[132:135]
    ds_read_b64_tr_b16 a[134:135], v30 offset:61440
    v_mfma_f32_16x16x32_bf16 v[132:135], a[96:99], a[56:59], v[132:135]
    s_waitcnt lgkmcnt(4)
    s_mul_i32 s36, s58, 40960
    v_mfma_f32_16x16x32_bf16 v[140:143], a[104:107], a[56:59], v[140:143]
    ds_read_b64_tr_b16 a[136:137], v31 offset:49152
    v_mfma_f32_16x16x32_bf16 v[140:143], a[108:111], a[60:63], v[140:143]
    buffer_load_dwordx4 a[180:183], v12, s[12:15], s42 offen offset:2048 sc1
    v_mfma_f32_16x16x32_bf16 v[136:139], a[108:111], a[52:55], v[136:139]
    ds_read_b64_tr_b16 a[138:139], v31 offset:53248
    v_mfma_f32_16x16x32_bf16 v[136:139], a[104:107], a[48:51], v[136:139]
    s_sub_u32 s36, 176128, s36
    v_mfma_f32_16x16x32_bf16 v[172:175], a[104:107], a[40:43], v[172:175]
    ds_read_b64_tr_b16 a[140:141], v31 offset:57344
    v_mfma_f32_16x16x32_bf16 v[172:175], a[108:111], a[44:47], v[172:175]
    v_mfma_f32_16x16x32_bf16 v[168:171], a[108:111], a[36:39], v[168:171]
    ds_read_b64_tr_b16 a[142:143], v31 offset:61440
    v_mfma_f32_16x16x32_bf16 v[168:171], a[104:107], a[32:35], v[168:171]
    s_lshr_b32 s44, s3, 5
    s_barrier
    s_waitcnt lgkmcnt(4)
    v_mfma_f32_16x16x32_bf16 v[176:179], a[128:131], a[32:35], v[176:179]
    ds_read_b64_tr_b16 a[96:97], v32 offset:0
    v_mfma_f32_16x16x32_bf16 v[176:179], a[132:135], a[36:39], v[176:179]
    buffer_load_dwordx4 a[184:187], v13, s[12:15], s42 offen offset:0 sc1
    v_mfma_f32_16x16x32_bf16 v[180:183], a[132:135], a[44:47], v[180:183]
    ds_read_b64_tr_b16 a[98:99], v32 offset:4096
    v_mfma_f32_16x16x32_bf16 v[180:183], a[128:131], a[40:43], v[180:183]
    s_lshl_b32 s44, s44, 2
    v_mfma_f32_16x16x32_bf16 v[144:147], a[128:131], a[48:51], v[144:147]
    ds_read_b64_tr_b16 a[100:101], v32 offset:8192
    v_mfma_f32_16x16x32_bf16 v[144:147], a[132:135], a[52:55], v[144:147]
    buffer_load_dwordx4 a[188:191], v13, s[12:15], s42 offen offset:2048 sc1
    s_add_u32 s42, s42, 4096
    v_mfma_f32_16x16x32_bf16 v[148:151], a[132:135], a[60:63], v[148:151]
    ds_read_b64_tr_b16 a[102:103], v32 offset:12288
    v_mfma_f32_16x16x32_bf16 v[148:151], a[128:131], a[56:59], v[148:151]
    s_waitcnt lgkmcnt(4)
    s_add_u32 s44, s44, s28
    v_mfma_f32_16x16x32_bf16 v[156:159], a[136:139], a[56:59], v[156:159]
    ds_read_b64_tr_b16 a[104:105], v33 offset:0
    v_mfma_f32_16x16x32_bf16 v[156:159], a[140:143], a[60:63], v[156:159]
    v_mfma_f32_16x16x32_bf16 v[152:155], a[140:143], a[52:55], v[152:155]
    ds_read_b64_tr_b16 a[106:107], v33 offset:4096
    v_mfma_f32_16x16x32_bf16 v[152:155], a[136:139], a[48:51], v[152:155]
    buffer_load_dwordx4 a[192:195], v12, s[12:15], s43 offen offset:0 sc1
    s_lshl_b32 s44, s44, 7
    v_mfma_f32_16x16x32_bf16 v[188:191], a[136:139], a[40:43], v[188:191]
    ds_read_b64_tr_b16 a[108:109], v33 offset:8192
    v_mfma_f32_16x16x32_bf16 v[188:191], a[140:143], a[44:47], v[188:191]
    v_mfma_f32_16x16x32_bf16 v[184:187], a[140:143], a[36:39], v[184:187]
    ds_read_b64_tr_b16 a[110:111], v33 offset:12288
    v_mfma_f32_16x16x32_bf16 v[184:187], a[136:139], a[32:35], v[184:187]
    s_add_u32 s44, s44, L_p2midF-gated_mix__linear_kernel_hedgehog__dense_activation_mish__prompt_kernel
    s_waitcnt vmcnt(9) lgkmcnt(4)
    v_mfma_f32_16x16x32_bf16 v[96:99], a[96:99], a[64:67], v[96:99]
    ds_read_b64_tr_b16 a[128:129], v34 offset:0
    v_mfma_f32_16x16x32_bf16 v[96:99], a[100:103], a[68:71], v[96:99]
    buffer_load_dwordx4 a[196:199], v12, s[12:15], s43 offen offset:2048 sc1
    v_mfma_f32_16x16x32_bf16 v[100:103], a[100:103], a[76:79], v[100:103]
    ds_read_b64_tr_b16 a[130:131], v34 offset:4096
    v_mfma_f32_16x16x32_bf16 v[100:103], a[96:99], a[72:75], v[100:103]
    s_min_u32 s44, s44, L_end-gated_mix__linear_kernel_hedgehog__dense_activation_mish__prompt_kernel-8
    v_mfma_f32_16x16x32_bf16 v[64:67], a[96:99], a[80:83], v[64:67]
    ds_read_b64_tr_b16 a[132:133], v34 offset:8192
    v_mfma_f32_16x16x32_bf16 v[64:67], a[100:103], a[84:87], v[64:67]
    v_mfma_f32_16x16x32_bf16 v[68:71], a[100:103], a[92:95], v[68:71]
    ds_read_b64_tr_b16 a[134:135], v34 offset:12288
    v_mfma_f32_16x16x32_bf16 v[68:71], a[96:99], a[88:91], v[68:71]
    s_waitcnt lgkmcnt(4)
    v_mov_b32 v8, s44
    v_mfma_f32_16x16x32_bf16 v[76:79], a[104:107], a[88:91], v[76:79]
    ds_read_b64_tr_b16 a[136:137], v35 offset:0
    v_mfma_f32_16x16x32_bf16 v[76:79], a[108:111], a[92:95], v[76:79]
    buffer_load_dwordx4 a[200:203], v13, s[12:15], s43 offen offset:0 sc1
    v_mfma_f32_16x16x32_bf16 v[72:75], a[108:111], a[84:87], v[72:75]
    ds_read_b64_tr_b16 a[138:139], v35 offset:4096
    v_mfma_f32_16x16x32_bf16 v[72:75], a[104:107], a[80:83], v[72:75]
    v_add_u32 v40, 0x20000, v24
    v_mfma_f32_16x16x32_bf16 v[108:111], a[104:107], a[72:75], v[108:111]
    ds_read_b64_tr_b16 a[140:141], v35 offset:8192
    v_mfma_f32_16x16x32_bf16 v[108:111], a[108:111], a[76:79], v[108:111]
    v_mfma_f32_16x16x32_bf16 v[104:107], a[108:111], a[68:71], v[104:107]
    ds_read_b64_tr_b16 a[142:143], v35 offset:12288
    v_mfma_f32_16x16x32_bf16 v[104:107], a[104:107], a[64:67], v[104:107]
    v_add_u32 v41, 0x20000, v25
    s_waitcnt lgkmcnt(4)
    v_mfma_f32_16x16x32_bf16 v[112:115], a[128:131], a[64:67], v[112:115]
    ds_read_b64_tr_b16 a[96:97], v36 offset:0
    v_mfma_f32_16x16x32_bf16 v[112:115], a[132:135], a[68:71], v[112:115]
    buffer_load_dwordx4 a[204:207], v13, s[12:15], s43 offen offset:2048 sc1
    s_add_u32 s43, s43, 4096
    v_mfma_f32_16x16x32_bf16 v[116:119], a[132:135], a[76:79], v[116:119]
    ds_read_b64_tr_b16 a[98:99], v36 offset:4096
    v_mfma_f32_16x16x32_bf16 v[116:119], a[128:131], a[72:75], v[116:119]
    v_add_u32 v42, 0x20000, v26
    v_mfma_f32_16x16x32_bf16 v[80:83], a[128:131], a[80:83], v[80:83]
    ds_read_b64_tr_b16 a[100:101], v36 offset:8192
    v_mfma_f32_16x16x32_bf16 v[80:83], a[132:135], a[84:87], v[80:83]
    buffer_load_dwordx4 a[208:211], v12, s[12:15], s42 offen offset:0 sc1
    v_mfma_f32_16x16x32_bf16 v[84:87], a[132:135], a[92:95], v[84:87]
    ds_read_b64_tr_b16 a[102:103], v36 offset:12288
    v_mfma_f32_16x16x32_bf16 v[84:87], a[128:131], a[88:91], v[84:87]
    s_waitcnt lgkmcnt(4)
    v_add_u32 v43, 0x20000, v27
    v_mfma_f32_16x16x32_bf16 v[92:95], a[136:139], a[88:91], v[92:95]
    ds_read_b64_tr_b16 a[104:105], v37 offset:0
    v_mfma_f32_16x16x32_bf16 v[92:95], a[140:143], a[92:95], v[92:95]
    v_mfma_f32_16x16x32_bf16 v[88:91], a[140:143], a[84:87], v[88:91]
    ds_read_b64_tr_b16 a[106:107], v37 offset:4096
    v_mfma_f32_16x16x32_bf16 v[88:91], a[136:139], a[80:83], v[88:91]
    buffer_load_dwordx4 a[212:215], v12, s[12:15], s42 offen offset:2048 sc1
    v_add_u32 v44, 0x20000, v28
    v_mfma_f32_16x16x32_bf16 v[124:127], a[136:139], a[72:75], v[124:127]
    ds_read_b64_tr_b16 a[108:109], v37 offset:8192
    v_mfma_f32_16x16x32_bf16 v[124:127], a[140:143], a[76:79], v[124:127]
    v_mfma_f32_16x16x32_bf16 v[120:123], a[140:143], a[68:71], v[120:123]
    ds_read_b64_tr_b16 a[110:111], v37 offset:12288
    v_mfma_f32_16x16x32_bf16 v[120:123], a[136:139], a[64:67], v[120:123]
    v_add_u32 v45, 0x20000, v29
    s_waitcnt lgkmcnt(4)
    v_mfma_f32_16x16x32_bf16 v[160:163], a[96:99], a[64:67], v[160:163]
    buffer_load_dword v18, v14, s[12:15], s39 offen offset:0 sc1
    ds_read_b64_tr_b16 a[128:129], v38 offset:0
    v_mfma_f32_16x16x32_bf16 v[160:163], a[100:103], a[68:71], v[160:163]
    buffer_load_dwordx4 a[216:219], v13, s[12:15], s42 offen offset:0 sc1
    v_mfma_f32_16x16x32_bf16 v[164:167], a[100:103], a[76:79], v[164:167]
    ds_read_b64_tr_b16 a[130:131], v38 offset:4096
    v_mfma_f32_16x16x32_bf16 v[164:167], a[96:99], a[72:75], v[164:167]
    v_add_u32 v46, 0x20000, v30
    v_mfma_f32_16x16x32_bf16 v[128:131], a[96:99], a[80:83], v[128:131]
    ds_read_b64_tr_b16 a[132:133], v38 offset:8192
    v_mfma_f32_16x16x32_bf16 v[128:131], a[100:103], a[84:87], v[128:131]
    buffer_load_dwordx4 a[220:223], v13, s[12:15], s42 offen offset:2048 sc1
    s_add_u32 s42, s42, 4096
    v_mfma_f32_16x16x32_bf16 v[132:135], a[100:103], a[92:95], v[132:135]
    ds_read_b64_tr_b16 a[134:135], v38 offset:12288
    v_mfma_f32_16x16x32_bf16 v[132:135], a[96:99], a[88:91], v[132:135]
    s_waitcnt lgkmcnt(4)
    v_add_u32 v47, 0x20000, v31
    v_mfma_f32_16x16x32_bf16 v[140:143], a[104:107], a[88:91], v[140:143]
    ds_read_b64_tr_b16 a[136:137], v39 offset:0
    v_mfma_f32_16x16x32_bf16 v[140:143], a[108:111], a[92:95], v[140:143]
    v_mfma_f32_16x16x32_bf16 v[136:139], a[108:111], a[84:87], v[136:139]
    ds_read_b64_tr_b16 a[138:139], v39 offset:4096
    v_mfma_f32_16x16x32_bf16 v[136:139], a[104:107], a[80:83], v[136:139]
    buffer_load_dwordx4 a[224:227], v12, s[12:15], s43 offen offset:0 sc1
    v_and_b32 v20, 15, v1
    v_mfma_f32_16x16x32_bf16 v[172:175], a[104:107], a[72:75], v[172:175]
    ds_read_b64_tr_b16 a[140:141], v39 offset:8192
    v_mfma_f32_16x16x32_bf16 v[172:175], a[108:111], a[76:79], v[172:175]
    v_mfma_f32_16x16x32_bf16 v[168:171], a[108:111], a[68:71], v[168:171]
    ds_read_b64_tr_b16 a[142:143], v39 offset:12288
    v_mfma_f32_16x16x32_bf16 v[168:171], a[104:107], a[64:67], v[168:171]
    v_lshlrev_b32 v20, 8, v20
    s_barrier
    s_waitcnt lgkmcnt(4)
    v_mfma_f32_16x16x32_bf16 v[176:179], a[128:131], a[64:67], v[176:179]
    ds_read_b64_tr_b16 a[96:97], v32 offset:16384
    v_mfma_f32_16x16x32_bf16 v[176:179], a[132:135], a[68:71], v[176:179]
    buffer_load_dwordx4 a[228:231], v12, s[12:15], s43 offen offset:2048 sc1
    v_mfma_f32_16x16x32_bf16 v[180:183], a[132:135], a[76:79], v[180:183]
    ds_read_b64_tr_b16 a[98:99], v32 offset:20480
    v_mfma_f32_16x16x32_bf16 v[180:183], a[128:131], a[72:75], v[180:183]
    s_lshr_b32 s33, s59, 2
    v_mfma_f32_16x16x32_bf16 v[144:147], a[128:131], a[80:83], v[144:147]
    ds_read_b64_tr_b16 a[100:101], v32 offset:24576
    v_mfma_f32_16x16x32_bf16 v[144:147], a[132:135], a[84:87], v[144:147]
    v_mfma_f32_16x16x32_bf16 v[148:151], a[132:135], a[92:95], v[148:151]
    ds_read_b64_tr_b16 a[102:103], v32 offset:28672
    v_mfma_f32_16x16x32_bf16 v[148:151], a[128:131], a[88:91], v[148:151]
    s_waitcnt lgkmcnt(4)
    s_lshl_b32 s33, s33, 12
    v_mfma_f32_16x16x32_bf16 v[156:159], a[136:139], a[88:91], v[156:159]
    ds_read_b64_tr_b16 a[104:105], v33 offset:16384
    v_mfma_f32_16x16x32_bf16 v[156:159], a[140:143], a[92:95], v[156:159]
    buffer_load_dwordx4 a[232:235], v13, s[12:15], s43 offen offset:0 sc1
    v_mfma_f32_16x16x32_bf16 v[152:155], a[140:143], a[84:87], v[152:155]
    ds_read_b64_tr_b16 a[106:107], v33 offset:20480
    v_mfma_f32_16x16x32_bf16 v[152:155], a[136:139], a[80:83], v[152:155]
    s_lshl_b32 s44, s29, 7
    v_mfma_f32_16x16x32_bf16 v[188:191], a[136:139], a[72:75], v[188:191]
    ds_read_b64_tr_b16 a[108:109], v33 offset:24576
    v_mfma_f32_16x16x32_bf16 v[188:191], a[140:143], a[76:79], v[188:191]
    v_mfma_f32_16x16x32_bf16 v[184:187], a[140:143], a[68:71], v[184:187]
    ds_read_b64_tr_b16 a[110:111], v33 offset:28672
    v_mfma_f32_16x16x32_bf16 v[184:187], a[136:139], a[64:67], v[184:187]
    s_add_u32 s33, s33, s44
    s_waitcnt vmcnt(12) lgkmcnt(4)
    v_mfma_f32_16x16x32_bf16 v[96:99], a[96:99], a[160:163], v[96:99]
    ds_read_b64_tr_b16 a[128:129], v34 offset:16384
    v_mfma_f32_16x16x32_bf16 v[96:99], a[100:103], a[164:167], v[96:99]
    buffer_load_dwordx4 a[236:239], v13, s[12:15], s43 offen offset:2048 sc1
    s_add_u32 s43, s43, 4096
    v_mfma_f32_16x16x32_bf16 v[100:103], a[100:103], a[172:175], v[100:103]
    ds_read_b64_tr_b16 a[130:131], v34 offset:20480
    v_mfma_f32_16x16x32_bf16 v[100:103], a[96:99], a[168:171], v[100:103]
    s_lshl_b32 s44, s30, 3
    v_mfma_f32_16x16x32_bf16 v[64:67], a[96:99], a[176:179], v[64:67]
    ds_read_b64_tr_b16 a[132:133], v34 offset:24576
    v_mfma_f32_16x16x32_bf16 v[64:67], a[100:103], a[180:183], v[64:67]
    buffer_load_dwordx4 a[240:243], v12, s[12:15], s42 offen offset:0 sc1
    v_mfma_f32_16x16x32_bf16 v[68:71], a[100:103], a[188:191], v[68:71]
    ds_read_b64_tr_b16 a[134:135], v34 offset:28672
    v_mfma_f32_16x16x32_bf16 v[68:71], a[96:99], a[184:187], v[68:71]
    s_waitcnt lgkmcnt(4)
    s_add_u32 s33, s33, s44
    v_mfma_f32_16x16x32_bf16 v[76:79], a[104:107], a[184:187], v[76:79]
    ds_read_b64_tr_b16 a[136:137], v35 offset:16384
    v_mfma_f32_16x16x32_bf16 v[76:79], a[108:111], a[188:191], v[76:79]
    v_mfma_f32_16x16x32_bf16 v[72:75], a[108:111], a[180:183], v[72:75]
    ds_read_b64_tr_b16 a[138:139], v35 offset:20480
    v_mfma_f32_16x16x32_bf16 v[72:75], a[104:107], a[176:179], v[72:75]
    buffer_load_dwordx4 a[244:247], v12, s[12:15], s42 offen offset:2048 sc1
    s_add_u32 s33, s33, 0x2500000
    v_mfma_f32_16x16x32_bf16 v[108:111], a[104:107], a[168:171], v[108:111]
    ds_read_b64_tr_b16 a[140:141], v35 offset:24576
    v_mfma_f32_16x16x32_bf16 v[108:111], a[108:111], a[172:175], v[108:111]
    v_mfma_f32_16x16x32_bf16 v[104:107], a[108:111], a[164:167], v[104:107]
    ds_read_b64_tr_b16 a[142:143], v35 offset:28672
    v_mfma_f32_16x16x32_bf16 v[104:107], a[104:107], a[160:163], v[104:107]
    s_xor_b32 s49, s33, 0x1000
    s_waitcnt lgkmcnt(4)
    v_mfma_f32_16x16x32_bf16 v[112:115], a[128:131], a[160:163], v[112:115]
    ds_read_b64_tr_b16 a[96:97], v36 offset:16384
    v_mfma_f32_16x16x32_bf16 v[112:115], a[132:135], a[164:167], v[112:115]
    buffer_load_dwordx4 a[248:251], v13, s[12:15], s42 offen offset:0 sc1
    v_mfma_f32_16x16x32_bf16 v[116:119], a[132:135], a[172:175], v[116:119]
    ds_read_b64_tr_b16 a[98:99], v36 offset:20480
    v_mfma_f32_16x16x32_bf16 v[116:119], a[128:131], a[168:171], v[116:119]
    v_lshlrev_b32 v6, 4, v1
    v_mfma_f32_16x16x32_bf16 v[80:83], a[128:131], a[176:179], v[80:83]
    ds_read_b64_tr_b16 a[100:101], v36 offset:24576
    v_mfma_f32_16x16x32_bf16 v[80:83], a[132:135], a[180:183], v[80:83]
    v_mfma_f32_16x16x32_bf16 v[84:87], a[132:135], a[188:191], v[84:87]
    ds_read_b64_tr_b16 a[102:103], v36 offset:28672
    v_mfma_f32_16x16x32_bf16 v[84:87], a[128:131], a[184:187], v[84:87]
    s_waitcnt lgkmcnt(4)
    v_mov_b32 v22, 0x3f80
    v_mfma_f32_16x16x32_bf16 v[92:95], a[136:139], a[184:187], v[92:95]
    ds_read_b64_tr_b16 a[104:105], v37 offset:16384
    v_mfma_f32_16x16x32_bf16 v[92:95], a[140:143], a[188:191], v[92:95]
    buffer_load_dwordx4 a[252:255], v13, s[12:15], s42 offen offset:2048 sc1
    s_add_u32 s42, s42, 4096
    v_mfma_f32_16x16x32_bf16 v[88:91], a[140:143], a[180:183], v[88:91]
    s_waitcnt vmcnt(10)
    v_cmp_eq_u32 vcc, 1, v18
    ds_read_b64_tr_b16 a[106:107], v37 offset:20480
L_pg6:
    s_cbranch_execz L_tramp
    v_mfma_f32_16x16x32_bf16 v[88:91], a[136:139], a[176:179], v[88:91]
    v_mov_b32 v23, 0x3f800000
    v_mfma_f32_16x16x32_bf16 v[124:127], a[136:139], a[168:171], v[124:127]
    s_bcnt1_i32_b32 s78, vcc_lo
    ds_read_b64_tr_b16 a[108:109], v37 offset:24576
    v_mfma_f32_16x16x32_bf16 v[124:127], a[140:143], a[172:175], v[124:127]
    v_mfma_f32_16x16x32_bf16 v[120:123], a[140:143], a[164:167], v[120:123]
    s_cmp_lt_u32 s78, 16
    s_cbranch_scc1 L_spin6
L_got6:
    ds_read_b64_tr_b16 a[110:111], v37 offset:28672
    v_mfma_f32_16x16x32_bf16 v[120:123], a[136:139], a[160:163], v[120:123]
    s_lshl_b32 s45, s59, 16
    s_waitcnt lgkmcnt(4)
    v_mfma_f32_16x16x32_bf16 v[160:163], a[96:99], a[160:163], v[160:163]
    ds_read_b64_tr_b16 a[128:129], v38 offset:16384
    v_mfma_f32_16x16x32_bf16 v[160:163], a[100:103], a[164:167], v[160:163]
    buffer_load_dwordx4 v[192:195], v12, s[12:15], s43 offen offset:0 sc1
    v_mfma_f32_16x16x32_bf16 v[164:167], a[100:103], a[172:175], v[164:167]
    ds_read_b64_tr_b16 a[130:131], v38 offset:20480
    v_mfma_f32_16x16x32_bf16 v[164:167], a[96:99], a[168:171], v[164:167]
    s_lshl_b32 s31, s57, 8
    v_mfma_f32_16x16x32_bf16 v[128:131], a[96:99], a[176:179], v[128:131]
    ds_read_b64_tr_b16 a[132:133], v38 offset:24576
    v_mfma_f32_16x16x32_bf16 v[128:131], a[100:103], a[180:183], v[128:131]
    buffer_load_dwordx4 v[196:199], v12, s[12:15], s43 offen offset:2048 sc1
    v_mfma_f32_16x16x32_bf16 v[132:135], a[100:103], a[188:191], v[132:135]
    ds_read_b64_tr_b16 a[134:135], v38 offset:28672
    v_mfma_f32_16x16x32_bf16 v[132:135], a[96:99], a[184:187], v[132:135]
    s_waitcnt lgkmcnt(4)
    s_add_u32 s31, s31, s45
    v_mfma_f32_16x16x32_bf16 v[140:143], a[104:107], a[184:187], v[140:143]
    ds_read_b64_tr_b16 a[136:137], v39 offset:16384
    v_mfma_f32_16x16x32_bf16 v[140:143], a[108:111], a[188:191], v[140:143]
    v_mfma_f32_16x16x32_bf16 v[136:139], a[108:111], a[180:183], v[136:139]
    ds_read_b64_tr_b16 a[138:139], v39 offset:20480
    v_mfma_f32_16x16x32_bf16 v[136:139], a[104:107], a[176:179], v[136:139]
    buffer_load_dwordx4 v[200:203], v13, s[12:15], s43 offen offset:0 sc1
    s_lshl_b32 s45, s37, 7
    v_mfma_f32_16x16x32_bf16 v[172:175], a[104:107], a[168:171], v[172:175]
    ds_read_b64_tr_b16 a[140:141], v39 offset:24576
    v_mfma_f32_16x16x32_bf16 v[172:175], a[108:111], a[172:175], v[172:175]
    v_mfma_f32_16x16x32_bf16 v[168:171], a[108:111], a[164:167], v[168:171]
    ds_read_b64_tr_b16 a[142:143], v39 offset:28672
    v_mfma_f32_16x16x32_bf16 v[168:171], a[104:107], a[160:163], v[168:171]
    s_add_u32 s31, s31, s45
    s_barrier
    s_waitcnt lgkmcnt(4)
    v_mfma_f32_16x16x32_bf16 v[176:179], a[128:131], a[160:163], v[176:179]
    ds_read_b64_tr_b16 a[96:97], v32 offset:32768
    v_mfma_f32_16x16x32_bf16 v[176:179], a[132:135], a[164:167], v[176:179]
    buffer_load_dwordx4 v[204:207], v13, s[12:15], s43 offen offset:2048 sc1
    s_add_u32 s43, s43, 4096
    v_mfma_f32_16x16x32_bf16 v[180:183], a[132:135], a[172:175], v[180:183]
    ds_read_b64_tr_b16 a[98:99], v32 offset:36864
    v_mfma_f32_16x16x32_bf16 v[180:183], a[128:131], a[168:171], v[180:183]
    s_add_u32 s32, s31, 0x8000
    v_mfma_f32_16x16x32_bf16 v[144:147], a[128:131], a[176:179], v[144:147]
    ds_read_b64_tr_b16 a[100:101], v32 offset:40960
    v_mfma_f32_16x16x32_bf16 v[144:147], a[132:135], a[180:183], v[144:147]
    buffer_load_dwordx4 v[208:211], v12, s[12:15], s42 offen offset:0 sc1
    v_mfma_f32_16x16x32_bf16 v[148:151], a[132:135], a[188:191], v[148:151]
    ds_read_b64_tr_b16 a[102:103], v32 offset:45056
    v_mfma_f32_16x16x32_bf16 v[148:151], a[128:131], a[184:187], v[148:151]
    s_waitcnt lgkmcnt(4)
    v_lshrrev_b32 v21, 3, v1
    v_mfma_f32_16x16x32_bf16 v[156:159], a[136:139], a[184:187], v[156:159]
    ds_read_b64_tr_b16 a[104:105], v33 offset:32768
    v_mfma_f32_16x16x32_bf16 v[156:159], a[140:143], a[188:191], v[156:159]
    v_mfma_f32_16x16x32_bf16 v[152:155], a[140:143], a[180:183], v[152:155]
    ds_read_b64_tr_b16 a[106:107], v33 offset:36864
    v_mfma_f32_16x16x32_bf16 v[152:155], a[136:139], a[176:179], v[152:155]
    buffer_load_dwordx4 v[212:215], v12, s[12:15], s42 offen offset:2048 sc1
    v_xor_b32 v19, v21, v1
    v_mfma_f32_16x16x32_bf16 v[188:191], a[136:139], a[168:171], v[188:191]
    ds_read_b64_tr_b16 a[108:109], v33 offset:40960
    v_mfma_f32_16x16x32_bf16 v[188:191], a[140:143], a[172:175], v[188:191]
    v_mfma_f32_16x16x32_bf16 v[184:187], a[140:143], a[164:167], v[184:187]
    ds_read_b64_tr_b16 a[110:111], v33 offset:45056
    v_mfma_f32_16x16x32_bf16 v[184:187], a[136:139], a[160:163], v[184:187]
    v_and_b32 v19, 7, v19
    s_waitcnt vmcnt(14) lgkmcnt(4)
    v_mfma_f32_16x16x32_bf16 v[96:99], a[96:99], a[192:195], v[96:99]
    ds_read_b64_tr_b16 a[128:129], v34 offset:32768
    v_mfma_f32_16x16x32_bf16 v[96:99], a[100:103], a[196:199], v[96:99]
    buffer_load_dwordx4 v[216:219], v13, s[12:15], s42 offen offset:0 sc1
    v_mfma_f32_16x16x32_bf16 v[100:103], a[100:103], a[204:207], v[100:103]
    ds_read_b64_tr_b16 a[130:131], v34 offset:36864
    v_mfma_f32_16x16x32_bf16 v[100:103], a[96:99], a[200:203], v[100:103]
    v_lshlrev_b32 v19, 4, v19
    v_mfma_f32_16x16x32_bf16 v[64:67], a[96:99], a[208:211], v[64:67]
    ds_read_b64_tr_b16 a[132:133], v34 offset:40960
    v_mfma_f32_16x16x32_bf16 v[64:67], a[100:103], a[212:215], v[64:67]
    v_mfma_f32_16x16x32_bf16 v[68:71], a[100:103], a[220:223], v[68:71]
    ds_read_b64_tr_b16 a[134:135], v34 offset:45056
    v_mfma_f32_16x16x32_bf16 v[68:71], a[96:99], a[216:219], v[68:71]
    s_waitcnt lgkmcnt(4)
    v_lshl_add_u32 v19, v21, 11, v19
    v_mfma_f32_16x16x32_bf16 v[76:79], a[104:107], a[216:219], v[76:79]
    ds_read_b64_tr_b16 a[136:137], v35 offset:32768
    v_mfma_f32_16x16x32_bf16 v[76:79], a[108:111], a[220:223], v[76:79]
    buffer_load_dwordx4 v[220:223], v13, s[12:15], s42 offen offset:2048 sc1
    s_add_u32 s42, s42, 4096
    v_mfma_f32_16x16x32_bf16 v[72:75], a[108:111], a[212:215], v[72:75]
    ds_read_b64_tr_b16 a[138:139], v35 offset:36864
    v_mfma_f32_16x16x32_bf16 v[72:75], a[104:107], a[208:211], v[72:75]
    v_add_u32 v16, 0x4000, v19
    v_mfma_f32_16x16x32_bf16 v[108:111], a[104:107], a[200:203], v[108:111]
    ds_read_b64_tr_b16 a[140:141], v35 offset:40960
    v_mfma_f32_16x16x32_bf16 v[108:111], a[108:111], a[204:207], v[108:111]
    v_mfma_f32_16x16x32_bf16 v[104:107], a[108:111], a[196:199], v[104:107]
    ds_read_b64_tr_b16 a[142:143], v35 offset:45056
    v_mfma_f32_16x16x32_bf16 v[104:107], a[104:107], a[192:195], v[104:107]
    v_add_u32 v60, s63, v6
    s_waitcnt lgkmcnt(4)
    v_mfma_f32_16x16x32_bf16 v[112:115], a[128:131], a[192:195], v[112:115]
    ds_read_b64_tr_b16 a[96:97], v36 offset:32768
    v_mfma_f32_16x16x32_bf16 v[112:115], a[132:135], a[196:199], v[112:115]
    buffer_load_dwordx4 v[224:227], v12, s[12:15], s43 offen offset:0 sc1
    v_mfma_f32_16x16x32_bf16 v[116:119], a[132:135], a[204:207], v[116:119]
    ds_read_b64_tr_b16 a[98:99], v36 offset:36864
    global_load_dword v9, v8, s[84:85]
    v_mfma_f32_16x16x32_bf16 v[116:119], a[128:131], a[200:203], v[116:119]
    v_lshrrev_b32 v21, 5, v1
    v_mfma_f32_16x16x32_bf16 v[80:83], a[128:131], a[208:211], v[80:83]
    ds_read_b64_tr_b16 a[100:101], v36 offset:40960
    v_mfma_f32_16x16x32_bf16 v[80:83], a[132:135], a[212:215], v[80:83]
    buffer_load_dwordx4 v[228:231], v12, s[12:15], s43 offen offset:2048 sc1
    v_mfma_f32_16x16x32_bf16 v[84:87], a[132:135], a[220:223], v[84:87]
    ds_read_b64_tr_b16 a[102:103], v36 offset:45056
    v_mfma_f32_16x16x32_bf16 v[84:87], a[128:131], a[216:219], v[84:87]
    s_waitcnt lgkmcnt(4)
    v_xor_b32 v21, v21, v1
    v_mfma_f32_16x16x32_bf16 v[92:95], a[136:139], a[216:219], v[92:95]
    ds_read_b64_tr_b16 a[104:105], v37 offset:32768
    v_mfma_f32_16x16x32_bf16 v[92:95], a[140:143], a[220:223], v[92:95]
    v_mfma_f32_16x16x32_bf16 v[88:91], a[140:143], a[212:215], v[88:91]
    ds_read_b64_tr_b16 a[106:107], v37 offset:36864
    v_mfma_f32_16x16x32_bf16 v[88:91], a[136:139], a[208:211], v[88:91]
    buffer_load_dwordx4 v[232:235], v13, s[12:15], s43 offen offset:0 sc1
    v_and_b32 v21, 7, v21
    v_mfma_f32_16x16x32_bf16 v[124:127], a[136:139], a[200:203], v[124:127]
    ds_read_b64_tr_b16 a[108:109], v37 offset:40960
    v_mfma_f32_16x16x32_bf16 v[124:127], a[140:143], a[204:207], v[124:127]
    v_mfma_f32_16x16x32_bf16 v[120:123], a[140:143], a[196:199], v[120:123]
    ds_read_b64_tr_b16 a[110:111], v37 offset:45056
    v_mfma_f32_16x16x32_bf16 v[120:123], a[136:139], a[192:195], v[120:123]
    v_lshlrev_b32 v56, 4, v21
    s_waitcnt lgkmcnt(4)
    v_mfma_f32_16x16x32_bf16 v[160:163], a[96:99], a[192:195], v[160:163]
    ds_read_b64_tr_b16 a[128:129], v38 offset:32768
    v_mfma_f32_16x16x32_bf16 v[160:163], a[100:103], a[196:199], v[160:163]
    buffer_load_dwordx4 v[236:239], v13, s[12:15], s43 offen offset:2048 sc1
    s_add_u32 s43, s43, 4096
    v_mfma_f32_16x16x32_bf16 v[164:167], a[100:103], a[204:207], v[164:167]
    ds_read_b64_tr_b16 a[130:131], v38 offset:36864
    v_mfma_f32_16x16x32_bf16 v[164:167], a[96:99], a[200:203], v[164:167]
    v_and_b32 v21, 15, v1
    v_mfma_f32_16x16x32_bf16 v[128:131], a[96:99], a[208:211], v[128:131]
    ds_read_b64_tr_b16 a[132:133], v38 offset:40960
    v_mfma_f32_16x16x32_bf16 v[128:131], a[100:103], a[212:215], v[128:131]
    buffer_load_dwordx4 v[240:243], v12, s[12:15], s42 offen offset:0 sc1
    v_mfma_f32_16x16x32_bf16 v[132:135], a[100:103], a[220:223], v[132:135]
    ds_read_b64_tr_b16 a[134:135], v38 offset:45056
    v_mfma_f32_16x16x32_bf16 v[132:135], a[96:99], a[216:219], v[132:135]
    s_waitcnt lgkmcnt(4)
    v_lshl_add_u32 v56, v21, 7, v56
    v_mfma_f32_16x16x32_bf16 v[140:143], a[104:107], a[216:219], v[140:143]
    ds_read_b64_tr_b16 a[136:137], v39 offset:32768
    v_mfma_f32_16x16x32_bf16 v[140:143], a[108:111], a[220:223], v[140:143]
    v_mfma_f32_16x16x32_bf16 v[136:139], a[108:111], a[212:215], v[136:139]
    ds_read_b64_tr_b16 a[138:139], v39 offset:36864
    v_mfma_f32_16x16x32_bf16 v[136:139], a[104:107], a[208:211], v[136:139]
    buffer_load_dwordx4 v[244:247], v12, s[12:15], s42 offen offset:2048 sc1
    v_bfe_u32 v21, v1, 4, 1
    v_mfma_f32_16x16x32_bf16 v[172:175], a[104:107], a[200:203], v[172:175]
    ds_read_b64_tr_b16 a[140:141], v39 offset:40960
    v_mfma_f32_16x16x32_bf16 v[172:175], a[108:111], a[204:207], v[172:175]
    v_mfma_f32_16x16x32_bf16 v[168:171], a[108:111], a[196:199], v[168:171]
    ds_read_b64_tr_b16 a[142:143], v39 offset:45056
    v_mfma_f32_16x16x32_bf16 v[168:171], a[104:107], a[192:195], v[168:171]
    v_lshl_add_u32 v56, v21, 3, v56
    s_barrier
    s_waitcnt lgkmcnt(4)
    v_mfma_f32_16x16x32_bf16 v[176:179], a[128:131], a[192:195], v[176:179]
    ds_read_b64_tr_b16 a[96:97], v32 offset:49152
    v_mfma_f32_16x16x32_bf16 v[176:179], a[132:135], a[196:199], v[176:179]
    buffer_load_dwordx4 v[248:251], v13, s[12:15], s42 offen offset:0 sc1
    v_mfma_f32_16x16x32_bf16 v[180:183], a[132:135], a[204:207], v[180:183]
    ds_read_b64_tr_b16 a[98:99], v32 offset:53248
    v_mfma_f32_16x16x32_bf16 v[180:183], a[128:131], a[200:203], v[180:183]
    v_add_u32 v56, s63, v56
    v_mfma_f32_16x16x32_bf16 v[144:147], a[128:131], a[208:211], v[144:147]
    ds_read_b64_tr_b16 a[100:101], v32 offset:57344
    v_mfma_f32_16x16x32_bf16 v[144:147], a[132:135], a[212:215], v[144:147]
    buffer_load_dwordx4 v[252:255], v13, s[12:15], s42 offen offset:2048 sc1
    s_add_u32 s42, s42, 4096
    v_mfma_f32_16x16x32_bf16 v[148:151], a[132:135], a[220:223], v[148:151]
    ds_read_b64_tr_b16 a[102:103], v32 offset:61440
    v_mfma_f32_16x16x32_bf16 v[148:151], a[128:131], a[216:219], v[148:151]
    s_waitcnt lgkmcnt(4)
    v_xor_b32 v57, 32, v56
    v_mfma_f32_16x16x32_bf16 v[156:159], a[136:139], a[216:219], v[156:159]
    ds_read_b64_tr_b16 a[104:105], v33 offset:49152
    v_mfma_f32_16x16x32_bf16 v[156:159], a[140:143], a[220:223], v[156:159]
    s_add_u32 m0, s63, 0
    s_add_u32 s47, s62, 0x80000
    buffer_load_dwordx4 v2, s[64:67], s47 offen offset:0 lds
    v_mfma_f32_16x16x32_bf16 v[152:155], a[140:143], a[212:215], v[152:155]
    ds_read_b64_tr_b16 a[106:107], v33 offset:53248
    v_mfma_f32_16x16x32_bf16 v[152:155], a[136:139], a[208:211], v[152:155]
    v_xor_b32 v58, 64, v56
    v_mfma_f32_16x16x32_bf16 v[188:191], a[136:139], a[200:203], v[188:191]
    ds_read_b64_tr_b16 a[108:109], v33 offset:57344
    v_mfma_f32_16x16x32_bf16 v[188:191], a[140:143], a[204:207], v[188:191]
    buffer_load_dwordx4 v3, s[64:67], s47 offen offset:1024 lds
    v_mfma_f32_16x16x32_bf16 v[184:187], a[140:143], a[196:199], v[184:187]
    ds_read_b64_tr_b16 a[110:111], v33 offset:61440
    v_mfma_f32_16x16x32_bf16 v[184:187], a[136:139], a[192:195], v[184:187]
    v_xor_b32 v59, 96, v56
L_p2midF:
    s_waitcnt vmcnt(19) lgkmcnt(4)
    v_mfma_f32_16x16x32_bf16 v[96:99], a[96:99], a[224:227], v[96:99]
    buffer_load_dword v17, v7, s[12:15], s99 offen offset:0 sc1
    ds_read_b64_tr_b16 a[128:129], v34 offset:49152
    v_mfma_f32_16x16x32_bf16 v[96:99], a[100:103], a[228:231], v[96:99]
    buffer_load_dwordx4 v4, s[64:67], s47 offen offset:2048 lds
    v_mfma_f32_16x16x32_bf16 v[100:103], a[100:103], a[236:239], v[100:103]
    ds_read_b64_tr_b16 a[130:131], v34 offset:53248
    v_mfma_f32_16x16x32_bf16 v[100:103], a[96:99], a[232:235], v[100:103]
    s_xor_b32 s52, s34, 0xc000
    v_mfma_f32_16x16x32_bf16 v[64:67], a[96:99], a[240:243], v[64:67]
    ds_read_b64_tr_b16 a[132:133], v34 offset:57344
    v_mfma_f32_16x16x32_bf16 v[64:67], a[100:103], a[244:247], v[64:67]
    buffer_load_dwordx4 v5, s[64:67], s47 offen offset:3072 lds
    v_mfma_f32_16x16x32_bf16 v[68:71], a[100:103], a[252:255], v[68:71]
    ds_read_b64_tr_b16 a[134:135], v34 offset:61440
    v_mfma_f32_16x16x32_bf16 v[68:71], a[96:99], a[248:251], v[68:71]
    s_waitcnt lgkmcnt(4)
    s_add_u32 s52, s52, 0x2800000
    v_mfma_f32_16x16x32_bf16 v[76:79], a[104:107], a[248:251], v[76:79]
    ds_read_b64_tr_b16 a[136:137], v35 offset:49152
    v_mfma_f32_16x16x32_bf16 v[76:79], a[108:111], a[252:255], v[76:79]
    v_mfma_f32_16x16x32_bf16 v[72:75], a[108:111], a[244:247], v[72:75]
    ds_read_b64_tr_b16 a[138:139], v35 offset:53248
    v_mfma_f32_16x16x32_bf16 v[72:75], a[104:107], a[240:243], v[72:75]
    buffer_load_dwordx4 a[0:3], v12, s[12:15], s43 offen offset:0 sc1
    s_add_u32 s76, s34, 0x2800000
    v_mfma_f32_16x16x32_bf16 v[108:111], a[104:107], a[232:235], v[108:111]
    ds_read_b64_tr_b16 a[140:141], v35 offset:57344
    v_mfma_f32_16x16x32_bf16 v[108:111], a[108:111], a[236:239], v[108:111]
    v_mfma_f32_16x16x32_bf16 v[104:107], a[108:111], a[228:231], v[104:107]
    ds_read_b64_tr_b16 a[142:143], v35 offset:61440
    v_mfma_f32_16x16x32_bf16 v[104:107], a[104:107], a[224:227], v[104:107]
    s_xor_b32 s53, s34, 0x8000
    s_waitcnt lgkmcnt(4)
    v_mfma_f32_16x16x32_bf16 v[112:115], a[128:131], a[224:227], v[112:115]
    ds_read_b64_tr_b16 a[96:97], v36 offset:49152
    v_mfma_f32_16x16x32_bf16 v[112:115], a[132:135], a[228:231], v[112:115]
    buffer_load_dwordx4 a[4:7], v12, s[12:15], s43 offen offset:2048 sc1
    v_mfma_f32_16x16x32_bf16 v[116:119], a[132:135], a[236:239], v[116:119]
    ds_read_b64_tr_b16 a[98:99], v36 offset:53248
    v_mfma_f32_16x16x32_bf16 v[116:119], a[128:131], a[232:235], v[116:119]
    s_add_u32 s53, s53, 0x2c00000
    v_mfma_f32_16x16x32_bf16 v[80:83], a[128:131], a[240:243], v[80:83]
    ds_read_b64_tr_b16 a[100:101], v36 offset:57344
    v_mfma_f32_16x16x32_bf16 v[80:83], a[132:135], a[244:247], v[80:83]
    buffer_load_dwordx4 a[8:11], v13, s[12:15], s43 offen offset:0 sc1
    v_mfma_f32_16x16x32_bf16 v[84:87], a[132:135], a[252:255], v[84:87]
    ds_read_b64_tr_b16 a[102:103], v36 offset:61440
    v_mfma_f32_16x16x32_bf16 v[84:87], a[128:131], a[248:251], v[84:87]
    s_waitcnt lgkmcnt(4)
    s_add_u32 s77, s34, 0x2c00000
    v_mfma_f32_16x16x32_bf16 v[92:95], a[136:139], a[248:251], v[92:95]
    ds_read_b64_tr_b16 a[104:105], v37 offset:49152
    v_mfma_f32_16x16x32_bf16 v[92:95], a[140:143], a[252:255], v[92:95]
    buffer_load_dwordx4 a[12:15], v13, s[12:15], s43 offen offset:2048 sc1
    s_add_u32 s43, s43, 4096
    v_mfma_f32_16x16x32_bf16 v[88:91], a[140:143], a[244:247], v[88:91]
    ds_read_b64_tr_b16 a[106:107], v37 offset:53248
    v_mfma_f32_16x16x32_bf16 v[88:91], a[136:139], a[240:243], v[88:91]
    s_xor_b32 s54, s34, 0x4000
    v_mfma_f32_16x16x32_bf16 v[124:127], a[136:139], a[232:235], v[124:127]
    ds_read_b64_tr_b16 a[108:109], v37 offset:57344
    v_mfma_f32_16x16x32_bf16 v[124:127], a[140:143], a[236:239], v[124:127]
    buffer_load_dwordx4 a[16:19], v12, s[12:15], s42 offen offset:0 sc1
    v_mfma_f32_16x16x32_bf16 v[120:123], a[140:143], a[228:231], v[120:123]
    ds_read_b64_tr_b16 a[110:111], v37 offset:61440
    v_mfma_f32_16x16x32_bf16 v[120:123], a[136:139], a[224:227], v[120:123]
    s_add_u32 s54, s54, 0x3000000
    s_waitcnt lgkmcnt(4)
    v_mfma_f32_16x16x32_bf16 v[160:163], a[96:99], a[224:227], v[160:163]
    ds_read_b64_tr_b16 a[128:129], v38 offset:49152
    v_mfma_f32_16x16x32_bf16 v[160:163], a[100:103], a[228:231], v[160:163]
    buffer_load_dwordx4 a[20:23], v12, s[12:15], s42 offen offset:2048 sc1
    v_mfma_f32_16x16x32_bf16 v[164:167], a[100:103], a[236:239], v[164:167]
    ds_read_b64_tr_b16 a[130:131], v38 offset:53248
    v_mfma_f32_16x16x32_bf16 v[164:167], a[96:99], a[232:235], v[164:167]
    s_add_u32 s55, s34, 0x3000000
    v_mfma_f32_16x16x32_bf16 v[128:131], a[96:99], a[240:243], v[128:131]
    ds_read_b64_tr_b16 a[132:133], v38 offset:57344
    v_mfma_f32_16x16x32_bf16 v[128:131], a[100:103], a[244:247], v[128:131]
    buffer_load_dwordx4 a[24:27], v13, s[12:15], s42 offen offset:0 sc1
    v_mfma_f32_16x16x32_bf16 v[132:135], a[100:103], a[252:255], v[132:135]
    ds_read_b64_tr_b16 a[134:135], v38 offset:61440
    v_mfma_f32_16x16x32_bf16 v[132:135], a[96:99], a[248:251], v[132:135]
    s_waitcnt lgkmcnt(4)
    v_sub_u32 v10, 3, v1
    v_mfma_f32_16x16x32_bf16 v[140:143], a[104:107], a[248:251], v[140:143]
    ds_read_b64_tr_b16 a[136:137], v39 offset:49152
    v_mfma_f32_16x16x32_bf16 v[140:143], a[108:111], a[252:255], v[140:143]
    buffer_load_dwordx4 a[28:31], v13, s[12:15], s42 offen offset:2048 sc1
    s_add_u32 s42, s42, 4096
    v_mfma_f32_16x16x32_bf16 v[136:139], a[108:111], a[244:247], v[136:139]
    ds_read_b64_tr_b16 a[138:139], v39 offset:53248
    v_mfma_f32_16x16x32_bf16 v[136:139], a[104:107], a[240:243], v[136:139]
    v_and_b32 v10, 3, v10
    v_mfma_f32_16x16x32_bf16 v[172:175], a[104:107], a[232:235], v[172:175]
    ds_read_b64_tr_b16 a[140:141], v39 offset:57344
    v_mfma_f32_16x16x32_bf16 v[172:175], a[108:111], a[236:239], v[172:175]
    s_add_u32 m0, s63, 16384
    s_add_u32 s47, s62, 0xc0000
    buffer_load_dwordx4 v2, s[64:67], s47 offen offset:0 lds
    v_mfma_f32_16x16x32_bf16 v[168:171], a[108:111], a[228:231], v[168:171]
    ds_read_b64_tr_b16 a[142:143], v39 offset:61440
    v_mfma_f32_16x16x32_bf16 v[168:171], a[104:107], a[224:227], v[168:171]
    v_lshlrev_b32 v10, 10, v10
    s_barrier
    s_waitcnt lgkmcnt(4)
    v_mfma_f32_16x16x32_bf16 v[176:179], a[128:131], a[224:227], v[176:179]
    ds_read_b64_tr_b16 a[96:97], v40 offset:0
    v_mfma_f32_16x16x32_bf16 v[176:179], a[132:135], a[228:231], v[176:179]
    buffer_load_dwordx4 v3, s[64:67], s47 offen offset:1024 lds
    v_mfma_f32_16x16x32_bf16 v[180:183], a[132:135], a[236:239], v[180:183]
    ds_read_b64_tr_b16 a[98:99], v40 offset:4096
    v_mfma_f32_16x16x32_bf16 v[180:183], a[128:131], a[232:235], v[180:183]
    v_xor_b32 v10, s35, v10
    v_mfma_f32_16x16x32_bf16 v[144:147], a[128:131], a[240:243], v[144:147]
    ds_read_b64_tr_b16 a[100:101], v40 offset:8192
    v_mfma_f32_16x16x32_bf16 v[144:147], a[132:135], a[244:247], v[144:147]
    buffer_load_dwordx4 v4, s[64:67], s47 offen offset:2048 lds
    v_mfma_f32_16x16x32_bf16 v[148:151], a[132:135], a[252:255], v[148:151]
    ds_read_b64_tr_b16 a[102:103], v40 offset:12288
    v_mfma_f32_16x16x32_bf16 v[148:151], a[128:131], a[248:251], v[148:151]
    s_waitcnt lgkmcnt(4)
    v_add_u32 v10, 0x25c0000, v10
    v_mfma_f32_16x16x32_bf16 v[156:159], a[136:139], a[248:251], v[156:159]
    ds_read_b64_tr_b16 a[104:105], v41 offset:0
    v_mfma_f32_16x16x32_bf16 v[156:159], a[140:143], a[252:255], v[156:159]
    v_mfma_f32_16x16x32_bf16 v[152:155], a[140:143], a[244:247], v[152:155]
    s_waitcnt vmcnt(13)
    v_cmp_eq_u32 vcc, 1, v17
    ds_read_b64_tr_b16 a[106:107], v41 offset:4096
    v_mfma_f32_16x16x32_bf16 v[152:155], a[136:139], a[240:243], v[152:155]
    buffer_load_dwordx4 v5, s[64:67], s47 offen offset:3072 lds
    v_add_u32 v10, v10, v14
    v_mfma_f32_16x16x32_bf16 v[188:191], a[136:139], a[232:235], v[188:191]
    s_bcnt1_i32_b64 s78, vcc
    ds_read_b64_tr_b16 a[108:109], v41 offset:8192
    v_mfma_f32_16x16x32_bf16 v[188:191], a[140:143], a[236:239], v[188:191]
    v_mfma_f32_16x16x32_bf16 v[184:187], a[140:143], a[228:231], v[184:187]
    s_cmp_lt_u32 s78, 64
    s_cbranch_scc1 L_spin7
L_got7:
    ds_read_b64_tr_b16 a[110:111], v41 offset:12288
    v_mfma_f32_16x16x32_bf16 v[184:187], a[136:139], a[224:227], v[184:187]
    s_add_u32 s38, s35, 0x25c0000
    s_waitcnt lgkmcnt(4)
    v_mfma_f32_16x16x32_bf16 v[96:99], a[96:99], v[192:195], v[96:99]
    buffer_load_dword v18, v14, s[12:15], s40 offen offset:0 sc1
    ds_read_b64_tr_b16 a[128:129], v42 offset:0
    v_mfma_f32_16x16x32_bf16 v[96:99], a[100:103], v[196:199], v[96:99]
    buffer_load_dwordx2 v[48:49], v20, s[12:15], s33 offen sc1
    v_mfma_f32_16x16x32_bf16 v[100:103], a[100:103], v[204:207], v[100:103]
    ds_read_b64_tr_b16 a[130:131], v42 offset:4096
    v_mfma_f32_16x16x32_bf16 v[100:103], a[96:99], v[200:203], v[100:103]
    v_mfma_f32_16x16x32_bf16 v[64:67], a[96:99], v[208:211], v[64:67]
    ds_read_b64_tr_b16 a[132:133], v42 offset:8192
    v_mfma_f32_16x16x32_bf16 v[64:67], a[100:103], v[212:215], v[64:67]
    buffer_load_dwordx2 v[50:51], v20, s[12:15], s49 offen sc1
    v_mfma_f32_16x16x32_bf16 v[68:71], a[100:103], v[220:223], v[68:71]
    ds_read_b64_tr_b16 a[134:135], v42 offset:12288
    v_mfma_f32_16x16x32_bf16 v[68:71], a[96:99], v[216:219], v[68:71]
    s_waitcnt lgkmcnt(4)
    v_mfma_f32_16x16x32_bf16 v[76:79], a[104:107], v[216:219], v[76:79]
    ds_read_b64_tr_b16 a[136:137], v43 offset:0
    v_mfma_f32_16x16x32_bf16 v[76:79], a[108:111], v[220:223], v[76:79]
    buffer_load_dwordx4 a[32:35], v12, s[12:15], s43 offen offset:0 sc1
    v_mfma_f32_16x16x32_bf16 v[72:75], a[108:111], v[212:215], v[72:75]
    ds_read_b64_tr_b16 a[138:139], v43 offset:4096
    v_mfma_f32_16x16x32_bf16 v[72:75], a[104:107], v[208:211], v[72:75]
    v_mfma_f32_16x16x32_bf16 v[108:111], a[104:107], v[200:203], v[108:111]
    ds_read_b64_tr_b16 a[140:141], v43 offset:8192
    v_mfma_f32_16x16x32_bf16 v[108:111], a[108:111], v[204:207], v[108:111]
    buffer_load_dwordx4 a[36:39], v12, s[12:15], s43 offen offset:2048 sc1
    v_mfma_f32_16x16x32_bf16 v[104:107], a[108:111], v[196:199], v[104:107]
    ds_read_b64_tr_b16 a[142:143], v43 offset:12288
    v_mfma_f32_16x16x32_bf16 v[104:107], a[104:107], v[192:195], v[104:107]
    s_waitcnt lgkmcnt(4)
    v_mfma_f32_16x16x32_bf16 v[112:115], a[128:131], v[192:195], v[112:115]
    ds_read_b64_tr_b16 a[96:97], v44 offset:0
    v_mfma_f32_16x16x32_bf16 v[112:115], a[132:135], v[196:199], v[112:115]
    buffer_load_dwordx4 a[40:43], v13, s[12:15], s43 offen offset:0 sc1
    v_mfma_f32_16x16x32_bf16 v[116:119], a[132:135], v[204:207], v[116:119]
    ds_read_b64_tr_b16 a[98:99], v44 offset:4096
    v_mfma_f32_16x16x32_bf16 v[116:119], a[128:131], v[200:203], v[116:119]
    v_mfma_f32_16x16x32_bf16 v[80:83], a[128:131], v[208:211], v[80:83]
    ds_read_b64_tr_b16 a[100:101], v44 offset:8192
    v_mfma_f32_16x16x32_bf16 v[80:83], a[132:135], v[212:215], v[80:83]
    buffer_load_dwordx4 a[44:47], v13, s[12:15], s43 offen offset:2048 sc1
    s_add_u32 s43, s43, 4096
    v_mfma_f32_16x16x32_bf16 v[84:87], a[132:135], v[220:223], v[84:87]
    ds_read_b64_tr_b16 a[102:103], v44 offset:12288
    v_mfma_f32_16x16x32_bf16 v[84:87], a[128:131], v[216:219], v[84:87]
    s_waitcnt lgkmcnt(4)
    v_mfma_f32_16x16x32_bf16 v[92:95], a[136:139], v[216:219], v[92:95]
    ds_read_b64_tr_b16 a[104:105], v45 offset:0
    v_mfma_f32_16x16x32_bf16 v[92:95], a[140:143], v[220:223], v[92:95]
    v_mfma_f32_16x16x32_bf16 v[88:91], a[140:143], v[212:215], v[88:91]
    ds_read_b64_tr_b16 a[106:107], v45 offset:4096
    v_mfma_f32_16x16x32_bf16 v[88:91], a[136:139], v[208:211], v[88:91]
    buffer_load_dwordx4 a[48:51], v12, s[12:15], s42 offen offset:0 sc1
    v_mfma_f32_16x16x32_bf16 v[124:127], a[136:139], v[200:203], v[124:127]
    ds_read_b64_tr_b16 a[108:109], v45 offset:8192
    v_mfma_f32_16x16x32_bf16 v[124:127], a[140:143], v[204:207], v[124:127]
    v_mfma_f32_16x16x32_bf16 v[120:123], a[140:143], v[196:199], v[120:123]
    ds_read_b64_tr_b16 a[110:111], v45 offset:12288
    v_mfma_f32_16x16x32_bf16 v[120:123], a[136:139], v[192:195], v[120:123]
    s_waitcnt lgkmcnt(4)
    v_mfma_f32_16x16x32_bf16 v[160:163], a[96:99], v[192:195], v[160:163]
    ds_read_b64_tr_b16 a[128:129], v46 offset:0
    v_mfma_f32_16x16x32_bf16 v[160:163], a[100:103], v[196:199], v[160:163]
    buffer_load_dwordx4 a[52:55], v12, s[12:15], s42 offen offset:2048 sc1
    v_mfma_f32_16x16x32_bf16 v[164:167], a[100:103], v[204:207], v[164:167]
    ds_read_b64_tr_b16 a[130:131], v46 offset:4096
    v_mfma_f32_16x16x32_bf16 v[164:167], a[96:99], v[200:203], v[164:167]
    v_mfma_f32_16x16x32_bf16 v[128:131], a[96:99], v[208:211], v[128:131]
    ds_read_b64_tr_b16 a[132:133], v46 offset:8192
    v_mfma_f32_16x16x32_bf16 v[128:131], a[100:103], v[212:215], v[128:131]
    buffer_load_dwordx4 a[56:59], v13, s[12:15], s42 offen offset:0 sc1
    v_mfma_f32_16x16x32_bf16 v[132:135], a[100:103], v[220:223], v[132:135]
    ds_read_b64_tr_b16 a[134:135], v46 offset:12288
    v_mfma_f32_16x16x32_bf16 v[132:135], a[96:99], v[216:219], v[132:135]
    s_waitcnt lgkmcnt(4)
    v_mfma_f32_16x16x32_bf16 v[140:143], a[104:107], v[216:219], v[140:143]
    ds_read_b64_tr_b16 a[136:137], v47 offset:0
    v_mfma_f32_16x16x32_bf16 v[140:143], a[108:111], v[220:223], v[140:143]
    buffer_load_dwordx4 a[60:63], v13, s[12:15], s42 offen offset:2048 sc1
    s_add_u32 s42, s42, 4096
    v_mfma_f32_16x16x32_bf16 v[136:139], a[108:111], v[212:215], v[136:139]
    ds_read_b64_tr_b16 a[138:139], v47 offset:4096
    v_mfma_f32_16x16x32_bf16 v[136:139], a[104:107], v[208:211], v[136:139]
    v_mfma_f32_16x16x32_bf16 v[172:175], a[104:107], v[200:203], v[172:175]
    ds_read_b64_tr_b16 a[140:141], v47 offset:8192
    v_mfma_f32_16x16x32_bf16 v[172:175], a[108:111], v[204:207], v[172:175]
    s_add_u32 m0, s63, 32768
    s_add_u32 s47, s62, 0xf0000
    buffer_load_dwordx4 v2, s[64:67], s47 offen offset:0 lds
    v_mfma_f32_16x16x32_bf16 v[168:171], a[108:111], v[196:199], v[168:171]
    ds_read_b64_tr_b16 a[142:143], v47 offset:12288
    v_mfma_f32_16x16x32_bf16 v[168:171], a[104:107], v[192:195], v[168:171]
    s_barrier
    s_waitcnt lgkmcnt(4)
    v_mfma_f32_16x16x32_bf16 v[176:179], a[128:131], v[192:195], v[176:179]
    ds_read_b64_tr_b16 a[96:97], v40 offset:16384
    v_mfma_f32_16x16x32_bf16 v[176:179], a[132:135], v[196:199], v[176:179]
    buffer_load_dwordx4 v3, s[64:67], s47 offen offset:1024 lds
    v_mfma_f32_16x16x32_bf16 v[180:183], a[132:135], v[204:207], v[180:183]
    ds_read_b64_tr_b16 a[98:99], v40 offset:20480
    v_mfma_f32_16x16x32_bf16 v[180:183], a[128:131], v[200:203], v[180:183]
    v_mfma_f32_16x16x32_bf16 v[144:147], a[128:131], v[208:211], v[144:147]
    ds_read_b64_tr_b16 a[100:101], v40 offset:24576
    v_mfma_f32_16x16x32_bf16 v[144:147], a[132:135], v[212:215], v[144:147]
    buffer_load_dwordx4 v4, s[64:67], s47 offen offset:2048 lds
    v_mfma_f32_16x16x32_bf16 v[148:151], a[132:135], v[220:223], v[148:151]
    ds_read_b64_tr_b16 a[102:103], v40 offset:28672
    v_mfma_f32_16x16x32_bf16 v[148:151], a[128:131], v[216:219], v[148:151]
    s_waitcnt lgkmcnt(4)
    v_mfma_f32_16x16x32_bf16 v[156:159], a[136:139], v[216:219], v[156:159]
    ds_read_b64_tr_b16 a[104:105], v41 offset:16384
    v_mfma_f32_16x16x32_bf16 v[156:159], a[140:143], v[220:223], v[156:159]
    v_mfma_f32_16x16x32_bf16 v[152:155], a[140:143], v[212:215], v[152:155]
    s_waitcnt vmcnt(13)
    v_cmp_eq_u32 vcc, 1, v18
    ds_read_b64_tr_b16 a[106:107], v41 offset:20480
    v_mfma_f32_16x16x32_bf16 v[152:155], a[136:139], v[208:211], v[152:155]
    buffer_load_dwordx4 v5, s[64:67], s47 offen offset:3072 lds
    v_mfma_f32_16x16x32_bf16 v[188:191], a[136:139], v[200:203], v[188:191]
    s_bcnt1_i32_b32 s78, vcc_lo
    ds_read_b64_tr_b16 a[108:109], v41 offset:24576
    v_mfma_f32_16x16x32_bf16 v[188:191], a[140:143], v[204:207], v[188:191]
    v_mfma_f32_16x16x32_bf16 v[184:187], a[140:143], v[196:199], v[184:187]
    s_cmp_lt_u32 s78, 32
    s_cbranch_scc1 L_spin8
L_got8:
    ds_read_b64_tr_b16 a[110:111], v41 offset:28672
    v_mfma_f32_16x16x32_bf16 v[184:187], a[136:139], v[192:195], v[184:187]
    s_waitcnt lgkmcnt(4)
    v_mfma_f32_16x16x32_bf16 v[96:99], a[96:99], v[224:227], v[96:99]
    ds_read_b64_tr_b16 a[128:129], v42 offset:16384
    v_mfma_f32_16x16x32_bf16 v[96:99], a[100:103], v[228:231], v[96:99]
    buffer_load_dwordx4 a[64:67], v12, s[12:15], s43 offen offset:0 sc1
    v_mfma_f32_16x16x32_bf16 v[100:103], a[100:103], v[236:239], v[100:103]
    ds_read_b64_tr_b16 a[130:131], v42 offset:20480
    v_mfma_f32_16x16x32_bf16 v[100:103], a[96:99], v[232:235], v[100:103]
    v_mfma_f32_16x16x32_bf16 v[64:67], a[96:99], v[240:243], v[64:67]
    ds_read_b64_tr_b16 a[132:133], v42 offset:24576
    v_mfma_f32_16x16x32_bf16 v[64:67], a[100:103], v[244:247], v[64:67]
    buffer_load_dwordx4 a[68:71], v12, s[12:15], s43 offen offset:2048 sc1
    v_mfma_f32_16x16x32_bf16 v[68:71], a[100:103], v[252:255], v[68:71]
    ds_read_b64_tr_b16 a[134:135], v42 offset:28672
    v_mfma_f32_16x16x32_bf16 v[68:71], a[96:99], v[248:251], v[68:71]
    s_waitcnt lgkmcnt(4)
    v_mfma_f32_16x16x32_bf16 v[76:79], a[104:107], v[248:251], v[76:79]
    ds_read_b64_tr_b16 a[136:137], v43 offset:16384
    v_mfma_f32_16x16x32_bf16 v[76:79], a[108:111], v[252:255], v[76:79]
    buffer_load_dwordx4 a[72:75], v13, s[12:15], s43 offen offset:0 sc1
    v_mfma_f32_16x16x32_bf16 v[72:75], a[108:111], v[244:247], v[72:75]
    ds_read_b64_tr_b16 a[138:139], v43 offset:20480
    v_mfma_f32_16x16x32_bf16 v[72:75], a[104:107], v[240:243], v[72:75]
    v_mfma_f32_16x16x32_bf16 v[108:111], a[104:107], v[232:235], v[108:111]
    ds_read_b64_tr_b16 a[140:141], v43 offset:24576
    v_mfma_f32_16x16x32_bf16 v[108:111], a[108:111], v[236:239], v[108:111]
    buffer_load_dwordx4 a[76:79], v13, s[12:15], s43 offen offset:2048 sc1
    s_add_u32 s43, s43, 4096
    v_mfma_f32_16x16x32_bf16 v[104:107], a[108:111], v[228:231], v[104:107]
    ds_read_b64_tr_b16 a[142:143], v43 offset:28672
    v_mfma_f32_16x16x32_bf16 v[104:107], a[104:107], v[224:227], v[104:107]
    s_waitcnt lgkmcnt(4)
    v_mfma_f32_16x16x32_bf16 v[112:115], a[128:131], v[224:227], v[112:115]
    ds_read_b64_tr_b16 a[96:97], v44 offset:16384
    v_mfma_f32_16x16x32_bf16 v[112:115], a[132:135], v[228:231], v[112:115]
    buffer_load_dwordx4 a[80:83], v12, s[12:15], s42 offen offset:0 sc1
    v_mfma_f32_16x16x32_bf16 v[116:119], a[132:135], v[236:239], v[116:119]
    ds_read_b64_tr_b16 a[98:99], v44 offset:20480
    v_mfma_f32_16x16x32_bf16 v[116:119], a[128:131], v[232:235], v[116:119]
    v_mfma_f32_16x16x32_bf16 v[80:83], a[128:131], v[240:243], v[80:83]
    ds_read_b64_tr_b16 a[100:101], v44 offset:24576
    v_mfma_f32_16x16x32_bf16 v[80:83], a[132:135], v[244:247], v[80:83]
    buffer_load_dwordx4 a[84:87], v12, s[12:15], s42 offen offset:2048 sc1
    v_mfma_f32_16x16x32_bf16 v[84:87], a[132:135], v[252:255], v[84:87]
    ds_read_b64_tr_b16 a[102:103], v44 offset:28672
    v_mfma_f32_16x16x32_bf16 v[84:87], a[128:131], v[248:251], v[84:87]
    s_waitcnt lgkmcnt(4)
    v_mfma_f32_16x16x32_bf16 v[92:95], a[136:139], v[248:251], v[92:95]
    ds_read_b64_tr_b16 a[104:105], v45 offset:16384
    v_mfma_f32_16x16x32_bf16 v[92:95], a[140:143], v[252:255], v[92:95]
    v_mfma_f32_16x16x32_bf16 v[88:91], a[140:143], v[244:247], v[88:91]
    ds_read_b64_tr_b16 a[106:107], v45 offset:20480
    v_mfma_f32_16x16x32_bf16 v[88:91], a[136:139], v[240:243], v[88:91]
    buffer_load_dwordx4 a[88:91], v13, s[12:15], s42 offen offset:0 sc1
    v_mfma_f32_16x16x32_bf16 v[124:127], a[136:139], v[232:235], v[124:127]
L_pg7:
    s_cbranch_execz L_tramp
    ds_read_b64_tr_b16 a[108:109], v45 offset:24576
    v_mfma_f32_16x16x32_bf16 v[124:127], a[140:143], v[236:239], v[124:127]
    v_mfma_f32_16x16x32_bf16 v[120:123], a[140:143], v[228:231], v[120:123]
    ds_read_b64_tr_b16 a[110:111], v45 offset:28672
    v_mfma_f32_16x16x32_bf16 v[120:123], a[136:139], v[224:227], v[120:123]
    s_waitcnt lgkmcnt(4)
    v_mfma_f32_16x16x32_bf16 v[160:163], a[96:99], v[224:227], v[160:163]
    ds_read_b64_tr_b16 a[128:129], v46 offset:16384
    v_mfma_f32_16x16x32_bf16 v[160:163], a[100:103], v[228:231], v[160:163]
    buffer_load_dwordx4 a[92:95], v13, s[12:15], s42 offen offset:2048 sc1
    s_add_u32 s42, s42, 4096
    v_mfma_f32_16x16x32_bf16 v[164:167], a[100:103], v[236:239], v[164:167]
    ds_read_b64_tr_b16 a[130:131], v46 offset:20480
    v_mfma_f32_16x16x32_bf16 v[164:167], a[96:99], v[232:235], v[164:167]
    v_mfma_f32_16x16x32_bf16 v[128:131], a[96:99], v[240:243], v[128:131]
    ds_read_b64_tr_b16 a[132:133], v46 offset:24576
    v_mfma_f32_16x16x32_bf16 v[128:131], a[100:103], v[244:247], v[128:131]
    s_add_u32 m0, s63, 49152
    s_add_u32 s47, s62, 0x130000
    buffer_load_dwordx4 v2, s[64:67], s47 offen offset:0 lds
    v_mfma_f32_16x16x32_bf16 v[132:135], a[100:103], v[252:255], v[132:135]
    ds_read_b64_tr_b16 a[134:135], v46 offset:28672
    v_mfma_f32_16x16x32_bf16 v[132:135], a[96:99], v[248:251], v[132:135]
    s_waitcnt lgkmcnt(4)
    v_mfma_f32_16x16x32_bf16 v[140:143], a[104:107], v[248:251], v[140:143]
    ds_read_b64_tr_b16 a[136:137], v47 offset:16384
    v_mfma_f32_16x16x32_bf16 v[140:143], a[108:111], v[252:255], v[140:143]
    buffer_load_dwordx4 v3, s[64:67], s47 offen offset:1024 lds
    v_mfma_f32_16x16x32_bf16 v[136:139], a[108:111], v[244:247], v[136:139]
    ds_read_b64_tr_b16 a[138:139], v47 offset:20480
    v_mfma_f32_16x16x32_bf16 v[136:139], a[104:107], v[240:243], v[136:139]
    v_mfma_f32_16x16x32_bf16 v[172:175], a[104:107], v[232:235], v[172:175]
    ds_read_b64_tr_b16 a[140:141], v47 offset:24576
    v_mfma_f32_16x16x32_bf16 v[172:175], a[108:111], v[236:239], v[172:175]
    buffer_load_dwordx4 v4, s[64:67], s47 offen offset:2048 lds
    v_mfma_f32_16x16x32_bf16 v[168:171], a[108:111], v[228:231], v[168:171]
    ds_read_b64_tr_b16 a[142:143], v47 offset:28672
    v_mfma_f32_16x16x32_bf16 v[168:171], a[104:107], v[224:227], v[168:171]
    s_barrier
    s_waitcnt lgkmcnt(4)
    v_mfma_f32_16x16x32_bf16 v[176:179], a[128:131], v[224:227], v[176:179]
    ds_read_b64_tr_b16 a[96:97], v24 offset:0
    v_mfma_f32_16x16x32_bf16 v[176:179], a[132:135], v[228:231], v[176:179]
    buffer_load_dwordx4 v5, s[64:67], s47 offen offset:3072 lds
    v_mfma_f32_16x16x32_bf16 v[180:183], a[132:135], v[236:239], v[180:183]
    ds_read_b64_tr_b16 a[98:99], v24 offset:4096
    v_mfma_f32_16x16x32_bf16 v[180:183], a[128:131], v[232:235], v[180:183]
    v_mfma_f32_16x16x32_bf16 v[144:147], a[128:131], v[240:243], v[144:147]
    ds_read_b64_tr_b16 a[100:101], v24 offset:8192
    v_mfma_f32_16x16x32_bf16 v[144:147], a[132:135], v[244:247], v[144:147]
    buffer_load_dwordx4 a[160:163], v12, s[12:15], s43 offen offset:0 sc1
    v_mfma_f32_16x16x32_bf16 v[148:151], a[132:135], v[252:255], v[148:151]
    ds_read_b64_tr_b16 a[102:103], v24 offset:12288
    v_mfma_f32_16x16x32_bf16 v[148:151], a[128:131], v[248:251], v[148:151]
    s_waitcnt lgkmcnt(4)
    v_mfma_f32_16x16x32_bf16 v[156:159], a[136:139], v[248:251], v[156:159]
    ds_read_b64_tr_b16 a[104:105], v25 offset:0
    v_mfma_f32_16x16x32_bf16 v[156:159], a[140:143], v[252:255], v[156:159]
    v_mfma_f32_16x16x32_bf16 v[152:155], a[140:143], v[244:247], v[152:155]
    ds_read_b64_tr_b16 a[106:107], v25 offset:4096
    v_mfma_f32_16x16x32_bf16 v[152:155], a[136:139], v[240:243], v[152:155]
    buffer_load_dwordx4 a[164:167], v12, s[12:15], s43 offen offset:2048 sc1
    v_mfma_f32_16x16x32_bf16 v[188:191], a[136:139], v[232:235], v[188:191]
    ds_read_b64_tr_b16 a[108:109], v25 offset:8192
    v_mfma_f32_16x16x32_bf16 v[188:191], a[140:143], v[236:239], v[188:191]
    v_mfma_f32_16x16x32_bf16 v[184:187], a[140:143], v[228:231], v[184:187]
    ds_read_b64_tr_b16 a[110:111], v25 offset:12288
    v_mfma_f32_16x16x32_bf16 v[184:187], a[136:139], v[224:227], v[184:187]
    s_waitcnt lgkmcnt(4)
    v_mfma_f32_16x16x32_bf16 v[96:99], a[96:99], a[0:3], v[96:99]
    ds_read_b64_tr_b16 a[128:129], v26 offset:0
    v_mfma_f32_16x16x32_bf16 v[96:99], a[100:103], a[4:7], v[96:99]
    buffer_load_dwordx4 a[168:171], v13, s[12:15], s43 offen offset:0 sc1
    v_mfma_f32_16x16x32_bf16 v[100:103], a[100:103], a[12:15], v[100:103]
    ds_read_b64_tr_b16 a[130:131], v26 offset:4096
    v_mfma_f32_16x16x32_bf16 v[100:103], a[96:99], a[8:11], v[100:103]
    v_mfma_f32_16x16x32_bf16 v[64:67], a[96:99], a[16:19], v[64:67]
    ds_read_b64_tr_b16 a[132:133], v26 offset:8192
    v_mfma_f32_16x16x32_bf16 v[64:67], a[100:103], a[20:23], v[64:67]
    buffer_load_dwordx4 a[172:175], v13, s[12:15], s43 offen offset:2048 sc1
    s_add_u32 s43, s43, 4096
    v_mfma_f32_16x16x32_bf16 v[68:71], a[100:103], a[28:31], v[68:71]
    ds_read_b64_tr_b16 a[134:135], v26 offset:12288
    v_mfma_f32_16x16x32_bf16 v[68:71], a[96:99], a[24:27], v[68:71]
    s_waitcnt lgkmcnt(4)
    v_mfma_f32_16x16x32_bf16 v[76:79], a[104:107], a[24:27], v[76:79]
    ds_read_b64_tr_b16 a[136:137], v27 offset:0
    v_mfma_f32_16x16x32_bf16 v[76:79], a[108:111], a[28:31], v[76:79]
    s_add_u32 m0, s63, 65536
    s_add_u32 s47, s62, 0x160000
    buffer_load_dwordx4 v2, s[64:67], s47 offen offset:0 lds
    v_mfma_f32_16x16x32_bf16 v[72:75], a[108:111], a[20:23], v[72:75]
    ds_read_b64_tr_b16 a[138:139], v27 offset:4096
    v_mfma_f32_16x16x32_bf16 v[72:75], a[104:107], a[16:19], v[72:75]
    v_mfma_f32_16x16x32_bf16 v[108:111], a[104:107], a[8:11], v[108:111]
    ds_read_b64_tr_b16 a[140:141], v27 offset:8192
    v_mfma_f32_16x16x32_bf16 v[108:111], a[108:111], a[12:15], v[108:111]
    buffer_load_dwordx4 v3, s[64:67], s47 offen offset:1024 lds
    v_mfma_f32_16x16x32_bf16 v[104:107], a[108:111], a[4:7], v[104:107]
    ds_read_b64_tr_b16 a[142:143], v27 offset:12288
    v_mfma_f32_16x16x32_bf16 v[104:107], a[104:107], a[0:3], v[104:107]
    s_waitcnt lgkmcnt(4)
    v_mfma_f32_16x16x32_bf16 v[112:115], a[128:131], a[0:3], v[112:115]
    ds_read_b64_tr_b16 a[96:97], v28 offset:0
    v_mfma_f32_16x16x32_bf16 v[112:115], a[132:135], a[4:7], v[112:115]
    buffer_load_dwordx4 v4, s[64:67], s47 offen offset:2048 lds
    v_mfma_f32_16x16x32_bf16 v[116:119], a[132:135], a[12:15], v[116:119]
    ds_read_b64_tr_b16 a[98:99], v28 offset:4096
    v_mfma_f32_16x16x32_bf16 v[116:119], a[128:131], a[8:11], v[116:119]
    v_mfma_f32_16x16x32_bf16 v[80:83], a[128:131], a[16:19], v[80:83]
    ds_read_b64_tr_b16 a[100:101], v28 offset:8192
    v_mfma_f32_16x16x32_bf16 v[80:83], a[132:135], a[20:23], v[80:83]
    buffer_load_dwordx4 v5, s[64:67], s47 offen offset:3072 lds
    v_mfma_f32_16x16x32_bf16 v[84:87], a[132:135], a[28:31], v[84:87]
    ds_read_b64_tr_b16 a[102:103], v28 offset:12288
    v_mfma_f32_16x16x32_bf16 v[84:87], a[128:131], a[24:27], v[84:87]
    s_waitcnt lgkmcnt(4)
    v_mfma_f32_16x16x32_bf16 v[92:95], a[136:139], a[24:27], v[92:95]
    ds_read_b64_tr_b16 a[104:105], v29 offset:0
    v_mfma_f32_16x16x32_bf16 v[92:95], a[140:143], a[28:31], v[92:95]
    s_add_u32 m0, s63, 81920
    s_add_u32 s47, s62, 0x1a0000
    buffer_load_dwordx4 v2, s[64:67], s47 offen offset:0 lds
    v_mfma_f32_16x16x32_bf16 v[88:91], a[140:143], a[20:23], v[88:91]
    ds_read_b64_tr_b16 a[106:107], v29 offset:4096
    v_mfma_f32_16x16x32_bf16 v[88:91], a[136:139], a[16:19], v[88:91]
    v_mfma_f32_16x16x32_bf16 v[124:127], a[136:139], a[8:11], v[124:127]
    ds_read_b64_tr_b16 a[108:109], v29 offset:8192
    v_mfma_f32_16x16x32_bf16 v[124:127], a[140:143], a[12:15], v[124:127]
    buffer_load_dwordx4 v3, s[64:67], s47 offen offset:1024 lds
    v_mfma_f32_16x16x32_bf16 v[120:123], a[140:143], a[4:7], v[120:123]
    ds_read_b64_tr_b16 a[110:111], v29 offset:12288
    v_mfma_f32_16x16x32_bf16 v[120:123], a[136:139], a[0:3], v[120:123]
    s_waitcnt lgkmcnt(4)
    v_mfma_f32_16x16x32_bf16 v[160:163], a[96:99], a[0:3], v[160:163]
    ds_read_b64_tr_b16 a[128:129], v30 offset:0
    v_mfma_f32_16x16x32_bf16 v[160:163], a[100:103], a[4:7], v[160:163]
    buffer_load_dwordx4 v4, s[64:67], s47 offen offset:2048 lds
    v_mfma_f32_16x16x32_bf16 v[164:167], a[100:103], a[12:15], v[164:167]
    ds_read_b64_tr_b16 a[130:131], v30 offset:4096
    v_mfma_f32_16x16x32_bf16 v[164:167], a[96:99], a[8:11], v[164:167]
    v_mfma_f32_16x16x32_bf16 v[128:131], a[96:99], a[16:19], v[128:131]
    ds_read_b64_tr_b16 a[132:133], v30 offset:8192
    s_waitcnt vmcnt(35)
    v_mfma_f32_16x16x32_bf16 v[128:131], a[100:103], a[20:23], v[128:131]
    buffer_load_dwordx4 v5, s[64:67], s47 offen offset:3072 lds
    v_sub_f32 v48, 1.0, v48
    v_mfma_f32_16x16x32_bf16 v[132:135], a[100:103], a[28:31], v[132:135]
    ds_read_b64_tr_b16 a[134:135], v30 offset:12288
    v_mfma_f32_16x16x32_bf16 v[132:135], a[96:99], a[24:27], v[132:135]
    s_waitcnt lgkmcnt(4)
    v_sub_f32 v49, 1.0, v49
    v_mfma_f32_16x16x32_bf16 v[140:143], a[104:107], a[24:27], v[140:143]
    ds_read_b64_tr_b16 a[136:137], v31 offset:0
    v_mfma_f32_16x16x32_bf16 v[140:143], a[108:111], a[28:31], v[140:143]
    v_sub_f32 v50, 1.0, v50
    v_mfma_f32_16x16x32_bf16 v[136:139], a[108:111], a[20:23], v[136:139]
    ds_read_b64_tr_b16 a[138:139], v31 offset:4096
    v_mfma_f32_16x16x32_bf16 v[136:139], a[104:107], a[16:19], v[136:139]
    buffer_load_dwordx4 a[176:179], v12, s[12:15], s43 offen offset:0 sc1
    v_sub_f32 v51, 1.0, v51
    v_mfma_f32_16x16x32_bf16 v[172:175], a[104:107], a[8:11], v[172:175]
    ds_read_b64_tr_b16 a[140:141], v31 offset:8192
    v_mfma_f32_16x16x32_bf16 v[172:175], a[108:111], a[12:15], v[172:175]
    v_mfma_f32_16x16x32_bf16 v[168:171], a[108:111], a[4:7], v[168:171]
    ds_read_b64_tr_b16 a[142:143], v31 offset:12288
    v_mfma_f32_16x16x32_bf16 v[168:171], a[104:107], a[0:3], v[168:171]
    s_barrier
    s_waitcnt lgkmcnt(4)
    v_mfma_f32_16x16x32_bf16 v[176:179], a[128:131], a[0:3], v[176:179]
    ds_read_b64_tr_b16 a[96:97], v24 offset:16384
    v_mfma_f32_16x16x32_bf16 v[176:179], a[132:135], a[4:7], v[176:179]
    buffer_load_dwordx4 a[180:183], v12, s[12:15], s43 offen offset:2048 sc1
    v_mfma_f32_16x16x32_bf16 v[180:183], a[132:135], a[12:15], v[180:183]
    ds_read_b64_tr_b16 a[98:99], v24 offset:20480
    v_mfma_f32_16x16x32_bf16 v[180:183], a[128:131], a[8:11], v[180:183]
    v_mfma_f32_16x16x32_bf16 v[144:147], a[128:131], a[16:19], v[144:147]
    ds_read_b64_tr_b16 a[100:101], v24 offset:24576
    v_mfma_f32_16x16x32_bf16 v[144:147], a[132:135], a[20:23], v[144:147]
    buffer_load_dwordx4 a[184:187], v13, s[12:15], s43 offen offset:0 sc1
    v_mfma_f32_16x16x32_bf16 v[148:151], a[132:135], a[28:31], v[148:151]
    ds_read_b64_tr_b16 a[102:103], v24 offset:28672
    v_mfma_f32_16x16x32_bf16 v[148:151], a[128:131], a[24:27], v[148:151]
    s_waitcnt lgkmcnt(4)
    v_mfma_f32_16x16x32_bf16 v[156:159], a[136:139], a[24:27], v[156:159]
    ds_read_b64_tr_b16 a[104:105], v25 offset:16384
    v_mfma_f32_16x16x32_bf16 v[156:159], a[140:143], a[28:31], v[156:159]
    buffer_load_dwordx4 a[188:191], v13, s[12:15], s43 offen offset:2048 sc1
    s_add_u32 s43, s43, 4096
    v_mfma_f32_16x16x32_bf16 v[152:155], a[140:143], a[20:23], v[152:155]
    ds_read_b64_tr_b16 a[106:107], v25 offset:20480
    v_mfma_f32_16x16x32_bf16 v[152:155], a[136:139], a[16:19], v[152:155]
    v_mfma_f32_16x16x32_bf16 v[188:191], a[136:139], a[8:11], v[188:191]
    ds_read_b64_tr_b16 a[108:109], v25 offset:24576
    v_mfma_f32_16x16x32_bf16 v[188:191], a[140:143], a[12:15], v[188:191]
    buffer_load_dwordx4 a[192:195], v12, s[12:15], s43 offen offset:0 sc1
    v_mfma_f32_16x16x32_bf16 v[184:187], a[140:143], a[4:7], v[184:187]
    ds_read_b64_tr_b16 a[110:111], v25 offset:28672
    v_mfma_f32_16x16x32_bf16 v[184:187], a[136:139], a[0:3], v[184:187]
    s_waitcnt vmcnt(33) lgkmcnt(4)
    v_mfma_f32_16x16x32_bf16 v[96:99], a[96:99], a[32:35], v[96:99]
    ds_read_b64_tr_b16 a[128:129], v26 offset:16384
    v_mfma_f32_16x16x32_bf16 v[96:99], a[100:103], a[36:39], v[96:99]
    buffer_load_dwordx4 a[196:199], v12, s[12:15], s43 offen offset:2048 sc1
    v_mfma_f32_16x16x32_bf16 v[100:103], a[100:103], a[44:47], v[100:103]
    ds_read_b64_tr_b16 a[130:131], v26 offset:20480
    v_mfma_f32_16x16x32_bf16 v[100:103], a[96:99], a[40:43], v[100:103]
    v_mfma_f32_16x16x32_bf16 v[64:67], a[96:99], a[48:51], v[64:67]
    ds_read_b64_tr_b16 a[132:133], v26 offset:24576
    v_mfma_f32_16x16x32_bf16 v[64:67], a[100:103], a[52:55], v[64:67]
    buffer_load_dwordx4 a[200:203], v13, s[12:15], s43 offen offset:0 sc1
    v_mfma_f32_16x16x32_bf16 v[68:71], a[100:103], a[60:63], v[68:71]
    ds_read_b64_tr_b16 a[134:135], v26 offset:28672
    v_mfma_f32_16x16x32_bf16 v[68:71], a[96:99], a[56:59], v[68:71]
    s_waitcnt lgkmcnt(4)
    v_mfma_f32_16x16x32_bf16 v[76:79], a[104:107], a[56:59], v[76:79]
    ds_read_b64_tr_b16 a[136:137], v27 offset:16384
    v_mfma_f32_16x16x32_bf16 v[76:79], a[108:111], a[60:63], v[76:79]
    v_mfma_f32_16x16x32_bf16 v[72:75], a[108:111], a[52:55], v[72:75]
    ds_read_b64_tr_b16 a[138:139], v27 offset:20480
    v_mfma_f32_16x16x32_bf16 v[72:75], a[104:107], a[48:51], v[72:75]
    buffer_load_dwordx4 a[204:207], v13, s[12:15], s43 offen offset:2048 sc1
    s_add_u32 s43, s43, s36
    v_mfma_f32_16x16x32_bf16 v[108:111], a[104:107], a[40:43], v[108:111]
    ds_read_b64_tr_b16 a[140:141], v27 offset:24576
    v_mfma_f32_16x16x32_bf16 v[108:111], a[108:111], a[44:47], v[108:111]
    v_mfma_f32_16x16x32_bf16 v[104:107], a[108:111], a[36:39], v[104:107]
    ds_read_b64_tr_b16 a[142:143], v27 offset:28672
    v_mfma_f32_16x16x32_bf16 v[104:107], a[104:107], a[32:35], v[104:107]
    s_waitcnt lgkmcnt(4)
    v_mfma_f32_16x16x32_bf16 v[112:115], a[128:131], a[32:35], v[112:115]
    ds_read_b64_tr_b16 a[96:97], v28 offset:16384
    v_mfma_f32_16x16x32_bf16 v[112:115], a[132:135], a[36:39], v[112:115]
    s_add_u32 m0, s63, 98304
    s_add_u32 s47, s98, 0x0
    buffer_load_dwordx4 v2, s[68:71], s47 offen offset:0 lds
    v_mfma_f32_16x16x32_bf16 v[116:119], a[132:135], a[44:47], v[116:119]
    ds_read_b64_tr_b16 a[98:99], v28 offset:20480
    v_mfma_f32_16x16x32_bf16 v[116:119], a[128:131], a[40:43], v[116:119]
    v_mfma_f32_16x16x32_bf16 v[80:83], a[128:131], a[48:51], v[80:83]
    ds_read_b64_tr_b16 a[100:101], v28 offset:24576
    v_mfma_f32_16x16x32_bf16 v[80:83], a[132:135], a[52:55], v[80:83]
    buffer_load_dwordx4 v3, s[68:71], s47 offen offset:1024 lds
    v_mfma_f32_16x16x32_bf16 v[84:87], a[132:135], a[60:63], v[84:87]
    ds_read_b64_tr_b16 a[102:103], v28 offset:28672
    v_mfma_f32_16x16x32_bf16 v[84:87], a[128:131], a[56:59], v[84:87]
    s_waitcnt lgkmcnt(4)
    v_mfma_f32_16x16x32_bf16 v[92:95], a[136:139], a[56:59], v[92:95]
    ds_read_b64_tr_b16 a[104:105], v29 offset:16384
    v_mfma_f32_16x16x32_bf16 v[92:95], a[140:143], a[60:63], v[92:95]
    buffer_load_dwordx4 v4, s[68:71], s47 offen offset:2048 lds
    v_mfma_f32_16x16x32_bf16 v[88:91], a[140:143], a[52:55], v[88:91]
    ds_read_b64_tr_b16 a[106:107], v29 offset:20480
    v_mfma_f32_16x16x32_bf16 v[88:91], a[136:139], a[48:51], v[88:91]
    v_mfma_f32_16x16x32_bf16 v[124:127], a[136:139], a[40:43], v[124:127]
    ds_read_b64_tr_b16 a[108:109], v29 offset:24576
    v_mfma_f32_16x16x32_bf16 v[124:127], a[140:143], a[44:47], v[124:127]
    buffer_load_dwordx4 v5, s[68:71], s47 offen offset:3072 lds
    v_mfma_f32_16x16x32_bf16 v[120:123], a[140:143], a[36:39], v[120:123]
    ds_read_b64_tr_b16 a[110:111], v29 offset:28672
    v_mfma_f32_16x16x32_bf16 v[120:123], a[136:139], a[32:35], v[120:123]
    s_waitcnt lgkmcnt(4)
    v_mfma_f32_16x16x32_bf16 v[160:163], a[96:99], a[32:35], v[160:163]
    ds_read_b64_tr_b16 a[128:129], v30 offset:16384
    v_mfma_f32_16x16x32_bf16 v[160:163], a[100:103], a[36:39], v[160:163]
    s_add_u32 m0, s63, 114688
    s_add_u32 s47, s98, 0x20000
    buffer_load_dwordx4 v2, s[68:71], s47 offen offset:0 lds
    v_mfma_f32_16x16x32_bf16 v[164:167], a[100:103], a[44:47], v[164:167]
    ds_read_b64_tr_b16 a[130:131], v30 offset:20480
    v_mfma_f32_16x16x32_bf16 v[164:167], a[96:99], a[40:43], v[164:167]
    v_mfma_f32_16x16x32_bf16 v[128:131], a[96:99], a[48:51], v[128:131]
    ds_read_b64_tr_b16 a[132:133], v30 offset:24576
    v_mfma_f32_16x16x32_bf16 v[128:131], a[100:103], a[52:55], v[128:131]
    buffer_load_dwordx4 v3, s[68:71], s47 offen offset:1024 lds
    v_mfma_f32_16x16x32_bf16 v[132:135], a[100:103], a[60:63], v[132:135]
    ds_read_b64_tr_b16 a[134:135], v30 offset:28672
    v_mfma_f32_16x16x32_bf16 v[132:135], a[96:99], a[56:59], v[132:135]
    s_waitcnt lgkmcnt(4)
    v_mfma_f32_16x16x32_bf16 v[140:143], a[104:107], a[56:59], v[140:143]
    ds_read_b64_tr_b16 a[136:137], v31 offset:16384
    v_mfma_f32_16x16x32_bf16 v[140:143], a[108:111], a[60:63], v[140:143]
    v_mfma_f32_16x16x32_bf16 v[136:139], a[108:111], a[52:55], v[136:139]
    ds_read_b64_tr_b16 a[138:139], v31 offset:20480
    v_mfma_f32_16x16x32_bf16 v[136:139], a[104:107], a[48:51], v[136:139]
    buffer_load_dwordx4 v4, s[68:71], s47 offen offset:2048 lds
    v_mfma_f32_16x16x32_bf16 v[172:175], a[104:107], a[40:43], v[172:175]
    ds_read_b64_tr_b16 a[140:141], v31 offset:24576
    v_mfma_f32_16x16x32_bf16 v[172:175], a[108:111], a[44:47], v[172:175]
    v_mfma_f32_16x16x32_bf16 v[168:171], a[108:111], a[36:39], v[168:171]
    ds_read_b64_tr_b16 a[142:143], v31 offset:28672
    v_mfma_f32_16x16x32_bf16 v[168:171], a[104:107], a[32:35], v[168:171]
    s_waitcnt vmcnt(39)
    s_barrier
    s_waitcnt lgkmcnt(4)
    v_mfma_f32_16x16x32_bf16 v[176:179], a[128:131], a[32:35], v[176:179]
    ds_read_b64_tr_b16 a[96:97], v24 offset:32768
    v_mfma_f32_16x16x32_bf16 v[176:179], a[132:135], a[36:39], v[176:179]
    buffer_load_dwordx4 v5, s[68:71], s47 offen offset:3072 lds
    v_mfma_f32_16x16x32_bf16 v[180:183], a[132:135], a[44:47], v[180:183]
    ds_read_b64_tr_b16 a[98:99], v24 offset:36864
    v_mfma_f32_16x16x32_bf16 v[180:183], a[128:131], a[40:43], v[180:183]
    v_mfma_f32_16x16x32_bf16 v[144:147], a[128:131], a[48:51], v[144:147]
    ds_read_b64_tr_b16 a[100:101], v24 offset:40960
    v_mfma_f32_16x16x32_bf16 v[144:147], a[132:135], a[52:55], v[144:147]
    buffer_load_dwordx4 a[208:211], v12, s[12:15], s43 offen offset:0 sc1
    v_mfma_f32_16x16x32_bf16 v[148:151], a[132:135], a[60:63], v[148:151]
    ds_read_b64_tr_b16 a[102:103], v24 offset:45056
    v_mfma_f32_16x16x32_bf16 v[148:151], a[128:131], a[56:59], v[148:151]
    s_waitcnt lgkmcnt(4)
    v_mfma_f32_16x16x32_bf16 v[156:159], a[136:139], a[56:59], v[156:159]
    ds_read_b64_tr_b16 a[104:105], v25 offset:32768
    v_mfma_f32_16x16x32_bf16 v[156:159], a[140:143], a[60:63], v[156:159]
    buffer_load_dwordx4 a[212:215], v12, s[12:15], s43 offen offset:2048 sc1
    v_mfma_f32_16x16x32_bf16 v[152:155], a[140:143], a[52:55], v[152:155]
    ds_read_b64_tr_b16 a[106:107], v25 offset:36864
    v_mfma_f32_16x16x32_bf16 v[152:155], a[136:139], a[48:51], v[152:155]
    v_mfma_f32_16x16x32_bf16 v[188:191], a[136:139], a[40:43], v[188:191]
    ds_read_b64_tr_b16 a[108:109], v25 offset:40960
    v_mfma_f32_16x16x32_bf16 v[188:191], a[140:143], a[44:47], v[188:191]
    buffer_load_dwordx4 a[216:219], v13, s[12:15], s43 offen offset:0 sc1
    v_mfma_f32_16x16x32_bf16 v[184:187], a[140:143], a[36:39], v[184:187]
    ds_read_b64_tr_b16 a[110:111], v25 offset:45056
    v_mfma_f32_16x16x32_bf16 v[184:187], a[136:139], a[32:35], v[184:187]
    s_barrier
    s_waitcnt vmcnt(35) lgkmcnt(4)
    v_mfma_f32_16x16x32_bf16 v[96:99], a[96:99], a[64:67], v[96:99]
    ds_read_b64_tr_b16 a[128:129], v26 offset:32768
    v_mfma_f32_16x16x32_bf16 v[96:99], a[100:103], a[68:71], v[96:99]
    buffer_load_dwordx4 a[220:223], v13, s[12:15], s43 offen offset:2048 sc1
    s_add_u32 s43, s43, 4096
    v_mfma_f32_16x16x32_bf16 v[100:103], a[100:103], a[76:79], v[100:103]
    ds_read_b64_tr_b16 a[130:131], v26 offset:36864
    v_mfma_f32_16x16x32_bf16 v[100:103], a[96:99], a[72:75], v[100:103]
    v_mfma_f32_16x16x32_bf16 v[64:67], a[96:99], a[80:83], v[64:67]
    ds_read_b64_tr_b16 a[132:133], v26 offset:40960
    v_mfma_f32_16x16x32_bf16 v[64:67], a[100:103], a[84:87], v[64:67]
    buffer_load_dwordx4 a[224:227], v12, s[12:15], s43 offen offset:0 sc1
    v_mfma_f32_16x16x32_bf16 v[68:71], a[100:103], a[92:95], v[68:71]
    ds_read_b64_tr_b16 a[134:135], v26 offset:45056
    v_mfma_f32_16x16x32_bf16 v[68:71], a[96:99], a[88:91], v[68:71]
    s_waitcnt lgkmcnt(4)
    v_mfma_f32_16x16x32_bf16 v[76:79], a[104:107], a[88:91], v[76:79]
    ds_read_b64_tr_b16 a[136:137], v27 offset:32768
    v_mfma_f32_16x16x32_bf16 v[76:79], a[108:111], a[92:95], v[76:79]
    v_mfma_f32_16x16x32_bf16 v[72:75], a[108:111], a[84:87], v[72:75]
    ds_read_b64_tr_b16 a[138:139], v27 offset:36864
    v_mfma_f32_16x16x32_bf16 v[72:75], a[104:107], a[80:83], v[72:75]
    buffer_load_dwordx4 a[228:231], v12, s[12:15], s43 offen offset:2048 sc1
    v_mfma_f32_16x16x32_bf16 v[108:111], a[104:107], a[72:75], v[108:111]
    ds_read_b64_tr_b16 a[140:141], v27 offset:40960
    v_mfma_f32_16x16x32_bf16 v[108:111], a[108:111], a[76:79], v[108:111]
    v_mfma_f32_16x16x32_bf16 v[104:107], a[108:111], a[68:71], v[104:107]
    ds_read_b64_tr_b16 a[142:143], v27 offset:45056
    v_mfma_f32_16x16x32_bf16 v[104:107], a[104:107], a[64:67], v[104:107]
    s_waitcnt lgkmcnt(4)
    v_mfma_f32_16x16x32_bf16 v[112:115], a[128:131], a[64:67], v[112:115]
    ds_read_b64_tr_b16 a[96:97], v28 offset:32768
    v_mfma_f32_16x16x32_bf16 v[112:115], a[132:135], a[68:71], v[112:115]
    buffer_load_dwordx4 a[232:235], v13, s[12:15], s43 offen offset:0 sc1
    v_mfma_f32_16x16x32_bf16 v[116:119], a[132:135], a[76:79], v[116:119]
    ds_read_b64_tr_b16 a[98:99], v28 offset:36864
    v_mfma_f32_16x16x32_bf16 v[116:119], a[128:131], a[72:75], v[116:119]
    v_mfma_f32_16x16x32_bf16 v[80:83], a[128:131], a[80:83], v[80:83]
    ds_read_b64_tr_b16 a[100:101], v28 offset:40960
    v_mfma_f32_16x16x32_bf16 v[80:83], a[132:135], a[84:87], v[80:83]
    buffer_load_dwordx4 a[236:239], v13, s[12:15], s43 offen offset:2048 sc1
    s_add_u32 s43, s43, 4096
    v_mfma_f32_16x16x32_bf16 v[84:87], a[132:135], a[92:95], v[84:87]
    ds_read_b64_tr_b16 a[102:103], v28 offset:45056
    v_mfma_f32_16x16x32_bf16 v[84:87], a[128:131], a[88:91], v[84:87]
    s_waitcnt lgkmcnt(4)
    v_mfma_f32_16x16x32_bf16 v[92:95], a[136:139], a[88:91], v[92:95]
    ds_read_b64_tr_b16 a[104:105], v29 offset:32768
    v_mfma_f32_16x16x32_bf16 v[92:95], a[140:143], a[92:95], v[92:95]
    s_add_u32 m0, s63, 131072
    s_add_u32 s47, s98, 0x40000
    buffer_load_dwordx4 v2, s[68:71], s47 offen offset:0 lds
    v_mfma_f32_16x16x32_bf16 v[88:91], a[140:143], a[84:87], v[88:91]
    ds_read_b64_tr_b16 a[106:107], v29 offset:36864
    v_mfma_f32_16x16x32_bf16 v[88:91], a[136:139], a[80:83], v[88:91]
    v_mfma_f32_16x16x32_bf16 v[124:127], a[136:139], a[72:75], v[124:127]
    ds_read_b64_tr_b16 a[108:109], v29 offset:40960
    v_mfma_f32_16x16x32_bf16 v[124:127], a[140:143], a[76:79], v[124:127]
    buffer_load_dwordx4 v3, s[68:71], s47 offen offset:1024 lds
    v_mfma_f32_16x16x32_bf16 v[120:123], a[140:143], a[68:71], v[120:123]
    ds_read_b64_tr_b16 a[110:111], v29 offset:45056
    v_mfma_f32_16x16x32_bf16 v[120:123], a[136:139], a[64:67], v[120:123]
    s_waitcnt vmcnt(38)
    s_barrier
    s_waitcnt lgkmcnt(4)
    v_mfma_f32_16x16x32_bf16 v[160:163], a[96:99], a[64:67], v[160:163]
    ds_read_b64_tr_b16 a[128:129], v30 offset:32768
    v_mfma_f32_16x16x32_bf16 v[160:163], a[100:103], a[68:71], v[160:163]
    buffer_load_dwordx4 v4, s[68:71], s47 offen offset:2048 lds
    v_mfma_f32_16x16x32_bf16 v[164:167], a[100:103], a[76:79], v[164:167]
    ds_read_b64_tr_b16 a[130:131], v30 offset:36864
    v_mfma_f32_16x16x32_bf16 v[164:167], a[96:99], a[72:75], v[164:167]
    v_mfma_f32_16x16x32_bf16 v[128:131], a[96:99], a[80:83], v[128:131]
    ds_read_b64_tr_b16 a[132:133], v30 offset:40960
    v_mfma_f32_16x16x32_bf16 v[128:131], a[100:103], a[84:87], v[128:131]
    buffer_load_dwordx4 v5, s[68:71], s47 offen offset:3072 lds
    v_mfma_f32_16x16x32_bf16 v[132:135], a[100:103], a[92:95], v[132:135]
    ds_read_b64_tr_b16 a[134:135], v30 offset:45056
    v_mfma_f32_16x16x32_bf16 v[132:135], a[96:99], a[88:91], v[132:135]
    s_waitcnt lgkmcnt(4)
    v_mfma_f32_16x16x32_bf16 v[140:143], a[104:107], a[88:91], v[140:143]
    ds_read_b64_tr_b16 a[136:137], v31 offset:32768
    v_mfma_f32_16x16x32_bf16 v[140:143], a[108:111], a[92:95], v[140:143]
    s_add_u32 m0, s63, 147456
    s_add_u32 s47, s98, 0x60000
    buffer_load_dwordx4 v2, s[68:71], s47 offen offset:0 lds
    v_mfma_f32_16x16x32_bf16 v[136:139], a[108:111], a[84:87], v[136:139]
    ds_read_b64_tr_b16 a[138:139], v31 offset:36864
    v_mfma_f32_16x16x32_bf16 v[136:139], a[104:107], a[80:83], v[136:139]
    v_mfma_f32_16x16x32_bf16 v[172:175], a[104:107], a[72:75], v[172:175]
    ds_read_b64_tr_b16 a[140:141], v31 offset:40960
    v_mfma_f32_16x16x32_bf16 v[172:175], a[108:111], a[76:79], v[172:175]
    buffer_load_dwordx4 v3, s[68:71], s47 offen offset:1024 lds
    v_mfma_f32_16x16x32_bf16 v[168:171], a[108:111], a[68:71], v[168:171]
    ds_read_b64_tr_b16 a[142:143], v31 offset:45056
    v_mfma_f32_16x16x32_bf16 v[168:171], a[104:107], a[64:67], v[168:171]
    s_waitcnt lgkmcnt(4)
    v_mfma_f32_16x16x32_bf16 v[176:179], a[128:131], a[64:67], v[176:179]
    ds_read_b64_tr_b16 a[96:97], v28 offset:49152
    ds_read_b64_tr_b16 a[98:99], v28 offset:53248
    v_mfma_f32_16x16x32_bf16 v[176:179], a[132:135], a[68:71], v[176:179]
    buffer_load_dwordx4 v4, s[68:71], s47 offen offset:2048 lds
    v_mfma_f32_16x16x32_bf16 v[180:183], a[132:135], a[76:79], v[180:183]
    ds_read_b64_tr_b16 a[100:101], v28 offset:57344
    ds_read_b64_tr_b16 a[102:103], v28 offset:61440
    v_mfma_f32_16x16x32_bf16 v[180:183], a[128:131], a[72:75], v[180:183]
    v_mfma_f32_16x16x32_bf16 v[144:147], a[128:131], a[80:83], v[144:147]
    ds_read_b64_tr_b16 a[104:105], v29 offset:49152
    ds_read_b64_tr_b16 a[106:107], v29 offset:53248
    v_mfma_f32_16x16x32_bf16 v[144:147], a[132:135], a[84:87], v[144:147]
    buffer_load_dwordx4 v5, s[68:71], s47 offen offset:3072 lds
    v_mfma_f32_16x16x32_bf16 v[148:151], a[132:135], a[92:95], v[148:151]
    ds_read_b64_tr_b16 a[108:109], v29 offset:57344
    ds_read_b64_tr_b16 a[110:111], v29 offset:61440
    v_mfma_f32_16x16x32_bf16 v[148:151], a[128:131], a[88:91], v[148:151]
    s_waitcnt lgkmcnt(8)
    v_mfma_f32_16x16x32_bf16 v[156:159], a[136:139], a[88:91], v[156:159]
    ds_read_b64_tr_b16 a[112:113], v30 offset:49152
    ds_read_b64_tr_b16 a[114:115], v30 offset:53248
    v_mfma_f32_16x16x32_bf16 v[156:159], a[140:143], a[92:95], v[156:159]
    v_mfma_f32_16x16x32_bf16 v[152:155], a[140:143], a[84:87], v[152:155]
    ds_read_b64_tr_b16 a[116:117], v30 offset:57344
    ds_read_b64_tr_b16 a[118:119], v30 offset:61440
    v_mfma_f32_16x16x32_bf16 v[152:155], a[136:139], a[80:83], v[152:155]
    buffer_load_dwordx4 a[240:243], v12, s[12:15], s43 offen offset:0 sc1
    v_mfma_f32_16x16x32_bf16 v[188:191], a[136:139], a[72:75], v[188:191]
    ds_read_b64_tr_b16 a[120:121], v31 offset:49152
    ds_read_b64_tr_b16 a[122:123], v31 offset:53248
    v_mfma_f32_16x16x32_bf16 v[188:191], a[140:143], a[76:79], v[188:191]
    v_mfma_f32_16x16x32_bf16 v[184:187], a[140:143], a[68:71], v[184:187]
    ds_read_b64_tr_b16 a[124:125], v31 offset:57344
    ds_read_b64_tr_b16 a[126:127], v31 offset:61440
    v_mfma_f32_16x16x32_bf16 v[184:187], a[136:139], a[64:67], v[184:187]
    s_waitcnt vmcnt(33)
    s_barrier
    s_waitcnt lgkmcnt(12)
    v_mfma_f32_16x16x32_bf16 v[160:163], a[96:99], a[160:163], v[160:163]
    ds_read_b64_tr_b16 a[128:129], v36 offset:0
    ds_read_b64_tr_b16 a[130:131], v36 offset:4096
    v_mfma_f32_16x16x32_bf16 v[160:163], a[100:103], a[164:167], v[160:163]
    buffer_load_dwordx4 a[244:247], v12, s[12:15], s43 offen offset:2048 sc1
    v_mfma_f32_16x16x32_bf16 v[164:167], a[100:103], a[172:175], v[164:167]
    ds_read_b64_tr_b16 a[132:133], v36 offset:8192
    ds_read_b64_tr_b16 a[134:135], v36 offset:12288
    v_mfma_f32_16x16x32_bf16 v[164:167], a[96:99], a[168:171], v[164:167]
    s_waitcnt lgkmcnt(12)
    v_mfma_f32_16x16x32_bf16 v[172:175], a[104:107], a[168:171], v[172:175]
    ds_read_b64_tr_b16 a[136:137], v37 offset:0
    ds_read_b64_tr_b16 a[138:139], v37 offset:4096
    v_mfma_f32_16x16x32_bf16 v[172:175], a[108:111], a[172:175], v[172:175]
    buffer_load_dwordx4 a[248:251], v13, s[12:15], s43 offen offset:0 sc1
    v_mfma_f32_16x16x32_bf16 v[168:171], a[108:111], a[164:167], v[168:171]
    ds_read_b64_tr_b16 a[140:141], v37 offset:8192
    ds_read_b64_tr_b16 a[142:143], v37 offset:12288
    v_mfma_f32_16x16x32_bf16 v[168:171], a[104:107], a[160:163], v[168:171]
    s_waitcnt lgkmcnt(12)
    v_mfma_f32_16x16x32_bf16 v[176:179], a[112:115], a[160:163], v[176:179]
    ds_read_b64_tr_b16 a[144:145], v38 offset:0
    ds_read_b64_tr_b16 a[146:147], v38 offset:4096
    v_mfma_f32_16x16x32_bf16 v[176:179], a[116:119], a[164:167], v[176:179]
    buffer_load_dwordx4 a[252:255], v13, s[12:15], s43 offen offset:2048 sc1
    s_add_u32 s43, s43, 4096
    v_mfma_f32_16x16x32_bf16 v[180:183], a[116:119], a[172:175], v[180:183]
    ds_read_b64_tr_b16 a[148:149], v38 offset:8192
    ds_read_b64_tr_b16 a[150:151], v38 offset:12288
    v_mfma_f32_16x16x32_bf16 v[180:183], a[112:115], a[168:171], v[180:183]
    s_waitcnt lgkmcnt(12)
    v_mfma_f32_16x16x32_bf16 v[188:191], a[120:123], a[168:171], v[188:191]
    ds_read_b64_tr_b16 a[152:153], v39 offset:0
    ds_read_b64_tr_b16 a[154:155], v39 offset:4096
    v_mfma_f32_16x16x32_bf16 v[188:191], a[124:127], a[172:175], v[188:191]
    buffer_load_dwordx4 v[192:195], v12, s[12:15], s43 offen offset:0 sc1
    v_mfma_f32_16x16x32_bf16 v[184:187], a[124:127], a[164:167], v[184:187]
    ds_read_b64_tr_b16 a[156:157], v39 offset:8192
    ds_read_b64_tr_b16 a[158:159], v39 offset:12288
    v_mfma_f32_16x16x32_bf16 v[184:187], a[120:123], a[160:163], v[184:187]
    s_waitcnt vmcnt(33) lgkmcnt(12)
    v_mfma_f32_16x16x32_bf16 v[160:163], a[128:131], a[176:179], v[160:163]
    ds_read_b64_tr_b16 a[96:97], v36 offset:16384
    ds_read_b64_tr_b16 a[98:99], v36 offset:20480
    v_mfma_f32_16x16x32_bf16 v[160:163], a[132:135], a[180:183], v[160:163]
    buffer_load_dwordx4 v[196:199], v12, s[12:15], s43 offen offset:2048 sc1
    v_mfma_f32_16x16x32_bf16 v[164:167], a[132:135], a[188:191], v[164:167]
    ds_read_b64_tr_b16 a[100:101], v36 offset:24576
    ds_read_b64_tr_b16 a[102:103], v36 offset:28672
    v_mfma_f32_16x16x32_bf16 v[164:167], a[128:131], a[184:187], v[164:167]
    s_waitcnt lgkmcnt(12)
    v_mfma_f32_16x16x32_bf16 v[172:175], a[136:139], a[184:187], v[172:175]
    ds_read_b64_tr_b16 a[104:105], v37 offset:16384
    ds_read_b64_tr_b16 a[106:107], v37 offset:20480
    v_mfma_f32_16x16x32_bf16 v[172:175], a[140:143], a[188:191], v[172:175]
    buffer_load_dwordx4 v[200:203], v13, s[12:15], s43 offen offset:0 sc1
    v_mfma_f32_16x16x32_bf16 v[168:171], a[140:143], a[180:183], v[168:171]
    ds_read_b64_tr_b16 a[108:109], v37 offset:24576
    ds_read_b64_tr_b16 a[110:111], v37 offset:28672
    v_mfma_f32_16x16x32_bf16 v[168:171], a[136:139], a[176:179], v[168:171]
    s_waitcnt lgkmcnt(12)
    v_mfma_f32_16x16x32_bf16 v[176:179], a[144:147], a[176:179], v[176:179]
    ds_read_b64_tr_b16 a[112:113], v38 offset:16384
    ds_read_b64_tr_b16 a[114:115], v38 offset:20480
    v_mfma_f32_16x16x32_bf16 v[176:179], a[148:151], a[180:183], v[176:179]
    v_mfma_f32_16x16x32_bf16 v[180:183], a[148:151], a[188:191], v[180:183]
    ds_read_b64_tr_b16 a[116:117], v38 offset:24576
    ds_read_b64_tr_b16 a[118:119], v38 offset:28672
    v_mfma_f32_16x16x32_bf16 v[180:183], a[144:147], a[184:187], v[180:183]
    s_waitcnt lgkmcnt(12)
    buffer_load_dwordx4 v[204:207], v13, s[12:15], s43 offen offset:2048 sc1
    s_add_u32 s43, s43, 4096
    v_mfma_f32_16x16x32_bf16 v[188:191], a[152:155], a[184:187], v[188:191]
    ds_read_b64_tr_b16 a[120:121], v39 offset:16384
    ds_read_b64_tr_b16 a[122:123], v39 offset:20480
    v_mfma_f32_16x16x32_bf16 v[188:191], a[156:159], a[188:191], v[188:191]
L_pg8:
    s_cbranch_execz L_tramp
    v_mfma_f32_16x16x32_bf16 v[184:187], a[156:159], a[180:183], v[184:187]
    ds_read_b64_tr_b16 a[124:125], v39 offset:24576
    ds_read_b64_tr_b16 a[126:127], v39 offset:28672
    v_mfma_f32_16x16x32_bf16 v[184:187], a[152:155], a[176:179], v[184:187]
    s_waitcnt vmcnt(24)
    s_barrier
    s_waitcnt lgkmcnt(12)
    v_mfma_f32_16x16x32_bf16 v[160:163], a[96:99], a[192:195], v[160:163]
    ds_read_b64_tr_b16 a[128:129], v36 offset:32768
    ds_read_b64_tr_b16 a[130:131], v36 offset:36864
    v_mfma_f32_16x16x32_bf16 v[160:163], a[100:103], a[196:199], v[160:163]
    s_add_u32 m0, s63, 0
    s_add_u32 s47, s98, 0x80000
    buffer_load_dwordx4 v2, s[68:71], s47 offen offset:0 lds
    v_mfma_f32_16x16x32_bf16 v[164:167], a[100:103], a[204:207], v[164:167]
    ds_read_b64_tr_b16 a[132:133], v36 offset:40960
    ds_read_b64_tr_b16 a[134:135], v36 offset:45056
    v_mfma_f32_16x16x32_bf16 v[164:167], a[96:99], a[200:203], v[164:167]
    s_waitcnt lgkmcnt(12)
    v_mfma_f32_16x16x32_bf16 v[172:175], a[104:107], a[200:203], v[172:175]
    ds_read_b64_tr_b16 a[136:137], v37 offset:32768
    ds_read_b64_tr_b16 a[138:139], v37 offset:36864
    v_mfma_f32_16x16x32_bf16 v[172:175], a[108:111], a[204:207], v[172:175]
    buffer_load_dwordx4 v3, s[68:71], s47 offen offset:1024 lds
    v_mfma_f32_16x16x32_bf16 v[168:171], a[108:111], a[196:199], v[168:171]
    ds_read_b64_tr_b16 a[140:141], v37 offset:40960
    ds_read_b64_tr_b16 a[142:143], v37 offset:45056
    v_mul_f32 v160, v50, v160
    v_mfma_f32_16x16x32_bf16 v[168:171], a[104:107], a[192:195], v[168:171]
    s_waitcnt lgkmcnt(12)
    v_mul_f32 v161, v50, v161
    v_mfma_f32_16x16x32_bf16 v[176:179], a[112:115], a[192:195], v[176:179]
    ds_read_b64_tr_b16 a[144:145], v38 offset:32768
    ds_read_b64_tr_b16 a[146:147], v38 offset:36864
    v_mul_f32 v162, v50, v162
    v_mfma_f32_16x16x32_bf16 v[176:179], a[116:119], a[196:199], v[176:179]
    buffer_load_dwordx4 v4, s[68:71], s47 offen offset:2048 lds
    v_mul_f32 v163, v50, v163
    v_mfma_f32_16x16x32_bf16 v[180:183], a[116:119], a[204:207], v[180:183]
    ds_read_b64_tr_b16 a[148:149], v38 offset:40960
    ds_read_b64_tr_b16 a[150:151], v38 offset:45056
    v_mul_f32 v164, v51, v164
    v_mul_f32 v168, v50, v168
    v_mfma_f32_16x16x32_bf16 v[180:183], a[112:115], a[200:203], v[180:183]
    s_waitcnt lgkmcnt(12)
    v_mul_f32 v165, v51, v165
    v_mul_f32 v169, v50, v169
    v_mfma_f32_16x16x32_bf16 v[188:191], a[120:123], a[200:203], v[188:191]
    ds_read_b64_tr_b16 a[152:153], v39 offset:32768
    ds_read_b64_tr_b16 a[154:155], v39 offset:36864
    v_mul_f32 v166, v51, v166
    v_mul_f32 v170, v50, v170
    v_mfma_f32_16x16x32_bf16 v[188:191], a[124:127], a[204:207], v[188:191]
    buffer_load_dwordx4 v5, s[68:71], s47 offen offset:3072 lds
    v_mul_f32 v167, v51, v167
    v_mul_f32 v171, v50, v171
    v_mfma_f32_16x16x32_bf16 v[184:187], a[124:127], a[196:199], v[184:187]
    ds_read_b64_tr_b16 a[156:157], v39 offset:40960
    ds_read_b64_tr_b16 a[158:159], v39 offset:45056
    v_mul_f32 v172, v51, v172
    v_mul_f32 v176, v50, v176
    v_mfma_f32_16x16x32_bf16 v[184:187], a[120:123], a[192:195], v[184:187]
    v_mul_f32 v173, v51, v173
    v_mul_f32 v177, v50, v177
    s_waitcnt vmcnt(24) lgkmcnt(12)
    v_mfma_f32_16x16x32_bf16 v[160:163], a[128:131], a[208:211], v[160:163]
    ds_read_b64_tr_b16 a[96:97], v36 offset:49152
    ds_read_b64_tr_b16 a[98:99], v36 offset:53248
    v_mul_f32 v174, v51, v174
    v_mul_f32 v178, v50, v178
    v_mfma_f32_16x16x32_bf16 v[160:163], a[132:135], a[212:215], v[160:163]
    buffer_load_dwordx4 v[208:211], v12, s[12:15], s43 offen offset:0 sc1
    v_mul_f32 v175, v51, v175
    v_mul_f32 v179, v50, v179
    v_mfma_f32_16x16x32_bf16 v[164:167], a[132:135], a[220:223], v[164:167]
    ds_read_b64_tr_b16 a[100:101], v36 offset:57344
    ds_read_b64_tr_b16 a[102:103], v36 offset:61440
    v_mul_f32 v180, v51, v180
    v_mul_f32 v184, v50, v184
    v_mfma_f32_16x16x32_bf16 v[164:167], a[128:131], a[216:219], v[164:167]
    s_waitcnt lgkmcnt(12)
    v_mul_f32 v181, v51, v181
    v_mul_f32 v185, v50, v185
    v_mfma_f32_16x16x32_bf16 v[172:175], a[136:139], a[216:219], v[172:175]
    ds_read_b64_tr_b16 a[104:105], v37 offset:49152
    ds_read_b64_tr_b16 a[106:107], v37 offset:53248
    v_mul_f32 v182, v51, v182
    v_mul_f32 v186, v50, v186
    v_mfma_f32_16x16x32_bf16 v[172:175], a[140:143], a[220:223], v[172:175]
    buffer_load_dwordx4 v[212:215], v12, s[12:15], s43 offen offset:2048 sc1
    v_mul_f32 v183, v51, v183
    v_mul_f32 v187, v50, v187
    v_mfma_f32_16x16x32_bf16 v[168:171], a[140:143], a[212:215], v[168:171]
    ds_read_b64_tr_b16 a[108:109], v37 offset:57344
    ds_read_b64_tr_b16 a[110:111], v37 offset:61440
    v_mul_f32 v188, v51, v188
    v_mfma_f32_16x16x32_bf16 v[168:171], a[136:139], a[208:211], v[168:171]
    s_waitcnt lgkmcnt(12)
    v_mul_f32 v189, v51, v189
    v_mfma_f32_16x16x32_bf16 v[176:179], a[144:147], a[208:211], v[176:179]
    ds_read_b64_tr_b16 a[112:113], v38 offset:49152
    ds_read_b64_tr_b16 a[114:115], v38 offset:53248
    v_mul_f32 v190, v51, v190
    v_mfma_f32_16x16x32_bf16 v[176:179], a[148:151], a[212:215], v[176:179]
    v_mul_f32 v191, v51, v191
    v_mfma_f32_16x16x32_bf16 v[180:183], a[148:151], a[220:223], v[180:183]
    ds_read_b64_tr_b16 a[116:117], v38 offset:57344
    ds_read_b64_tr_b16 a[118:119], v38 offset:61440
    v_mfma_f32_16x16x32_bf16 v[180:183], a[144:147], a[216:219], v[180:183]
    s_waitcnt lgkmcnt(12)
    buffer_load_dwordx4 v[216:219], v13, s[12:15], s43 offen offset:0 sc1
    v_mfma_f32_16x16x32_bf16 v[188:191], a[152:155], a[216:219], v[188:191]
    ds_read_b64_tr_b16 a[120:121], v39 offset:49152
    ds_read_b64_tr_b16 a[122:123], v39 offset:53248
    v_mfma_f32_16x16x32_bf16 v[188:191], a[156:159], a[220:223], v[188:191]
    v_mfma_f32_16x16x32_bf16 v[184:187], a[156:159], a[212:215], v[184:187]
    ds_read_b64_tr_b16 a[124:125], v39 offset:57344
    ds_read_b64_tr_b16 a[126:127], v39 offset:61440
    v_mfma_f32_16x16x32_bf16 v[184:187], a[152:155], a[208:211], v[184:187]
    s_waitcnt vmcnt(15)
    s_barrier
    s_waitcnt lgkmcnt(12)
    v_mfma_f32_16x16x32_bf16 v[160:163], a[96:99], a[224:227], v[160:163]
    ds_read_b64_tr_b16 a[128:129], v44 offset:0
    ds_read_b64_tr_b16 a[130:131], v44 offset:4096
    v_mfma_f32_16x16x32_bf16 v[160:163], a[100:103], a[228:231], v[160:163]
    buffer_load_dwordx4 v[220:223], v13, s[12:15], s43 offen offset:2048 sc1
    s_add_u32 s43, s43, 4096
    v_mfma_f32_16x16x32_bf16 v[164:167], a[100:103], a[236:239], v[164:167]
    ds_read_b64_tr_b16 a[132:133], v44 offset:8192
    ds_read_b64_tr_b16 a[134:135], v44 offset:12288
    v_mfma_f32_16x16x32_bf16 v[164:167], a[96:99], a[232:235], v[164:167]
    s_waitcnt lgkmcnt(12)
    v_mfma_f32_16x16x32_bf16 v[172:175], a[104:107], a[232:235], v[172:175]
    ds_read_b64_tr_b16 a[136:137], v45 offset:0
    ds_read_b64_tr_b16 a[138:139], v45 offset:4096
    v_mfma_f32_16x16x32_bf16 v[172:175], a[108:111], a[236:239], v[172:175]
    buffer_load_dwordx4 v[224:227], v12, s[12:15], s42 offen offset:0 sc1
    v_mfma_f32_16x16x32_bf16 v[168:171], a[108:111], a[228:231], v[168:171]
    ds_read_b64_tr_b16 a[140:141], v45 offset:8192
    ds_read_b64_tr_b16 a[142:143], v45 offset:12288
    v_mfma_f32_16x16x32_bf16 v[168:171], a[104:107], a[224:227], v[168:171]
    s_waitcnt lgkmcnt(12)
    v_mfma_f32_16x16x32_bf16 v[176:179], a[112:115], a[224:227], v[176:179]
    ds_read_b64_tr_b16 a[144:145], v46 offset:0
    ds_read_b64_tr_b16 a[146:147], v46 offset:4096
    v_mfma_f32_16x16x32_bf16 v[176:179], a[116:119], a[228:231], v[176:179]
    buffer_load_dwordx4 v[228:231], v12, s[12:15], s42 offen offset:2048 sc1
    v_mfma_f32_16x16x32_bf16 v[180:183], a[116:119], a[236:239], v[180:183]
    ds_read_b64_tr_b16 a[148:149], v46 offset:8192
    ds_read_b64_tr_b16 a[150:151], v46 offset:12288
    v_mfma_f32_16x16x32_bf16 v[180:183], a[112:115], a[232:235], v[180:183]
    s_waitcnt lgkmcnt(12)
    v_mfma_f32_16x16x32_bf16 v[188:191], a[120:123], a[232:235], v[188:191]
    ds_read_b64_tr_b16 a[152:153], v47 offset:0
    ds_read_b64_tr_b16 a[154:155], v47 offset:4096
    v_mfma_f32_16x16x32_bf16 v[188:191], a[124:127], a[236:239], v[188:191]
    buffer_load_dwordx4 v[232:235], v13, s[12:15], s42 offen offset:0 sc1
    v_mfma_f32_16x16x32_bf16 v[184:187], a[124:127], a[228:231], v[184:187]
    ds_read_b64_tr_b16 a[156:157], v47 offset:8192
    ds_read_b64_tr_b16 a[158:159], v47 offset:12288
    v_mfma_f32_16x16x32_bf16 v[184:187], a[120:123], a[224:227], v[184:187]
    s_waitcnt vmcnt(15) lgkmcnt(12)
    v_mfma_f32_16x16x32_bf16 v[160:163], a[128:131], a[240:243], v[160:163]
    ds_read_b64_tr_b16 a[96:97], v44 offset:16384
    ds_read_b64_tr_b16 a[98:99], v44 offset:20480
    v_mfma_f32_16x16x32_bf16 v[160:163], a[132:135], a[244:247], v[160:163]
    buffer_load_dwordx4 v[236:239], v13, s[12:15], s42 offen offset:2048 sc1
    s_add_u32 s42, s42, 4096
    v_mfma_f32_16x16x32_bf16 v[164:167], a[132:135], a[252:255], v[164:167]
    ds_read_b64_tr_b16 a[100:101], v44 offset:24576
    ds_read_b64_tr_b16 a[102:103], v44 offset:28672
    v_mfma_f32_16x16x32_bf16 v[164:167], a[128:131], a[248:251], v[164:167]
    s_waitcnt lgkmcnt(12)
    v_mfma_f32_16x16x32_bf16 v[172:175], a[136:139], a[248:251], v[172:175]
    ds_read_b64_tr_b16 a[104:105], v45 offset:16384
    ds_read_b64_tr_b16 a[106:107], v45 offset:20480
    v_mfma_f32_16x16x32_bf16 v[172:175], a[140:143], a[252:255], v[172:175]
    buffer_load_dwordx4 v[240:243], v12, s[12:15], s42 offen offset:0 sc1
    v_mfma_f32_16x16x32_bf16 v[168:171], a[140:143], a[244:247], v[168:171]
    ds_read_b64_tr_b16 a[108:109], v45 offset:24576
    ds_read_b64_tr_b16 a[110:111], v45 offset:28672
    v_mfma_f32_16x16x32_bf16 v[168:171], a[136:139], a[240:243], v[168:171]
    s_waitcnt lgkmcnt(12)
    v_mfma_f32_16x16x32_bf16 v[176:179], a[144:147], a[240:243], v[176:179]
    ds_read_b64_tr_b16 a[112:113], v46 offset:16384
    ds_read_b64_tr_b16 a[114:115], v46 offset:20480
    v_mfma_f32_16x16x32_bf16 v[176:179], a[148:151], a[244:247], v[176:179]
    v_mfma_f32_16x16x32_bf16 v[180:183], a[148:151], a[252:255], v[180:183]
    ds_read_b64_tr_b16 a[116:117], v46 offset:24576
    ds_read_b64_tr_b16 a[118:119], v46 offset:28672
    v_mfma_f32_16x16x32_bf16 v[180:183], a[144:147], a[248:251], v[180:183]
    s_waitcnt lgkmcnt(12)
    buffer_load_dwordx4 v[244:247], v12, s[12:15], s42 offen offset:2048 sc1
    v_mfma_f32_16x16x32_bf16 v[188:191], a[152:155], a[248:251], v[188:191]
    ds_read_b64_tr_b16 a[120:121], v47 offset:16384
    ds_read_b64_tr_b16 a[122:123], v47 offset:20480
    v_mfma_f32_16x16x32_bf16 v[188:191], a[156:159], a[252:255], v[188:191]
    v_mfma_f32_16x16x32_bf16 v[184:187], a[156:159], a[244:247], v[184:187]
    ds_read_b64_tr_b16 a[124:125], v47 offset:24576
    ds_read_b64_tr_b16 a[126:127], v47 offset:28672
    v_mfma_f32_16x16x32_bf16 v[184:187], a[152:155], a[240:243], v[184:187]
    s_waitcnt vmcnt(10)
    s_barrier
    s_waitcnt lgkmcnt(12)
    v_mfma_f32_16x16x32_bf16 v[160:163], a[96:99], v[192:195], v[160:163]
    ds_read_b64_tr_b16 a[128:129], v28 offset:0
    ds_read_b64_tr_b16 a[130:131], v28 offset:4096
    v_mfma_f32_16x16x32_bf16 v[160:163], a[100:103], v[196:199], v[160:163]
    buffer_load_dwordx4 v[248:251], v13, s[12:15], s42 offen offset:0 sc1
    v_mfma_f32_16x16x32_bf16 v[164:167], a[100:103], v[204:207], v[164:167]
    ds_read_b64_tr_b16 a[132:133], v28 offset:8192
    ds_read_b64_tr_b16 a[134:135], v28 offset:12288
    v_mfma_f32_16x16x32_bf16 v[164:167], a[96:99], v[200:203], v[164:167]
    s_waitcnt lgkmcnt(12)
    v_mfma_f32_16x16x32_bf16 v[172:175], a[104:107], v[200:203], v[172:175]
    ds_read_b64_tr_b16 a[136:137], v29 offset:0
    ds_read_b64_tr_b16 a[138:139], v29 offset:4096
    v_mfma_f32_16x16x32_bf16 v[172:175], a[108:111], v[204:207], v[172:175]
    buffer_load_dwordx4 v[252:255], v13, s[12:15], s42 offen offset:2048 sc1
    s_add_u32 s42, s42, 4096
    v_mfma_f32_16x16x32_bf16 v[168:171], a[108:111], v[196:199], v[168:171]
    ds_read_b64_tr_b16 a[140:141], v29 offset:8192
    ds_read_b64_tr_b16 a[142:143], v29 offset:12288
    v_mfma_f32_16x16x32_bf16 v[168:171], a[104:107], v[192:195], v[168:171]
    s_waitcnt lgkmcnt(12)
    v_mfma_f32_16x16x32_bf16 v[176:179], a[112:115], v[192:195], v[176:179]
    ds_read_b64_tr_b16 a[144:145], v30 offset:0
    ds_read_b64_tr_b16 a[146:147], v30 offset:4096
    v_mfma_f32_16x16x32_bf16 v[176:179], a[116:119], v[196:199], v[176:179]
    buffer_load_dwordx4 a[0:3], v12, s[12:15], s42 offen offset:0 sc1
    v_mfma_f32_16x16x32_bf16 v[180:183], a[116:119], v[204:207], v[180:183]
    ds_read_b64_tr_b16 a[148:149], v30 offset:8192
    ds_read_b64_tr_b16 a[150:151], v30 offset:12288
    v_mfma_f32_16x16x32_bf16 v[180:183], a[112:115], v[200:203], v[180:183]
    s_waitcnt lgkmcnt(12)
    v_mfma_f32_16x16x32_bf16 v[188:191], a[120:123], v[200:203], v[188:191]
    ds_read_b64_tr_b16 a[152:153], v31 offset:0
    ds_read_b64_tr_b16 a[154:155], v31 offset:4096
    v_mfma_f32_16x16x32_bf16 v[188:191], a[124:127], v[204:207], v[188:191]
    buffer_load_dwordx4 a[4:7], v12, s[12:15], s42 offen offset:2048 sc1
    v_mfma_f32_16x16x32_bf16 v[184:187], a[124:127], v[196:199], v[184:187]
    ds_read_b64_tr_b16 a[156:157], v31 offset:8192
    ds_read_b64_tr_b16 a[158:159], v31 offset:12288
    v_mfma_f32_16x16x32_bf16 v[184:187], a[120:123], v[192:195], v[184:187]
    s_waitcnt vmcnt(10) lgkmcnt(12)
    v_mfma_f32_16x16x32_bf16 v[160:163], a[128:131], v[208:211], v[160:163]
    ds_read_b64_tr_b16 a[96:97], v24 offset:49152
    ds_read_b64_tr_b16 a[98:99], v24 offset:53248
    v_mfma_f32_16x16x32_bf16 v[160:163], a[132:135], v[212:215], v[160:163]
    buffer_load_dwordx4 a[8:11], v13, s[12:15], s42 offen offset:0 sc1
    v_mfma_f32_16x16x32_bf16 v[164:167], a[132:135], v[220:223], v[164:167]
    ds_read_b64_tr_b16 a[100:101], v24 offset:57344
    ds_read_b64_tr_b16 a[102:103], v24 offset:61440
    v_mfma_f32_16x16x32_bf16 v[164:167], a[128:131], v[216:219], v[164:167]
    s_waitcnt lgkmcnt(12)
    v_mfma_f32_16x16x32_bf16 v[172:175], a[136:139], v[216:219], v[172:175]
    ds_read_b64_tr_b16 a[104:105], v25 offset:49152
    ds_read_b64_tr_b16 a[106:107], v25 offset:53248
    v_mfma_f32_16x16x32_bf16 v[172:175], a[140:143], v[220:223], v[172:175]
    buffer_load_dwordx4 a[12:15], v13, s[12:15], s42 offen offset:2048 sc1
    s_add_u32 s42, s42, s36
    v_mfma_f32_16x16x32_bf16 v[168:171], a[140:143], v[212:215], v[168:171]
    ds_read_b64_tr_b16 a[108:109], v25 offset:57344
    ds_read_b64_tr_b16 a[110:111], v25 offset:61440
    v_mfma_f32_16x16x32_bf16 v[168:171], a[136:139], v[208:211], v[168:171]
    s_waitcnt lgkmcnt(12)
    v_mfma_f32_16x16x32_bf16 v[176:179], a[144:147], v[208:211], v[176:179]
    ds_read_b64_tr_b16 a[112:113], v26 offset:49152
    ds_read_b64_tr_b16 a[114:115], v26 offset:53248
    v_mfma_f32_16x16x32_bf16 v[176:179], a[148:151], v[212:215], v[176:179]
    v_mfma_f32_16x16x32_bf16 v[180:183], a[148:151], v[220:223], v[180:183]
    ds_read_b64_tr_b16 a[116:117], v26 offset:57344
    ds_read_b64_tr_b16 a[118:119], v26 offset:61440
    v_mfma_f32_16x16x32_bf16 v[180:183], a[144:147], v[216:219], v[180:183]
    s_waitcnt lgkmcnt(12)
    buffer_load_dwordx4 a[16:19], v12, s[12:15], s42 offen offset:0 sc1
    v_mfma_f32_16x16x32_bf16 v[188:191], a[152:155], v[216:219], v[188:191]
    ds_read_b64_tr_b16 a[120:121], v27 offset:49152
    ds_read_b64_tr_b16 a[122:123], v27 offset:53248
    v_mfma_f32_16x16x32_bf16 v[188:191], a[156:159], v[220:223], v[188:191]
    v_mfma_f32_16x16x32_bf16 v[184:187], a[156:159], v[212:215], v[184:187]
    ds_read_b64_tr_b16 a[124:125], v27 offset:57344
    ds_read_b64_tr_b16 a[126:127], v27 offset:61440
    v_mfma_f32_16x16x32_bf16 v[184:187], a[152:155], v[208:211], v[184:187]
    s_waitcnt lgkmcnt(12)
    v_mfma_f32_16x16x32_bf16 v[96:99], a[96:99], a[160:163], v[96:99]
    ds_read_b64_tr_b16 a[128:129], v32 offset:0
    ds_read_b64_tr_b16 a[130:131], v32 offset:4096
    v_cvt_pk_bf16_f32 v160, v160, v161
    v_mfma_f32_16x16x32_bf16 v[96:99], a[100:103], a[164:167], v[96:99]
    v_cvt_pk_bf16_f32 v161, v162, v163
    v_mfma_f32_16x16x32_bf16 v[100:103], a[100:103], a[172:175], v[100:103]
    ds_read_b64_tr_b16 a[132:133], v32 offset:8192
    ds_read_b64_tr_b16 a[134:135], v32 offset:12288
    v_cvt_pk_bf16_f32 v162, v164, v165
    v_mfma_f32_16x16x32_bf16 v[100:103], a[96:99], a[168:171], v[100:103]
    s_waitcnt lgkmcnt(12)
    v_cvt_pk_bf16_f32 v163, v166, v167
    buffer_store_dwordx4 v[160:163], v6, s[12:15], s52 offen offset:0 sc1
    v_mfma_f32_16x16x32_bf16 v[108:111], a[104:107], a[168:171], v[108:111]
    ds_read_b64_tr_b16 a[136:137], v33 offset:0
    ds_read_b64_tr_b16 a[138:139], v33 offset:4096
    v_cvt_pk_bf16_f32 v164, v168, v169
    v_mfma_f32_16x16x32_bf16 v[108:111], a[108:111], a[172:175], v[108:111]
    v_cvt_pk_bf16_f32 v165, v170, v171
    v_mfma_f32_16x16x32_bf16 v[104:107], a[108:111], a[164:167], v[104:107]
    ds_read_b64_tr_b16 a[140:141], v33 offset:8192
    ds_read_b64_tr_b16 a[142:143], v33 offset:12288
    v_cvt_pk_bf16_f32 v166, v172, v173
    v_mfma_f32_16x16x32_bf16 v[104:107], a[104:107], a[160:163], v[104:107]
    s_waitcnt lgkmcnt(12)
    v_cvt_pk_bf16_f32 v167, v174, v175
    buffer_store_dwordx4 v[164:167], v6, s[12:15], s52 offen offset:1024 sc1
    v_mfma_f32_16x16x32_bf16 v[112:115], a[112:115], a[160:163], v[112:115]
    ds_read_b64_tr_b16 a[144:145], v34 offset:0
    ds_read_b64_tr_b16 a[146:147], v34 offset:4096
    v_cvt_pk_bf16_f32 v168, v176, v177
    v_mfma_f32_16x16x32_bf16 v[112:115], a[116:119], a[164:167], v[112:115]
    v_cvt_pk_bf16_f32 v169, v178, v179
    v_mfma_f32_16x16x32_bf16 v[116:119], a[116:119], a[172:175], v[116:119]
    ds_read_b64_tr_b16 a[148:149], v34 offset:8192
    ds_read_b64_tr_b16 a[150:151], v34 offset:12288
    v_cvt_pk_bf16_f32 v170, v180, v181
    v_mfma_f32_16x16x32_bf16 v[116:119], a[112:115], a[168:171], v[116:119]
    s_waitcnt lgkmcnt(12)
    v_cvt_pk_bf16_f32 v171, v182, v183
    buffer_store_dwordx4 v[168:171], v6, s[12:15], s52 offen offset:2048 sc1
    v_mfma_f32_16x16x32_bf16 v[124:127], a[120:123], a[168:171], v[124:127]
    ds_read_b64_tr_b16 a[152:153], v35 offset:0
    ds_read_b64_tr_b16 a[154:155], v35 offset:4096
    v_cvt_pk_bf16_f32 v172, v184, v185
    v_mfma_f32_16x16x32_bf16 v[124:127], a[124:127], a[172:175], v[124:127]
    v_cvt_pk_bf16_f32 v173, v186, v187
    v_mfma_f32_16x16x32_bf16 v[120:123], a[124:127], a[164:167], v[120:123]
    ds_read_b64_tr_b16 a[156:157], v35 offset:8192
    ds_read_b64_tr_b16 a[158:159], v35 offset:12288
    v_cvt_pk_bf16_f32 v174, v188, v189
    v_mfma_f32_16x16x32_bf16 v[120:123], a[120:123], a[160:163], v[120:123]
    v_cvt_pk_bf16_f32 v175, v190, v191
    buffer_store_dwordx4 v[172:175], v6, s[12:15], s52 offen offset:3072 sc1
    s_waitcnt lgkmcnt(12)
    v_mfma_f32_16x16x32_bf16 v[96:99], a[128:131], a[176:179], v[96:99]
    ds_read_b64_tr_b16 a[96:97], v32 offset:16384
    ds_read_b64_tr_b16 a[98:99], v32 offset:20480
    v_mfma_f32_16x16x32_bf16 v[96:99], a[132:135], a[180:183], v[96:99]
    v_mfma_f32_16x16x32_bf16 v[100:103], a[132:135], a[188:191], v[100:103]
    ds_read_b64_tr_b16 a[100:101], v32 offset:24576
    ds_read_b64_tr_b16 a[102:103], v32 offset:28672
    v_mfma_f32_16x16x32_bf16 v[100:103], a[128:131], a[184:187], v[100:103]
    s_waitcnt lgkmcnt(12)
    v_mfma_f32_16x16x32_bf16 v[108:111], a[136:139], a[184:187], v[108:111]
    ds_read_b64_tr_b16 a[104:105], v33 offset:16384
    ds_read_b64_tr_b16 a[106:107], v33 offset:20480
    v_mfma_f32_16x16x32_bf16 v[108:111], a[140:143], a[188:191], v[108:111]
    v_mfma_f32_16x16x32_bf16 v[104:107], a[140:143], a[180:183], v[104:107]
    ds_read_b64_tr_b16 a[108:109], v33 offset:24576
    ds_read_b64_tr_b16 a[110:111], v33 offset:28672
    v_mfma_f32_16x16x32_bf16 v[104:107], a[136:139], a[176:179], v[104:107]
    s_waitcnt lgkmcnt(12)
    v_mfma_f32_16x16x32_bf16 v[112:115], a[144:147], a[176:179], v[112:115]
    ds_read_b64_tr_b16 a[112:113], v34 offset:16384
    ds_read_b64_tr_b16 a[114:115], v34 offset:20480
    v_mfma_f32_16x16x32_bf16 v[112:115], a[148:151], a[180:183], v[112:115]
    v_mfma_f32_16x16x32_bf16 v[116:119], a[148:151], a[188:191], v[116:119]
    ds_read_b64_tr_b16 a[116:117], v34 offset:24576
    ds_read_b64_tr_b16 a[118:119], v34 offset:28672
    v_mfma_f32_16x16x32_bf16 v[116:119], a[144:147], a[184:187], v[116:119]
    s_waitcnt lgkmcnt(12)
    v_mfma_f32_16x16x32_bf16 v[124:127], a[152:155], a[184:187], v[124:127]
    ds_read_b64_tr_b16 a[120:121], v35 offset:16384
    ds_read_b64_tr_b16 a[122:123], v35 offset:20480
    v_mfma_f32_16x16x32_bf16 v[124:127], a[156:159], a[188:191], v[124:127]
    v_mfma_f32_16x16x32_bf16 v[120:123], a[156:159], a[180:183], v[120:123]
    ds_read_b64_tr_b16 a[124:125], v35 offset:24576
    ds_read_b64_tr_b16 a[126:127], v35 offset:28672
    v_mfma_f32_16x16x32_bf16 v[120:123], a[152:155], a[176:179], v[120:123]
    s_waitcnt lgkmcnt(12)
    v_mfma_f32_16x16x32_bf16 v[96:99], a[96:99], a[192:195], v[96:99]
    ds_read_b64_tr_b16 a[128:129], v32 offset:32768
    ds_read_b64_tr_b16 a[130:131], v32 offset:36864
    v_mfma_f32_16x16x32_bf16 v[96:99], a[100:103], a[196:199], v[96:99]
    buffer_load_dwordx4 a[20:23], v12, s[12:15], s42 offen offset:2048 sc1
    v_mfma_f32_16x16x32_bf16 v[100:103], a[100:103], a[204:207], v[100:103]
    ds_read_b64_tr_b16 a[132:133], v32 offset:40960
    ds_read_b64_tr_b16 a[134:135], v32 offset:45056
    v_mfma_f32_16x16x32_bf16 v[100:103], a[96:99], a[200:203], v[100:103]
    s_waitcnt lgkmcnt(12)
    v_mfma_f32_16x16x32_bf16 v[108:111], a[104:107], a[200:203], v[108:111]
    ds_read_b64_tr_b16 a[136:137], v33 offset:32768
    ds_read_b64_tr_b16 a[138:139], v33 offset:36864
    v_mfma_f32_16x16x32_bf16 v[108:111], a[108:111], a[204:207], v[108:111]
    buffer_load_dwordx4 a[24:27], v13, s[12:15], s42 offen offset:0 sc1
    v_mfma_f32_16x16x32_bf16 v[104:107], a[108:111], a[196:199], v[104:107]
    ds_read_b64_tr_b16 a[140:141], v33 offset:40960
    ds_read_b64_tr_b16 a[142:143], v33 offset:45056
    v_mul_f32 v96, v50, v96
    v_mfma_f32_16x16x32_bf16 v[104:107], a[104:107], a[192:195], v[104:107]
    s_waitcnt lgkmcnt(12)
    v_mul_f32 v97, v50, v97
    v_mfma_f32_16x16x32_bf16 v[112:115], a[112:115], a[192:195], v[112:115]
    ds_read_b64_tr_b16 a[144:145], v34 offset:32768
    ds_read_b64_tr_b16 a[146:147], v34 offset:36864
    v_mul_f32 v98, v50, v98
    v_mfma_f32_16x16x32_bf16 v[112:115], a[116:119], a[196:199], v[112:115]
    v_mul_f32 v99, v50, v99
    v_mfma_f32_16x16x32_bf16 v[116:119], a[116:119], a[204:207], v[116:119]
    ds_read_b64_tr_b16 a[148:149], v34 offset:40960
    ds_read_b64_tr_b16 a[150:151], v34 offset:45056
    v_mul_f32 v100, v51, v100
    v_mul_f32 v104, v50, v104
    v_mfma_f32_16x16x32_bf16 v[116:119], a[112:115], a[200:203], v[116:119]
    s_waitcnt lgkmcnt(12)
    buffer_load_dwordx4 a[28:31], v13, s[12:15], s42 offen offset:2048 sc1
    s_add_u32 s42, s42, 4096
    v_mul_f32 v101, v51, v101
    v_mul_f32 v105, v50, v105
    v_mfma_f32_16x16x32_bf16 v[124:127], a[120:123], a[200:203], v[124:127]
    ds_read_b64_tr_b16 a[152:153], v35 offset:32768
    ds_read_b64_tr_b16 a[154:155], v35 offset:36864
    v_mul_f32 v102, v51, v102
    v_mul_f32 v106, v50, v106
    v_mfma_f32_16x16x32_bf16 v[124:127], a[124:127], a[204:207], v[124:127]
    v_mul_f32 v103, v51, v103
    v_mul_f32 v107, v50, v107
    v_mfma_f32_16x16x32_bf16 v[120:123], a[124:127], a[196:199], v[120:123]
    ds_read_b64_tr_b16 a[156:157], v35 offset:40960
    ds_read_b64_tr_b16 a[158:159], v35 offset:45056
    v_mul_f32 v108, v51, v108
    v_mul_f32 v112, v50, v112
    v_mfma_f32_16x16x32_bf16 v[120:123], a[120:123], a[192:195], v[120:123]
    v_mul_f32 v109, v51, v109
    v_mul_f32 v113, v50, v113
    s_waitcnt lgkmcnt(12)
    v_mfma_f32_16x16x32_bf16 v[96:99], a[128:131], a[208:211], v[96:99]
    ds_read_b64_tr_b16 a[96:97], v32 offset:49152
    ds_read_b64_tr_b16 a[98:99], v32 offset:53248
    v_mul_f32 v110, v51, v110
    v_mul_f32 v114, v50, v114
    v_mfma_f32_16x16x32_bf16 v[96:99], a[132:135], a[212:215], v[96:99]
    buffer_load_dwordx4 a[32:35], v12, s[12:15], s42 offen offset:0 sc1
    v_mul_f32 v111, v51, v111
    v_mul_f32 v115, v50, v115
    v_mfma_f32_16x16x32_bf16 v[100:103], a[132:135], a[220:223], v[100:103]
    ds_read_b64_tr_b16 a[100:101], v32 offset:57344
    ds_read_b64_tr_b16 a[102:103], v32 offset:61440
    v_mul_f32 v116, v51, v116
    v_mul_f32 v120, v50, v120
    v_mfma_f32_16x16x32_bf16 v[100:103], a[128:131], a[216:219], v[100:103]
    s_waitcnt lgkmcnt(12)
    v_mul_f32 v117, v51, v117
    v_mul_f32 v121, v50, v121
    v_mfma_f32_16x16x32_bf16 v[108:111], a[136:139], a[216:219], v[108:111]
    ds_read_b64_tr_b16 a[104:105], v33 offset:49152
    ds_read_b64_tr_b16 a[106:107], v33 offset:53248
    v_mul_f32 v118, v51, v118
    v_mul_f32 v122, v50, v122
    v_mfma_f32_16x16x32_bf16 v[108:111], a[140:143], a[220:223], v[108:111]
    buffer_load_dwordx4 a[36:39], v12, s[12:15], s42 offen offset:2048 sc1
    v_mul_f32 v119, v51, v119
    v_mul_f32 v123, v50, v123
    v_mfma_f32_16x16x32_bf16 v[104:107], a[140:143], a[212:215], v[104:107]
    ds_read_b64_tr_b16 a[108:109], v33 offset:57344
    ds_read_b64_tr_b16 a[110:111], v33 offset:61440
    v_mul_f32 v124, v51, v124
    v_mfma_f32_16x16x32_bf16 v[104:107], a[136:139], a[208:211], v[104:107]
    s_waitcnt lgkmcnt(12)
    v_mul_f32 v125, v51, v125
    v_mfma_f32_16x16x32_bf16 v[112:115], a[144:147], a[208:211], v[112:115]
    ds_read_b64_tr_b16 a[112:113], v34 offset:49152
    ds_read_b64_tr_b16 a[114:115], v34 offset:53248
    v_mul_f32 v126, v51, v126
    v_mfma_f32_16x16x32_bf16 v[112:115], a[148:151], a[212:215], v[112:115]
    buffer_load_dwordx4 a[40:43], v13, s[12:15], s42 offen offset:0 sc1
    v_mul_f32 v127, v51, v127
    v_mfma_f32_16x16x32_bf16 v[116:119], a[148:151], a[220:223], v[116:119]
    ds_read_b64_tr_b16 a[116:117], v34 offset:57344
    ds_read_b64_tr_b16 a[118:119], v34 offset:61440
    v_mfma_f32_16x16x32_bf16 v[116:119], a[144:147], a[216:219], v[116:119]
    s_waitcnt lgkmcnt(12)
    v_mfma_f32_16x16x32_bf16 v[124:127], a[152:155], a[216:219], v[124:127]
    ds_read_b64_tr_b16 a[120:121], v35 offset:49152
    ds_read_b64_tr_b16 a[122:123], v35 offset:53248
    v_mfma_f32_16x16x32_bf16 v[124:127], a[156:159], a[220:223], v[124:127]
    buffer_load_dwordx4 a[44:47], v13, s[12:15], s42 offen offset:2048 sc1
    s_add_u32 s42, s42, 4096
    v_mfma_f32_16x16x32_bf16 v[120:123], a[156:159], a[212:215], v[120:123]
    ds_read_b64_tr_b16 a[124:125], v35 offset:57344
    ds_read_b64_tr_b16 a[126:127], v35 offset:61440
    v_mfma_f32_16x16x32_bf16 v[120:123], a[152:155], a[208:211], v[120:123]
    s_waitcnt lgkmcnt(12)
    v_mfma_f32_16x16x32_bf16 v[96:99], a[96:99], a[224:227], v[96:99]
    ds_read_b64_tr_b16 a[128:129], v40 offset:0
    ds_read_b64_tr_b16 a[130:131], v40 offset:4096
    v_mfma_f32_16x16x32_bf16 v[96:99], a[100:103], a[228:231], v[96:99]
    buffer_load_dwordx4 a[48:51], v12, s[12:15], s42 offen offset:0 sc1
    v_mfma_f32_16x16x32_bf16 v[100:103], a[100:103], a[236:239], v[100:103]
    ds_read_b64_tr_b16 a[132:133], v40 offset:8192
    ds_read_b64_tr_b16 a[134:135], v40 offset:12288
    s_waitcnt vmcnt(8)
    s_mov_b64 exec, 1
    buffer_store_dword v15, v10, s[12:15], 0 offen sc1
    s_mov_b64 exec, -1
    v_mfma_f32_16x16x32_bf16 v[100:103], a[96:99], a[232:235], v[100:103]
    s_waitcnt lgkmcnt(12)
    v_mfma_f32_16x16x32_bf16 v[108:111], a[104:107], a[232:235], v[108:111]
    ds_read_b64_tr_b16 a[136:137], v41 offset:0
    ds_read_b64_tr_b16 a[138:139], v41 offset:4096
    v_mfma_f32_16x16x32_bf16 v[108:111], a[108:111], a[236:239], v[108:111]
    buffer_load_dwordx4 a[52:55], v12, s[12:15], s42 offen offset:2048 sc1
    v_mfma_f32_16x16x32_bf16 v[104:107], a[108:111], a[228:231], v[104:107]
    ds_read_b64_tr_b16 a[140:141], v41 offset:8192
    ds_read_b64_tr_b16 a[142:143], v41 offset:12288
    v_mfma_f32_16x16x32_bf16 v[104:107], a[104:107], a[224:227], v[104:107]
    s_waitcnt lgkmcnt(12)
    v_mfma_f32_16x16x32_bf16 v[112:115], a[112:115], a[224:227], v[112:115]
    ds_read_b64_tr_b16 a[144:145], v42 offset:0
    ds_read_b64_tr_b16 a[146:147], v42 offset:4096
    v_mfma_f32_16x16x32_bf16 v[112:115], a[116:119], a[228:231], v[112:115]
    v_mfma_f32_16x16x32_bf16 v[116:119], a[116:119], a[236:239], v[116:119]
    ds_read_b64_tr_b16 a[148:149], v42 offset:8192
    ds_read_b64_tr_b16 a[150:151], v42 offset:12288
    v_mfma_f32_16x16x32_bf16 v[116:119], a[112:115], a[232:235], v[116:119]
    s_waitcnt lgkmcnt(12)
    buffer_load_dwordx4 a[56:59], v13, s[12:15], s42 offen offset:0 sc1
    v_mfma_f32_16x16x32_bf16 v[124:127], a[120:123], a[232:235], v[124:127]
    ds_read_b64_tr_b16 a[152:153], v43 offset:0
    ds_read_b64_tr_b16 a[154:155], v43 offset:4096
    v_mfma_f32_16x16x32_bf16 v[124:127], a[124:127], a[236:239], v[124:127]
    v_mfma_f32_16x16x32_bf16 v[120:123], a[124:127], a[228:231], v[120:123]
    ds_read_b64_tr_b16 a[156:157], v43 offset:8192
    ds_read_b64_tr_b16 a[158:159], v43 offset:12288
    v_mfma_f32_16x16x32_bf16 v[120:123], a[120:123], a[224:227], v[120:123]
    s_waitcnt lgkmcnt(12)
    v_mfma_f32_16x16x32_bf16 v[96:99], a[128:131], a[240:243], v[96:99]
    ds_read_b64_tr_b16 a[96:97], v40 offset:16384
    ds_read_b64_tr_b16 a[98:99], v40 offset:20480
    v_mfma_f32_16x16x32_bf16 v[96:99], a[132:135], a[244:247], v[96:99]
    buffer_load_dwordx4 a[60:63], v13, s[12:15], s42 offen offset:2048 sc1
    s_add_u32 s42, s42, 4096
    v_mfma_f32_16x16x32_bf16 v[100:103], a[132:135], a[252:255], v[100:103]
    ds_read_b64_tr_b16 a[100:101], v40 offset:24576
    ds_read_b64_tr_b16 a[102:103], v40 offset:28672
    v_mfma_f32_16x16x32_bf16 v[100:103], a[128:131], a[248:251], v[100:103]
    s_waitcnt lgkmcnt(12)
    v_mfma_f32_16x16x32_bf16 v[108:111], a[136:139], a[248:251], v[108:111]
    ds_read_b64_tr_b16 a[104:105], v41 offset:16384
    ds_read_b64_tr_b16 a[106:107], v41 offset:20480
    v_mfma_f32_16x16x32_bf16 v[108:111], a[140:143], a[252:255], v[108:111]
    buffer_load_dwordx4 a[64:67], v12, s[12:15], s42 offen offset:0 sc1
    v_mfma_f32_16x16x32_bf16 v[104:107], a[140:143], a[244:247], v[104:107]
    ds_read_b64_tr_b16 a[108:109], v41 offset:24576
    ds_read_b64_tr_b16 a[110:111], v41 offset:28672
    v_mfma_f32_16x16x32_bf16 v[104:107], a[136:139], a[240:243], v[104:107]
    s_waitcnt lgkmcnt(12)
    v_mfma_f32_16x16x32_bf16 v[112:115], a[144:147], a[240:243], v[112:115]
    ds_read_b64_tr_b16 a[112:113], v42 offset:16384
    ds_read_b64_tr_b16 a[114:115], v42 offset:20480
    v_mfma_f32_16x16x32_bf16 v[112:115], a[148:151], a[244:247], v[112:115]
    buffer_load_dwordx4 a[68:71], v12, s[12:15], s42 offen offset:2048 sc1
    v_mfma_f32_16x16x32_bf16 v[116:119], a[148:151], a[252:255], v[116:119]
    ds_read_b64_tr_b16 a[116:117], v42 offset:24576
    ds_read_b64_tr_b16 a[118:119], v42 offset:28672
    v_mfma_f32_16x16x32_bf16 v[116:119], a[144:147], a[248:251], v[116:119]
    s_waitcnt lgkmcnt(12)
    v_mfma_f32_16x16x32_bf16 v[124:127], a[152:155], a[248:251], v[124:127]
    ds_read_b64_tr_b16 a[120:121], v43 offset:16384
    ds_read_b64_tr_b16 a[122:123], v43 offset:20480
    v_mfma_f32_16x16x32_bf16 v[124:127], a[156:159], a[252:255], v[124:127]
    buffer_load_dwordx4 a[72:75], v13, s[12:15], s42 offen offset:0 sc1
    v_mfma_f32_16x16x32_bf16 v[120:123], a[156:159], a[244:247], v[120:123]
    ds_read_b64_tr_b16 a[124:125], v43 offset:24576
    ds_read_b64_tr_b16 a[126:127], v43 offset:28672
L_pg9:
    s_cbranch_execz L_tramp
    v_mfma_f32_16x16x32_bf16 v[120:123], a[152:155], a[240:243], v[120:123]
    s_waitcnt lgkmcnt(12)
    v_mfma_f32_16x16x32_bf16 v[96:99], a[96:99], v[192:195], v[96:99]
    ds_read_b64_tr_b16 a[128:129], v24 offset:0
    ds_read_b64_tr_b16 a[130:131], v24 offset:4096
    v_mfma_f32_16x16x32_bf16 v[96:99], a[100:103], v[196:199], v[96:99]
    buffer_load_dwordx4 a[76:79], v13, s[12:15], s42 offen offset:2048 sc1
    s_add_u32 s42, s42, 4096
    v_mfma_f32_16x16x32_bf16 v[100:103], a[100:103], v[204:207], v[100:103]
    ds_read_b64_tr_b16 a[132:133], v24 offset:8192
    ds_read_b64_tr_b16 a[134:135], v24 offset:12288
    v_mfma_f32_16x16x32_bf16 v[100:103], a[96:99], v[200:203], v[100:103]
    s_waitcnt lgkmcnt(12)
    v_mfma_f32_16x16x32_bf16 v[108:111], a[104:107], v[200:203], v[108:111]
    ds_read_b64_tr_b16 a[136:137], v25 offset:0
    ds_read_b64_tr_b16 a[138:139], v25 offset:4096
    v_mfma_f32_16x16x32_bf16 v[108:111], a[108:111], v[204:207], v[108:111]
    buffer_load_dwordx4 a[80:83], v12, s[12:15], s42 offen offset:0 sc1
    v_mfma_f32_16x16x32_bf16 v[104:107], a[108:111], v[196:199], v[104:107]
    ds_read_b64_tr_b16 a[140:141], v25 offset:8192
    ds_read_b64_tr_b16 a[142:143], v25 offset:12288
    v_mfma_f32_16x16x32_bf16 v[104:107], a[104:107], v[192:195], v[104:107]
    s_waitcnt lgkmcnt(12)
    v_mfma_f32_16x16x32_bf16 v[112:115], a[112:115], v[192:195], v[112:115]
    ds_read_b64_tr_b16 a[144:145], v26 offset:0
    ds_read_b64_tr_b16 a[146:147], v26 offset:4096
    v_mfma_f32_16x16x32_bf16 v[112:115], a[116:119], v[196:199], v[112:115]
    v_mfma_f32_16x16x32_bf16 v[116:119], a[116:119], v[204:207], v[116:119]
    ds_read_b64_tr_b16 a[148:149], v26 offset:8192
    ds_read_b64_tr_b16 a[150:151], v26 offset:12288
    v_mfma_f32_16x16x32_bf16 v[116:119], a[112:115], v[200:203], v[116:119]
    s_waitcnt lgkmcnt(12)
    buffer_load_dwordx4 a[84:87], v12, s[12:15], s42 offen offset:2048 sc1
    v_mfma_f32_16x16x32_bf16 v[124:127], a[120:123], v[200:203], v[124:127]
    ds_read_b64_tr_b16 a[152:153], v27 offset:0
    ds_read_b64_tr_b16 a[154:155], v27 offset:4096
    v_mfma_f32_16x16x32_bf16 v[124:127], a[124:127], v[204:207], v[124:127]
    v_mfma_f32_16x16x32_bf16 v[120:123], a[124:127], v[196:199], v[120:123]
    ds_read_b64_tr_b16 a[156:157], v27 offset:8192
    ds_read_b64_tr_b16 a[158:159], v27 offset:12288
    v_mfma_f32_16x16x32_bf16 v[120:123], a[120:123], v[192:195], v[120:123]
    s_waitcnt lgkmcnt(12)
    v_mfma_f32_16x16x32_bf16 v[96:99], a[128:131], v[208:211], v[96:99]
    ds_read_b64_tr_b16 a[96:97], v28 offset:49152
    ds_read_b64_tr_b16 a[98:99], v28 offset:53248
    v_mfma_f32_16x16x32_bf16 v[96:99], a[132:135], v[212:215], v[96:99]
    buffer_load_dwordx4 a[88:91], v13, s[12:15], s42 offen offset:0 sc1
    v_mfma_f32_16x16x32_bf16 v[100:103], a[132:135], v[220:223], v[100:103]
    ds_read_b64_tr_b16 a[100:101], v28 offset:57344
    ds_read_b64_tr_b16 a[102:103], v28 offset:61440
    v_mfma_f32_16x16x32_bf16 v[100:103], a[128:131], v[216:219], v[100:103]
    s_waitcnt lgkmcnt(12)
    v_mfma_f32_16x16x32_bf16 v[108:111], a[136:139], v[216:219], v[108:111]
    ds_read_b64_tr_b16 a[104:105], v29 offset:49152
    ds_read_b64_tr_b16 a[106:107], v29 offset:53248
    v_mfma_f32_16x16x32_bf16 v[108:111], a[140:143], v[220:223], v[108:111]
    v_mfma_f32_16x16x32_bf16 v[104:107], a[140:143], v[212:215], v[104:107]
    ds_read_b64_tr_b16 a[108:109], v29 offset:57344
    ds_read_b64_tr_b16 a[110:111], v29 offset:61440
    v_mfma_f32_16x16x32_bf16 v[104:107], a[136:139], v[208:211], v[104:107]
    s_waitcnt lgkmcnt(12)
    v_mfma_f32_16x16x32_bf16 v[112:115], a[144:147], v[208:211], v[112:115]
    ds_read_b64_tr_b16 a[112:113], v30 offset:49152
    ds_read_b64_tr_b16 a[114:115], v30 offset:53248
    v_mfma_f32_16x16x32_bf16 v[112:115], a[148:151], v[212:215], v[112:115]
    buffer_load_dwordx4 a[92:95], v13, s[12:15], s42 offen offset:2048 sc1
    s_add_u32 s42, s42, 4096
    v_mfma_f32_16x16x32_bf16 v[116:119], a[148:151], v[220:223], v[116:119]
    ds_read_b64_tr_b16 a[116:117], v30 offset:57344
    ds_read_b64_tr_b16 a[118:119], v30 offset:61440
    v_mfma_f32_16x16x32_bf16 v[116:119], a[144:147], v[216:219], v[116:119]
    s_waitcnt lgkmcnt(12)
    v_mfma_f32_16x16x32_bf16 v[124:127], a[152:155], v[216:219], v[124:127]
    ds_read_b64_tr_b16 a[120:121], v31 offset:49152
    ds_read_b64_tr_b16 a[122:123], v31 offset:53248
    v_mfma_f32_16x16x32_bf16 v[124:127], a[156:159], v[220:223], v[124:127]
    v_mfma_f32_16x16x32_bf16 v[120:123], a[156:159], v[212:215], v[120:123]
    ds_read_b64_tr_b16 a[124:125], v31 offset:57344
    ds_read_b64_tr_b16 a[126:127], v31 offset:61440
    v_mfma_f32_16x16x32_bf16 v[120:123], a[152:155], v[208:211], v[120:123]
    s_waitcnt lgkmcnt(12)
    v_mfma_f32_16x16x32_bf16 v[128:131], a[96:99], v[224:227], v[128:131]
    ds_read_b64_tr_b16 a[128:129], v36 offset:0
    ds_read_b64_tr_b16 a[130:131], v36 offset:4096
    v_cvt_pk_bf16_f32 v96, v96, v97
    v_mfma_f32_16x16x32_bf16 v[128:131], a[100:103], v[228:231], v[128:131]
    v_cvt_pk_bf16_f32 v97, v98, v99
    v_mfma_f32_16x16x32_bf16 v[132:135], a[100:103], v[236:239], v[132:135]
    ds_read_b64_tr_b16 a[132:133], v36 offset:8192
    ds_read_b64_tr_b16 a[134:135], v36 offset:12288
    v_cvt_pk_bf16_f32 v98, v100, v101
    v_mfma_f32_16x16x32_bf16 v[132:135], a[96:99], v[232:235], v[132:135]
    s_waitcnt lgkmcnt(12)
    v_cvt_pk_bf16_f32 v99, v102, v103
    buffer_store_dwordx4 v[96:99], v6, s[12:15], s53 offen offset:0 sc1
    v_mfma_f32_16x16x32_bf16 v[140:143], a[104:107], v[232:235], v[140:143]
    ds_read_b64_tr_b16 a[136:137], v37 offset:0
    ds_read_b64_tr_b16 a[138:139], v37 offset:4096
    v_cvt_pk_bf16_f32 v100, v104, v105
    v_mfma_f32_16x16x32_bf16 v[140:143], a[108:111], v[236:239], v[140:143]
    v_cvt_pk_bf16_f32 v101, v106, v107
    v_mfma_f32_16x16x32_bf16 v[136:139], a[108:111], v[228:231], v[136:139]
    ds_read_b64_tr_b16 a[140:141], v37 offset:8192
    ds_read_b64_tr_b16 a[142:143], v37 offset:12288
    v_cvt_pk_bf16_f32 v102, v108, v109
    v_mfma_f32_16x16x32_bf16 v[136:139], a[104:107], v[224:227], v[136:139]
    s_waitcnt lgkmcnt(12)
    v_cvt_pk_bf16_f32 v103, v110, v111
    buffer_store_dwordx4 v[100:103], v6, s[12:15], s53 offen offset:1024 sc1
    v_mfma_f32_16x16x32_bf16 v[144:147], a[112:115], v[224:227], v[144:147]
    ds_read_b64_tr_b16 a[144:145], v38 offset:0
    ds_read_b64_tr_b16 a[146:147], v38 offset:4096
    v_cvt_pk_bf16_f32 v104, v112, v113
    v_mfma_f32_16x16x32_bf16 v[144:147], a[116:119], v[228:231], v[144:147]
    v_cvt_pk_bf16_f32 v105, v114, v115
    v_mfma_f32_16x16x32_bf16 v[148:151], a[116:119], v[236:239], v[148:151]
    ds_read_b64_tr_b16 a[148:149], v38 offset:8192
    ds_read_b64_tr_b16 a[150:151], v38 offset:12288
    v_cvt_pk_bf16_f32 v106, v116, v117
    v_mfma_f32_16x16x32_bf16 v[148:151], a[112:115], v[232:235], v[148:151]
    s_waitcnt lgkmcnt(12)
    v_cvt_pk_bf16_f32 v107, v118, v119
    buffer_store_dwordx4 v[104:107], v6, s[12:15], s53 offen offset:2048 sc1
    v_mfma_f32_16x16x32_bf16 v[156:159], a[120:123], v[232:235], v[156:159]
    ds_read_b64_tr_b16 a[152:153], v39 offset:0
    ds_read_b64_tr_b16 a[154:155], v39 offset:4096
    v_cvt_pk_bf16_f32 v108, v120, v121
    v_mfma_f32_16x16x32_bf16 v[156:159], a[124:127], v[236:239], v[156:159]
    v_cvt_pk_bf16_f32 v109, v122, v123
    v_mfma_f32_16x16x32_bf16 v[152:155], a[124:127], v[228:231], v[152:155]
    ds_read_b64_tr_b16 a[156:157], v39 offset:8192
    ds_read_b64_tr_b16 a[158:159], v39 offset:12288
    v_cvt_pk_bf16_f32 v110, v124, v125
    v_mfma_f32_16x16x32_bf16 v[152:155], a[120:123], v[224:227], v[152:155]
    v_cvt_pk_bf16_f32 v111, v126, v127
    buffer_store_dwordx4 v[108:111], v6, s[12:15], s53 offen offset:3072 sc1
    s_waitcnt lgkmcnt(12)
    v_mfma_f32_16x16x32_bf16 v[128:131], a[128:131], v[240:243], v[128:131]
    v_mov_b32 v18, 0
    s_mov_b64 exec, 1
    buffer_atomic_or v18, v14, s[12:15], s38 offen offset:0 sc0 sc1
    s_mov_b64 exec, -1
    ds_read_b64_tr_b16 a[96:97], v36 offset:16384
    ds_read_b64_tr_b16 a[98:99], v36 offset:20480
    v_mfma_f32_16x16x32_bf16 v[128:131], a[132:135], v[244:247], v[128:131]
    v_mfma_f32_16x16x32_bf16 v[132:135], a[132:135], v[252:255], v[132:135]
    ds_read_b64_tr_b16 a[100:101], v36 offset:24576
    ds_read_b64_tr_b16 a[102:103], v36 offset:28672
    v_mfma_f32_16x16x32_bf16 v[132:135], a[128:131], v[248:251], v[132:135]
    s_waitcnt lgkmcnt(12)
    v_mfma_f32_16x16x32_bf16 v[140:143], a[136:139], v[248:251], v[140:143]
    ds_read_b64_tr_b16 a[104:105], v37 offset:16384
    ds_read_b64_tr_b16 a[106:107], v37 offset:20480
    v_mfma_f32_16x16x32_bf16 v[140:143], a[140:143], v[252:255], v[140:143]
    v_mfma_f32_16x16x32_bf16 v[136:139], a[140:143], v[244:247], v[136:139]
    ds_read_b64_tr_b16 a[108:109], v37 offset:24576
    ds_read_b64_tr_b16 a[110:111], v37 offset:28672
    v_mfma_f32_16x16x32_bf16 v[136:139], a[136:139], v[240:243], v[136:139]
    s_waitcnt lgkmcnt(12)
    v_mfma_f32_16x16x32_bf16 v[144:147], a[144:147], v[240:243], v[144:147]
    ds_read_b64_tr_b16 a[112:113], v38 offset:16384
    ds_read_b64_tr_b16 a[114:115], v38 offset:20480
    v_mfma_f32_16x16x32_bf16 v[144:147], a[148:151], v[244:247], v[144:147]
    v_mfma_f32_16x16x32_bf16 v[148:151], a[148:151], v[252:255], v[148:151]
    ds_read_b64_tr_b16 a[116:117], v38 offset:24576
    ds_read_b64_tr_b16 a[118:119], v38 offset:28672
    v_mfma_f32_16x16x32_bf16 v[148:151], a[144:147], v[248:251], v[148:151]
    s_waitcnt lgkmcnt(12)
    v_mfma_f32_16x16x32_bf16 v[156:159], a[152:155], v[248:251], v[156:159]
    ds_read_b64_tr_b16 a[120:121], v39 offset:16384
    ds_read_b64_tr_b16 a[122:123], v39 offset:20480
    v_mfma_f32_16x16x32_bf16 v[156:159], a[156:159], v[252:255], v[156:159]
    v_mfma_f32_16x16x32_bf16 v[152:155], a[156:159], v[244:247], v[152:155]
    ds_read_b64_tr_b16 a[124:125], v39 offset:24576
    ds_read_b64_tr_b16 a[126:127], v39 offset:28672
    v_mfma_f32_16x16x32_bf16 v[152:155], a[152:155], v[240:243], v[152:155]
    s_waitcnt lgkmcnt(12)
    v_mfma_f32_16x16x32_bf16 v[128:131], a[96:99], a[0:3], v[128:131]
    ds_read_b64_tr_b16 a[128:129], v36 offset:32768
    ds_read_b64_tr_b16 a[130:131], v36 offset:36864
    v_mfma_f32_16x16x32_bf16 v[128:131], a[100:103], a[4:7], v[128:131]
    v_mfma_f32_16x16x32_bf16 v[132:135], a[100:103], a[12:15], v[132:135]
    ds_read_b64_tr_b16 a[132:133], v36 offset:40960
    ds_read_b64_tr_b16 a[134:135], v36 offset:45056
    v_mfma_f32_16x16x32_bf16 v[132:135], a[96:99], a[8:11], v[132:135]
    s_waitcnt lgkmcnt(12)
    v_mfma_f32_16x16x32_bf16 v[140:143], a[104:107], a[8:11], v[140:143]
    ds_read_b64_tr_b16 a[136:137], v37 offset:32768
    ds_read_b64_tr_b16 a[138:139], v37 offset:36864
    v_mfma_f32_16x16x32_bf16 v[140:143], a[108:111], a[12:15], v[140:143]
    v_mfma_f32_16x16x32_bf16 v[136:139], a[108:111], a[4:7], v[136:139]
    ds_read_b64_tr_b16 a[140:141], v37 offset:40960
    ds_read_b64_tr_b16 a[142:143], v37 offset:45056
    v_mul_f32 v128, v48, v128
    v_mfma_f32_16x16x32_bf16 v[136:139], a[104:107], a[0:3], v[136:139]
    s_waitcnt lgkmcnt(12)
    v_mul_f32 v129, v48, v129
    v_mfma_f32_16x16x32_bf16 v[144:147], a[112:115], a[0:3], v[144:147]
    ds_read_b64_tr_b16 a[144:145], v38 offset:32768
    ds_read_b64_tr_b16 a[146:147], v38 offset:36864
    v_mul_f32 v130, v48, v130
    v_mfma_f32_16x16x32_bf16 v[144:147], a[116:119], a[4:7], v[144:147]
    v_mul_f32 v131, v48, v131
    v_mfma_f32_16x16x32_bf16 v[148:151], a[116:119], a[12:15], v[148:151]
    ds_read_b64_tr_b16 a[148:149], v38 offset:40960
    ds_read_b64_tr_b16 a[150:151], v38 offset:45056
    v_mul_f32 v132, v49, v132
    v_mul_f32 v136, v48, v136
    v_mfma_f32_16x16x32_bf16 v[148:151], a[112:115], a[8:11], v[148:151]
    s_waitcnt lgkmcnt(12)
    v_mul_f32 v133, v49, v133
    v_mul_f32 v137, v48, v137
    v_mfma_f32_16x16x32_bf16 v[156:159], a[120:123], a[8:11], v[156:159]
    ds_read_b64_tr_b16 a[152:153], v39 offset:32768
    ds_read_b64_tr_b16 a[154:155], v39 offset:36864
    v_mul_f32 v134, v49, v134
    v_mul_f32 v138, v48, v138
    v_mfma_f32_16x16x32_bf16 v[156:159], a[124:127], a[12:15], v[156:159]
    v_mul_f32 v135, v49, v135
    v_mul_f32 v139, v48, v139
    v_mfma_f32_16x16x32_bf16 v[152:155], a[124:127], a[4:7], v[152:155]
    ds_read_b64_tr_b16 a[156:157], v39 offset:40960
    ds_read_b64_tr_b16 a[158:159], v39 offset:45056
    v_mul_f32 v140, v49, v140
    v_mul_f32 v144, v48, v144
    v_mfma_f32_16x16x32_bf16 v[152:155], a[120:123], a[0:3], v[152:155]
    v_mul_f32 v141, v49, v141
    v_mul_f32 v145, v48, v145
    s_waitcnt vmcnt(22) lgkmcnt(12)
    v_mfma_f32_16x16x32_bf16 v[128:131], a[128:131], a[16:19], v[128:131]
    ds_read_b64_tr_b16 a[96:97], v36 offset:49152
    ds_read_b64_tr_b16 a[98:99], v36 offset:53248
    v_mul_f32 v142, v49, v142
    v_mul_f32 v146, v48, v146
    v_mfma_f32_16x16x32_bf16 v[128:131], a[132:135], a[20:23], v[128:131]
    v_mul_f32 v143, v49, v143
    v_mul_f32 v147, v48, v147
    v_mfma_f32_16x16x32_bf16 v[132:135], a[132:135], a[28:31], v[132:135]
    ds_read_b64_tr_b16 a[100:101], v36 offset:57344
    ds_read_b64_tr_b16 a[102:103], v36 offset:61440
    v_mul_f32 v148, v49, v148
    v_mul_f32 v152, v48, v152
    v_mfma_f32_16x16x32_bf16 v[132:135], a[128:131], a[24:27], v[132:135]
    s_waitcnt lgkmcnt(12)
    v_mul_f32 v149, v49, v149
    v_mul_f32 v153, v48, v153
    v_mfma_f32_16x16x32_bf16 v[140:143], a[136:139], a[24:27], v[140:143]
    ds_read_b64_tr_b16 a[104:105], v37 offset:49152
    ds_read_b64_tr_b16 a[106:107], v37 offset:53248
    v_mul_f32 v150, v49, v150
    v_mul_f32 v154, v48, v154
    v_mfma_f32_16x16x32_bf16 v[140:143], a[140:143], a[28:31], v[140:143]
    v_mul_f32 v151, v49, v151
    v_mul_f32 v155, v48, v155
    v_mfma_f32_16x16x32_bf16 v[136:139], a[140:143], a[20:23], v[136:139]
    ds_read_b64_tr_b16 a[108:109], v37 offset:57344
    ds_read_b64_tr_b16 a[110:111], v37 offset:61440
    v_mul_f32 v156, v49, v156
    v_mfma_f32_16x16x32_bf16 v[136:139], a[136:139], a[16:19], v[136:139]
    s_waitcnt lgkmcnt(12)
    v_mul_f32 v157, v49, v157
    v_mfma_f32_16x16x32_bf16 v[144:147], a[144:147], a[16:19], v[144:147]
    ds_read_b64_tr_b16 a[112:113], v38 offset:49152
    ds_read_b64_tr_b16 a[114:115], v38 offset:53248
    v_mul_f32 v158, v49, v158
    v_mfma_f32_16x16x32_bf16 v[144:147], a[148:151], a[20:23], v[144:147]
    v_mul_f32 v159, v49, v159
    v_mfma_f32_16x16x32_bf16 v[148:151], a[148:151], a[28:31], v[148:151]
    s_waitcnt vmcnt(0)
    v_cmp_eq_u32 vcc, 1, v18
    ds_read_b64_tr_b16 a[116:117], v38 offset:57344
    ds_read_b64_tr_b16 a[118:119], v38 offset:61440
    v_mfma_f32_16x16x32_bf16 v[148:151], a[144:147], a[24:27], v[148:151]
    s_waitcnt lgkmcnt(12)
    v_mfma_f32_16x16x32_bf16 v[156:159], a[152:155], a[24:27], v[156:159]
    s_bcnt1_i32_b32 s78, vcc_lo
    ds_read_b64_tr_b16 a[120:121], v39 offset:49152
    ds_read_b64_tr_b16 a[122:123], v39 offset:53248
    v_mfma_f32_16x16x32_bf16 v[156:159], a[156:159], a[28:31], v[156:159]
    v_mfma_f32_16x16x32_bf16 v[152:155], a[156:159], a[20:23], v[152:155]
    s_cmp_lt_u32 s78, 1
    s_cbranch_scc1 L_spin9
L_got9:
    ds_read_b64_tr_b16 a[124:125], v39 offset:57344
    ds_read_b64_tr_b16 a[126:127], v39 offset:61440
    v_mfma_f32_16x16x32_bf16 v[152:155], a[152:155], a[16:19], v[152:155]
    s_waitcnt lgkmcnt(12)
    v_mfma_f32_16x16x32_bf16 v[128:131], a[96:99], a[32:35], v[128:131]
    ds_read_b64_tr_b16 a[128:129], v44 offset:0
    ds_read_b64_tr_b16 a[130:131], v44 offset:4096
    v_mfma_f32_16x16x32_bf16 v[128:131], a[100:103], a[36:39], v[128:131]
    buffer_load_dwordx4 v[176:179], v6, s[12:15], s76 offen offset:0 sc1
    v_mfma_f32_16x16x32_bf16 v[132:135], a[100:103], a[44:47], v[132:135]
    ds_read_b64_tr_b16 a[132:133], v44 offset:8192
    ds_read_b64_tr_b16 a[134:135], v44 offset:12288
    s_mov_b64 exec, 2
    buffer_store_dword v15, v10, s[12:15], 0 offen sc1
    s_mov_b64 exec, -1
    v_mfma_f32_16x16x32_bf16 v[132:135], a[96:99], a[40:43], v[132:135]
    s_waitcnt lgkmcnt(12)
    v_mfma_f32_16x16x32_bf16 v[140:143], a[104:107], a[40:43], v[140:143]
    ds_read_b64_tr_b16 a[136:137], v45 offset:0
    ds_read_b64_tr_b16 a[138:139], v45 offset:4096
    v_mfma_f32_16x16x32_bf16 v[140:143], a[108:111], a[44:47], v[140:143]
    buffer_load_dwordx4 v[180:183], v6, s[12:15], s76 offen offset:1024 sc1
    v_mfma_f32_16x16x32_bf16 v[136:139], a[108:111], a[36:39], v[136:139]
    ds_read_b64_tr_b16 a[140:141], v45 offset:8192
    ds_read_b64_tr_b16 a[142:143], v45 offset:12288
    v_mfma_f32_16x16x32_bf16 v[136:139], a[104:107], a[32:35], v[136:139]
    s_waitcnt lgkmcnt(12)
    v_mfma_f32_16x16x32_bf16 v[144:147], a[112:115], a[32:35], v[144:147]
    ds_read_b64_tr_b16 a[144:145], v46 offset:0
    ds_read_b64_tr_b16 a[146:147], v46 offset:4096
    v_mfma_f32_16x16x32_bf16 v[144:147], a[116:119], a[36:39], v[144:147]
    buffer_load_dwordx4 v[184:187], v6, s[12:15], s76 offen offset:2048 sc1
    v_mfma_f32_16x16x32_bf16 v[148:151], a[116:119], a[44:47], v[148:151]
    ds_read_b64_tr_b16 a[148:149], v46 offset:8192
    ds_read_b64_tr_b16 a[150:151], v46 offset:12288
    v_mfma_f32_16x16x32_bf16 v[148:151], a[112:115], a[40:43], v[148:151]
    s_waitcnt lgkmcnt(12)
    v_mfma_f32_16x16x32_bf16 v[156:159], a[120:123], a[40:43], v[156:159]
    ds_read_b64_tr_b16 a[152:153], v47 offset:0
    ds_read_b64_tr_b16 a[154:155], v47 offset:4096
    v_mfma_f32_16x16x32_bf16 v[156:159], a[124:127], a[44:47], v[156:159]
    buffer_load_dwordx4 v[188:191], v6, s[12:15], s76 offen offset:3072 sc1
    v_mfma_f32_16x16x32_bf16 v[152:155], a[124:127], a[36:39], v[152:155]
    ds_read_b64_tr_b16 a[156:157], v47 offset:8192
    ds_read_b64_tr_b16 a[158:159], v47 offset:12288
    v_mfma_f32_16x16x32_bf16 v[152:155], a[120:123], a[32:35], v[152:155]
    s_waitcnt lgkmcnt(12)
    v_mfma_f32_16x16x32_bf16 v[128:131], a[128:131], a[48:51], v[128:131]
    ds_read_b64_tr_b16 a[96:97], v44 offset:16384
    ds_read_b64_tr_b16 a[98:99], v44 offset:20480
    v_mfma_f32_16x16x32_bf16 v[128:131], a[132:135], a[52:55], v[128:131]
    v_mfma_f32_16x16x32_bf16 v[132:135], a[132:135], a[60:63], v[132:135]
    ds_read_b64_tr_b16 a[100:101], v44 offset:24576
    ds_read_b64_tr_b16 a[102:103], v44 offset:28672
    v_mfma_f32_16x16x32_bf16 v[132:135], a[128:131], a[56:59], v[132:135]
    s_waitcnt lgkmcnt(12)
    v_mfma_f32_16x16x32_bf16 v[140:143], a[136:139], a[56:59], v[140:143]
    ds_read_b64_tr_b16 a[104:105], v45 offset:16384
    ds_read_b64_tr_b16 a[106:107], v45 offset:20480
    v_mfma_f32_16x16x32_bf16 v[140:143], a[140:143], a[60:63], v[140:143]
    v_mfma_f32_16x16x32_bf16 v[136:139], a[140:143], a[52:55], v[136:139]
    ds_read_b64_tr_b16 a[108:109], v45 offset:24576
    ds_read_b64_tr_b16 a[110:111], v45 offset:28672
    v_mfma_f32_16x16x32_bf16 v[136:139], a[136:139], a[48:51], v[136:139]
    s_waitcnt lgkmcnt(12)
    v_mfma_f32_16x16x32_bf16 v[144:147], a[144:147], a[48:51], v[144:147]
    ds_read_b64_tr_b16 a[112:113], v46 offset:16384
    ds_read_b64_tr_b16 a[114:115], v46 offset:20480
    v_mfma_f32_16x16x32_bf16 v[144:147], a[148:151], a[52:55], v[144:147]
    v_mfma_f32_16x16x32_bf16 v[148:151], a[148:151], a[60:63], v[148:151]
    ds_read_b64_tr_b16 a[116:117], v46 offset:24576
    ds_read_b64_tr_b16 a[118:119], v46 offset:28672
    v_mfma_f32_16x16x32_bf16 v[148:151], a[144:147], a[56:59], v[148:151]
    s_waitcnt lgkmcnt(12)
    v_mfma_f32_16x16x32_bf16 v[156:159], a[152:155], a[56:59], v[156:159]
    ds_read_b64_tr_b16 a[120:121], v47 offset:16384
    ds_read_b64_tr_b16 a[122:123], v47 offset:20480
    v_mfma_f32_16x16x32_bf16 v[156:159], a[156:159], a[60:63], v[156:159]
    v_mfma_f32_16x16x32_bf16 v[152:155], a[156:159], a[52:55], v[152:155]
    ds_read_b64_tr_b16 a[124:125], v47 offset:24576
    ds_read_b64_tr_b16 a[126:127], v47 offset:28672
    v_mfma_f32_16x16x32_bf16 v[152:155], a[152:155], a[48:51], v[152:155]
    s_waitcnt lgkmcnt(12)
    v_mfma_f32_16x16x32_bf16 v[128:131], a[96:99], a[64:67], v[128:131]
    ds_read_b64_tr_b16 a[128:129], v28 offset:0
    ds_read_b64_tr_b16 a[130:131], v28 offset:4096
    v_mfma_f32_16x16x32_bf16 v[128:131], a[100:103], a[68:71], v[128:131]
    v_mfma_f32_16x16x32_bf16 v[132:135], a[100:103], a[76:79], v[132:135]
    ds_read_b64_tr_b16 a[132:133], v28 offset:8192
    ds_read_b64_tr_b16 a[134:135], v28 offset:12288
    v_mfma_f32_16x16x32_bf16 v[132:135], a[96:99], a[72:75], v[132:135]
    s_waitcnt lgkmcnt(12)
    v_mfma_f32_16x16x32_bf16 v[140:143], a[104:107], a[72:75], v[140:143]
    ds_read_b64_tr_b16 a[136:137], v29 offset:0
    ds_read_b64_tr_b16 a[138:139], v29 offset:4096
    v_mfma_f32_16x16x32_bf16 v[140:143], a[108:111], a[76:79], v[140:143]
    v_mfma_f32_16x16x32_bf16 v[136:139], a[108:111], a[68:71], v[136:139]
    ds_read_b64_tr_b16 a[140:141], v29 offset:8192
    ds_read_b64_tr_b16 a[142:143], v29 offset:12288
    v_mfma_f32_16x16x32_bf16 v[136:139], a[104:107], a[64:67], v[136:139]
    s_waitcnt lgkmcnt(12)
    v_mfma_f32_16x16x32_bf16 v[144:147], a[112:115], a[64:67], v[144:147]
    ds_read_b64_tr_b16 a[144:145], v30 offset:0
    ds_read_b64_tr_b16 a[146:147], v30 offset:4096
    v_mfma_f32_16x16x32_bf16 v[144:147], a[116:119], a[68:71], v[144:147]
    v_mfma_f32_16x16x32_bf16 v[148:151], a[116:119], a[76:79], v[148:151]
    ds_read_b64_tr_b16 a[148:149], v30 offset:8192
    ds_read_b64_tr_b16 a[150:151], v30 offset:12288
    v_mfma_f32_16x16x32_bf16 v[148:151], a[112:115], a[72:75], v[148:151]
    s_waitcnt lgkmcnt(12)
    v_mfma_f32_16x16x32_bf16 v[156:159], a[120:123], a[72:75], v[156:159]
    ds_read_b64_tr_b16 a[152:153], v31 offset:0
    ds_read_b64_tr_b16 a[154:155], v31 offset:4096
    v_mfma_f32_16x16x32_bf16 v[156:159], a[124:127], a[76:79], v[156:159]
    v_mfma_f32_16x16x32_bf16 v[152:155], a[124:127], a[68:71], v[152:155]
    ds_read_b64_tr_b16 a[156:157], v31 offset:8192
    ds_read_b64_tr_b16 a[158:159], v31 offset:12288
    v_mfma_f32_16x16x32_bf16 v[152:155], a[120:123], a[64:67], v[152:155]
    s_waitcnt lgkmcnt(12)
    v_mfma_f32_16x16x32_bf16 v[128:131], a[128:131], a[80:83], v[128:131]
    ds_read_b64_tr_b16 a[96:97], v24 offset:49152
    ds_read_b64_tr_b16 a[98:99], v24 offset:53248
    v_mfma_f32_16x16x32_bf16 v[128:131], a[132:135], a[84:87], v[128:131]
    v_mfma_f32_16x16x32_bf16 v[132:135], a[132:135], a[92:95], v[132:135]
    ds_read_b64_tr_b16 a[100:101], v24 offset:57344
    ds_read_b64_tr_b16 a[102:103], v24 offset:61440
    v_mfma_f32_16x16x32_bf16 v[132:135], a[128:131], a[88:91], v[132:135]
    s_waitcnt lgkmcnt(12)
    v_mfma_f32_16x16x32_bf16 v[140:143], a[136:139], a[88:91], v[140:143]
    ds_read_b64_tr_b16 a[104:105], v25 offset:49152
    ds_read_b64_tr_b16 a[106:107], v25 offset:53248
    v_mfma_f32_16x16x32_bf16 v[140:143], a[140:143], a[92:95], v[140:143]
    v_mfma_f32_16x16x32_bf16 v[136:139], a[140:143], a[84:87], v[136:139]
    ds_read_b64_tr_b16 a[108:109], v25 offset:57344
    ds_read_b64_tr_b16 a[110:111], v25 offset:61440
    v_mfma_f32_16x16x32_bf16 v[136:139], a[136:139], a[80:83], v[136:139]
    s_waitcnt lgkmcnt(12)
    v_mfma_f32_16x16x32_bf16 v[144:147], a[144:147], a[80:83], v[144:147]
    ds_read_b64_tr_b16 a[112:113], v26 offset:49152
    ds_read_b64_tr_b16 a[114:115], v26 offset:53248
    v_mfma_f32_16x16x32_bf16 v[144:147], a[148:151], a[84:87], v[144:147]
    v_mfma_f32_16x16x32_bf16 v[148:151], a[148:151], a[92:95], v[148:151]
    ds_read_b64_tr_b16 a[116:117], v26 offset:57344
    ds_read_b64_tr_b16 a[118:119], v26 offset:61440
    v_mfma_f32_16x16x32_bf16 v[148:151], a[144:147], a[88:91], v[148:151]
    s_waitcnt lgkmcnt(12)
    v_mfma_f32_16x16x32_bf16 v[156:159], a[152:155], a[88:91], v[156:159]
    ds_read_b64_tr_b16 a[120:121], v27 offset:49152
    ds_read_b64_tr_b16 a[122:123], v27 offset:53248
    v_mfma_f32_16x16x32_bf16 v[156:159], a[156:159], a[92:95], v[156:159]
    v_mfma_f32_16x16x32_bf16 v[152:155], a[156:159], a[84:87], v[152:155]
    ds_read_b64_tr_b16 a[124:125], v27 offset:57344
    ds_read_b64_tr_b16 a[126:127], v27 offset:61440
    v_mfma_f32_16x16x32_bf16 v[152:155], a[152:155], a[80:83], v[152:155]
    s_waitcnt lgkmcnt(12)
    v_mfma_f32_16x16x32_bf16 v[64:67], a[96:99], v[224:227], v[64:67]
    ds_read_b64_tr_b16 a[128:129], v32 offset:0
    ds_read_b64_tr_b16 a[130:131], v32 offset:4096
    v_cvt_pk_bf16_f32 v128, v128, v129
    v_mfma_f32_16x16x32_bf16 v[64:67], a[100:103], v[228:231], v[64:67]
    v_cvt_pk_bf16_f32 v129, v130, v131
    v_mfma_f32_16x16x32_bf16 v[68:71], a[100:103], v[236:239], v[68:71]
    ds_read_b64_tr_b16 a[132:133], v32 offset:8192
    ds_read_b64_tr_b16 a[134:135], v32 offset:12288
    v_cvt_pk_bf16_f32 v130, v132, v133
    v_mfma_f32_16x16x32_bf16 v[68:71], a[96:99], v[232:235], v[68:71]
    s_waitcnt lgkmcnt(12)
    v_cvt_pk_bf16_f32 v131, v134, v135
    buffer_store_dwordx4 v[128:131], v6, s[12:15], s54 offen offset:0 sc1
    v_mfma_f32_16x16x32_bf16 v[76:79], a[104:107], v[232:235], v[76:79]
    ds_read_b64_tr_b16 a[136:137], v33 offset:0
    ds_read_b64_tr_b16 a[138:139], v33 offset:4096
    v_cvt_pk_bf16_f32 v132, v136, v137
    v_mfma_f32_16x16x32_bf16 v[76:79], a[108:111], v[236:239], v[76:79]
    v_cvt_pk_bf16_f32 v133, v138, v139
    v_mfma_f32_16x16x32_bf16 v[72:75], a[108:111], v[228:231], v[72:75]
    ds_read_b64_tr_b16 a[140:141], v33 offset:8192
    ds_read_b64_tr_b16 a[142:143], v33 offset:12288
    v_cvt_pk_bf16_f32 v134, v140, v141
    v_mfma_f32_16x16x32_bf16 v[72:75], a[104:107], v[224:227], v[72:75]
    s_waitcnt lgkmcnt(12)
    v_cvt_pk_bf16_f32 v135, v142, v143
    buffer_store_dwordx4 v[132:135], v6, s[12:15], s54 offen offset:1024 sc1
    v_mfma_f32_16x16x32_bf16 v[80:83], a[112:115], v[224:227], v[80:83]
    ds_read_b64_tr_b16 a[144:145], v34 offset:0
    ds_read_b64_tr_b16 a[146:147], v34 offset:4096
    v_cvt_pk_bf16_f32 v136, v144, v145
    v_mfma_f32_16x16x32_bf16 v[80:83], a[116:119], v[228:231], v[80:83]
    v_cvt_pk_bf16_f32 v137, v146, v147
    v_mfma_f32_16x16x32_bf16 v[84:87], a[116:119], v[236:239], v[84:87]
    ds_read_b64_tr_b16 a[148:149], v34 offset:8192
    ds_read_b64_tr_b16 a[150:151], v34 offset:12288
    v_cvt_pk_bf16_f32 v138, v148, v149
    v_mfma_f32_16x16x32_bf16 v[84:87], a[112:115], v[232:235], v[84:87]
    s_waitcnt lgkmcnt(12)
    v_cvt_pk_bf16_f32 v139, v150, v151
    buffer_store_dwordx4 v[136:139], v6, s[12:15], s54 offen offset:2048 sc1
    v_mfma_f32_16x16x32_bf16 v[92:95], a[120:123], v[232:235], v[92:95]
    ds_read_b64_tr_b16 a[152:153], v35 offset:0
    ds_read_b64_tr_b16 a[154:155], v35 offset:4096
    v_cvt_pk_bf16_f32 v140, v152, v153
    v_mfma_f32_16x16x32_bf16 v[92:95], a[124:127], v[236:239], v[92:95]
    v_cvt_pk_bf16_f32 v141, v154, v155
    v_mfma_f32_16x16x32_bf16 v[88:91], a[124:127], v[228:231], v[88:91]
    ds_read_b64_tr_b16 a[156:157], v35 offset:8192
    ds_read_b64_tr_b16 a[158:159], v35 offset:12288
    v_cvt_pk_bf16_f32 v142, v156, v157
    v_mfma_f32_16x16x32_bf16 v[88:91], a[120:123], v[224:227], v[88:91]
    v_cvt_pk_bf16_f32 v143, v158, v159
    buffer_store_dwordx4 v[140:143], v6, s[12:15], s54 offen offset:3072 sc1
    s_waitcnt lgkmcnt(12)
    v_mfma_f32_16x16x32_bf16 v[64:67], a[128:131], v[240:243], v[64:67]
    v_mov_b32 v18, 0
    s_mov_b64 exec, 1
    buffer_atomic_or v18, v14, s[12:15], s38 offen offset:4 sc0 sc1
    s_mov_b64 exec, -1
    ds_read_b64_tr_b16 a[96:97], v32 offset:16384
    ds_read_b64_tr_b16 a[98:99], v32 offset:20480
    v_mfma_f32_16x16x32_bf16 v[64:67], a[132:135], v[244:247], v[64:67]
    v_mfma_f32_16x16x32_bf16 v[68:71], a[132:135], v[252:255], v[68:71]
    ds_read_b64_tr_b16 a[100:101], v32 offset:24576
    ds_read_b64_tr_b16 a[102:103], v32 offset:28672
    v_mfma_f32_16x16x32_bf16 v[68:71], a[128:131], v[248:251], v[68:71]
    s_waitcnt lgkmcnt(12)
    v_mfma_f32_16x16x32_bf16 v[76:79], a[136:139], v[248:251], v[76:79]
    ds_read_b64_tr_b16 a[104:105], v33 offset:16384
    ds_read_b64_tr_b16 a[106:107], v33 offset:20480
    v_mfma_f32_16x16x32_bf16 v[76:79], a[140:143], v[252:255], v[76:79]
    v_mfma_f32_16x16x32_bf16 v[72:75], a[140:143], v[244:247], v[72:75]
    ds_read_b64_tr_b16 a[108:109], v33 offset:24576
    ds_read_b64_tr_b16 a[110:111], v33 offset:28672
    v_mfma_f32_16x16x32_bf16 v[72:75], a[136:139], v[240:243], v[72:75]
    s_waitcnt lgkmcnt(12)
    v_mfma_f32_16x16x32_bf16 v[80:83], a[144:147], v[240:243], v[80:83]
    ds_read_b64_tr_b16 a[112:113], v34 offset:16384
    ds_read_b64_tr_b16 a[114:115], v34 offset:20480
    v_mfma_f32_16x16x32_bf16 v[80:83], a[148:151], v[244:247], v[80:83]
    v_mfma_f32_16x16x32_bf16 v[84:87], a[148:151], v[252:255], v[84:87]
    ds_read_b64_tr_b16 a[116:117], v34 offset:24576
    ds_read_b64_tr_b16 a[118:119], v34 offset:28672
    v_mfma_f32_16x16x32_bf16 v[84:87], a[144:147], v[248:251], v[84:87]
    s_waitcnt lgkmcnt(12)
    v_mfma_f32_16x16x32_bf16 v[92:95], a[152:155], v[248:251], v[92:95]
    ds_read_b64_tr_b16 a[120:121], v35 offset:16384
    ds_read_b64_tr_b16 a[122:123], v35 offset:20480
    v_mfma_f32_16x16x32_bf16 v[92:95], a[156:159], v[252:255], v[92:95]
    v_mfma_f32_16x16x32_bf16 v[88:91], a[156:159], v[244:247], v[88:91]
    ds_read_b64_tr_b16 a[124:125], v35 offset:24576
    ds_read_b64_tr_b16 a[126:127], v35 offset:28672
    v_mfma_f32_16x16x32_bf16 v[88:91], a[152:155], v[240:243], v[88:91]
    s_waitcnt lgkmcnt(12)
    v_mfma_f32_16x16x32_bf16 v[64:67], a[96:99], a[0:3], v[64:67]
    ds_read_b64_tr_b16 a[128:129], v32 offset:32768
    ds_read_b64_tr_b16 a[130:131], v32 offset:36864
    v_mfma_f32_16x16x32_bf16 v[64:67], a[100:103], a[4:7], v[64:67]
    v_mfma_f32_16x16x32_bf16 v[68:71], a[100:103], a[12:15], v[68:71]
    ds_read_b64_tr_b16 a[132:133], v32 offset:40960
    ds_read_b64_tr_b16 a[134:135], v32 offset:45056
    v_mfma_f32_16x16x32_bf16 v[68:71], a[96:99], a[8:11], v[68:71]
    s_waitcnt lgkmcnt(12)
    v_mfma_f32_16x16x32_bf16 v[76:79], a[104:107], a[8:11], v[76:79]
    ds_read_b64_tr_b16 a[136:137], v33 offset:32768
    ds_read_b64_tr_b16 a[138:139], v33 offset:36864
    v_mfma_f32_16x16x32_bf16 v[76:79], a[108:111], a[12:15], v[76:79]
    v_mfma_f32_16x16x32_bf16 v[72:75], a[108:111], a[4:7], v[72:75]
    ds_read_b64_tr_b16 a[140:141], v33 offset:40960
    ds_read_b64_tr_b16 a[142:143], v33 offset:45056
    v_mul_f32 v64, v48, v64
    v_mfma_f32_16x16x32_bf16 v[72:75], a[104:107], a[0:3], v[72:75]
    s_waitcnt lgkmcnt(12)
    v_mul_f32 v65, v48, v65
    v_mfma_f32_16x16x32_bf16 v[80:83], a[112:115], a[0:3], v[80:83]
    ds_read_b64_tr_b16 a[144:145], v34 offset:32768
    ds_read_b64_tr_b16 a[146:147], v34 offset:36864
    v_mul_f32 v66, v48, v66
    v_mfma_f32_16x16x32_bf16 v[80:83], a[116:119], a[4:7], v[80:83]
    v_mul_f32 v67, v48, v67
    v_mfma_f32_16x16x32_bf16 v[84:87], a[116:119], a[12:15], v[84:87]
    ds_read_b64_tr_b16 a[148:149], v34 offset:40960
L_pg10:
    s_cbranch_execz L_tramp
    ds_read_b64_tr_b16 a[150:151], v34 offset:45056
    v_mul_f32 v68, v49, v68
    v_mul_f32 v72, v48, v72
    v_mfma_f32_16x16x32_bf16 v[84:87], a[112:115], a[8:11], v[84:87]
    s_waitcnt lgkmcnt(12)
    v_mul_f32 v69, v49, v69
    v_mul_f32 v73, v48, v73
    v_mfma_f32_16x16x32_bf16 v[92:95], a[120:123], a[8:11], v[92:95]
    ds_read_b64_tr_b16 a[152:153], v35 offset:32768
    ds_read_b64_tr_b16 a[154:155], v35 offset:36864
    v_mul_f32 v70, v49, v70
    v_mul_f32 v74, v48, v74
    v_mfma_f32_16x16x32_bf16 v[92:95], a[124:127], a[12:15], v[92:95]
    v_mul_f32 v71, v49, v71
    v_mul_f32 v75, v48, v75
    v_mfma_f32_16x16x32_bf16 v[88:91], a[124:127], a[4:7], v[88:91]
    ds_read_b64_tr_b16 a[156:157], v35 offset:40960
    ds_read_b64_tr_b16 a[158:159], v35 offset:45056
    v_mul_f32 v76, v49, v76
    v_mul_f32 v80, v48, v80
    v_mfma_f32_16x16x32_bf16 v[88:91], a[120:123], a[0:3], v[88:91]
    v_mul_f32 v77, v49, v77
    v_mul_f32 v81, v48, v81
    s_waitcnt lgkmcnt(12)
    v_mfma_f32_16x16x32_bf16 v[64:67], a[128:131], a[16:19], v[64:67]
    ds_read_b64_tr_b16 a[96:97], v32 offset:49152
    ds_read_b64_tr_b16 a[98:99], v32 offset:53248
    v_mul_f32 v78, v49, v78
    v_mul_f32 v82, v48, v82
    v_mfma_f32_16x16x32_bf16 v[64:67], a[132:135], a[20:23], v[64:67]
    v_mul_f32 v79, v49, v79
    v_mul_f32 v83, v48, v83
    v_mfma_f32_16x16x32_bf16 v[68:71], a[132:135], a[28:31], v[68:71]
    ds_read_b64_tr_b16 a[100:101], v32 offset:57344
    ds_read_b64_tr_b16 a[102:103], v32 offset:61440
    v_mul_f32 v84, v49, v84
    v_mul_f32 v88, v48, v88
    v_mfma_f32_16x16x32_bf16 v[68:71], a[128:131], a[24:27], v[68:71]
    s_waitcnt lgkmcnt(12)
    v_mul_f32 v85, v49, v85
    v_mul_f32 v89, v48, v89
    v_mfma_f32_16x16x32_bf16 v[76:79], a[136:139], a[24:27], v[76:79]
    ds_read_b64_tr_b16 a[104:105], v33 offset:49152
    ds_read_b64_tr_b16 a[106:107], v33 offset:53248
    v_mul_f32 v86, v49, v86
    v_mul_f32 v90, v48, v90
    v_mfma_f32_16x16x32_bf16 v[76:79], a[140:143], a[28:31], v[76:79]
    v_mul_f32 v87, v49, v87
    v_mul_f32 v91, v48, v91
    v_mfma_f32_16x16x32_bf16 v[72:75], a[140:143], a[20:23], v[72:75]
    ds_read_b64_tr_b16 a[108:109], v33 offset:57344
    ds_read_b64_tr_b16 a[110:111], v33 offset:61440
    v_mul_f32 v92, v49, v92
    v_mfma_f32_16x16x32_bf16 v[72:75], a[136:139], a[16:19], v[72:75]
    s_waitcnt lgkmcnt(12)
    v_mul_f32 v93, v49, v93
    v_mfma_f32_16x16x32_bf16 v[80:83], a[144:147], a[16:19], v[80:83]
    ds_read_b64_tr_b16 a[112:113], v34 offset:49152
    ds_read_b64_tr_b16 a[114:115], v34 offset:53248
    v_mul_f32 v94, v49, v94
    v_mfma_f32_16x16x32_bf16 v[80:83], a[148:151], a[20:23], v[80:83]
    v_mul_f32 v95, v49, v95
    v_mfma_f32_16x16x32_bf16 v[84:87], a[148:151], a[28:31], v[84:87]
    ds_read_b64_tr_b16 a[116:117], v34 offset:57344
    ds_read_b64_tr_b16 a[118:119], v34 offset:61440
    v_mfma_f32_16x16x32_bf16 v[84:87], a[144:147], a[24:27], v[84:87]
    s_waitcnt lgkmcnt(12)
    v_mfma_f32_16x16x32_bf16 v[92:95], a[152:155], a[24:27], v[92:95]
    ds_read_b64_tr_b16 a[120:121], v35 offset:49152
    ds_read_b64_tr_b16 a[122:123], v35 offset:53248
    v_mfma_f32_16x16x32_bf16 v[92:95], a[156:159], a[28:31], v[92:95]
    v_mfma_f32_16x16x32_bf16 v[88:91], a[156:159], a[20:23], v[88:91]
    ds_read_b64_tr_b16 a[124:125], v35 offset:57344
    ds_read_b64_tr_b16 a[126:127], v35 offset:61440
    v_mfma_f32_16x16x32_bf16 v[88:91], a[152:155], a[16:19], v[88:91]
    s_waitcnt vmcnt(1)
    s_mov_b64 exec, 4
    buffer_store_dword v15, v10, s[12:15], 0 offen sc1
    s_mov_b64 exec, -1
    s_waitcnt vmcnt(1)
    v_readfirstlane_b32 s78, v18
    s_nop 0
    s_cmp_ge_u32 s78, 1
    s_cbranch_scc1 L_got10
    s_mov_b32 s79, 0
L_spinl10:
    v_mov_b32 v18, 0
    s_mov_b64 exec, 1
    buffer_atomic_or v18, v14, s[12:15], s38 offen offset:4 sc0 sc1
    s_mov_b64 exec, -1
    s_waitcnt vmcnt(0)
    v_readfirstlane_b32 s78, v18
    s_add_u32 s79, s79, 1
    s_cmp_ge_u32 s78, 1
    s_cbranch_scc1 L_got10
    s_cmp_lt_u32 s79, 0x80000
    s_cbranch_scc1 L_spinl10
L_got10:
    s_waitcnt lgkmcnt(12)
    v_mfma_f32_16x16x32_bf16 v[64:67], a[96:99], a[32:35], v[64:67]
    ds_read_b64_tr_b16 a[128:129], v40 offset:0
    ds_read_b64_tr_b16 a[130:131], v40 offset:4096
    v_mfma_f32_16x16x32_bf16 v[64:67], a[100:103], a[36:39], v[64:67]
    buffer_load_dwordx4 v[112:115], v6, s[12:15], s77 offen offset:0 sc1
    v_mfma_f32_16x16x32_bf16 v[68:71], a[100:103], a[44:47], v[68:71]
    ds_read_b64_tr_b16 a[132:133], v40 offset:8192
    ds_read_b64_tr_b16 a[134:135], v40 offset:12288
    v_mfma_f32_16x16x32_bf16 v[68:71], a[96:99], a[40:43], v[68:71]
    s_waitcnt lgkmcnt(12)
    v_mfma_f32_16x16x32_bf16 v[76:79], a[104:107], a[40:43], v[76:79]
    ds_read_b64_tr_b16 a[136:137], v41 offset:0
    ds_read_b64_tr_b16 a[138:139], v41 offset:4096
    v_mfma_f32_16x16x32_bf16 v[76:79], a[108:111], a[44:47], v[76:79]
    buffer_load_dwordx4 v[116:119], v6, s[12:15], s77 offen offset:1024 sc1
    v_mfma_f32_16x16x32_bf16 v[72:75], a[108:111], a[36:39], v[72:75]
    ds_read_b64_tr_b16 a[140:141], v41 offset:8192
    ds_read_b64_tr_b16 a[142:143], v41 offset:12288
    v_mfma_f32_16x16x32_bf16 v[72:75], a[104:107], a[32:35], v[72:75]
    s_waitcnt lgkmcnt(12)
    v_mfma_f32_16x16x32_bf16 v[80:83], a[112:115], a[32:35], v[80:83]
    ds_read_b64_tr_b16 a[144:145], v42 offset:0
    ds_read_b64_tr_b16 a[146:147], v42 offset:4096
    v_mfma_f32_16x16x32_bf16 v[80:83], a[116:119], a[36:39], v[80:83]
    buffer_load_dwordx4 v[120:123], v6, s[12:15], s77 offen offset:2048 sc1
    v_mfma_f32_16x16x32_bf16 v[84:87], a[116:119], a[44:47], v[84:87]
    ds_read_b64_tr_b16 a[148:149], v42 offset:8192
    ds_read_b64_tr_b16 a[150:151], v42 offset:12288
    v_mfma_f32_16x16x32_bf16 v[84:87], a[112:115], a[40:43], v[84:87]
    s_waitcnt lgkmcnt(12)
    v_mfma_f32_16x16x32_bf16 v[92:95], a[120:123], a[40:43], v[92:95]
    ds_read_b64_tr_b16 a[152:153], v43 offset:0
    ds_read_b64_tr_b16 a[154:155], v43 offset:4096
    v_mfma_f32_16x16x32_bf16 v[92:95], a[124:127], a[44:47], v[92:95]
    buffer_load_dwordx4 v[124:127], v6, s[12:15], s77 offen offset:3072 sc1
    v_mfma_f32_16x16x32_bf16 v[88:91], a[124:127], a[36:39], v[88:91]
    ds_read_b64_tr_b16 a[156:157], v43 offset:8192
    ds_read_b64_tr_b16 a[158:159], v43 offset:12288
    v_mfma_f32_16x16x32_bf16 v[88:91], a[120:123], a[32:35], v[88:91]
    s_waitcnt lgkmcnt(12)
    v_mfma_f32_16x16x32_bf16 v[64:67], a[128:131], a[48:51], v[64:67]
    ds_read_b64_tr_b16 a[96:97], v40 offset:16384
    ds_read_b64_tr_b16 a[98:99], v40 offset:20480
    v_mfma_f32_16x16x32_bf16 v[64:67], a[132:135], a[52:55], v[64:67]
    v_mfma_f32_16x16x32_bf16 v[68:71], a[132:135], a[60:63], v[68:71]
    ds_read_b64_tr_b16 a[100:101], v40 offset:24576
    ds_read_b64_tr_b16 a[102:103], v40 offset:28672
    v_mfma_f32_16x16x32_bf16 v[68:71], a[128:131], a[56:59], v[68:71]
    s_waitcnt lgkmcnt(12)
    v_mfma_f32_16x16x32_bf16 v[76:79], a[136:139], a[56:59], v[76:79]
    ds_read_b64_tr_b16 a[104:105], v41 offset:16384
    ds_read_b64_tr_b16 a[106:107], v41 offset:20480
    v_mfma_f32_16x16x32_bf16 v[76:79], a[140:143], a[60:63], v[76:79]
    v_mfma_f32_16x16x32_bf16 v[72:75], a[140:143], a[52:55], v[72:75]
    ds_read_b64_tr_b16 a[108:109], v41 offset:24576
    ds_read_b64_tr_b16 a[110:111], v41 offset:28672
    v_mfma_f32_16x16x32_bf16 v[72:75], a[136:139], a[48:51], v[72:75]
    s_waitcnt lgkmcnt(12)
    v_mfma_f32_16x16x32_bf16 v[80:83], a[144:147], a[48:51], v[80:83]
    ds_read_b64_tr_b16 a[112:113], v42 offset:16384
    ds_read_b64_tr_b16 a[114:115], v42 offset:20480
    v_mfma_f32_16x16x32_bf16 v[80:83], a[148:151], a[52:55], v[80:83]
    v_mfma_f32_16x16x32_bf16 v[84:87], a[148:151], a[60:63], v[84:87]
    ds_read_b64_tr_b16 a[116:117], v42 offset:24576
    ds_read_b64_tr_b16 a[118:119], v42 offset:28672
    v_mfma_f32_16x16x32_bf16 v[84:87], a[144:147], a[56:59], v[84:87]
    s_waitcnt lgkmcnt(12)
    v_mfma_f32_16x16x32_bf16 v[92:95], a[152:155], a[56:59], v[92:95]
    ds_read_b64_tr_b16 a[120:121], v43 offset:16384
    ds_read_b64_tr_b16 a[122:123], v43 offset:20480
    v_mfma_f32_16x16x32_bf16 v[92:95], a[156:159], a[60:63], v[92:95]
    v_mfma_f32_16x16x32_bf16 v[88:91], a[156:159], a[52:55], v[88:91]
    ds_read_b64_tr_b16 a[124:125], v43 offset:24576
    ds_read_b64_tr_b16 a[126:127], v43 offset:28672
    v_mfma_f32_16x16x32_bf16 v[88:91], a[152:155], a[48:51], v[88:91]
    s_waitcnt lgkmcnt(12)
    v_mfma_f32_16x16x32_bf16 v[64:67], a[96:99], a[64:67], v[64:67]
    v_mov_b32 v18, 0
    s_mov_b64 exec, 1
    buffer_atomic_or v18, v14, s[12:15], s38 offen offset:8 sc0 sc1
    s_mov_b64 exec, -1
    ds_read_b64_tr_b16 a[128:129], v24 offset:0
    ds_read_b64_tr_b16 a[130:131], v24 offset:4096
    v_mfma_f32_16x16x32_bf16 v[64:67], a[100:103], a[68:71], v[64:67]
    v_mfma_f32_16x16x32_bf16 v[68:71], a[100:103], a[76:79], v[68:71]
    ds_read_b64_tr_b16 a[132:133], v24 offset:8192
    ds_read_b64_tr_b16 a[134:135], v24 offset:12288
    v_mfma_f32_16x16x32_bf16 v[68:71], a[96:99], a[72:75], v[68:71]
    s_waitcnt lgkmcnt(12)
    v_mfma_f32_16x16x32_bf16 v[76:79], a[104:107], a[72:75], v[76:79]
    ds_read_b64_tr_b16 a[136:137], v25 offset:0
    ds_read_b64_tr_b16 a[138:139], v25 offset:4096
    v_mfma_f32_16x16x32_bf16 v[76:79], a[108:111], a[76:79], v[76:79]
    v_mfma_f32_16x16x32_bf16 v[72:75], a[108:111], a[68:71], v[72:75]
    ds_read_b64_tr_b16 a[140:141], v25 offset:8192
    ds_read_b64_tr_b16 a[142:143], v25 offset:12288
    v_mfma_f32_16x16x32_bf16 v[72:75], a[104:107], a[64:67], v[72:75]
    s_waitcnt lgkmcnt(12)
    v_mfma_f32_16x16x32_bf16 v[80:83], a[112:115], a[64:67], v[80:83]
    ds_read_b64_tr_b16 a[144:145], v26 offset:0
    ds_read_b64_tr_b16 a[146:147], v26 offset:4096
    v_mfma_f32_16x16x32_bf16 v[80:83], a[116:119], a[68:71], v[80:83]
    v_mfma_f32_16x16x32_bf16 v[84:87], a[116:119], a[76:79], v[84:87]
    ds_read_b64_tr_b16 a[148:149], v26 offset:8192
    ds_read_b64_tr_b16 a[150:151], v26 offset:12288
    v_mfma_f32_16x16x32_bf16 v[84:87], a[112:115], a[72:75], v[84:87]
    s_waitcnt lgkmcnt(12)
    v_mfma_f32_16x16x32_bf16 v[92:95], a[120:123], a[72:75], v[92:95]
    ds_read_b64_tr_b16 a[152:153], v27 offset:0
    ds_read_b64_tr_b16 a[154:155], v27 offset:4096
    v_mfma_f32_16x16x32_bf16 v[92:95], a[124:127], a[76:79], v[92:95]
    v_mfma_f32_16x16x32_bf16 v[88:91], a[124:127], a[68:71], v[88:91]
    ds_read_b64_tr_b16 a[156:157], v27 offset:8192
    ds_read_b64_tr_b16 a[158:159], v27 offset:12288
    v_mfma_f32_16x16x32_bf16 v[88:91], a[120:123], a[64:67], v[88:91]
    s_waitcnt lgkmcnt(12)
    v_mfma_f32_16x16x32_bf16 v[64:67], a[128:131], a[80:83], v[64:67]
    v_mfma_f32_16x16x32_bf16 v[64:67], a[132:135], a[84:87], v[64:67]
    v_mfma_f32_16x16x32_bf16 v[68:71], a[132:135], a[92:95], v[68:71]
    v_mfma_f32_16x16x32_bf16 v[68:71], a[128:131], a[88:91], v[68:71]
    s_waitcnt lgkmcnt(8)
    v_mfma_f32_16x16x32_bf16 v[76:79], a[136:139], a[88:91], v[76:79]
    v_mfma_f32_16x16x32_bf16 v[76:79], a[140:143], a[92:95], v[76:79]
    v_mfma_f32_16x16x32_bf16 v[72:75], a[140:143], a[84:87], v[72:75]
    v_mfma_f32_16x16x32_bf16 v[72:75], a[136:139], a[80:83], v[72:75]
    s_waitcnt lgkmcnt(4)
    v_mfma_f32_16x16x32_bf16 v[80:83], a[144:147], a[80:83], v[80:83]
    v_mfma_f32_16x16x32_bf16 v[80:83], a[148:151], a[84:87], v[80:83]
    v_mfma_f32_16x16x32_bf16 v[84:87], a[148:151], a[92:95], v[84:87]
    v_mfma_f32_16x16x32_bf16 v[84:87], a[144:147], a[88:91], v[84:87]
    s_waitcnt lgkmcnt(0)
    v_mfma_f32_16x16x32_bf16 v[92:95], a[152:155], a[88:91], v[92:95]
    v_mfma_f32_16x16x32_bf16 v[92:95], a[156:159], a[92:95], v[92:95]
    v_mfma_f32_16x16x32_bf16 v[88:91], a[156:159], a[84:87], v[88:91]
    v_mfma_f32_16x16x32_bf16 v[88:91], a[152:155], a[80:83], v[88:91]
    s_waitcnt vmcnt(0)
    v_readfirstlane_b32 s78, v18
    s_nop 0
    s_cmp_ge_u32 s78, 1
    s_cbranch_scc1 L_got11
    s_mov_b32 s79, 0
L_spinl11:
    v_mov_b32 v18, 0
    s_mov_b64 exec, 1
    buffer_atomic_or v18, v14, s[12:15], s38 offen offset:8 sc0 sc1
    s_mov_b64 exec, -1
    s_waitcnt vmcnt(0)
    v_readfirstlane_b32 s78, v18
    s_add_u32 s79, s79, 1
    s_cmp_ge_u32 s78, 1
    s_cbranch_scc1 L_got11
    s_cmp_lt_u32 s79, 0x80000
    s_cbranch_scc1 L_spinl11
L_got11:
    buffer_load_dwordx4 v[144:147], v6, s[12:15], s55 offen offset:0 sc1
    buffer_load_dwordx4 v[148:151], v6, s[12:15], s55 offen offset:1024 sc1
    buffer_load_dwordx4 v[152:155], v6, s[12:15], s55 offen offset:2048 sc1
    buffer_load_dwordx4 v[156:159], v6, s[12:15], s55 offen offset:3072 sc1
    v_dot2c_f32_bf16 v64, v176, v22
    v_dot2c_f32_bf16 v65, v176, v23
    v_dot2c_f32_bf16 v66, v177, v22
    v_dot2c_f32_bf16 v67, v177, v23
    v_dot2c_f32_bf16 v68, v178, v22
    v_dot2c_f32_bf16 v69, v178, v23
    v_dot2c_f32_bf16 v70, v179, v22
    v_dot2c_f32_bf16 v71, v179, v23
    v_dot2c_f32_bf16 v72, v180, v22
    v_dot2c_f32_bf16 v73, v180, v23
    v_dot2c_f32_bf16 v74, v181, v22
    v_dot2c_f32_bf16 v75, v181, v23
    v_dot2c_f32_bf16 v76, v182, v22
    v_dot2c_f32_bf16 v77, v182, v23
    v_dot2c_f32_bf16 v78, v183, v22
    v_dot2c_f32_bf16 v79, v183, v23
    v_dot2c_f32_bf16 v80, v184, v22
    v_dot2c_f32_bf16 v81, v184, v23
    v_dot2c_f32_bf16 v82, v185, v22
    v_dot2c_f32_bf16 v83, v185, v23
    v_dot2c_f32_bf16 v84, v186, v22
    v_dot2c_f32_bf16 v85, v186, v23
    v_dot2c_f32_bf16 v86, v187, v22
    v_dot2c_f32_bf16 v87, v187, v23
    v_dot2c_f32_bf16 v88, v188, v22
    v_dot2c_f32_bf16 v89, v188, v23
    v_dot2c_f32_bf16 v90, v189, v22
    v_dot2c_f32_bf16 v91, v189, v23
    v_dot2c_f32_bf16 v92, v190, v22
    v_dot2c_f32_bf16 v93, v190, v23
    v_dot2c_f32_bf16 v94, v191, v22
    v_dot2c_f32_bf16 v95, v191, v23
    v_dot2c_f32_bf16 v64, v112, v22
    v_dot2c_f32_bf16 v65, v112, v23
    v_dot2c_f32_bf16 v66, v113, v22
    v_dot2c_f32_bf16 v67, v113, v23
    v_dot2c_f32_bf16 v68, v114, v22
    v_dot2c_f32_bf16 v69, v114, v23
    v_dot2c_f32_bf16 v70, v115, v22
    v_dot2c_f32_bf16 v71, v115, v23
    v_dot2c_f32_bf16 v72, v116, v22
    v_dot2c_f32_bf16 v73, v116, v23
    v_dot2c_f32_bf16 v74, v117, v22
    v_dot2c_f32_bf16 v75, v117, v23
    v_dot2c_f32_bf16 v76, v118, v22
    v_dot2c_f32_bf16 v77, v118, v23
    v_dot2c_f32_bf16 v78, v119, v22
    v_dot2c_f32_bf16 v79, v119, v23
    v_dot2c_f32_bf16 v80, v120, v22
    v_dot2c_f32_bf16 v81, v120, v23
    v_dot2c_f32_bf16 v82, v121, v22
    v_dot2c_f32_bf16 v83, v121, v23
    v_dot2c_f32_bf16 v84, v122, v22
    v_dot2c_f32_bf16 v85, v122, v23
    v_dot2c_f32_bf16 v86, v123, v22
    v_dot2c_f32_bf16 v87, v123, v23
    v_dot2c_f32_bf16 v88, v124, v22
    v_dot2c_f32_bf16 v89, v124, v23
    v_dot2c_f32_bf16 v90, v125, v22
    v_dot2c_f32_bf16 v91, v125, v23
    v_dot2c_f32_bf16 v92, v126, v22
    v_dot2c_f32_bf16 v93, v126, v23
    v_dot2c_f32_bf16 v94, v127, v22
    v_dot2c_f32_bf16 v95, v127, v23
    s_waitcnt vmcnt(0)
    v_dot2c_f32_bf16 v64, v144, v22
    v_dot2c_f32_bf16 v65, v144, v23
    v_dot2c_f32_bf16 v66, v145, v22
    v_dot2c_f32_bf16 v67, v145, v23
    v_dot2c_f32_bf16 v72, v148, v22
    v_dot2c_f32_bf16 v73, v148, v23
    v_dot2c_f32_bf16 v74, v149, v22
    v_dot2c_f32_bf16 v75, v149, v23
    v_dot2c_f32_bf16 v80, v152, v22
    v_dot2c_f32_bf16 v81, v152, v23
    v_dot2c_f32_bf16 v82, v153, v22
    v_dot2c_f32_bf16 v83, v153, v23
    v_dot2c_f32_bf16 v88, v156, v22
    v_dot2c_f32_bf16 v89, v156, v23
    v_dot2c_f32_bf16 v90, v157, v22
    v_dot2c_f32_bf16 v91, v157, v23
    v_cvt_pk_bf16_f32 v24, v64, v65
    v_cvt_pk_bf16_f32 v25, v66, v67
    v_cvt_pk_bf16_f32 v26, v72, v73
    v_cvt_pk_bf16_f32 v27, v74, v75
    v_cvt_pk_bf16_f32 v28, v80, v81
    v_cvt_pk_bf16_f32 v29, v82, v83
    v_cvt_pk_bf16_f32 v30, v88, v89
    v_cvt_pk_bf16_f32 v31, v90, v91
    ds_write_b64 v56, v[24:25] offset:32768
    ds_write_b64 v57, v[26:27] offset:32768
    ds_write_b64 v58, v[28:29] offset:32768
    ds_write_b64 v59, v[30:31] offset:32768
    ds_read_b128 v[160:163], v60 offset:32768
    ds_read_b128 v[164:167], v60 offset:33792
    v_dot2c_f32_bf16 v68, v146, v22
    v_dot2c_f32_bf16 v69, v146, v23
    v_dot2c_f32_bf16 v70, v147, v22
    v_dot2c_f32_bf16 v71, v147, v23
    v_dot2c_f32_bf16 v76, v150, v22
    v_dot2c_f32_bf16 v77, v150, v23
    v_dot2c_f32_bf16 v78, v151, v22
    v_dot2c_f32_bf16 v79, v151, v23
    v_dot2c_f32_bf16 v84, v154, v22
    v_dot2c_f32_bf16 v85, v154, v23
    v_dot2c_f32_bf16 v86, v155, v22
    v_dot2c_f32_bf16 v87, v155, v23
    v_dot2c_f32_bf16 v92, v158, v22
    v_dot2c_f32_bf16 v93, v158, v23
    v_dot2c_f32_bf16 v94, v159, v22
    v_dot2c_f32_bf16 v95, v159, v23
    s_waitcnt lgkmcnt(1)
    buffer_store_dwordx4 v[160:163], v19, s[72:75], s31 offen sc1
    s_waitcnt lgkmcnt(0)
    buffer_store_dwordx4 v[164:167], v16, s[72:75], s31 offen sc1
    v_cvt_pk_bf16_f32 v32, v68, v69
    v_cvt_pk_bf16_f32 v33, v70, v71
    v_cvt_pk_bf16_f32 v34, v76, v77
    v_cvt_pk_bf16_f32 v35, v78, v79
    v_cvt_pk_bf16_f32 v36, v84, v85
    v_cvt_pk_bf16_f32 v37, v86, v87
    v_cvt_pk_bf16_f32 v38, v92, v93
    v_cvt_pk_bf16_f32 v39, v94, v95
    ds_write_b64 v56, v[32:33] offset:34816
    ds_write_b64 v57, v[34:35] offset:34816
    ds_write_b64 v58, v[36:37] offset:34816
    ds_write_b64 v59, v[38:39] offset:34816
    ds_read_b128 v[168:171], v60 offset:34816
    ds_read_b128 v[172:175], v60 offset:35840
    s_waitcnt lgkmcnt(1)
    buffer_store_dwordx4 v[168:171], v19, s[72:75], s32 offen sc1
    s_waitcnt lgkmcnt(0)
    buffer_store_dwordx4 v[172:175], v16, s[72:75], s32 offen sc1
L_exit0:
    s_endpgm
L_spin4:
    s_mov_b32 s79, 0
L_spinl4:
    global_load_dword v29, v11, s[24:25] sc1
    s_waitcnt vmcnt(0)
    v_cmp_eq_u32 vcc, 1, v29
    s_nop 0
    s_bcnt1_i32_b32 s78, vcc_lo
    s_add_u32 s79, s79, 1
    s_cmp_ge_u32 s78, 1
    s_cbranch_scc1 L_got4
    s_cmp_lt_u32 s79, 0x80000
    s_cbranch_scc1 L_spinl4
    s_branch L_got4
L_spin6:
    s_mov_b32 s79, 0
L_spinl6:
    buffer_load_dword v18, v14, s[12:15], s39 offen offset:0 sc1
    s_waitcnt vmcnt(0)
    v_cmp_eq_u32 vcc, 1, v18
    s_nop 0
    s_bcnt1_i32_b32 s78, vcc_lo
    s_add_u32 s79, s79, 1
    s_cmp_ge_u32 s78, 16
    s_cbranch_scc1 L_got6
    s_cmp_lt_u32 s79, 0x80000
    s_cbranch_scc1 L_spinl6
    s_branch L_got6
L_spin7:
    s_mov_b32 s79, 0
L_spinl7:
    buffer_load_dword v17, v7, s[12:15], s99 offen offset:0 sc1
    s_waitcnt vmcnt(0)
    v_cmp_eq_u32 vcc, 1, v17
    s_nop 0
    s_bcnt1_i32_b64 s78, vcc
    s_add_u32 s79, s79, 1
    s_cmp_ge_u32 s78, 64
    s_cbranch_scc1 L_got7
    s_cmp_lt_u32 s79, 0x80000
    s_cbranch_scc1 L_spinl7
    s_branch L_got7
L_spin8:
    s_mov_b32 s79, 0
L_spinl8:
    buffer_load_dword v18, v14, s[12:15], s40 offen offset:0 sc1
    s_waitcnt vmcnt(0)
    v_cmp_eq_u32 vcc, 1, v18
    s_nop 0
    s_bcnt1_i32_b32 s78, vcc_lo
    s_add_u32 s79, s79, 1
    s_cmp_ge_u32 s78, 32
    s_cbranch_scc1 L_got8
    s_cmp_lt_u32 s79, 0x80000
    s_cbranch_scc1 L_spinl8
    s_branch L_got8
L_spin9:
    s_mov_b32 s79, 0
L_spinl9:
    v_mov_b32 v18, 0
    s_mov_b64 exec, 1
    buffer_atomic_or v18, v14, s[12:15], s38 offen offset:0 sc0 sc1
    s_mov_b64 exec, -1
    s_waitcnt vmcnt(0)
    v_cmp_eq_u32 vcc, 1, v18
    s_nop 0
    s_bcnt1_i32_b32 s78, vcc_lo
    s_add_u32 s79, s79, 1
    s_cmp_ge_u32 s78, 1
    s_cbranch_scc1 L_got9
    s_cmp_lt_u32 s79, 0x80000
    s_cbranch_scc1 L_spinl9
    s_branch L_got9
.p2align 6
.fill 560, 4, 0xbf810000
L_qkv:
    s_load_dwordx2 s[68:69], s[0:1], 24
    s_load_dwordx2 s[64:65], s[0:1], 56
    s_load_dwordx2 s[72:73], s[0:1], 72
    s_load_dwordx2 s[24:25], s[0:1], 80
    s_load_dwordx2 s[12:13], s[0:1], 88
    s_load_dwordx2 s[96:97], s[0:1], 16
    s_load_dwordx2 s[92:93], s[0:1], 64
    s_bfe_u32 s45, s2, 0x20001
    s_lshr_b32 s44, s2, 6
    s_lshl2_add_u32 s27, s45, s44
    s_lshr_b32 s29, s28, 1
    s_and_b32 s30, s28, 1
    s_mov_b32 s33, 0
    s_mov_b32 s10, 0x600000
    s_mov_b32 s11, 0x20000
    s_lshr_b32 s44, s2, 3
    s_lshl2_add_u32 s44, s44, s28
    s_mul_i32 s44, s44, 6144
    s_lshl_b32 s45, s45, 9
    s_add_u32 s44, s44, s45
    v_min_u32 v18, 2, v1
    v_lshlrev_b32 v18, 11, v18
    buffer_load_dword v31, v18, s[8:11], s44 offen offset:384
    s_mul_i32 s44, s28, 98304
    s_mul_i32 s45, s27, 128
    s_add_u32 s44, s44, s45
    s_mul_i32 s42, s28, 6144
    s_add_u32 m0, s42, 0
    v_add_u32 v18, 0, v1
    v_mul_u32_u24 v19, 2731, v18
    v_lshrrev_b32 v19, 16, v19
    v_mul_u32_u24 v20, 24, v19
    v_sub_u32 v18, v18, v20
    v_lshrrev_b32 v20, 1, v19
    v_and_b32 v20, 4, v20
    v_and_or_b32 v20, v19, 2, v20
    v_xor_b32 v18, v18, v20
    v_lshrrev_b32 v20, 3, v18
    v_lshlrev_b32 v20, 11, v20
    v_and_b32 v18, 7, v18
    v_lshl_add_u32 v18, v18, 4, v20
    v_mul_u32_u24 v19, 6144, v19
    v_add3_u32 v6, v18, v19, s44
    buffer_load_dwordx4 v6, s[8:11], s33 offen offset:0 lds
    v_add_u32 v18, 64, v1
    v_mul_u32_u24 v19, 2731, v18
    v_lshrrev_b32 v19, 16, v19
    v_mul_u32_u24 v20, 24, v19
    v_sub_u32 v18, v18, v20
    v_lshrrev_b32 v20, 1, v19
    v_and_b32 v20, 4, v20
    v_and_or_b32 v20, v19, 2, v20
    v_xor_b32 v18, v18, v20
    v_lshrrev_b32 v20, 3, v18
    v_lshlrev_b32 v20, 11, v20
    v_and_b32 v18, 7, v18
    v_lshl_add_u32 v18, v18, 4, v20
    v_mul_u32_u24 v19, 6144, v19
    v_add3_u32 v7, v18, v19, s44
    v_subrev_u32 v7, 1024, v7
    buffer_load_dwordx4 v7, s[8:11], s33 offen offset:1024 lds
    v_add_u32 v18, 128, v1
    v_mul_u32_u24 v19, 2731, v18
    v_lshrrev_b32 v19, 16, v19
    v_mul_u32_u24 v20, 24, v19
    v_sub_u32 v18, v18, v20
    v_lshrrev_b32 v20, 1, v19
    v_and_b32 v20, 4, v20
    v_and_or_b32 v20, v19, 2, v20
    v_xor_b32 v18, v18, v20
    v_lshrrev_b32 v20, 3, v18
    v_lshlrev_b32 v20, 11, v20
    v_and_b32 v18, 7, v18
    v_lshl_add_u32 v18, v18, 4, v20
    v_mul_u32_u24 v19, 6144, v19
    v_add3_u32 v8, v18, v19, s44
    v_subrev_u32 v8, 2048, v8
    buffer_load_dwordx4 v8, s[8:11], s33 offen offset:2048 lds
    v_add_u32 v18, 192, v1
    v_mul_u32_u24 v19, 2731, v18
    v_lshrrev_b32 v19, 16, v19
    v_mul_u32_u24 v20, 24, v19
    v_sub_u32 v18, v18, v20
    v_lshrrev_b32 v20, 1, v19
    v_and_b32 v20, 4, v20
    v_and_or_b32 v20, v19, 2, v20
    v_xor_b32 v18, v18, v20
    v_lshrrev_b32 v20, 3, v18
    v_lshlrev_b32 v20, 11, v20
    v_and_b32 v18, 7, v18
    v_lshl_add_u32 v18, v18, 4, v20
    v_mul_u32_u24 v19, 6144, v19
    v_add3_u32 v9, v18, v19, s44
    v_subrev_u32 v9, 3072, v9
    buffer_load_dwordx4 v9, s[8:11], s33 offen offset:3072 lds
    s_add_u32 m0, s42, 4096
    v_add_u32 v18, 256, v1
    v_mul_u32_u24 v19, 2731, v18
    v_lshrrev_b32 v19, 16, v19
    v_mul_u32_u24 v20, 24, v19
    v_sub_u32 v18, v18, v20
    v_lshrrev_b32 v20, 1, v19
    v_and_b32 v20, 4, v20
    v_and_or_b32 v20, v19, 2, v20
    v_xor_b32 v18, v18, v20
    v_lshrrev_b32 v20, 3, v18
    v_lshlrev_b32 v20, 11, v20
    v_and_b32 v18, 7, v18
    v_lshl_add_u32 v18, v18, 4, v20
    v_mul_u32_u24 v19, 6144, v19
    v_add3_u32 v10, v18, v19, s44
    buffer_load_dwordx4 v10, s[8:11], s33 offen offset:0 lds
    v_add_u32 v18, 320, v1
    v_mul_u32_u24 v19, 2731, v18
    v_lshrrev_b32 v19, 16, v19
    v_mul_u32_u24 v20, 24, v19
    v_sub_u32 v18, v18, v20
    v_lshrrev_b32 v20, 1, v19
    v_and_b32 v20, 4, v20
    v_and_or_b32 v20, v19, 2, v20
    v_xor_b32 v18, v18, v20
    v_lshrrev_b32 v20, 3, v18
    v_lshlrev_b32 v20, 11, v20
    v_and_b32 v18, 7, v18
    v_lshl_add_u32 v18, v18, 4, v20
    v_mul_u32_u24 v19, 6144, v19
    v_add3_u32 v11, v18, v19, s44
    v_subrev_u32 v11, 1024, v11
    buffer_load_dwordx4 v11, s[8:11], s33 offen offset:1024 lds
    s_add_u32 s33, s33, 393216
    s_add_u32 m0, s42, 122880
    s_nop 0
    buffer_load_dwordx4 v6, s[8:11], s33 offen offset:0 lds
    buffer_load_dwordx4 v7, s[8:11], s33 offen offset:1024 lds
    buffer_load_dwordx4 v8, s[8:11], s33 offen offset:2048 lds
    buffer_load_dwordx4 v9, s[8:11], s33 offen offset:3072 lds
    s_add_u32 m0, s42, 126976
    s_nop 0
    buffer_load_dwordx4 v10, s[8:11], s33 offen offset:0 lds
    buffer_load_dwordx4 v11, s[8:11], s33 offen offset:1024 lds
    s_add_u32 s33, s33, 393216
    s_lshl_b32 s40, s28, 13
    s_add_u32 s41, s40, 4096
    s_add_u32 s32, s32, 128
    s_sub_u32 s31, s32, 0x10000
    s_lshl2_add_u32 s3, s2, s28
    s_lshl_b32 s53, s3, 12
    s_movk_i32 s38, 256
    v_and_b32 v18, 1, v1
    v_lshlrev_b32 v18, 7, v18
    v_bfe_u32 v19, v1, 1, 1
    v_lshl_add_u32 v28, v19, 11, v18
    s_mov_b64 s[20:21], s[4:5]
    s_mov_b64 s[22:23], s[6:7]
    s_mov_b64 s[16:17], s[8:9]
    s_mov_b64 s[18:19], s[10:11]
    buffer_load_dword v31, v28, s[20:23], s53 offen
    s_add_u32 s53, s53, s38
    s_lshr_b32 s44, s2, 3
    s_lshl2_add_u32 s44, s44, s28
    s_add_u32 s44, s44, 128
    s_mul_i32 s44, s44, 6144
    s_lshr_b32 s45, s27, 2
    s_mul_i32 s45, s45, 512
    s_add_u32 s52, s44, s45
    s_mov_b32 s37, 786432
    v_min_u32 v18, 11, v1
    v_and_b32 v19, 3, v18
    v_lshrrev_b32 v18, 2, v18
    v_lshlrev_b32 v19, 7, v19
    v_lshl_add_u32 v29, v18, 11, v19
    s_waitcnt lgkmcnt(0)
    s_mov_b32 s14, 0x3400000
    s_mov_b32 s15, 0x20000
    v_and_b32 v18, 15, v1
    v_lshrrev_b32 v19, 4, v1
    v_lshrrev_b32 v20, 1, v18
    v_xor_b32 v20, v20, v19
    v_lshlrev_b32 v20, 4, v20
    v_lshl_add_u32 v20, v18, 7, v20
    s_lshl_b32 s44, s29, 14
    s_add_u32 s44, s44, 0x8000
    v_add_u32 v13, s44, v20
    v_xor_b32 v14, 64, v13
    v_bfe_u32 v18, v1, 2, 2
    v_lshl_add_u32 v20, v19, 3, v18
    v_mul_u32_u24 v20, 384, v20
    v_and_b32 v21, 3, v1
    v_lshl_add_u32 v20, v21, 3, v20
    v_and_b32 v19, 1, v19
    v_lshrrev_b32 v18, 1, v18
    v_lshl_or_b32 v18, v19, 1, v18
    s_lshl_b32 s44, s30, 1
    v_xor_b32 v18, s44, v18
    v_lshl_add_u32 v15, v18, 5, v20
    v_xor_b32 v18, 1, v18
    v_lshl_add_u32 v16, v18, 5, v20
    s_and_b32 s56, s2, 4
    s_lshr_b32 s44, s2, 6
    s_add_u32 s56, s56, s44
    s_and_b32 s58, s2, 3
    s_bfe_u32 s57, s2, 0x30003
    s_lshl_b32 s59, s56, 1
    s_lshr_b32 s44, s58, 1
    s_add_u32 s59, s59, s44
    s_lshl_b32 s59, s59, 2
    s_add_u32 s59, s59, s28
    s_mul_i32 s44, s58, 1835008
    s_mul_i32 s60, s29, 262144
    s_add_u32 s60, s60, s44
    s_mul_i32 s61, s29, 458752
    s_add_u32 s61, s61, s44
    s_mul_i32 s62, s29, 65536
    s_add_u32 s62, s62, s44
    s_lshl_b32 s63, s28, 12
    s_lshr_b32 s44, s2, 3
    s_lshl2_add_u32 s44, s44, s28
    s_mul_i32 s45, s44, 384
    s_add_u32 s45, s45, L_qkv-gated_mix__linear_kernel_hedgehog__dense_activation_mish__prompt_kernel
    v_min_u32 v18, 2, v1
    v_lshl_add_u32 v30, v18, 7, s45
    v_min_u32 v30, L_end-gated_mix__linear_kernel_hedgehog__dense_activation_mish__prompt_kernel-8, v30
    s_mov_b32 s66, 0x700000
    s_mov_b32 s67, 0x20000
    s_mov_b32 s70, 0x200000
    s_mov_b32 s71, 0x20000
    s_mov_b32 s74, 0x400000
    s_mov_b32 s75, 0x20000
    s_mov_b32 s94, 0x800
    s_mov_b32 s95, 0x20000
    v_mov_b64 v[208:209], 0
    v_mov_b64 v[210:211], 0
    v_mov_b64 v[212:213], 0
    v_mov_b64 v[214:215], 0
    v_mov_b64 v[216:217], 0
    v_mov_b64 v[218:219], 0
    v_mov_b64 v[220:221], 0
    v_mov_b64 v[222:223], 0
    v_mov_b64 v[224:225], 0
    v_mov_b64 v[226:227], 0
    v_mov_b64 v[228:229], 0
    v_mov_b64 v[230:231], 0
    v_mov_b64 v[232:233], 0
    v_mov_b64 v[234:235], 0
    v_mov_b64 v[236:237], 0
    v_mov_b64 v[238:239], 0
    v_mov_b64 v[240:241], 0
    v_mov_b64 v[242:243], 0
    v_mov_b64 v[244:245], 0
    v_mov_b64 v[246:247], 0
    v_mov_b64 v[248:249], 0
    v_mov_b64 v[250:251], 0
    v_mov_b64 v[252:253], 0
    v_mov_b64 v[254:255], 0
    s_mov_b32 s98, 0x10000
    s_mov_b32 s99, 0x20000
    s_lshl_b32 s54, s27, 1
    s_add_u32 s54, s54, s30
    s_lshl_b32 s55, s28, 11
    s_add_u32 s55, s55, 155648
    v_lshlrev_b32 v45, 4, v1
    s_mov_b64 exec, 0
    s_cmp_eq_u32 s29, 1
    s_cbranch_scc1 L_hb12
    s_cmp_eq_u32 s30, 1
    s_cbranch_scc1 L_ha12
    s_call_b64 s[86:87], L_pg12
    s_branch L_hd12
L_ha12:
    s_call_b64 s[86:87], L_pg13
    s_branch L_hd12
L_hb12:
    s_cmp_eq_u32 s30, 1
    s_cbranch_scc1 L_hc12
    s_call_b64 s[86:87], L_pg14
    s_branch L_hd12
L_hc12:
    s_call_b64 s[86:87], L_pg15
L_hd12:
    s_mov_b64 exec, -1
    buffer_load_dword v31, v29, s[16:19], s52 offen
    s_add_u32 s52, s52, s37
    buffer_load_dword v31, v28, s[20:23], s53 offen
    s_add_u32 s53, s53, s38
    s_mov_b32 s35, 0x10000
    s_waitcnt vmcnt(9)
    s_barrier
    ds_read_b64_tr_b16 a[0:1], v15 offset:0
    ds_read_b64_tr_b16 a[2:3], v15 offset:1536
    ds_read_b64_tr_b16 a[4:5], v15 offset:12288
    ds_read_b64_tr_b16 a[6:7], v15 offset:13824
    ds_read_b128 a[112:115], v13 offset:0
    ds_read_b128 a[116:119], v14 offset:0
    ds_read_b64_tr_b16 a[8:9], v16 offset:0
    ds_read_b64_tr_b16 a[10:11], v16 offset:1536
    ds_read_b64_tr_b16 a[12:13], v16 offset:12288
    ds_read_b64_tr_b16 a[14:15], v16 offset:13824
    ds_read_b64_tr_b16 a[16:17], v15 offset:128
    ds_read_b64_tr_b16 a[18:19], v15 offset:1664
    ds_read_b64_tr_b16 a[20:21], v15 offset:12416
    ds_read_b64_tr_b16 a[22:23], v15 offset:13952
    ds_read_b64_tr_b16 a[24:25], v16 offset:128
    ds_read_b64_tr_b16 a[26:27], v16 offset:1664
    ds_read_b64_tr_b16 a[28:29], v16 offset:12416
    ds_read_b64_tr_b16 a[30:31], v16 offset:13952
    ds_read_b64_tr_b16 a[32:33], v15 offset:256
    ds_read_b64_tr_b16 a[34:35], v15 offset:1792
    ds_read_b64_tr_b16 a[36:37], v15 offset:12544
    ds_read_b64_tr_b16 a[38:39], v15 offset:14080
    ds_read_b64_tr_b16 a[40:41], v16 offset:256
    ds_read_b64_tr_b16 a[42:43], v16 offset:1792
    ds_read_b64_tr_b16 a[44:45], v16 offset:12544
    ds_read_b64_tr_b16 a[46:47], v16 offset:14080
    ds_read_b128 a[120:123], v13 offset:2048
    ds_read_b128 a[124:127], v14 offset:2048
    v_add_u32 v15, 98304, v15
    v_add_u32 v16, 98304, v16
    s_waitcnt lgkmcnt(14)
    v_mfma_f32_16x16x32_bf16 v[64:67], a[0:3], a[112:115], 0
    s_add_u32 m0, s35, s40
    v_mfma_f32_16x16x32_bf16 v[64:67], a[4:7], a[116:119], v[64:67]
    buffer_load_dwordx4 v2, s[4:7], s31 offen offset:0 lds
    v_mfma_f32_16x16x32_bf16 v[68:71], a[12:15], a[116:119], 0
    v_mfma_f32_16x16x32_bf16 v[68:71], a[8:11], a[112:115], v[68:71]
    buffer_load_dwordx4 v3, s[4:7], s31 offen offset:1024 lds
    v_mfma_f32_16x16x32_bf16 v[72:75], a[16:19], a[112:115], 0
    v_mfma_f32_16x16x32_bf16 v[72:75], a[20:23], a[116:119], v[72:75]
    s_waitcnt lgkmcnt(10)
    buffer_load_dwordx4 v4, s[4:7], s31 offen offset:2048 lds
    v_mfma_f32_16x16x32_bf16 v[76:79], a[28:31], a[116:119], 0
    v_mfma_f32_16x16x32_bf16 v[76:79], a[24:27], a[112:115], v[76:79]
    s_waitcnt lgkmcnt(6)
    v_mfma_f32_16x16x32_bf16 v[80:83], a[112:115], a[32:35], 0
    ds_read_b128 a[128:131], v13 offset:4096
    v_mfma_f32_16x16x32_bf16 v[80:83], a[116:119], a[36:39], v[80:83]
    s_waitcnt lgkmcnt(3)
    buffer_load_dwordx4 v5, s[4:7], s31 offen offset:3072 lds
    v_mfma_f32_16x16x32_bf16 v[84:87], a[116:119], a[44:47], 0
    ds_read_b128 a[132:135], v14 offset:4096
    s_add_u32 m0, s35, s41
    v_mfma_f32_16x16x32_bf16 v[84:87], a[112:115], a[40:43], v[84:87]
    s_waitcnt lgkmcnt(2)
    buffer_load_dwordx4 v2, s[4:7], s32 offen offset:0 lds
    v_mfma_f32_16x16x32_bf16 v[108:111], a[120:123], a[40:43], 0
    ds_read_b128 a[136:139], v13 offset:6144
    v_mfma_f32_16x16x32_bf16 v[108:111], a[124:127], a[44:47], v[108:111]
    buffer_load_dwordx4 v3, s[4:7], s32 offen offset:1024 lds
    v_mfma_f32_16x16x32_bf16 v[104:107], a[124:127], a[36:39], 0
    ds_read_b128 a[140:143], v14 offset:6144
    v_mfma_f32_16x16x32_bf16 v[104:107], a[120:123], a[32:35], v[104:107]
    buffer_load_dwordx4 v4, s[4:7], s32 offen offset:2048 lds
    s_mov_b64 exec, 0
    s_cmp_eq_u32 s29, 1
    s_cbranch_scc1 L_hb14
    s_cmp_eq_u32 s30, 1
    s_cbranch_scc1 L_ha14
    s_call_b64 s[86:87], L_pg16
    s_branch L_hd14
L_ha14:
    s_call_b64 s[86:87], L_pg17
    s_branch L_hd14
L_hb14:
    s_cmp_eq_u32 s30, 1
    s_cbranch_scc1 L_hc14
    s_call_b64 s[86:87], L_pg18
    s_branch L_hd14
L_hc14:
    s_call_b64 s[86:87], L_pg19
L_hd14:
    s_mov_b64 exec, -1
    v_mfma_f32_16x16x32_bf16 v[100:103], a[24:27], a[120:123], 0
    v_mfma_f32_16x16x32_bf16 v[100:103], a[28:31], a[124:127], v[100:103]
    v_mfma_f32_16x16x32_bf16 v[96:99], a[20:23], a[124:127], 0
    v_mfma_f32_16x16x32_bf16 v[96:99], a[16:19], a[120:123], v[96:99]
    buffer_load_dwordx4 v5, s[4:7], s32 offen offset:3072 lds
    v_mfma_f32_16x16x32_bf16 v[92:95], a[8:11], a[120:123], 0
    s_add_u32 s31, s31, 128
    s_add_u32 s32, s32, 128
    s_mov_b32 s35, 0
    s_add_u32 m0, s42, 98304
    v_mfma_f32_16x16x32_bf16 v[92:95], a[12:15], a[124:127], v[92:95]
    buffer_load_dwordx4 v6, s[8:11], s33 offen offset:0 lds
    v_mfma_f32_16x16x32_bf16 v[88:91], a[4:7], a[124:127], 0
    v_mfma_f32_16x16x32_bf16 v[88:91], a[0:3], a[120:123], v[88:91]
    s_waitcnt lgkmcnt(2)
    buffer_load_dwordx4 v7, s[8:11], s33 offen offset:1024 lds
    v_mfma_f32_16x16x32_bf16 v[112:115], a[0:3], a[128:131], 0
    ds_read_b128 a[112:115], v13 offset:8192
    v_mfma_f32_16x16x32_bf16 v[112:115], a[4:7], a[132:135], v[112:115]
    buffer_load_dwordx4 v8, s[8:11], s33 offen offset:2048 lds
    v_mfma_f32_16x16x32_bf16 v[116:119], a[12:15], a[132:135], 0
    ds_read_b128 a[116:119], v14 offset:8192
    v_mfma_f32_16x16x32_bf16 v[116:119], a[8:11], a[128:131], v[116:119]
    s_mov_b64 exec, 0
    s_cmp_eq_u32 s29, 1
    s_cbranch_scc1 L_hb15
    s_cmp_eq_u32 s30, 1
    s_cbranch_scc1 L_ha15
    s_call_b64 s[86:87], L_pg20
    s_branch L_hd15
L_ha15:
    s_call_b64 s[86:87], L_pg21
    s_branch L_hd15
L_hb15:
    s_cmp_eq_u32 s30, 1
    s_cbranch_scc1 L_hc15
    s_call_b64 s[86:87], L_pg22
    s_branch L_hd15
L_hc15:
    s_nop 0
L_hd15:
    s_mov_b64 exec, -1
    v_mfma_f32_16x16x32_bf16 v[120:123], a[16:19], a[128:131], 0
    v_mfma_f32_16x16x32_bf16 v[120:123], a[20:23], a[132:135], v[120:123]
    buffer_load_dwordx4 v9, s[8:11], s33 offen offset:3072 lds
    v_mfma_f32_16x16x32_bf16 v[124:127], a[28:31], a[132:135], 0
    s_add_u32 m0, s42, 102400
    v_mfma_f32_16x16x32_bf16 v[124:127], a[24:27], a[128:131], v[124:127]
    buffer_load_dwordx4 v10, s[8:11], s33 offen offset:0 lds
    v_mfma_f32_16x16x32_bf16 v[128:131], a[128:131], a[32:35], 0
    v_mfma_f32_16x16x32_bf16 v[128:131], a[132:135], a[36:39], v[128:131]
    buffer_load_dwordx4 v11, s[8:11], s33 offen offset:1024 lds
    v_mfma_f32_16x16x32_bf16 v[132:135], a[132:135], a[44:47], 0
    s_add_u32 s33, s33, 393216
    v_mfma_f32_16x16x32_bf16 v[132:135], a[128:131], a[40:43], v[132:135]
    s_waitcnt lgkmcnt(2)
    s_waitcnt vmcnt(16)
    s_barrier
    v_mfma_f32_16x16x32_bf16 v[156:159], a[136:139], a[40:43], 0
    ds_read_b128 a[120:123], v13 offset:10240
    s_add_u32 m0, s35, s40
    v_mfma_f32_16x16x32_bf16 v[156:159], a[140:143], a[44:47], v[156:159]
    ds_read_b64_tr_b16 a[56:57], v15 offset:24576
    buffer_load_dwordx4 v2, s[4:7], s31 offen offset:0 lds
    v_mfma_f32_16x16x32_bf16 v[152:155], a[140:143], a[36:39], 0
    ds_read_b128 a[124:127], v14 offset:10240
    v_mfma_f32_16x16x32_bf16 v[152:155], a[136:139], a[32:35], v[152:155]
    ds_read_b64_tr_b16 a[58:59], v15 offset:26112
    buffer_load_dwordx4 v3, s[4:7], s31 offen offset:1024 lds
    v_mfma_f32_16x16x32_bf16 v[148:151], a[24:27], a[136:139], 0
    ds_read_b64_tr_b16 a[60:61], v15 offset:36864
    v_mfma_f32_16x16x32_bf16 v[148:151], a[28:31], a[140:143], v[148:151]
    ds_read_b64_tr_b16 a[62:63], v15 offset:38400
    v_mfma_f32_16x16x32_bf16 v[144:147], a[20:23], a[140:143], 0
    ds_read_b64_tr_b16 a[64:65], v16 offset:24576
    v_mfma_f32_16x16x32_bf16 v[144:147], a[16:19], a[136:139], v[144:147]
    ds_read_b64_tr_b16 a[66:67], v16 offset:26112
    buffer_load_dwordx4 v4, s[4:7], s31 offen offset:2048 lds
    v_mfma_f32_16x16x32_bf16 v[140:143], a[8:11], a[136:139], 0
    ds_read_b64_tr_b16 a[68:69], v16 offset:36864
    v_mfma_f32_16x16x32_bf16 v[140:143], a[12:15], a[140:143], v[140:143]
    ds_read_b64_tr_b16 a[70:71], v16 offset:38400
    buffer_load_dwordx4 v5, s[4:7], s31 offen offset:3072 lds
    v_mfma_f32_16x16x32_bf16 v[136:139], a[4:7], a[140:143], 0
    ds_read_b64_tr_b16 a[72:73], v15 offset:24704
    v_mfma_f32_16x16x32_bf16 v[136:139], a[0:3], a[136:139], v[136:139]
    s_waitcnt lgkmcnt(11)
    ds_read_b64_tr_b16 a[74:75], v15 offset:26240
    v_mfma_f32_16x16x32_bf16 v[160:163], a[0:3], a[112:115], 0
    ds_read_b128 a[128:131], v13 offset:12288
    s_add_u32 m0, s35, s41
    v_mfma_f32_16x16x32_bf16 v[160:163], a[4:7], a[116:119], v[160:163]
    ds_read_b64_tr_b16 a[76:77], v15 offset:36992
    buffer_load_dwordx4 v2, s[4:7], s32 offen offset:0 lds
    v_mfma_f32_16x16x32_bf16 v[164:167], a[12:15], a[116:119], 0
    ds_read_b128 a[132:135], v14 offset:12288
    v_mfma_f32_16x16x32_bf16 v[164:167], a[8:11], a[112:115], v[164:167]
    ds_read_b64_tr_b16 a[78:79], v15 offset:38528
    buffer_load_dwordx4 v3, s[4:7], s32 offen offset:1024 lds
    v_mfma_f32_16x16x32_bf16 v[168:171], a[16:19], a[112:115], 0
    v_mfma_f32_16x16x32_bf16 v[168:171], a[20:23], a[116:119], v[168:171]
    ds_read_b64_tr_b16 a[80:81], v16 offset:24704
    v_mfma_f32_16x16x32_bf16 v[172:175], a[28:31], a[116:119], 0
    ds_read_b64_tr_b16 a[82:83], v16 offset:26240
    v_mfma_f32_16x16x32_bf16 v[172:175], a[24:27], a[112:115], v[172:175]
    ds_read_b64_tr_b16 a[84:85], v16 offset:36992
    buffer_load_dwordx4 v4, s[4:7], s32 offen offset:2048 lds
    v_mfma_f32_16x16x32_bf16 v[176:179], a[112:115], a[32:35], 0
    ds_read_b64_tr_b16 a[86:87], v16 offset:38528
    v_mfma_f32_16x16x32_bf16 v[176:179], a[116:119], a[36:39], v[176:179]
    ds_read_b64_tr_b16 a[88:89], v15 offset:24832
    buffer_load_dwordx4 v5, s[4:7], s32 offen offset:3072 lds
    v_mfma_f32_16x16x32_bf16 v[180:183], a[116:119], a[44:47], 0
    ds_read_b64_tr_b16 a[90:91], v15 offset:26368
    s_add_u32 s31, s31, 128
    s_add_u32 s32, s32, 128
    v_mfma_f32_16x16x32_bf16 v[180:183], a[112:115], a[40:43], v[180:183]
    s_waitcnt lgkmcnt(14)
    ds_read_b64_tr_b16 a[92:93], v15 offset:37120
    v_mfma_f32_16x16x32_bf16 v[204:207], a[120:123], a[40:43], 0
    ds_read_b128 a[136:139], v13 offset:14336
    s_lshl_b32 s47, s54, 11
    s_mov_b32 m0, s55
    v_mfma_f32_16x16x32_bf16 v[204:207], a[124:127], a[44:47], v[204:207]
    ds_read_b64_tr_b16 a[94:95], v15 offset:38656
    buffer_load_dwordx4 v45, s[96:99], s47 offen offset:0 lds
    v_mfma_f32_16x16x32_bf16 v[200:203], a[124:127], a[36:39], 0
    ds_read_b128 a[140:143], v14 offset:14336
    v_mfma_f32_16x16x32_bf16 v[200:203], a[120:123], a[32:35], v[200:203]
    ds_read_b64_tr_b16 a[96:97], v16 offset:24832
    buffer_load_dwordx4 v45, s[96:99], s47 offen offset:1024 lds
    v_mfma_f32_16x16x32_bf16 v[196:199], a[24:27], a[120:123], 0
    ds_read_b64_tr_b16 a[98:99], v16 offset:26368
    v_mfma_f32_16x16x32_bf16 v[196:199], a[28:31], a[124:127], v[196:199]
    ds_read_b64_tr_b16 a[100:101], v16 offset:37120
    v_mfma_f32_16x16x32_bf16 v[192:195], a[20:23], a[124:127], 0
    ds_read_b64_tr_b16 a[102:103], v16 offset:38656
    s_lshl_b32 s47, s30, 10
    v_mfma_f32_16x16x32_bf16 v[192:195], a[16:19], a[120:123], v[192:195]
    buffer_load_dword v31, v45, s[92:95], s47 offen
    v_mfma_f32_16x16x32_bf16 v[188:191], a[8:11], a[120:123], 0
    s_mov_b32 s35, 0x8000
    s_mov_b32 s34, 0x10000
    v_mfma_f32_16x16x32_bf16 v[188:191], a[12:15], a[124:127], v[188:191]
    v_add_u32 v13, 0x8000, v13
    v_mfma_f32_16x16x32_bf16 v[184:187], a[4:7], a[124:127], 0
    v_add_u32 v14, 0x8000, v14
    v_mfma_f32_16x16x32_bf16 v[184:187], a[0:3], a[120:123], v[184:187]
    s_cmp_lg_u32 s2, 1
    s_cbranch_scc1 L_nozero13
    v_mov_b64 v[40:41], 0
    v_mov_b64 v[42:43], 0
    s_mul_i32 s44, s28, 6144
    s_add_u32 s44, s44, 0x2520000
    s_add_u32 s45, s44, 4096
    buffer_store_dwordx4 v[40:43], v45, s[12:15], s44 offen offset:0 sc1
    buffer_store_dwordx4 v[40:43], v45, s[12:15], s44 offen offset:1024 sc1
    buffer_store_dwordx4 v[40:43], v45, s[12:15], s44 offen offset:2048 sc1
    buffer_store_dwordx4 v[40:43], v45, s[12:15], s44 offen offset:3072 sc1
    buffer_store_dwordx4 v[40:43], v45, s[12:15], s45 offen offset:0 sc1
    buffer_store_dwordx4 v[40:43], v45, s[12:15], s45 offen offset:1024 sc1
L_nozero13:
L_pg12:
    s_cbranch_execz L_tramp
    s_mov_b32 s39, 0
    s_mov_b32 s43, 3
    s_waitcnt vmcnt(11)
    s_waitcnt lgkmcnt(0)
    s_barrier
.p2align 6
L_loopQ:
    v_mfma_f32_16x16x32_bf16 v[208:211], a[0:3], a[128:131], v[208:211]
    ds_read_b128 a[112:115], v13 offset:0
    s_add_u32 m0, s42, 122880
    v_mfma_f32_16x16x32_bf16 v[208:211], a[4:7], a[132:135], v[208:211]
    buffer_load_dwordx4 v6, s[8:11], s33 offen offset:0 lds
    v_mfma_f32_16x16x32_bf16 v[212:215], a[12:15], a[132:135], v[212:215]
    ds_read_b128 a[116:119], v14 offset:0
    v_mfma_f32_16x16x32_bf16 v[212:215], a[8:11], a[128:131], v[212:215]
    v_mfma_f32_16x16x32_bf16 v[216:219], a[16:19], a[128:131], v[216:219]
    v_mfma_f32_16x16x32_bf16 v[216:219], a[20:23], a[132:135], v[216:219]
    buffer_load_dwordx4 v7, s[8:11], s33 offen offset:1024 lds
    v_mfma_f32_16x16x32_bf16 v[220:223], a[28:31], a[132:135], v[220:223]
    v_mfma_f32_16x16x32_bf16 v[220:223], a[24:27], a[128:131], v[220:223]
    v_mfma_f32_16x16x32_bf16 v[224:227], a[128:131], a[32:35], v[224:227]
    v_mfma_f32_16x16x32_bf16 v[224:227], a[132:135], a[36:39], v[224:227]
    buffer_load_dwordx4 v8, s[8:11], s33 offen offset:2048 lds
    v_mfma_f32_16x16x32_bf16 v[228:231], a[132:135], a[44:47], v[228:231]
    v_mfma_f32_16x16x32_bf16 v[228:231], a[128:131], a[40:43], v[228:231]
    v_mfma_f32_16x16x32_bf16 v[252:255], a[136:139], a[40:43], v[252:255]
    ds_read_b128 a[120:123], v13 offset:2048
    v_mfma_f32_16x16x32_bf16 v[252:255], a[140:143], a[44:47], v[252:255]
    buffer_load_dwordx4 v9, s[8:11], s33 offen offset:3072 lds
    v_mfma_f32_16x16x32_bf16 v[248:251], a[140:143], a[36:39], v[248:251]
    ds_read_b128 a[124:127], v14 offset:2048
    v_mfma_f32_16x16x32_bf16 v[248:251], a[136:139], a[32:35], v[248:251]
    v_mfma_f32_16x16x32_bf16 v[244:247], a[24:27], a[136:139], v[244:247]
    s_add_u32 m0, s42, 126976
    v_mfma_f32_16x16x32_bf16 v[244:247], a[28:31], a[140:143], v[244:247]
    buffer_load_dwordx4 v10, s[8:11], s33 offen offset:0 lds
    v_mfma_f32_16x16x32_bf16 v[240:243], a[20:23], a[140:143], v[240:243]
    v_mfma_f32_16x16x32_bf16 v[240:243], a[16:19], a[136:139], v[240:243]
    v_mfma_f32_16x16x32_bf16 v[236:239], a[8:11], a[136:139], v[236:239]
    v_mfma_f32_16x16x32_bf16 v[236:239], a[12:15], a[140:143], v[236:239]
    buffer_load_dwordx4 v11, s[8:11], s33 offen offset:1024 lds
    v_mfma_f32_16x16x32_bf16 v[232:235], a[4:7], a[140:143], v[232:235]
    s_add_u32 s33, s33, 393216
    v_mfma_f32_16x16x32_bf16 v[232:235], a[0:3], a[136:139], v[232:235]
    s_waitcnt lgkmcnt(2)
    v_mfma_f32_16x16x32_bf16 v[64:67], a[56:59], a[112:115], v[64:67]
    ds_read_b128 a[128:131], v13 offset:4096
    v_mfma_f32_16x16x32_bf16 v[64:67], a[60:63], a[116:119], v[64:67]
    ds_read_b64_tr_b16 a[0:1], v15 offset:0
    buffer_load_dword v31, v29, s[16:19], s52 offen
    v_mfma_f32_16x16x32_bf16 v[68:71], a[68:71], a[116:119], v[68:71]
    ds_read_b128 a[132:135], v14 offset:4096
    s_add_u32 s52, s52, s37
    v_mfma_f32_16x16x32_bf16 v[68:71], a[64:67], a[112:115], v[68:71]
    v_mfma_f32_16x16x32_bf16 v[72:75], a[72:75], a[112:115], v[72:75]
    ds_read_b64_tr_b16 a[2:3], v15 offset:1536
    v_mfma_f32_16x16x32_bf16 v[72:75], a[76:79], a[116:119], v[72:75]
    v_mfma_f32_16x16x32_bf16 v[76:79], a[84:87], a[116:119], v[76:79]
    ds_read_b64_tr_b16 a[4:5], v15 offset:12288
    v_mfma_f32_16x16x32_bf16 v[76:79], a[80:83], a[112:115], v[76:79]
    buffer_load_dword v31, v28, s[20:23], s53 offen
    v_mfma_f32_16x16x32_bf16 v[80:83], a[112:115], a[88:91], v[80:83]
    ds_read_b64_tr_b16 a[6:7], v15 offset:13824
    s_add_u32 s53, s53, s38
    v_mfma_f32_16x16x32_bf16 v[80:83], a[116:119], a[92:95], v[80:83]
    v_mfma_f32_16x16x32_bf16 v[84:87], a[116:119], a[100:103], v[84:87]
    ds_read_b64_tr_b16 a[8:9], v16 offset:0
    v_mfma_f32_16x16x32_bf16 v[84:87], a[112:115], a[96:99], v[84:87]
    s_waitcnt lgkmcnt(7)
    ds_read_b64_tr_b16 a[10:11], v16 offset:1536
    v_mfma_f32_16x16x32_bf16 v[108:111], a[120:123], a[96:99], v[108:111]
    ds_read_b128 a[136:139], v13 offset:6144
    s_add_u32 m0, s35, s40
    v_mfma_f32_16x16x32_bf16 v[108:111], a[124:127], a[100:103], v[108:111]
    buffer_load_dwordx4 v2, s[4:7], s31 offen offset:0 lds
    v_mfma_f32_16x16x32_bf16 v[104:107], a[124:127], a[92:95], v[104:107]
    ds_read_b128 a[140:143], v14 offset:6144
    v_mfma_f32_16x16x32_bf16 v[104:107], a[120:123], a[88:91], v[104:107]
    v_mfma_f32_16x16x32_bf16 v[100:103], a[80:83], a[120:123], v[100:103]
    ds_read_b64_tr_b16 a[12:13], v16 offset:12288
    v_mfma_f32_16x16x32_bf16 v[100:103], a[84:87], a[124:127], v[100:103]
    v_mfma_f32_16x16x32_bf16 v[96:99], a[76:79], a[124:127], v[96:99]
    ds_read_b64_tr_b16 a[14:15], v16 offset:13824
    v_mfma_f32_16x16x32_bf16 v[96:99], a[72:75], a[120:123], v[96:99]
    buffer_load_dwordx4 v3, s[4:7], s31 offen offset:1024 lds
    v_mfma_f32_16x16x32_bf16 v[92:95], a[64:67], a[120:123], v[92:95]
    ds_read_b64_tr_b16 a[16:17], v15 offset:128
    v_mfma_f32_16x16x32_bf16 v[92:95], a[68:71], a[124:127], v[92:95]
    v_mfma_f32_16x16x32_bf16 v[88:91], a[60:63], a[124:127], v[88:91]
    ds_read_b64_tr_b16 a[18:19], v15 offset:1664
    v_mfma_f32_16x16x32_bf16 v[88:91], a[56:59], a[120:123], v[88:91]
    s_waitcnt lgkmcnt(11)
    v_mfma_f32_16x16x32_bf16 v[112:115], a[56:59], a[128:131], v[112:115]
    ds_read_b128 a[112:115], v13 offset:8192
    v_mfma_f32_16x16x32_bf16 v[112:115], a[60:63], a[132:135], v[112:115]
    ds_read_b64_tr_b16 a[20:21], v15 offset:12416
    v_mfma_f32_16x16x32_bf16 v[116:119], a[68:71], a[132:135], v[116:119]
    ds_read_b128 a[116:119], v14 offset:8192
    v_mfma_f32_16x16x32_bf16 v[116:119], a[64:67], a[128:131], v[116:119]
    buffer_load_dwordx4 v4, s[4:7], s31 offen offset:2048 lds
    v_mfma_f32_16x16x32_bf16 v[120:123], a[72:75], a[128:131], v[120:123]
    ds_read_b64_tr_b16 a[22:23], v15 offset:13952
    v_mfma_f32_16x16x32_bf16 v[120:123], a[76:79], a[132:135], v[120:123]
    v_mfma_f32_16x16x32_bf16 v[124:127], a[84:87], a[132:135], v[124:127]
    ds_read_b64_tr_b16 a[24:25], v16 offset:128
    v_mfma_f32_16x16x32_bf16 v[124:127], a[80:83], a[128:131], v[124:127]
    v_mfma_f32_16x16x32_bf16 v[128:131], a[128:131], a[88:91], v[128:131]
    ds_read_b64_tr_b16 a[26:27], v16 offset:1664
    v_mfma_f32_16x16x32_bf16 v[128:131], a[132:135], a[92:95], v[128:131]
    buffer_load_dwordx4 v5, s[4:7], s31 offen offset:3072 lds
    v_mfma_f32_16x16x32_bf16 v[132:135], a[132:135], a[100:103], v[132:135]
    ds_read_b64_tr_b16 a[28:29], v16 offset:12416
    v_mfma_f32_16x16x32_bf16 v[132:135], a[128:131], a[96:99], v[132:135]
    s_waitcnt lgkmcnt(11)
    ds_read_b64_tr_b16 a[30:31], v16 offset:13952
    v_mfma_f32_16x16x32_bf16 v[156:159], a[136:139], a[96:99], v[156:159]
    ds_read_b128 a[120:123], v13 offset:10240
    v_mfma_f32_16x16x32_bf16 v[156:159], a[140:143], a[100:103], v[156:159]
    v_mfma_f32_16x16x32_bf16 v[152:155], a[140:143], a[92:95], v[152:155]
    ds_read_b128 a[124:127], v14 offset:10240
    v_mfma_f32_16x16x32_bf16 v[152:155], a[136:139], a[88:91], v[152:155]
    v_mfma_f32_16x16x32_bf16 v[148:151], a[80:83], a[136:139], v[148:151]
    ds_read_b64_tr_b16 a[32:33], v15 offset:256
    s_add_u32 m0, s35, s41
    v_mfma_f32_16x16x32_bf16 v[148:151], a[84:87], a[140:143], v[148:151]
    buffer_load_dwordx4 v2, s[4:7], s32 offen offset:0 lds
    v_mfma_f32_16x16x32_bf16 v[144:147], a[76:79], a[140:143], v[144:147]
    ds_read_b64_tr_b16 a[34:35], v15 offset:1792
    v_mfma_f32_16x16x32_bf16 v[144:147], a[72:75], a[136:139], v[144:147]
    v_mfma_f32_16x16x32_bf16 v[140:143], a[64:67], a[136:139], v[140:143]
    ds_read_b64_tr_b16 a[36:37], v15 offset:12544
    v_mfma_f32_16x16x32_bf16 v[140:143], a[68:71], a[140:143], v[140:143]
    v_mfma_f32_16x16x32_bf16 v[136:139], a[60:63], a[140:143], v[136:139]
    ds_read_b64_tr_b16 a[38:39], v15 offset:14080
    v_mfma_f32_16x16x32_bf16 v[136:139], a[56:59], a[136:139], v[136:139]
    s_waitcnt lgkmcnt(11)
    buffer_load_dwordx4 v3, s[4:7], s32 offen offset:1024 lds
    v_mfma_f32_16x16x32_bf16 v[160:163], a[56:59], a[112:115], v[160:163]
    ds_read_b128 a[128:131], v13 offset:12288
    v_mfma_f32_16x16x32_bf16 v[160:163], a[60:63], a[116:119], v[160:163]
    ds_read_b64_tr_b16 a[40:41], v16 offset:256
    v_mfma_f32_16x16x32_bf16 v[164:167], a[68:71], a[116:119], v[164:167]
    ds_read_b128 a[132:135], v14 offset:12288
    v_mfma_f32_16x16x32_bf16 v[164:167], a[64:67], a[112:115], v[164:167]
    v_mfma_f32_16x16x32_bf16 v[168:171], a[72:75], a[112:115], v[168:171]
    ds_read_b64_tr_b16 a[42:43], v16 offset:1792
    v_mfma_f32_16x16x32_bf16 v[168:171], a[76:79], a[116:119], v[168:171]
    v_mfma_f32_16x16x32_bf16 v[172:175], a[84:87], a[116:119], v[172:175]
    ds_read_b64_tr_b16 a[44:45], v16 offset:12544
    v_mfma_f32_16x16x32_bf16 v[172:175], a[80:83], a[112:115], v[172:175]
    buffer_load_dwordx4 v4, s[4:7], s32 offen offset:2048 lds
    v_mfma_f32_16x16x32_bf16 v[176:179], a[112:115], a[88:91], v[176:179]
    ds_read_b64_tr_b16 a[46:47], v16 offset:14080
    v_mfma_f32_16x16x32_bf16 v[176:179], a[116:119], a[92:95], v[176:179]
    v_mfma_f32_16x16x32_bf16 v[180:183], a[116:119], a[100:103], v[180:183]
    v_mfma_f32_16x16x32_bf16 v[180:183], a[112:115], a[96:99], v[180:183]
    s_waitcnt lgkmcnt(10)
    v_mfma_f32_16x16x32_bf16 v[204:207], a[120:123], a[96:99], v[204:207]
    ds_read_b128 a[136:139], v13 offset:14336
    v_mfma_f32_16x16x32_bf16 v[204:207], a[124:127], a[100:103], v[204:207]
    buffer_load_dwordx4 v5, s[4:7], s32 offen offset:3072 lds
    v_mfma_f32_16x16x32_bf16 v[200:203], a[124:127], a[92:95], v[200:203]
    ds_read_b128 a[140:143], v14 offset:14336
    s_add_u32 s31, s31, 128
    s_add_u32 s32, s32, 128
    v_mfma_f32_16x16x32_bf16 v[200:203], a[120:123], a[88:91], v[200:203]
    v_mfma_f32_16x16x32_bf16 v[196:199], a[80:83], a[120:123], v[196:199]
    s_add_u32 s46, s34, 0x8000
    s_cmp_eq_u32 s46, 0x18000
    s_cselect_b32 s46, 0, s46
    v_mfma_f32_16x16x32_bf16 v[196:199], a[84:87], a[124:127], v[196:199]
    s_sub_u32 s36, s46, s34
    s_mov_b32 s35, s34
    v_mfma_f32_16x16x32_bf16 v[192:195], a[76:79], a[124:127], v[192:195]
    s_mov_b32 s34, s46
    v_add_u32 v13, s36, v13
    v_mfma_f32_16x16x32_bf16 v[192:195], a[72:75], a[120:123], v[192:195]
    v_add_u32 v14, s36, v14
    v_mfma_f32_16x16x32_bf16 v[188:191], a[64:67], a[120:123], v[188:191]
    v_mfma_f32_16x16x32_bf16 v[188:191], a[68:71], a[124:127], v[188:191]
    v_mfma_f32_16x16x32_bf16 v[184:187], a[60:63], a[124:127], v[184:187]
    v_mfma_f32_16x16x32_bf16 v[184:187], a[56:59], a[120:123], v[184:187]
    s_waitcnt vmcnt(10) lgkmcnt(0)
    s_barrier
    v_mfma_f32_16x16x32_bf16 v[208:211], a[56:59], a[128:131], v[208:211]
    ds_read_b128 a[112:115], v13 offset:0
    s_add_u32 m0, s42, 98304
    v_mfma_f32_16x16x32_bf16 v[208:211], a[60:63], a[132:135], v[208:211]
    buffer_load_dwordx4 v6, s[8:11], s33 offen offset:0 lds
    v_mfma_f32_16x16x32_bf16 v[212:215], a[68:71], a[132:135], v[212:215]
    ds_read_b128 a[116:119], v14 offset:0
    v_mfma_f32_16x16x32_bf16 v[212:215], a[64:67], a[128:131], v[212:215]
    v_mfma_f32_16x16x32_bf16 v[216:219], a[72:75], a[128:131], v[216:219]
    v_mfma_f32_16x16x32_bf16 v[216:219], a[76:79], a[132:135], v[216:219]
    buffer_load_dwordx4 v7, s[8:11], s33 offen offset:1024 lds
    v_mfma_f32_16x16x32_bf16 v[220:223], a[84:87], a[132:135], v[220:223]
    v_mfma_f32_16x16x32_bf16 v[220:223], a[80:83], a[128:131], v[220:223]
    v_mfma_f32_16x16x32_bf16 v[224:227], a[128:131], a[88:91], v[224:227]
    v_mfma_f32_16x16x32_bf16 v[224:227], a[132:135], a[92:95], v[224:227]
    buffer_load_dwordx4 v8, s[8:11], s33 offen offset:2048 lds
    v_mfma_f32_16x16x32_bf16 v[228:231], a[132:135], a[100:103], v[228:231]
    v_mfma_f32_16x16x32_bf16 v[228:231], a[128:131], a[96:99], v[228:231]
    v_mfma_f32_16x16x32_bf16 v[252:255], a[136:139], a[96:99], v[252:255]
    ds_read_b128 a[120:123], v13 offset:2048
    v_mfma_f32_16x16x32_bf16 v[252:255], a[140:143], a[100:103], v[252:255]
    buffer_load_dwordx4 v9, s[8:11], s33 offen offset:3072 lds
    v_mfma_f32_16x16x32_bf16 v[248:251], a[140:143], a[92:95], v[248:251]
    ds_read_b128 a[124:127], v14 offset:2048
    v_mfma_f32_16x16x32_bf16 v[248:251], a[136:139], a[88:91], v[248:251]
    v_mfma_f32_16x16x32_bf16 v[244:247], a[80:83], a[136:139], v[244:247]
    s_add_u32 m0, s42, 102400
    v_mfma_f32_16x16x32_bf16 v[244:247], a[84:87], a[140:143], v[244:247]
    buffer_load_dwordx4 v10, s[8:11], s33 offen offset:0 lds
    v_mfma_f32_16x16x32_bf16 v[240:243], a[76:79], a[140:143], v[240:243]
    v_mfma_f32_16x16x32_bf16 v[240:243], a[72:75], a[136:139], v[240:243]
    v_mfma_f32_16x16x32_bf16 v[236:239], a[64:67], a[136:139], v[236:239]
    v_mfma_f32_16x16x32_bf16 v[236:239], a[68:71], a[140:143], v[236:239]
    buffer_load_dwordx4 v11, s[8:11], s33 offen offset:1024 lds
    v_mfma_f32_16x16x32_bf16 v[232:235], a[60:63], a[140:143], v[232:235]
    s_add_u32 s33, s33, 393216
    v_mfma_f32_16x16x32_bf16 v[232:235], a[56:59], a[136:139], v[232:235]
    s_waitcnt lgkmcnt(2)
    v_mfma_f32_16x16x32_bf16 v[64:67], a[0:3], a[112:115], v[64:67]
    ds_read_b128 a[128:131], v13 offset:4096
    v_mfma_f32_16x16x32_bf16 v[64:67], a[4:7], a[116:119], v[64:67]
    ds_read_b64_tr_b16 a[56:57], v15 offset:24576
    buffer_load_dword v31, v29, s[16:19], s52 offen
    v_mfma_f32_16x16x32_bf16 v[68:71], a[12:15], a[116:119], v[68:71]
    ds_read_b128 a[132:135], v14 offset:4096
    s_add_u32 s52, s52, s37
    v_mfma_f32_16x16x32_bf16 v[68:71], a[8:11], a[112:115], v[68:71]
    v_mfma_f32_16x16x32_bf16 v[72:75], a[16:19], a[112:115], v[72:75]
    ds_read_b64_tr_b16 a[58:59], v15 offset:26112
    v_mfma_f32_16x16x32_bf16 v[72:75], a[20:23], a[116:119], v[72:75]
    v_mfma_f32_16x16x32_bf16 v[76:79], a[28:31], a[116:119], v[76:79]
    ds_read_b64_tr_b16 a[60:61], v15 offset:36864
    v_mfma_f32_16x16x32_bf16 v[76:79], a[24:27], a[112:115], v[76:79]
    buffer_load_dword v31, v28, s[20:23], s53 offen
    v_mfma_f32_16x16x32_bf16 v[80:83], a[112:115], a[32:35], v[80:83]
    ds_read_b64_tr_b16 a[62:63], v15 offset:38400
    s_add_u32 s53, s53, s38
    v_mfma_f32_16x16x32_bf16 v[80:83], a[116:119], a[36:39], v[80:83]
    v_mfma_f32_16x16x32_bf16 v[84:87], a[116:119], a[44:47], v[84:87]
    ds_read_b64_tr_b16 a[64:65], v16 offset:24576
    v_mfma_f32_16x16x32_bf16 v[84:87], a[112:115], a[40:43], v[84:87]
    s_waitcnt lgkmcnt(7)
    ds_read_b64_tr_b16 a[66:67], v16 offset:26112
    v_mfma_f32_16x16x32_bf16 v[108:111], a[120:123], a[40:43], v[108:111]
    ds_read_b128 a[136:139], v13 offset:6144
    s_add_u32 m0, s35, s40
    v_mfma_f32_16x16x32_bf16 v[108:111], a[124:127], a[44:47], v[108:111]
    buffer_load_dwordx4 v2, s[4:7], s31 offen offset:0 lds
    v_mfma_f32_16x16x32_bf16 v[104:107], a[124:127], a[36:39], v[104:107]
    ds_read_b128 a[140:143], v14 offset:6144
    v_mfma_f32_16x16x32_bf16 v[104:107], a[120:123], a[32:35], v[104:107]
    v_mfma_f32_16x16x32_bf16 v[100:103], a[24:27], a[120:123], v[100:103]
    ds_read_b64_tr_b16 a[68:69], v16 offset:36864
    v_mfma_f32_16x16x32_bf16 v[100:103], a[28:31], a[124:127], v[100:103]
    v_mfma_f32_16x16x32_bf16 v[96:99], a[20:23], a[124:127], v[96:99]
    ds_read_b64_tr_b16 a[70:71], v16 offset:38400
    v_mfma_f32_16x16x32_bf16 v[96:99], a[16:19], a[120:123], v[96:99]
    buffer_load_dwordx4 v3, s[4:7], s31 offen offset:1024 lds
    v_mfma_f32_16x16x32_bf16 v[92:95], a[8:11], a[120:123], v[92:95]
    ds_read_b64_tr_b16 a[72:73], v15 offset:24704
    v_mfma_f32_16x16x32_bf16 v[92:95], a[12:15], a[124:127], v[92:95]
    v_mfma_f32_16x16x32_bf16 v[88:91], a[4:7], a[124:127], v[88:91]
    ds_read_b64_tr_b16 a[74:75], v15 offset:26240
    v_mfma_f32_16x16x32_bf16 v[88:91], a[0:3], a[120:123], v[88:91]
    s_waitcnt lgkmcnt(11)
    v_mfma_f32_16x16x32_bf16 v[112:115], a[0:3], a[128:131], v[112:115]
    ds_read_b128 a[112:115], v13 offset:8192
    v_mfma_f32_16x16x32_bf16 v[112:115], a[4:7], a[132:135], v[112:115]
    ds_read_b64_tr_b16 a[76:77], v15 offset:36992
    v_mfma_f32_16x16x32_bf16 v[116:119], a[12:15], a[132:135], v[116:119]
    ds_read_b128 a[116:119], v14 offset:8192
    v_mfma_f32_16x16x32_bf16 v[116:119], a[8:11], a[128:131], v[116:119]
    buffer_load_dwordx4 v4, s[4:7], s31 offen offset:2048 lds
    v_mfma_f32_16x16x32_bf16 v[120:123], a[16:19], a[128:131], v[120:123]
    ds_read_b64_tr_b16 a[78:79], v15 offset:38528
    v_mfma_f32_16x16x32_bf16 v[120:123], a[20:23], a[132:135], v[120:123]
    v_mfma_f32_16x16x32_bf16 v[124:127], a[28:31], a[132:135], v[124:127]
    ds_read_b64_tr_b16 a[80:81], v16 offset:24704
    v_mfma_f32_16x16x32_bf16 v[124:127], a[24:27], a[128:131], v[124:127]
    v_mfma_f32_16x16x32_bf16 v[128:131], a[128:131], a[32:35], v[128:131]
    ds_read_b64_tr_b16 a[82:83], v16 offset:26240
    v_mfma_f32_16x16x32_bf16 v[128:131], a[132:135], a[36:39], v[128:131]
    buffer_load_dwordx4 v5, s[4:7], s31 offen offset:3072 lds
    v_mfma_f32_16x16x32_bf16 v[132:135], a[132:135], a[44:47], v[132:135]
    ds_read_b64_tr_b16 a[84:85], v16 offset:36992
    v_mfma_f32_16x16x32_bf16 v[132:135], a[128:131], a[40:43], v[132:135]
    s_waitcnt lgkmcnt(11)
    ds_read_b64_tr_b16 a[86:87], v16 offset:38528
    v_mfma_f32_16x16x32_bf16 v[156:159], a[136:139], a[40:43], v[156:159]
    ds_read_b128 a[120:123], v13 offset:10240
    v_mfma_f32_16x16x32_bf16 v[156:159], a[140:143], a[44:47], v[156:159]
    v_mfma_f32_16x16x32_bf16 v[152:155], a[140:143], a[36:39], v[152:155]
    ds_read_b128 a[124:127], v14 offset:10240
    v_mfma_f32_16x16x32_bf16 v[152:155], a[136:139], a[32:35], v[152:155]
    v_mfma_f32_16x16x32_bf16 v[148:151], a[24:27], a[136:139], v[148:151]
    ds_read_b64_tr_b16 a[88:89], v15 offset:24832
    s_add_u32 m0, s35, s41
    v_mfma_f32_16x16x32_bf16 v[148:151], a[28:31], a[140:143], v[148:151]
    buffer_load_dwordx4 v2, s[4:7], s32 offen offset:0 lds
    v_mfma_f32_16x16x32_bf16 v[144:147], a[20:23], a[140:143], v[144:147]
    ds_read_b64_tr_b16 a[90:91], v15 offset:26368
    v_mfma_f32_16x16x32_bf16 v[144:147], a[16:19], a[136:139], v[144:147]
    v_mfma_f32_16x16x32_bf16 v[140:143], a[8:11], a[136:139], v[140:143]
    ds_read_b64_tr_b16 a[92:93], v15 offset:37120
    v_mfma_f32_16x16x32_bf16 v[140:143], a[12:15], a[140:143], v[140:143]
    v_mfma_f32_16x16x32_bf16 v[136:139], a[4:7], a[140:143], v[136:139]
    ds_read_b64_tr_b16 a[94:95], v15 offset:38656
    v_mfma_f32_16x16x32_bf16 v[136:139], a[0:3], a[136:139], v[136:139]
    s_waitcnt lgkmcnt(11)
    buffer_load_dwordx4 v3, s[4:7], s32 offen offset:1024 lds
    v_mfma_f32_16x16x32_bf16 v[160:163], a[0:3], a[112:115], v[160:163]
    ds_read_b128 a[128:131], v13 offset:12288
    v_mfma_f32_16x16x32_bf16 v[160:163], a[4:7], a[116:119], v[160:163]
    ds_read_b64_tr_b16 a[96:97], v16 offset:24832
    v_mfma_f32_16x16x32_bf16 v[164:167], a[12:15], a[116:119], v[164:167]
    ds_read_b128 a[132:135], v14 offset:12288
    v_mfma_f32_16x16x32_bf16 v[164:167], a[8:11], a[112:115], v[164:167]
    v_mfma_f32_16x16x32_bf16 v[168:171], a[16:19], a[112:115], v[168:171]
    ds_read_b64_tr_b16 a[98:99], v16 offset:26368
    v_mfma_f32_16x16x32_bf16 v[168:171], a[20:23], a[116:119], v[168:171]
    v_mfma_f32_16x16x32_bf16 v[172:175], a[28:31], a[116:119], v[172:175]
    ds_read_b64_tr_b16 a[100:101], v16 offset:37120
    v_mfma_f32_16x16x32_bf16 v[172:175], a[24:27], a[112:115], v[172:175]
    buffer_load_dwordx4 v4, s[4:7], s32 offen offset:2048 lds
    v_mfma_f32_16x16x32_bf16 v[176:179], a[112:115], a[32:35], v[176:179]
    ds_read_b64_tr_b16 a[102:103], v16 offset:38656
    v_mfma_f32_16x16x32_bf16 v[176:179], a[116:119], a[36:39], v[176:179]
    v_mfma_f32_16x16x32_bf16 v[180:183], a[116:119], a[44:47], v[180:183]
    v_mfma_f32_16x16x32_bf16 v[180:183], a[112:115], a[40:43], v[180:183]
    s_waitcnt lgkmcnt(10)
    v_mfma_f32_16x16x32_bf16 v[204:207], a[120:123], a[40:43], v[204:207]
    ds_read_b128 a[136:139], v13 offset:14336
    v_mfma_f32_16x16x32_bf16 v[204:207], a[124:127], a[44:47], v[204:207]
    buffer_load_dwordx4 v5, s[4:7], s32 offen offset:3072 lds
    v_mfma_f32_16x16x32_bf16 v[200:203], a[124:127], a[36:39], v[200:203]
    ds_read_b128 a[140:143], v14 offset:14336
    s_add_u32 s31, s31, 128
    s_add_u32 s32, s32, 128
    v_mfma_f32_16x16x32_bf16 v[200:203], a[120:123], a[32:35], v[200:203]
    v_mfma_f32_16x16x32_bf16 v[196:199], a[24:27], a[120:123], v[196:199]
    s_add_u32 s46, s34, 0x8000
    s_cmp_eq_u32 s46, 0x18000
    s_cselect_b32 s46, 0, s46
    v_mfma_f32_16x16x32_bf16 v[196:199], a[28:31], a[124:127], v[196:199]
    s_sub_u32 s36, s46, s34
    s_mov_b32 s35, s34
    v_mfma_f32_16x16x32_bf16 v[192:195], a[20:23], a[124:127], v[192:195]
    s_mov_b32 s34, s46
    v_add_u32 v13, s36, v13
    v_mfma_f32_16x16x32_bf16 v[192:195], a[16:19], a[120:123], v[192:195]
    v_add_u32 v14, s36, v14
    v_mfma_f32_16x16x32_bf16 v[188:191], a[8:11], a[120:123], v[188:191]
    v_mfma_f32_16x16x32_bf16 v[188:191], a[12:15], a[124:127], v[188:191]
    s_add_u32 s39, s39, 1
    v_mfma_f32_16x16x32_bf16 v[184:187], a[4:7], a[124:127], v[184:187]
    s_cmp_lt_u32 s39, s43
    v_mfma_f32_16x16x32_bf16 v[184:187], a[0:3], a[120:123], v[184:187]
    s_waitcnt vmcnt(10) lgkmcnt(0)
    s_barrier
    s_cbranch_scc1 L_loopQ
    s_cmp_eq_u32 s39, 6
    s_cbranch_scc1 L_doneQ
    s_mov_b32 s43, 6
    s_mov_b64 s[16:17], s[64:65]
    s_mov_b32 s18, s66
    s_mov_b64 s[20:21], s[68:69]
    s_mov_b32 s22, s70
    s_lshr_b32 s44, s2, 0
    s_lshl2_add_u32 s44, s44, s28
    s_lshl_b32 s52, s44, 10
    s_mul_i32 s53, s44, 384
    s_mov_b32 s37, 0x100000
    s_mov_b32 s38, 0x60000
    v_lshlrev_b32 v29, 4, v1
    v_min_u32 v28, 2, v1
    v_lshlrev_b32 v28, 7, v28
    global_load_dword v31, v30, s[84:85]
    s_cmp_lg_u32 s3, 4
    s_cbranch_scc1 L_loopQ
    v_mov_b32 v18, 0
    v_mov_b32 v19, 1
    s_mov_b64 exec, 1
    global_store_dword v18, v19, s[24:25] sc1
    s_mov_b64 exec, -1
    s_branch L_loopQ
L_doneQ:
    v_mfma_f32_16x16x32_bf16 v[208:211], a[0:3], a[128:131], v[208:211]
    ds_read_b128 a[112:115], v13 offset:0
    s_add_u32 m0, s42, 122880
    v_mfma_f32_16x16x32_bf16 v[208:211], a[4:7], a[132:135], v[208:211]
    buffer_load_dwordx4 v6, s[8:11], s33 offen offset:0 lds
    s_lshl_b32 s44, s30, 15
    s_lshl_b32 s45, s57, 8
    s_add_u32 s44, s44, s45
    v_mfma_f32_16x16x32_bf16 v[212:215], a[12:15], a[132:135], v[212:215]
    ds_read_b128 a[116:119], v14 offset:0
    v_mfma_f32_16x16x32_bf16 v[212:215], a[8:11], a[128:131], v[212:215]
    v_mfma_f32_16x16x32_bf16 v[216:219], a[16:19], a[128:131], v[216:219]
    v_mfma_f32_16x16x32_bf16 v[216:219], a[20:23], a[132:135], v[216:219]
    buffer_load_dwordx4 v7, s[8:11], s33 offen offset:1024 lds
    v_lshrrev_b32 v22, 4, v1
    v_mfma_f32_16x16x32_bf16 v[220:223], a[28:31], a[132:135], v[220:223]
    v_mfma_f32_16x16x32_bf16 v[220:223], a[24:27], a[128:131], v[220:223]
    v_mfma_f32_16x16x32_bf16 v[224:227], a[128:131], a[32:35], v[224:227]
    v_mfma_f32_16x16x32_bf16 v[224:227], a[132:135], a[36:39], v[224:227]
    buffer_load_dwordx4 v8, s[8:11], s33 offen offset:2048 lds
    v_lshlrev_b32 v23, 1, v22
    v_mfma_f32_16x16x32_bf16 v[228:231], a[132:135], a[44:47], v[228:231]
    v_mfma_f32_16x16x32_bf16 v[228:231], a[128:131], a[40:43], v[228:231]
    v_mfma_f32_16x16x32_bf16 v[252:255], a[136:139], a[40:43], v[252:255]
    ds_read_b128 a[120:123], v13 offset:2048
    v_mfma_f32_16x16x32_bf16 v[252:255], a[140:143], a[44:47], v[252:255]
    buffer_load_dwordx4 v9, s[8:11], s33 offen offset:3072 lds
    v_and_b32 v24, 15, v1
    v_mfma_f32_16x16x32_bf16 v[248:251], a[140:143], a[36:39], v[248:251]
    ds_read_b128 a[124:127], v14 offset:2048
    v_mfma_f32_16x16x32_bf16 v[248:251], a[136:139], a[32:35], v[248:251]
    v_mfma_f32_16x16x32_bf16 v[244:247], a[24:27], a[136:139], v[244:247]
    s_add_u32 m0, s42, 126976
    v_mfma_f32_16x16x32_bf16 v[244:247], a[28:31], a[140:143], v[244:247]
    buffer_load_dwordx4 v10, s[8:11], s33 offen offset:0 lds
    v_xor_b32 v23, v23, v24
    v_mfma_f32_16x16x32_bf16 v[240:243], a[20:23], a[140:143], v[240:243]
    v_mfma_f32_16x16x32_bf16 v[240:243], a[16:19], a[136:139], v[240:243]
    v_mfma_f32_16x16x32_bf16 v[236:239], a[8:11], a[136:139], v[236:239]
    v_mfma_f32_16x16x32_bf16 v[236:239], a[12:15], a[140:143], v[236:239]
    buffer_load_dwordx4 v11, s[8:11], s33 offen offset:1024 lds
    v_lshlrev_b32 v23, 4, v23
    v_mfma_f32_16x16x32_bf16 v[232:235], a[4:7], a[140:143], v[232:235]
    s_add_u32 s33, s33, 393216
    v_mfma_f32_16x16x32_bf16 v[232:235], a[0:3], a[136:139], v[232:235]
    s_waitcnt lgkmcnt(2)
    v_mfma_f32_16x16x32_bf16 v[64:67], a[56:59], a[112:115], v[64:67]
    ds_read_b128 a[128:131], v13 offset:4096
    v_mfma_f32_16x16x32_bf16 v[64:67], a[60:63], a[116:119], v[64:67]
    ds_read_b64_tr_b16 a[0:1], v15 offset:0
    buffer_load_dword v31, v29, s[16:19], s52 offen
    v_lshl_add_u32 v23, v22, 11, v23
    v_mfma_f32_16x16x32_bf16 v[68:71], a[68:71], a[116:119], v[68:71]
    ds_read_b128 a[132:135], v14 offset:4096
    s_add_u32 s52, s52, s37
    v_mfma_f32_16x16x32_bf16 v[68:71], a[64:67], a[112:115], v[68:71]
    v_mfma_f32_16x16x32_bf16 v[72:75], a[72:75], a[112:115], v[72:75]
    ds_read_b64_tr_b16 a[2:3], v15 offset:1536
    v_mfma_f32_16x16x32_bf16 v[72:75], a[76:79], a[116:119], v[72:75]
    v_add_u32 v18, s44, v23
    v_mfma_f32_16x16x32_bf16 v[76:79], a[84:87], a[116:119], v[76:79]
    ds_read_b64_tr_b16 a[4:5], v15 offset:12288
    v_mfma_f32_16x16x32_bf16 v[76:79], a[80:83], a[112:115], v[76:79]
    buffer_load_dword v31, v28, s[20:23], s53 offen
    v_mfma_f32_16x16x32_bf16 v[80:83], a[112:115], a[88:91], v[80:83]
    ds_read_b64_tr_b16 a[6:7], v15 offset:13824
    s_add_u32 s53, s53, s38
    v_mfma_f32_16x16x32_bf16 v[80:83], a[116:119], a[92:95], v[80:83]
    v_xor_b32 v23, 128, v18
    v_mfma_f32_16x16x32_bf16 v[84:87], a[116:119], a[100:103], v[84:87]
    ds_read_b64_tr_b16 a[8:9], v16 offset:0
    v_mfma_f32_16x16x32_bf16 v[84:87], a[112:115], a[96:99], v[84:87]
    s_waitcnt lgkmcnt(7)
    ds_read_b64_tr_b16 a[10:11], v16 offset:1536
    v_mfma_f32_16x16x32_bf16 v[108:111], a[120:123], a[96:99], v[108:111]
    ds_read_b128 a[136:139], v13 offset:6144
    s_add_u32 m0, s35, s40
    v_mfma_f32_16x16x32_bf16 v[108:111], a[124:127], a[100:103], v[108:111]
    buffer_load_dwordx4 v2, s[4:7], s31 offen offset:0 lds
    v_add_u32 v19, 7168, v23
    v_mfma_f32_16x16x32_bf16 v[104:107], a[124:127], a[92:95], v[104:107]
    ds_read_b128 a[140:143], v14 offset:6144
    v_mfma_f32_16x16x32_bf16 v[104:107], a[120:123], a[88:91], v[104:107]
    v_mfma_f32_16x16x32_bf16 v[100:103], a[80:83], a[120:123], v[100:103]
    ds_read_b64_tr_b16 a[12:13], v16 offset:12288
    v_mfma_f32_16x16x32_bf16 v[100:103], a[84:87], a[124:127], v[100:103]
    v_add_u32 v20, 14336, v18
    v_mfma_f32_16x16x32_bf16 v[96:99], a[76:79], a[124:127], v[96:99]
    ds_read_b64_tr_b16 a[14:15], v16 offset:13824
    v_mfma_f32_16x16x32_bf16 v[96:99], a[72:75], a[120:123], v[96:99]
    buffer_load_dwordx4 v3, s[4:7], s31 offen offset:1024 lds
    v_mfma_f32_16x16x32_bf16 v[92:95], a[64:67], a[120:123], v[92:95]
    ds_read_b64_tr_b16 a[16:17], v15 offset:128
    v_mfma_f32_16x16x32_bf16 v[92:95], a[68:71], a[124:127], v[92:95]
    v_add_u32 v21, 21504, v23
    v_mfma_f32_16x16x32_bf16 v[88:91], a[60:63], a[124:127], v[88:91]
    ds_read_b64_tr_b16 a[18:19], v15 offset:1664
    v_mfma_f32_16x16x32_bf16 v[88:91], a[56:59], a[120:123], v[88:91]
    s_waitcnt lgkmcnt(11)
    v_mfma_f32_16x16x32_bf16 v[112:115], a[56:59], a[128:131], v[112:115]
    ds_read_b128 a[112:115], v13 offset:8192
    v_mfma_f32_16x16x32_bf16 v[112:115], a[60:63], a[132:135], v[112:115]
    ds_read_b64_tr_b16 a[20:21], v15 offset:12416
    v_lshrrev_b32 v46, 2, v1
    v_mfma_f32_16x16x32_bf16 v[116:119], a[68:71], a[132:135], v[116:119]
    ds_read_b128 a[116:119], v14 offset:8192
    v_mfma_f32_16x16x32_bf16 v[116:119], a[64:67], a[128:131], v[116:119]
    buffer_load_dwordx4 v4, s[4:7], s31 offen offset:2048 lds
    v_mfma_f32_16x16x32_bf16 v[120:123], a[72:75], a[128:131], v[120:123]
    ds_read_b64_tr_b16 a[22:23], v15 offset:13952
    v_mfma_f32_16x16x32_bf16 v[120:123], a[76:79], a[132:135], v[120:123]
    v_lshlrev_b32 v46, 6, v46
    v_mfma_f32_16x16x32_bf16 v[124:127], a[84:87], a[132:135], v[124:127]
    ds_read_b64_tr_b16 a[24:25], v16 offset:128
    v_mfma_f32_16x16x32_bf16 v[124:127], a[80:83], a[128:131], v[124:127]
    v_mfma_f32_16x16x32_bf16 v[128:131], a[128:131], a[88:91], v[128:131]
    ds_read_b64_tr_b16 a[26:27], v16 offset:1664
    v_mfma_f32_16x16x32_bf16 v[128:131], a[132:135], a[92:95], v[128:131]
    buffer_load_dwordx4 v5, s[4:7], s31 offen offset:3072 lds
    v_and_b32 v47, 3, v1
    v_mfma_f32_16x16x32_bf16 v[132:135], a[132:135], a[100:103], v[132:135]
    ds_read_b64_tr_b16 a[28:29], v16 offset:12416
    v_mfma_f32_16x16x32_bf16 v[132:135], a[128:131], a[96:99], v[132:135]
    s_waitcnt lgkmcnt(11)
    ds_read_b64_tr_b16 a[30:31], v16 offset:13952
    v_mfma_f32_16x16x32_bf16 v[156:159], a[136:139], a[96:99], v[156:159]
    ds_read_b128 a[120:123], v13 offset:10240
    v_mfma_f32_16x16x32_bf16 v[156:159], a[140:143], a[100:103], v[156:159]
    v_lshl_add_u32 v46, v47, 3, v46
    v_mfma_f32_16x16x32_bf16 v[152:155], a[140:143], a[92:95], v[152:155]
    ds_read_b128 a[124:127], v14 offset:10240
    v_mfma_f32_16x16x32_bf16 v[152:155], a[136:139], a[88:91], v[152:155]
    v_mfma_f32_16x16x32_bf16 v[148:151], a[80:83], a[136:139], v[148:151]
    ds_read_b64_tr_b16 a[32:33], v15 offset:256
    s_add_u32 m0, s35, s41
    v_mfma_f32_16x16x32_bf16 v[148:151], a[84:87], a[140:143], v[148:151]
    buffer_load_dwordx4 v2, s[4:7], s32 offen offset:0 lds
    v_add_u32 v46, s55, v46
    v_mfma_f32_16x16x32_bf16 v[144:147], a[76:79], a[140:143], v[144:147]
    ds_read_b64_tr_b16 a[34:35], v15 offset:1792
    v_mfma_f32_16x16x32_bf16 v[144:147], a[72:75], a[136:139], v[144:147]
    v_mfma_f32_16x16x32_bf16 v[140:143], a[64:67], a[136:139], v[140:143]
    ds_read_b64_tr_b16 a[36:37], v15 offset:12544
    v_mfma_f32_16x16x32_bf16 v[140:143], a[68:71], a[140:143], v[140:143]
    ds_read_b64_tr_b16 v[48:49], v46 offset:0
    v_mfma_f32_16x16x32_bf16 v[136:139], a[60:63], a[140:143], v[136:139]
    ds_read_b64_tr_b16 a[38:39], v15 offset:14080
    v_mfma_f32_16x16x32_bf16 v[136:139], a[56:59], a[136:139], v[136:139]
    s_waitcnt lgkmcnt(12)
    buffer_load_dwordx4 v3, s[4:7], s32 offen offset:1024 lds
    v_mfma_f32_16x16x32_bf16 v[160:163], a[56:59], a[112:115], v[160:163]
    ds_read_b128 a[128:131], v13 offset:12288
    v_mfma_f32_16x16x32_bf16 v[160:163], a[60:63], a[116:119], v[160:163]
    ds_read_b64_tr_b16 a[40:41], v16 offset:256
    ds_read_b64_tr_b16 v[50:51], v46 offset:1024
    v_mfma_f32_16x16x32_bf16 v[164:167], a[68:71], a[116:119], v[164:167]
    ds_read_b128 a[132:135], v14 offset:12288
    v_mfma_f32_16x16x32_bf16 v[164:167], a[64:67], a[112:115], v[164:167]
    v_mfma_f32_16x16x32_bf16 v[168:171], a[72:75], a[112:115], v[168:171]
    ds_read_b64_tr_b16 a[42:43], v16 offset:1792
    v_mfma_f32_16x16x32_bf16 v[168:171], a[76:79], a[116:119], v[168:171]
    ds_read_b64_tr_b16 v[52:53], v46 offset:32
    v_mfma_f32_16x16x32_bf16 v[172:175], a[84:87], a[116:119], v[172:175]
L_pg13:
    s_cbranch_execz L_tramp
    ds_read_b64_tr_b16 a[44:45], v16 offset:12544
    v_mfma_f32_16x16x32_bf16 v[172:175], a[80:83], a[112:115], v[172:175]
    buffer_load_dwordx4 v4, s[4:7], s32 offen offset:2048 lds
    v_mfma_f32_16x16x32_bf16 v[176:179], a[112:115], a[88:91], v[176:179]
    ds_read_b64_tr_b16 a[46:47], v16 offset:14080
    v_mfma_f32_16x16x32_bf16 v[176:179], a[116:119], a[92:95], v[176:179]
    ds_read_b64_tr_b16 v[54:55], v46 offset:1056
    v_mfma_f32_16x16x32_bf16 v[180:183], a[116:119], a[100:103], v[180:183]
    v_mfma_f32_16x16x32_bf16 v[180:183], a[112:115], a[96:99], v[180:183]
    s_waitcnt lgkmcnt(14)
    v_mfma_f32_16x16x32_bf16 v[204:207], a[120:123], a[96:99], v[204:207]
    ds_read_b128 a[136:139], v13 offset:14336
    v_mfma_f32_16x16x32_bf16 v[204:207], a[124:127], a[100:103], v[204:207]
    buffer_load_dwordx4 v5, s[4:7], s32 offen offset:3072 lds
    s_mov_b32 s48, 0xbfb8aa3b
    v_mfma_f32_16x16x32_bf16 v[200:203], a[124:127], a[92:95], v[200:203]
    ds_read_b128 a[140:143], v14 offset:14336
    s_add_u32 s31, s31, 128
    s_add_u32 s32, s32, 128
    v_mfma_f32_16x16x32_bf16 v[200:203], a[120:123], a[88:91], v[200:203]
    v_mfma_f32_16x16x32_bf16 v[196:199], a[80:83], a[120:123], v[196:199]
    s_add_u32 s46, s34, 0x8000
    s_cmp_eq_u32 s46, 0x18000
    s_cselect_b32 s46, 0, s46
    v_mfma_f32_16x16x32_bf16 v[196:199], a[84:87], a[124:127], v[196:199]
    s_sub_u32 s36, s46, s34
    s_mov_b32 s35, s34
    s_mov_b32 s50, 0x3fb8aa3b
    v_mfma_f32_16x16x32_bf16 v[192:195], a[76:79], a[124:127], v[192:195]
    s_mov_b32 s34, s46
    v_add_u32 v13, s36, v13
    v_mfma_f32_16x16x32_bf16 v[192:195], a[72:75], a[120:123], v[192:195]
    v_add_u32 v14, s36, v14
    v_mfma_f32_16x16x32_bf16 v[188:191], a[64:67], a[120:123], v[188:191]
    v_mfma_f32_16x16x32_bf16 v[188:191], a[68:71], a[124:127], v[188:191]
    v_mfma_f32_16x16x32_bf16 v[184:187], a[60:63], a[124:127], v[184:187]
    v_mfma_f32_16x16x32_bf16 v[184:187], a[56:59], a[120:123], v[184:187]
    s_waitcnt vmcnt(10) lgkmcnt(0)
    s_barrier
    v_mov_b64 v[2:3], v[18:19]
    v_mov_b64 v[4:5], v[20:21]
    v_mfma_f32_16x16x32_bf16 v[208:211], a[56:59], a[128:131], v[208:211]
    ds_read_b128 a[112:115], v13 offset:0
    v_mov_b32 v11, 0
    v_mfma_f32_16x16x32_bf16 v[208:211], a[60:63], a[132:135], v[208:211]
    s_mul_i32 s44, s30, 24576
    v_mfma_f32_16x16x32_bf16 v[212:215], a[68:71], a[132:135], v[212:215]
    ds_read_b128 a[116:119], v14 offset:0
    v_subrev_u32 v18, s44, v18
    v_mfma_f32_16x16x32_bf16 v[212:215], a[64:67], a[128:131], v[212:215]
    global_load_dword v31, v30, s[84:85]
    s_sub_u32 s44, s44, 8192
    v_mfma_f32_16x16x32_bf16 v[216:219], a[72:75], a[128:131], v[216:219]
    v_subrev_u32 v19, s44, v19
    v_mfma_f32_16x16x32_bf16 v[216:219], a[76:79], a[132:135], v[216:219]
    s_sub_u32 s44, s44, 8192
    v_mfma_f32_16x16x32_bf16 v[220:223], a[84:87], a[132:135], v[220:223]
    v_subrev_u32 v20, s44, v20
    v_mfma_f32_16x16x32_bf16 v[220:223], a[80:83], a[128:131], v[220:223]
    global_load_dword v29, v11, s[24:25] sc1
    s_sub_u32 s44, s44, 8192
    v_mfma_f32_16x16x32_bf16 v[224:227], a[128:131], a[88:91], v[224:227]
    v_subrev_u32 v21, s44, v21
    v_mfma_f32_16x16x32_bf16 v[224:227], a[132:135], a[92:95], v[224:227]
    s_sub_u32 s44, s44, 8192
    v_mfma_f32_16x16x32_bf16 v[228:231], a[132:135], a[100:103], v[228:231]
    s_add_u32 m0, s63, 65536
    s_add_u32 s47, s60, 0xe0000
    v_mfma_f32_16x16x32_bf16 v[228:231], a[128:131], a[96:99], v[228:231]
    buffer_load_dwordx4 v2, s[64:67], s47 offen offset:0 lds
    v_add_u32 v12, 40, v1
    v_mfma_f32_16x16x32_bf16 v[252:255], a[136:139], a[96:99], v[252:255]
    ds_read_b128 a[120:123], v13 offset:2048
    v_and_b32 v12, 64, v12
    v_mfma_f32_16x16x32_bf16 v[252:255], a[140:143], a[100:103], v[252:255]
    v_lshlrev_b32 v12, 1, v12
    v_mfma_f32_16x16x32_bf16 v[248:251], a[140:143], a[92:95], v[248:251]
    ds_read_b128 a[124:127], v14 offset:2048
    v_lshl_add_u32 v12, v1, 4, v12
    v_mfma_f32_16x16x32_bf16 v[248:251], a[136:139], a[88:91], v[248:251]
    buffer_load_dwordx4 v3, s[64:67], s47 offen offset:1024 lds
    v_lshrrev_b32 v22, 2, v1
    v_mfma_f32_16x16x32_bf16 v[244:247], a[80:83], a[136:139], v[244:247]
    v_and_b32 v23, 3, v1
    v_mfma_f32_16x16x32_bf16 v[244:247], a[84:87], a[140:143], v[244:247]
    v_lshlrev_b32 v23, 3, v23
    v_mfma_f32_16x16x32_bf16 v[240:243], a[76:79], a[140:143], v[240:243]
    v_lshl_add_u32 v23, v22, 8, v23
    v_mfma_f32_16x16x32_bf16 v[240:243], a[72:75], a[136:139], v[240:243]
    buffer_load_dwordx4 v4, s[64:67], s47 offen offset:2048 lds
    s_and_b32 s37, s58, 1
    v_mfma_f32_16x16x32_bf16 v[236:239], a[64:67], a[136:139], v[236:239]
    v_mfma_f32_16x16x32_bf16 v[236:239], a[68:71], a[140:143], v[236:239]
    s_lshl_b32 s45, s37, 2
    v_mfma_f32_16x16x32_bf16 v[232:235], a[60:63], a[140:143], v[232:235]
    v_and_b32 v22, 7, v22
    v_mfma_f32_16x16x32_bf16 v[232:235], a[56:59], a[136:139], v[232:235]
    s_waitcnt lgkmcnt(2)
    buffer_load_dwordx4 v5, s[64:67], s47 offen offset:3072 lds
    v_xor_b32 v22, s45, v22
    v_mfma_f32_16x16x32_bf16 v[64:67], a[0:3], a[112:115], v[64:67]
    ds_read_b128 a[128:131], v13 offset:4096
    v_lshl_add_u32 v10, v22, 5, v23
    v_mfma_f32_16x16x32_bf16 v[64:67], a[4:7], a[116:119], v[64:67]
    v_and_b32 v40, 15, v1
    v_mfma_f32_16x16x32_bf16 v[68:71], a[12:15], a[116:119], v[68:71]
    ds_read_b128 a[132:135], v14 offset:4096
    s_add_u32 m0, s63, 81920
    s_add_u32 s47, s60, 0x150000
    v_lshrrev_b32 v41, 4, v1
    v_mfma_f32_16x16x32_bf16 v[68:71], a[8:11], a[112:115], v[68:71]
    buffer_load_dwordx4 v2, s[64:67], s47 offen offset:0 lds
    v_lshlrev_b32 v41, 2, v41
    v_mfma_f32_16x16x32_bf16 v[72:75], a[16:19], a[112:115], v[72:75]
    ds_read_b64_tr_b16 a[56:57], v15 offset:24576
    ds_read_b64_tr_b16 a[58:59], v15 offset:26112
    ds_read_b64_tr_b16 a[60:61], v15 offset:36864
    ds_read_b64_tr_b16 a[62:63], v15 offset:38400
    v_sub_u32 v40, v40, v41
    v_mfma_f32_16x16x32_bf16 v[72:75], a[20:23], a[116:119], v[72:75]
    v_mov_b32 v43, 0x3f80
    v_mfma_f32_16x16x32_bf16 v[76:79], a[28:31], a[116:119], v[76:79]
    ds_read_b64_tr_b16 a[64:65], v16 offset:24576
    ds_read_b64_tr_b16 a[66:67], v16 offset:26112
    v_mfma_f32_16x16x32_bf16 v[76:79], a[24:27], a[112:115], v[76:79]
    v_mov_b32 v44, 0x3f800000
    v_mfma_f32_16x16x32_bf16 v[80:83], a[112:115], a[32:35], v[80:83]
    ds_read_b64_tr_b16 a[68:69], v16 offset:36864
    ds_read_b64_tr_b16 a[70:71], v16 offset:38400
    v_cmp_eq_u32 vcc, 0, v40
    v_mfma_f32_16x16x32_bf16 v[80:83], a[116:119], a[36:39], v[80:83]
    buffer_load_dwordx4 v3, s[64:67], s47 offen offset:1024 lds
    v_accvgpr_write_b32 a198, 0
    v_mfma_f32_16x16x32_bf16 v[84:87], a[116:119], a[44:47], v[84:87]
    ds_read_b64_tr_b16 a[72:73], v15 offset:24704
    ds_read_b64_tr_b16 a[74:75], v15 offset:26240
    v_cndmask_b32 v42, 0, v43, vcc
    v_mfma_f32_16x16x32_bf16 v[84:87], a[112:115], a[40:43], v[84:87]
    s_waitcnt vmcnt(8)
    s_barrier
    s_waitcnt lgkmcnt(12)
    v_cmp_eq_u32 vcc, 1, v40
    v_mfma_f32_16x16x32_bf16 v[108:111], a[120:123], a[40:43], v[108:111]
    ds_read_b128 a[136:139], v13 offset:32768
    v_accvgpr_write_b32 a200, 0
    v_mfma_f32_16x16x32_bf16 v[108:111], a[124:127], a[44:47], v[108:111]
    buffer_load_dwordx4 v4, s[64:67], s47 offen offset:2048 lds
    v_cndmask_b32 v42, v42, v44, vcc
    v_mfma_f32_16x16x32_bf16 v[104:107], a[124:127], a[36:39], v[104:107]
    ds_read_b128 a[140:143], v14 offset:32768
    v_accvgpr_write_b32 a196, v42
    v_mfma_f32_16x16x32_bf16 v[104:107], a[120:123], a[32:35], v[104:107]
    v_accvgpr_write_b32 a202, v42
    v_mfma_f32_16x16x32_bf16 v[100:103], a[24:27], a[120:123], v[100:103]
    ds_read_b64_tr_b16 a[76:77], v15 offset:36992
    ds_read_b64_tr_b16 a[78:79], v15 offset:38528
    v_cmp_eq_u32 vcc, 2, v40
    v_mfma_f32_16x16x32_bf16 v[100:103], a[28:31], a[124:127], v[100:103]
    buffer_load_dwordx4 v5, s[64:67], s47 offen offset:3072 lds
    v_mfma_f32_16x16x32_bf16 v[96:99], a[20:23], a[124:127], v[96:99]
    ds_read_b64_tr_b16 a[80:81], v16 offset:24704
    ds_read_b64_tr_b16 a[82:83], v16 offset:26240
    ds_read_b64_tr_b16 a[84:85], v16 offset:36992
    ds_read_b64_tr_b16 a[86:87], v16 offset:38528
    v_accvgpr_write_b32 a199, 0
    v_mfma_f32_16x16x32_bf16 v[96:99], a[16:19], a[120:123], v[96:99]
    v_cndmask_b32 v42, 0, v43, vcc
    v_mfma_f32_16x16x32_bf16 v[92:95], a[8:11], a[120:123], v[92:95]
    ds_read_b64_tr_b16 a[88:89], v15 offset:24832
    ds_read_b64_tr_b16 a[90:91], v15 offset:26368
    s_add_u32 m0, s63, 98304
    s_add_u32 s47, s61, 0x30000
    v_cmp_eq_u32 vcc, 3, v40
    v_mfma_f32_16x16x32_bf16 v[92:95], a[12:15], a[124:127], v[92:95]
    buffer_load_dwordx4 v18, s[64:67], s47 offen offset:0 lds
    v_accvgpr_write_b32 a201, 0
    v_mfma_f32_16x16x32_bf16 v[88:91], a[4:7], a[124:127], v[88:91]
    ds_read_b64_tr_b16 a[92:93], v15 offset:37120
    ds_read_b64_tr_b16 a[94:95], v15 offset:38656
    v_cndmask_b32 v42, v42, v44, vcc
    v_mfma_f32_16x16x32_bf16 v[88:91], a[0:3], a[120:123], v[88:91]
    s_waitcnt lgkmcnt(14)
    v_accvgpr_write_b32 a197, v42
    v_mfma_f32_16x16x32_bf16 v[112:115], a[0:3], a[128:131], v[112:115]
    ds_read_b128 a[112:115], v13 offset:34816
    v_accvgpr_write_b32 a203, v42
    v_mfma_f32_16x16x32_bf16 v[112:115], a[4:7], a[132:135], v[112:115]
    buffer_load_dwordx4 v19, s[64:67], s47 offen offset:1024 lds
    v_mov_b32 v42, 0x3f803f80
    v_mfma_f32_16x16x32_bf16 v[116:119], a[12:15], a[132:135], v[116:119]
    ds_read_b128 a[116:119], v14 offset:34816
    v_accvgpr_write_b32 a144, v42
    v_mfma_f32_16x16x32_bf16 v[116:119], a[8:11], a[128:131], v[116:119]
    v_mfma_f32_16x16x32_bf16 v[120:123], a[16:19], a[128:131], v[120:123]
    ds_read_b64_tr_b16 a[96:97], v16 offset:24832
    ds_read_b64_tr_b16 a[98:99], v16 offset:26368
    v_accvgpr_write_b32 a145, v42
    v_mfma_f32_16x16x32_bf16 v[120:123], a[20:23], a[132:135], v[120:123]
    buffer_load_dwordx4 v20, s[64:67], s47 offen offset:2048 lds
    v_accvgpr_write_b32 a146, v42
    v_mfma_f32_16x16x32_bf16 v[124:127], a[28:31], a[132:135], v[124:127]
    ds_read_b64_tr_b16 a[100:101], v16 offset:37120
    ds_read_b64_tr_b16 a[102:103], v16 offset:38656
    v_accvgpr_write_b32 a147, v42
    v_mfma_f32_16x16x32_bf16 v[124:127], a[24:27], a[128:131], v[124:127]
    s_mul_i32 s44, s29, 0x80008000
    v_mfma_f32_16x16x32_bf16 v[128:131], a[128:131], a[32:35], v[128:131]
    v_xor_b32 v48, s44, v48
    v_mfma_f32_16x16x32_bf16 v[128:131], a[132:135], a[36:39], v[128:131]
    buffer_load_dwordx4 v21, s[64:67], s47 offen offset:3072 lds
    v_xor_b32 v49, s44, v49
    v_mfma_f32_16x16x32_bf16 v[132:135], a[132:135], a[44:47], v[132:135]
    v_xor_b32 v50, s44, v50
    v_mfma_f32_16x16x32_bf16 v[132:135], a[128:131], a[40:43], v[132:135]
    s_waitcnt lgkmcnt(0)
    s_barrier
    v_xor_b32 v51, s44, v51
    v_mfma_f32_16x16x32_bf16 v[64:67], a[56:59], a[136:139], v[64:67]
    ds_read_b128 a[120:123], v13 offset:36864
    s_add_u32 m0, s63, 114688
    s_add_u32 s47, s61, 0x110000
    v_xor_b32 v52, s44, v52
    v_mfma_f32_16x16x32_bf16 v[64:67], a[60:63], a[140:143], v[64:67]
    buffer_load_dwordx4 v18, s[64:67], s47 offen offset:0 lds
    v_mfma_f32_16x16x32_bf16 v[68:71], a[68:71], a[140:143], v[68:71]
    ds_read_b128 a[124:127], v14 offset:36864
    v_xor_b32 v53, s44, v53
    v_mfma_f32_16x16x32_bf16 v[68:71], a[64:67], a[136:139], v[68:71]
    buffer_load_dwordx4 v19, s[64:67], s47 offen offset:1024 lds
    v_xor_b32 v54, s44, v54
    v_mfma_f32_16x16x32_bf16 v[72:75], a[72:75], a[136:139], v[72:75]
    v_xor_b32 v55, s44, v55
    v_mfma_f32_16x16x32_bf16 v[72:75], a[76:79], a[140:143], v[72:75]
    s_mul_i32 s44, s28, 6144
    v_mfma_f32_16x16x32_bf16 v[76:79], a[84:87], a[140:143], v[76:79]
    v_lshl_add_u32 v6, v1, 4, s44
    v_mfma_f32_16x16x32_bf16 v[76:79], a[80:83], a[136:139], v[76:79]
    buffer_load_dwordx4 v20, s[64:67], s47 offen offset:2048 lds
    s_xor_b32 s44, s28, 2
    v_mfma_f32_16x16x32_bf16 v[80:83], a[136:139], a[88:91], v[80:83]
    s_mul_i32 s44, s44, 6144
    v_mfma_f32_16x16x32_bf16 v[80:83], a[140:143], a[92:95], v[80:83]
    buffer_load_dwordx4 v21, s[64:67], s47 offen offset:3072 lds
    v_lshl_add_u32 v7, v1, 4, s44
    v_mfma_f32_16x16x32_bf16 v[84:87], a[140:143], a[100:103], v[84:87]
    v_and_b32 v8, 48, v1
    v_mfma_f32_16x16x32_bf16 v[84:87], a[136:139], a[96:99], v[84:87]
    v_mfma_f32_16x16x32_bf16 v[108:111], a[112:115], a[96:99], v[108:111]
    ds_read_b128 a[128:131], v13 offset:6144
    v_mfma_f32_16x16x32_bf16 v[108:111], a[116:119], a[100:103], v[108:111]
    v_mfma_f32_16x16x32_bf16 v[104:107], a[116:119], a[92:95], v[104:107]
    ds_read_b128 a[132:135], v14 offset:6144
    s_waitcnt vmcnt(16)
    v_cmp_eq_u32 vcc, 1, v29
    v_mfma_f32_16x16x32_bf16 v[104:107], a[112:115], a[88:91], v[104:107]
    v_mfma_f32_16x16x32_bf16 v[100:103], a[80:83], a[112:115], v[100:103]
    s_add_u32 m0, s63, 131072
    s_add_u32 s47, s62, 0x10000
    s_bcnt1_i32_b32 s78, vcc_lo
    v_mfma_f32_16x16x32_bf16 v[100:103], a[84:87], a[116:119], v[100:103]
    buffer_load_dwordx4 v2, s[64:67], s47 offen offset:0 lds
    v_mfma_f32_16x16x32_bf16 v[96:99], a[76:79], a[116:119], v[96:99]
    s_cmp_lt_u32 s78, 1
    s_cbranch_scc1 L_spin16
L_got16:
    v_mfma_f32_16x16x32_bf16 v[96:99], a[72:75], a[112:115], v[96:99]
    v_mfma_f32_16x16x32_bf16 v[92:95], a[64:67], a[112:115], v[92:95]
    v_mov_b32 v15, 1
    v_mfma_f32_16x16x32_bf16 v[92:95], a[68:71], a[116:119], v[92:95]
    v_mfma_f32_16x16x32_bf16 v[88:91], a[60:63], a[116:119], v[88:91]
    v_mfma_f32_16x16x32_bf16 v[88:91], a[56:59], a[112:115], v[88:91]
    s_waitcnt lgkmcnt(2)
    v_mfma_f32_16x16x32_bf16 v[112:115], a[56:59], a[120:123], v[112:115]
    ds_read_b128 a[136:139], v13 offset:38912
    v_mfma_f32_16x16x32_bf16 v[112:115], a[60:63], a[124:127], v[112:115]
    v_mfma_f32_16x16x32_bf16 v[116:119], a[68:71], a[124:127], v[116:119]
    ds_read_b128 a[140:143], v14 offset:38912
    v_mfma_f32_16x16x32_bf16 v[116:119], a[64:67], a[120:123], v[116:119]
    v_cvt_pk_bf16_f32 v16, v72, v73
    v_cvt_pk_bf16_f32 v17, v74, v75
    v_mfma_f32_16x16x32_bf16 v[120:123], a[72:75], a[120:123], v[120:123]
    s_mul_i32 s44, s58, 57344
    s_mul_i32 s42, s56, 4734976
    v_cvt_pk_bf16_f32 v18, v76, v77
    v_cvt_pk_bf16_f32 v19, v78, v79
    v_mfma_f32_16x16x32_bf16 v[120:123], a[76:79], a[124:127], v[120:123]
    v_cvt_pk_bf16_f32 v32, v96, v97
    v_cvt_pk_bf16_f32 v33, v98, v99
    v_mfma_f32_16x16x32_bf16 v[124:127], a[84:87], a[124:127], v[124:127]
    s_add_u32 s44, s44, s42
    v_cvt_pk_bf16_f32 v34, v100, v101
    v_cvt_pk_bf16_f32 v35, v102, v103
    v_mfma_f32_16x16x32_bf16 v[124:127], a[80:83], a[120:123], v[124:127]
    buffer_load_dwordx4 v3, s[64:67], s47 offen offset:1024 lds
    v_cvt_pk_bf16_f32 v56, v80, v81
    v_cvt_pk_bf16_f32 v57, v82, v83
    v_mfma_f32_16x16x32_bf16 v[72:75], v[48:51], v[16:19], 0
    v_mfma_f32_16x16x32_bf16 v[76:79], v[52:55], v[16:19], 0
    v_mfma_f32_16x16x32_bf16 v[96:99], v[48:51], v[32:35], 0
    v_mfma_f32_16x16x32_bf16 v[100:103], v[52:55], v[32:35], 0
    v_cvt_pk_bf16_f32 v58, v104, v105
    v_cvt_pk_bf16_f32 v59, v106, v107
    v_mfma_f32_16x16x32_bf16 v[128:131], a[120:123], a[88:91], v[128:131]
    s_and_b32 s42, s59, 7
    v_cvt_pk_bf16_f32 v60, v84, v85
    v_cvt_pk_bf16_f32 v61, v86, v87
    v_mfma_f32_16x16x32_bf16 v[128:131], a[124:127], a[92:95], v[128:131]
    v_cvt_pk_bf16_f32 v62, v108, v109
    v_cvt_pk_bf16_f32 v63, v110, v111
    v_mfma_f32_16x16x32_bf16 v[132:135], a[124:127], a[100:103], v[132:135]
    s_xor_b32 s43, s42, 4
    v_max3_f32 v28, v72, v73, v74
    v_max3_f32 v44, v96, v97, v98
    v_mfma_f32_16x16x32_bf16 v[132:135], a[120:123], a[96:99], v[132:135]
    s_waitcnt lgkmcnt(2)
    v_max3_f32 v29, -v72, -v73, -v74
    v_max3_f32 v45, -v96, -v97, -v98
    v_mfma_f32_16x16x32_bf16 v[156:159], a[128:131], a[40:43], v[156:159]
    ds_read_b128 a[112:115], v13 offset:8192
    v_max3_f32 v28, v28, v75, v76
    v_max3_f32 v44, v44, v99, v100
    v_mfma_f32_16x16x32_bf16 v[156:159], a[132:135], a[44:47], v[156:159]
    v_max3_f32 v29, v29, -v75, -v76
    v_max3_f32 v45, v45, -v99, -v100
    v_mfma_f32_16x16x32_bf16 v[152:155], a[132:135], a[36:39], v[152:155]
    ds_read_b128 a[116:119], v14 offset:8192
    v_max3_f32 v28, v28, v77, v78
    v_max3_f32 v44, v44, v101, v102
    v_mfma_f32_16x16x32_bf16 v[152:155], a[128:131], a[32:35], v[152:155]
    v_max3_f32 v29, v29, -v77, -v78
    v_max3_f32 v45, v45, -v101, -v102
    v_mfma_f32_16x16x32_bf16 v[148:151], a[24:27], a[128:131], v[148:151]
    s_mul_i32 s42, s42, 591872
    v_max_f32 v28, v28, v79
    v_max_f32 v44, v44, v103
    v_mfma_f32_16x16x32_bf16 v[148:151], a[28:31], a[132:135], v[148:151]
    v_max_f32_e64 v29, v29, -v79
    v_max_f32_e64 v45, v45, -v103
    v_mfma_f32_16x16x32_bf16 v[144:147], a[20:23], a[132:135], v[144:147]
    s_mul_i32 s43, s43, 591872
    v_permlane32_swap_b32 v28, v29
    v_mfma_f32_16x16x32_bf16 v[144:147], a[16:19], a[128:131], v[144:147]
    buffer_load_dwordx4 v4, s[64:67], s47 offen offset:2048 lds
    v_permlane32_swap_b32 v44, v45
    v_mfma_f32_16x16x32_bf16 v[140:143], a[8:11], a[128:131], v[140:143]
    s_add_u32 s42, s42, s44
    v_max_f32 v28, v28, v29
    v_max_f32 v44, v44, v45
    v_mfma_f32_16x16x32_bf16 v[140:143], a[12:15], a[132:135], v[140:143]
    v_mov_b32 v29, v28
    v_mov_b32 v45, v44
    v_mfma_f32_16x16x32_bf16 v[136:139], a[4:7], a[132:135], v[136:139]
    s_add_u32 s43, s43, s44
    v_permlane16_swap_b32 v28, v29
    v_mfma_f32_16x16x32_bf16 v[136:139], a[0:3], a[128:131], v[136:139]
    s_waitcnt lgkmcnt(2)
    v_permlane16_swap_b32 v44, v45
    v_mfma_f32_16x16x32_bf16 v[156:159], a[136:139], a[96:99], v[156:159]
    ds_read_b128 a[120:123], v13 offset:40960
    v_max_f32 v28, v28, v29
    v_max_f32 v44, v44, v45
    v_mfma_f32_16x16x32_bf16 v[156:159], a[140:143], a[100:103], v[156:159]
    v_mul_f32 v28, s48, v28
    v_mul_f32 v44, s48, v44
    v_mfma_f32_16x16x32_bf16 v[152:155], a[140:143], a[92:95], v[152:155]
    ds_read_b128 a[124:127], v14 offset:40960
    v_mov_b32 v29, v28
    v_mov_b32 v45, v44
    v_mfma_f32_16x16x32_bf16 v[152:155], a[136:139], a[88:91], v[152:155]
    v_permlane32_swap_b32 v28, v29
    v_mfma_f32_16x16x32_bf16 v[148:151], a[80:83], a[136:139], v[148:151]
    s_lshl_b32 s38, s56, 2
    v_permlane32_swap_b32 v44, v45
    v_mfma_f32_16x16x32_bf16 v[148:151], a[84:87], a[140:143], v[148:151]
    v_fma_f32 v20, v72, s50, v28
    v_fma_f32 v36, v96, s50, v44
    v_mfma_f32_16x16x32_bf16 v[144:147], a[76:79], a[140:143], v[144:147]
    s_add_u32 s38, s38, s58
    v_fma_f32 v21, v73, s50, v28
    v_fma_f32 v37, v97, s50, v44
    v_mfma_f32_16x16x32_bf16 v[144:147], a[72:75], a[136:139], v[144:147]
    v_fma_f32 v22, v74, s50, v28
    v_fma_f32 v38, v98, s50, v44
    v_mfma_f32_16x16x32_bf16 v[140:143], a[64:67], a[136:139], v[140:143]
    s_lshl_b32 s38, s38, 7
    v_fma_f32 v23, v75, s50, v28
    v_fma_f32 v39, v99, s50, v44
    v_mfma_f32_16x16x32_bf16 v[140:143], a[68:71], a[140:143], v[140:143]
    buffer_load_dwordx4 v5, s[64:67], s47 offen offset:3072 lds
    v_fma_f32 v24, v76, s50, v28
    v_fma_f32 v40, v100, s50, v44
    v_mfma_f32_16x16x32_bf16 v[136:139], a[60:63], a[140:143], v[136:139]
    s_add_u32 s38, s38, 0x2522000
    v_fma_f32 v25, v77, s50, v28
    v_fma_f32 v41, v101, s50, v44
    v_mfma_f32_16x16x32_bf16 v[136:139], a[56:59], a[136:139], v[136:139]
    s_waitcnt lgkmcnt(2)
    v_fma_f32 v26, v78, s50, v28
    v_fma_f32 v42, v102, s50, v44
    v_mfma_f32_16x16x32_bf16 v[160:163], a[0:3], a[112:115], v[160:163]
    ds_read_b128 a[128:131], v13 offset:10240
    v_fma_f32 v27, v79, s50, v28
    v_fma_f32 v43, v103, s50, v44
    v_mfma_f32_16x16x32_bf16 v[160:163], a[4:7], a[116:119], v[160:163]
    v_fma_f32 v72, v72, s48, v29
    v_fma_f32 v96, v96, s48, v45
    v_mfma_f32_16x16x32_bf16 v[164:167], a[12:15], a[116:119], v[164:167]
    ds_read_b128 a[132:135], v14 offset:10240
    v_fma_f32 v73, v73, s48, v29
    v_fma_f32 v97, v97, s48, v45
    v_mfma_f32_16x16x32_bf16 v[164:167], a[8:11], a[112:115], v[164:167]
    v_fma_f32 v74, v74, s48, v29
    v_fma_f32 v98, v98, s48, v45
    v_mfma_f32_16x16x32_bf16 v[168:171], a[16:19], a[112:115], v[168:171]
    s_add_u32 s39, s38, 4096
    v_fma_f32 v75, v75, s48, v29
    v_fma_f32 v99, v99, s48, v45
    v_mfma_f32_16x16x32_bf16 v[168:171], a[20:23], a[116:119], v[168:171]
    v_fma_f32 v76, v76, s48, v29
    v_fma_f32 v100, v100, s48, v45
    v_mfma_f32_16x16x32_bf16 v[172:175], a[28:31], a[116:119], v[172:175]
    s_lshl_b32 s44, s54, 1
    v_fma_f32 v77, v77, s48, v29
    v_fma_f32 v101, v101, s48, v45
    v_mfma_f32_16x16x32_bf16 v[172:175], a[24:27], a[112:115], v[172:175]
    v_fma_f32 v78, v78, s48, v29
    v_fma_f32 v102, v102, s48, v45
    v_mfma_f32_16x16x32_bf16 v[176:179], a[112:115], a[32:35], v[176:179]
    s_add_u32 m0, s63, 147456
    s_add_u32 s47, s62, 0x50000
    s_add_u32 s44, s44, s29
    v_fma_f32 v79, v79, s48, v29
    v_fma_f32 v103, v103, s48, v45
    v_mfma_f32_16x16x32_bf16 v[176:179], a[116:119], a[36:39], v[176:179]
    buffer_load_dwordx4 v2, s[64:67], s47 offen offset:0 lds
    v_exp_f32 v20, v20
    v_mfma_f32_16x16x32_bf16 v[180:183], a[116:119], a[44:47], v[180:183]
    s_lshl_b32 s76, s44, 15
    v_exp_f32 v36, v36
    v_mfma_f32_16x16x32_bf16 v[180:183], a[112:115], a[40:43], v[180:183]
    s_waitcnt lgkmcnt(2)
    v_exp_f32 v21, v21
    v_mfma_f32_16x16x32_bf16 v[160:163], a[56:59], a[120:123], v[160:163]
    ds_read_b128 a[136:139], v13 offset:43008
    v_exp_f32 v37, v37
    v_mfma_f32_16x16x32_bf16 v[160:163], a[60:63], a[124:127], v[160:163]
    v_exp_f32 v22, v22
    v_mfma_f32_16x16x32_bf16 v[164:167], a[68:71], a[124:127], v[164:167]
    ds_read_b128 a[140:143], v14 offset:43008
    v_exp_f32 v38, v38
    v_mfma_f32_16x16x32_bf16 v[164:167], a[64:67], a[120:123], v[164:167]
    v_exp_f32 v23, v23
    v_mfma_f32_16x16x32_bf16 v[168:171], a[72:75], a[120:123], v[168:171]
    s_add_u32 s76, s76, 0x2600000
    v_exp_f32 v39, v39
    v_mfma_f32_16x16x32_bf16 v[168:171], a[76:79], a[124:127], v[168:171]
    v_exp_f32 v24, v24
    v_mfma_f32_16x16x32_bf16 v[172:175], a[84:87], a[124:127], v[172:175]
    s_lshl_b32 s77, s44, 10
    v_exp_f32 v40, v40
    v_mfma_f32_16x16x32_bf16 v[172:175], a[80:83], a[120:123], v[172:175]
    v_exp_f32 v25, v25
    v_mfma_f32_16x16x32_bf16 v[176:179], a[120:123], a[88:91], v[176:179]
    s_add_u32 s77, s77, 0x2510000
    v_exp_f32 v41, v41
    v_mfma_f32_16x16x32_bf16 v[176:179], a[124:127], a[92:95], v[176:179]
    v_exp_f32 v26, v26
    v_mfma_f32_16x16x32_bf16 v[180:183], a[124:127], a[100:103], v[180:183]
    s_lshl_b32 s32, s44, 7
    v_exp_f32 v42, v42
    v_mfma_f32_16x16x32_bf16 v[180:183], a[120:123], a[96:99], v[180:183]
    s_waitcnt lgkmcnt(2)
    buffer_load_dwordx4 v3, s[64:67], s47 offen offset:1024 lds
    v_exp_f32 v27, v27
    v_mfma_f32_16x16x32_bf16 v[204:207], a[128:131], a[40:43], v[204:207]
    ds_read_b128 a[112:115], v13 offset:12288
    v_exp_f32 v43, v43
    v_mfma_f32_16x16x32_bf16 v[204:207], a[132:135], a[44:47], v[204:207]
    v_exp_f32 v72, v72
    v_mfma_f32_16x16x32_bf16 v[200:203], a[132:135], a[36:39], v[200:203]
    ds_read_b128 a[116:119], v14 offset:12288
    v_exp_f32 v96, v96
    v_mfma_f32_16x16x32_bf16 v[200:203], a[128:131], a[32:35], v[200:203]
    v_exp_f32 v73, v73
    v_mfma_f32_16x16x32_bf16 v[196:199], a[24:27], a[128:131], v[196:199]
    s_add_u32 s32, s32, 0x2520000
    v_exp_f32 v97, v97
    v_mfma_f32_16x16x32_bf16 v[196:199], a[28:31], a[132:135], v[196:199]
    v_exp_f32 v74, v74
    v_mfma_f32_16x16x32_bf16 v[192:195], a[20:23], a[132:135], v[192:195]
    s_lshl_b32 s44, s26, 1
    v_exp_f32 v98, v98
    v_mfma_f32_16x16x32_bf16 v[192:195], a[16:19], a[128:131], v[192:195]
    v_exp_f32 v75, v75
    v_mfma_f32_16x16x32_bf16 v[188:191], a[8:11], a[128:131], v[188:191]
    s_add_u32 s44, s44, s29
    s_lshl_b32 s52, s44, 7
    v_exp_f32 v99, v99
    v_mfma_f32_16x16x32_bf16 v[188:191], a[12:15], a[132:135], v[188:191]
    v_exp_f32 v76, v76
    v_mfma_f32_16x16x32_bf16 v[184:187], a[4:7], a[132:135], v[184:187]
    s_add_u32 s52, s52, 0x2525000
    v_exp_f32 v100, v100
    v_mfma_f32_16x16x32_bf16 v[184:187], a[0:3], a[128:131], v[184:187]
    s_waitcnt lgkmcnt(2)
    buffer_load_dwordx4 v4, s[64:67], s47 offen offset:2048 lds
    v_exp_f32 v77, v77
    v_mfma_f32_16x16x32_bf16 v[204:207], a[136:139], a[96:99], v[204:207]
    ds_read_b128 a[120:123], v13 offset:45056
    v_exp_f32 v101, v101
    v_mfma_f32_16x16x32_bf16 v[204:207], a[140:143], a[100:103], v[204:207]
    v_exp_f32 v78, v78
    v_mfma_f32_16x16x32_bf16 v[200:203], a[140:143], a[92:95], v[200:203]
    ds_read_b128 a[124:127], v14 offset:45056
    v_exp_f32 v102, v102
    v_mfma_f32_16x16x32_bf16 v[200:203], a[136:139], a[88:91], v[200:203]
    v_exp_f32 v79, v79
    v_mfma_f32_16x16x32_bf16 v[196:199], a[80:83], a[136:139], v[196:199]
    s_lshr_b32 s45, s27, 3
    v_exp_f32 v103, v103
    v_mfma_f32_16x16x32_bf16 v[196:199], a[84:87], a[140:143], v[196:199]
    v_add_f32 v16, v20, v22
    v_add_f32 v32, v36, v38
    v_mfma_f32_16x16x32_bf16 v[192:195], a[76:79], a[140:143], v[192:195]
    s_lshl1_add_u32 s51, s26, s45
    v_add_f32 v17, v21, v23
    v_add_f32 v33, v37, v39
    v_mfma_f32_16x16x32_bf16 v[192:195], a[72:75], a[136:139], v[192:195]
    v_add_f32 v18, v24, v26
    v_add_f32 v34, v40, v42
    v_mfma_f32_16x16x32_bf16 v[188:191], a[64:67], a[136:139], v[188:191]
    s_lshl_b32 s51, s51, 7
    v_add_f32 v19, v25, v27
    v_add_f32 v35, v41, v43
    v_mfma_f32_16x16x32_bf16 v[188:191], a[68:71], a[140:143], v[188:191]
    v_add_f32 v28, v72, v74
    v_add_f32 v44, v96, v98
    v_mfma_f32_16x16x32_bf16 v[184:187], a[60:63], a[140:143], v[184:187]
    s_add_u32 s51, s51, 0x2524000
    v_add_f32 v29, v73, v75
    v_add_f32 v45, v97, v99
    v_mfma_f32_16x16x32_bf16 v[184:187], a[56:59], a[136:139], v[184:187]
    s_waitcnt lgkmcnt(2)
    v_add_f32 v30, v76, v78
    v_add_f32 v46, v100, v102
    v_mfma_f32_16x16x32_bf16 v[208:211], a[0:3], a[112:115], v[208:211]
    ds_read_b128 a[128:131], v13 offset:14336
    v_add_f32 v31, v77, v79
    v_add_f32 v47, v101, v103
    v_mfma_f32_16x16x32_bf16 v[208:211], a[4:7], a[116:119], v[208:211]
    buffer_load_dwordx4 v5, s[64:67], s47 offen offset:3072 lds
    v_add_f32 v16, v16, v18
    v_add_f32 v32, v32, v34
    v_mfma_f32_16x16x32_bf16 v[212:215], a[12:15], a[116:119], v[212:215]
    ds_read_b128 a[132:135], v14 offset:14336
    v_add_f32 v17, v17, v19
    v_add_f32 v33, v33, v35
    v_mfma_f32_16x16x32_bf16 v[212:215], a[8:11], a[112:115], v[212:215]
    v_add_f32 v30, v28, v30
    v_add_f32 v46, v44, v46
    v_mfma_f32_16x16x32_bf16 v[216:219], a[16:19], a[112:115], v[216:219]
    s_lshl_b32 s49, s44, 5
    v_add_f32 v31, v29, v31
    v_add_f32 v47, v45, v47
    v_mfma_f32_16x16x32_bf16 v[216:219], a[20:23], a[116:119], v[216:219]
    v_add_f32 v28, v16, v17
    v_add_f32 v44, v32, v33
    v_mfma_f32_16x16x32_bf16 v[220:223], a[28:31], a[116:119], v[220:223]
    s_add_u32 s49, s49, s54
    v_add_f32 v29, v30, v31
    v_add_f32 v45, v46, v47
    v_mfma_f32_16x16x32_bf16 v[220:223], a[24:27], a[112:115], v[220:223]
    v_permlane32_swap_b32 v28, v29
    v_mfma_f32_16x16x32_bf16 v[224:227], a[112:115], a[32:35], v[224:227]
    s_mul_i32 s31, s26, 4734976
    v_cvt_pk_bf16_f32 v16, v120, v121
    v_mfma_f32_16x16x32_bf16 v[224:227], a[116:119], a[36:39], v[224:227]
    v_permlane32_swap_b32 v44, v45
    v_mfma_f32_16x16x32_bf16 v[228:231], a[116:119], a[44:47], v[228:231]
    s_mul_i32 s45, s29, 2367488
    v_add_f32 v28, v28, v29
    v_cvt_pk_bf16_f32 v17, v122, v123
    v_mfma_f32_16x16x32_bf16 v[228:231], a[112:115], a[40:43], v[228:231]
    s_waitcnt lgkmcnt(2)
    v_add_f32 v44, v44, v45
    v_mov_b32 v29, v28
    v_mfma_f32_16x16x32_bf16 v[208:211], a[56:59], a[120:123], v[208:211]
    ds_read_b128 a[136:139], v13 offset:47104
    v_cvt_pk_bf16_f32 v18, v124, v125
    v_mov_b32 v45, v44
    v_mfma_f32_16x16x32_bf16 v[208:211], a[60:63], a[124:127], v[208:211]
    v_permlane16_swap_b32 v28, v29
    v_mfma_f32_16x16x32_bf16 v[212:215], a[68:71], a[124:127], v[212:215]
    ds_read_b128 a[140:143], v14 offset:47104
    v_cvt_pk_bf16_f32 v19, v126, v127
    v_mfma_f32_16x16x32_bf16 v[212:215], a[64:67], a[120:123], v[212:215]
    v_permlane16_swap_b32 v44, v45
    v_mfma_f32_16x16x32_bf16 v[216:219], a[72:75], a[120:123], v[216:219]
    s_add_u32 s31, s31, s45
    v_add_f32 v28, v28, v29
    v_cvt_pk_bf16_f32 v32, v144, v145
    v_mfma_f32_16x16x32_bf16 v[216:219], a[76:79], a[124:127], v[216:219]
L_pg14:
    s_cbranch_execz L_tramp
    v_add_f32 v44, v44, v45
    v_mfma_f32_16x16x32_bf16 v[220:223], a[84:87], a[124:127], v[220:223]
    s_add_u32 s45, s27, 56
    v_rcp_f32 v28, v28
    v_mfma_f32_16x16x32_bf16 v[220:223], a[80:83], a[120:123], v[220:223]
    v_cvt_pk_bf16_f32 v33, v146, v147
    v_mfma_f32_16x16x32_bf16 v[224:227], a[120:123], a[88:91], v[224:227]
    s_mul_i32 s45, s45, 4096
    v_rcp_f32 v44, v44
    v_mfma_f32_16x16x32_bf16 v[224:227], a[124:127], a[92:95], v[224:227]
    v_mov_b32 v29, v28
    v_cvt_pk_bf16_f32 v34, v148, v149
    v_mfma_f32_16x16x32_bf16 v[228:231], a[124:127], a[100:103], v[228:231]
    s_add_u32 s31, s31, s45
    v_mov_b32 v45, v44
    v_mfma_f32_16x16x32_bf16 v[228:231], a[120:123], a[96:99], v[228:231]
    s_waitcnt lgkmcnt(0)
    s_barrier
    v_permlane32_swap_b32 v28, v29
    v_mfma_f32_16x16x32_bf16 v[252:255], a[128:131], a[40:43], v[252:255]
    s_add_u32 m0, s63, 32768
    s_add_u32 s47, s60, 0x0
    v_cvt_pk_bf16_f32 v35, v150, v151
    v_mfma_f32_16x16x32_bf16 v[252:255], a[132:135], a[44:47], v[252:255]
    buffer_load_dwordx4 v2, s[64:67], s47 offen offset:0 lds
    v_permlane32_swap_b32 v44, v45
    v_mfma_f32_16x16x32_bf16 v[248:251], a[132:135], a[36:39], v[248:251]
    v_mul_f32 v72, v72, v29
    v_mul_f32 v96, v96, v45
    v_mfma_f32_16x16x32_bf16 v[248:251], a[128:131], a[32:35], v[248:251]
    v_mul_f32 v73, v73, v29
    v_mul_f32 v97, v97, v45
    v_mfma_f32_16x16x32_bf16 v[244:247], a[24:27], a[128:131], v[244:247]
    s_mul_i32 s45, s30, 2048
    v_mul_f32 v74, v74, v29
    v_mul_f32 v98, v98, v45
    v_mfma_f32_16x16x32_bf16 v[244:247], a[28:31], a[132:135], v[244:247]
    buffer_load_dwordx4 v3, s[64:67], s47 offen offset:1024 lds
    v_mul_f32 v75, v75, v29
    v_mul_f32 v99, v99, v45
    v_mfma_f32_16x16x32_bf16 v[240:243], a[20:23], a[132:135], v[240:243]
    s_add_u32 s31, s31, s45
    v_mul_f32 v76, v76, v29
    v_mul_f32 v100, v100, v45
    v_mfma_f32_16x16x32_bf16 v[240:243], a[16:19], a[128:131], v[240:243]
    buffer_load_dwordx4 v4, s[64:67], s47 offen offset:2048 lds
    v_mul_f32 v77, v77, v29
    v_mul_f32 v101, v101, v45
    v_mfma_f32_16x16x32_bf16 v[236:239], a[8:11], a[128:131], v[236:239]
    s_lshl_b32 s53, s54, 2
    v_mul_f32 v78, v78, v29
    v_mul_f32 v102, v102, v45
    v_mfma_f32_16x16x32_bf16 v[236:239], a[12:15], a[132:135], v[236:239]
    v_mul_f32 v79, v79, v29
    v_mul_f32 v103, v103, v45
    v_mfma_f32_16x16x32_bf16 v[232:235], a[4:7], a[132:135], v[232:235]
    s_lshl_b32 s33, s26, 2
    v_mul_f32 v20, v20, v28
    v_mul_f32 v36, v36, v44
    v_mfma_f32_16x16x32_bf16 v[232:235], a[0:3], a[128:131], v[232:235]
    buffer_load_dwordx4 v5, s[64:67], s47 offen offset:3072 lds
    v_mul_f32 v21, v21, v28
    v_mfma_f32_16x16x32_bf16 v[120:123], v[48:51], v[16:19], 0
    v_mul_f32 v37, v37, v44
    v_mul_f32 v22, v22, v28
    v_mfma_f32_16x16x32_bf16 v[252:255], a[136:139], a[96:99], v[252:255]
    s_add_u32 m0, s63, 49152
    s_add_u32 s47, s60, 0x70000
    v_mul_f32 v38, v38, v44
    v_mfma_f32_16x16x32_bf16 v[124:127], v[52:55], v[16:19], 0
    v_mul_f32 v23, v23, v28
    v_mul_f32 v39, v39, v44
    v_mfma_f32_16x16x32_bf16 v[252:255], a[140:143], a[100:103], v[252:255]
    buffer_load_dwordx4 v2, s[64:67], s47 offen offset:0 lds
    v_mul_f32 v24, v24, v28
    v_mfma_f32_16x16x32_bf16 v[144:147], v[48:51], v[32:35], 0
    v_mul_f32 v40, v40, v44
    v_mul_f32 v25, v25, v28
    v_mfma_f32_16x16x32_bf16 v[248:251], a[140:143], a[92:95], v[248:251]
    v_mul_f32 v41, v41, v44
    v_mfma_f32_16x16x32_bf16 v[148:151], v[52:55], v[32:35], 0
    v_mul_f32 v26, v26, v28
    v_mul_f32 v42, v42, v44
    v_mfma_f32_16x16x32_bf16 v[248:251], a[136:139], a[88:91], v[248:251]
    v_mul_f32 v27, v27, v28
    v_mul_f32 v43, v43, v44
    v_mfma_f32_16x16x32_bf16 v[244:247], a[80:83], a[136:139], v[244:247]
    s_and_b32 s41, s27, 7
    v_cvt_pk_bf16_f32 v72, v72, v73
    v_cvt_pk_bf16_f32 v96, v96, v97
    v_mfma_f32_16x16x32_bf16 v[244:247], a[84:87], a[140:143], v[244:247]
    buffer_load_dwordx4 v3, s[64:67], s47 offen offset:1024 lds
    v_cvt_pk_bf16_f32 v73, v74, v75
    v_cvt_pk_bf16_f32 v97, v98, v99
    v_mfma_f32_16x16x32_bf16 v[240:243], a[76:79], a[140:143], v[240:243]
    s_lshl_b32 s41, s41, 2
    v_cvt_pk_bf16_f32 v74, v76, v77
    v_cvt_pk_bf16_f32 v98, v100, v101
    v_mfma_f32_16x16x32_bf16 v[240:243], a[72:75], a[136:139], v[240:243]
    buffer_load_dwordx4 v4, s[64:67], s47 offen offset:2048 lds
    v_cvt_pk_bf16_f32 v75, v78, v79
    v_cvt_pk_bf16_f32 v99, v102, v103
    v_mfma_f32_16x16x32_bf16 v[236:239], a[64:67], a[136:139], v[236:239]
    s_add_u32 s41, s41, s28
    v_cvt_pk_bf16_f32 v76, v20, v21
    v_cvt_pk_bf16_f32 v100, v36, v37
    v_mfma_f32_16x16x32_bf16 v[80:83], v[72:75], a[196:199], 0
    v_cvt_pk_bf16_f32 v77, v22, v23
    v_cvt_pk_bf16_f32 v101, v38, v39
    v_mfma_f32_16x16x32_bf16 v[84:87], v[72:75], a[200:203], 0
    v_cvt_pk_bf16_f32 v78, v24, v25
    v_cvt_pk_bf16_f32 v102, v40, v41
    v_mfma_f32_16x16x32_bf16 v[104:107], v[96:99], a[196:199], 0
    v_cvt_pk_bf16_f32 v79, v26, v27
    v_cvt_pk_bf16_f32 v103, v42, v43
    v_mfma_f32_16x16x32_bf16 v[108:111], v[96:99], a[200:203], 0
    v_mfma_f32_16x16x32_bf16 v[236:239], a[68:71], a[140:143], v[236:239]
    v_mfma_f32_16x16x32_bf16 v[232:235], a[60:63], a[140:143], v[232:235]
    s_lshl_b32 s41, s41, 2
    v_mfma_f32_16x16x32_bf16 v[232:235], a[56:59], a[136:139], v[232:235]
    buffer_load_dwordx4 v5, s[64:67], s47 offen offset:3072 lds
    v_and_b32 v14, 31, v1
    v_lshlrev_b32 v14, 2, v14
    v_and_b32 v13, 1, v1
    v_lshlrev_b32 v9, 2, v1
    s_lshl_b32 s45, s49, 9
    s_add_u32 s45, s45, 0x25c0000
    buffer_store_dword v11, v9, s[12:15], s45 offen offset:0 sc1
    buffer_store_dword v11, v9, s[12:15], s45 offen offset:256 sc1
    v_max3_f32 v28, v120, v121, v122
    v_max3_f32 v44, v144, v145, v146
    v_max3_f32 v29, -v120, -v121, -v122
    v_max3_f32 v45, -v144, -v145, -v146
    v_max3_f32 v28, v28, v123, v124
    v_max3_f32 v44, v44, v147, v148
    v_max3_f32 v29, v29, -v123, -v124
    v_max3_f32 v45, v45, -v147, -v148
    v_max3_f32 v28, v28, v125, v126
    v_max3_f32 v44, v44, v149, v150
    v_max3_f32 v29, v29, -v125, -v126
    v_max3_f32 v45, v45, -v149, -v150
    v_max_f32 v28, v28, v127
    v_max_f32 v44, v44, v151
    v_max_f32_e64 v29, v29, -v127
    v_max_f32_e64 v45, v45, -v151
    v_cvt_pk_bf16_f32 v72, v80, v81
    v_permlane32_swap_b32 v28, v29
    v_permlane32_swap_b32 v44, v45
    v_cvt_pk_bf16_f32 v73, v82, v83
    v_max_f32 v28, v28, v29
    v_max_f32 v44, v44, v45
    v_cvt_pk_bf16_f32 v96, v84, v85
    v_mov_b32 v29, v28
    v_mov_b32 v45, v44
    v_cvt_pk_bf16_f32 v97, v86, v87
    v_permlane16_swap_b32 v28, v29
    v_permlane16_swap_b32 v44, v45
    v_cvt_pk_bf16_f32 v74, v104, v105
    v_max_f32 v28, v28, v29
    v_max_f32 v44, v44, v45
    v_cvt_pk_bf16_f32 v75, v106, v107
    v_mul_f32 v28, s48, v28
    v_mul_f32 v44, s48, v44
    v_cvt_pk_bf16_f32 v98, v108, v109
    v_mov_b32 v29, v28
    v_mov_b32 v45, v44
    v_cvt_pk_bf16_f32 v99, v110, v111
    v_permlane32_swap_b32 v28, v29
    v_permlane32_swap_b32 v44, v45
    v_pk_fma_f32 v[20:21], v[120:121], s[50:51], v[28:29] op_sel_hi:[1,0,0]
    v_pk_fma_f32 v[36:37], v[144:145], s[50:51], v[44:45] op_sel_hi:[1,0,0]
    v_pk_fma_f32 v[22:23], v[122:123], s[50:51], v[28:29] op_sel_hi:[1,0,0]
    v_pk_fma_f32 v[38:39], v[146:147], s[50:51], v[44:45] op_sel_hi:[1,0,0]
    v_pk_fma_f32 v[24:25], v[124:125], s[50:51], v[28:29] op_sel_hi:[1,0,0]
    v_pk_fma_f32 v[40:41], v[148:149], s[50:51], v[44:45] op_sel_hi:[1,0,0]
    v_pk_fma_f32 v[26:27], v[126:127], s[50:51], v[28:29] op_sel_hi:[1,0,0]
    v_pk_fma_f32 v[42:43], v[150:151], s[50:51], v[44:45] op_sel_hi:[1,0,0]
    v_pk_fma_f32 v[120:121], v[120:121], s[48:49], v[28:29] op_sel:[0,0,1] op_sel_hi:[1,0,1]
    v_pk_fma_f32 v[144:145], v[144:145], s[48:49], v[44:45] op_sel:[0,0,1] op_sel_hi:[1,0,1]
    v_pk_fma_f32 v[122:123], v[122:123], s[48:49], v[28:29] op_sel:[0,0,1] op_sel_hi:[1,0,1]
    v_pk_fma_f32 v[146:147], v[146:147], s[48:49], v[44:45] op_sel:[0,0,1] op_sel_hi:[1,0,1]
    v_pk_fma_f32 v[124:125], v[124:125], s[48:49], v[28:29] op_sel:[0,0,1] op_sel_hi:[1,0,1]
    v_pk_fma_f32 v[148:149], v[148:149], s[48:49], v[44:45] op_sel:[0,0,1] op_sel_hi:[1,0,1]
    v_pk_fma_f32 v[126:127], v[126:127], s[48:49], v[28:29] op_sel:[0,0,1] op_sel_hi:[1,0,1]
    v_pk_fma_f32 v[150:151], v[150:151], s[48:49], v[44:45] op_sel:[0,0,1] op_sel_hi:[1,0,1]
    v_exp_f32 v20, v20
    v_mfma_f32_16x16x32_bf16 v[80:83], v[76:79], a[196:199], 0
    v_exp_f32 v36, v36
    v_mfma_f32_16x16x32_bf16 v[84:87], v[76:79], a[200:203], 0
    v_exp_f32 v21, v21
    v_mfma_f32_16x16x32_bf16 v[104:107], v[100:103], a[196:199], 0
    v_exp_f32 v37, v37
    v_mfma_f32_16x16x32_bf16 v[108:111], v[100:103], a[200:203], 0
    v_exp_f32 v22, v22
    v_mfma_f32_16x16x32_bf16 a[172:175], v[72:75], v[56:59], 0
    v_exp_f32 v38, v38
    v_mfma_f32_16x16x32_bf16 a[176:179], v[72:75], v[60:63], 0
    v_exp_f32 v23, v23
    v_mfma_f32_16x16x32_bf16 a[180:183], v[72:75], a[144:147], 0
    v_exp_f32 v39, v39
    v_mfma_f32_16x16x32_bf16 a[184:187], v[96:99], v[56:59], 0
    v_exp_f32 v24, v24
    v_mfma_f32_16x16x32_bf16 a[188:191], v[96:99], v[60:63], 0
    v_exp_f32 v40, v40
    v_mfma_f32_16x16x32_bf16 a[192:195], v[96:99], a[144:147], 0
    v_exp_f32 v25, v25
    v_exp_f32 v41, v41
    v_cvt_pk_bf16_f32 v76, v80, v81
    v_exp_f32 v26, v26
    v_cvt_pk_bf16_f32 v77, v82, v83
    v_exp_f32 v42, v42
    v_cvt_pk_bf16_f32 v100, v84, v85
    v_exp_f32 v27, v27
    v_cvt_pk_bf16_f32 v101, v86, v87
    v_exp_f32 v43, v43
    v_cvt_pk_bf16_f32 v78, v104, v105
    v_exp_f32 v120, v120
    v_cvt_pk_bf16_f32 v79, v106, v107
    v_exp_f32 v144, v144
    v_cvt_pk_bf16_f32 v102, v108, v109
    v_exp_f32 v121, v121
    v_cvt_pk_bf16_f32 v103, v110, v111
    v_exp_f32 v145, v145
    v_exp_f32 v122, v122
    v_mfma_f32_16x16x32_bf16 a[148:151], v[76:79], v[56:59], 0
    v_exp_f32 v146, v146
    v_mfma_f32_16x16x32_bf16 a[152:155], v[76:79], v[60:63], 0
    v_exp_f32 v123, v123
    v_mfma_f32_16x16x32_bf16 a[156:159], v[76:79], a[144:147], 0
    v_exp_f32 v147, v147
    v_mfma_f32_16x16x32_bf16 a[160:163], v[100:103], v[56:59], 0
    v_exp_f32 v124, v124
    v_mfma_f32_16x16x32_bf16 a[164:167], v[100:103], v[60:63], 0
    v_exp_f32 v148, v148
    v_mfma_f32_16x16x32_bf16 a[168:171], v[100:103], a[144:147], 0
    v_exp_f32 v125, v125
    v_exp_f32 v149, v149
    v_exp_f32 v126, v126
    v_cvt_pk_bf16_f32 v56, v128, v129
    v_cvt_pk_bf16_f32 v57, v130, v131
    v_cvt_pk_bf16_f32 v58, v152, v153
    v_cvt_pk_bf16_f32 v59, v154, v155
    v_cvt_pk_bf16_f32 v60, v132, v133
    v_cvt_pk_bf16_f32 v61, v134, v135
    v_cvt_pk_bf16_f32 v62, v156, v157
    v_cvt_pk_bf16_f32 v63, v158, v159
    v_exp_f32 v150, v150
    v_exp_f32 v127, v127
    v_exp_f32 v151, v151
    v_pk_add_f32 v[16:17], v[20:21], v[22:23]
    v_pk_add_f32 v[32:33], v[36:37], v[38:39]
    v_pk_add_f32 v[18:19], v[24:25], v[26:27]
    v_pk_add_f32 v[34:35], v[40:41], v[42:43]
    v_pk_add_f32 v[28:29], v[120:121], v[122:123]
    v_pk_add_f32 v[44:45], v[144:145], v[146:147]
    v_pk_add_f32 v[30:31], v[124:125], v[126:127]
    v_pk_add_f32 v[46:47], v[148:149], v[150:151]
    v_pk_add_f32 v[16:17], v[16:17], v[18:19]
    v_pk_add_f32 v[32:33], v[32:33], v[34:35]
    v_pk_add_f32 v[30:31], v[28:29], v[30:31]
    v_pk_add_f32 v[46:47], v[44:45], v[46:47]
    v_add_f32 v28, v16, v17
    v_add_f32 v44, v32, v33
    v_add_f32 v29, v30, v31
    v_add_f32 v45, v46, v47
    v_cvt_pk_bf16_f32 v16, v168, v169
    v_permlane32_swap_b32 v28, v29
    v_permlane32_swap_b32 v44, v45
    v_cvt_pk_bf16_f32 v17, v170, v171
    v_add_f32 v28, v28, v29
    v_add_f32 v44, v44, v45
    v_cvt_pk_bf16_f32 v18, v172, v173
    v_mov_b32 v29, v28
    v_mov_b32 v45, v44
    v_cvt_pk_bf16_f32 v19, v174, v175
    v_permlane16_swap_b32 v28, v29
    v_permlane16_swap_b32 v44, v45
    v_cvt_pk_bf16_f32 v32, v192, v193
    v_add_f32 v28, v28, v29
    v_add_f32 v44, v44, v45
    v_cvt_pk_bf16_f32 v33, v194, v195
    v_rcp_f32 v28, v28
    v_rcp_f32 v44, v44
    v_cvt_pk_bf16_f32 v34, v196, v197
    v_mov_b32 v29, v28
    v_mov_b32 v45, v44
    v_cvt_pk_bf16_f32 v35, v198, v199
    v_permlane32_swap_b32 v28, v29
    v_permlane32_swap_b32 v44, v45
    v_pk_mul_f32 v[120:121], v[120:121], v[28:29] op_sel:[0,1] op_sel_hi:[1,1]
    v_pk_mul_f32 v[144:145], v[144:145], v[44:45] op_sel:[0,1] op_sel_hi:[1,1]
    v_pk_mul_f32 v[122:123], v[122:123], v[28:29] op_sel:[0,1] op_sel_hi:[1,1]
    v_pk_mul_f32 v[146:147], v[146:147], v[44:45] op_sel:[0,1] op_sel_hi:[1,1]
    v_pk_mul_f32 v[124:125], v[124:125], v[28:29] op_sel:[0,1] op_sel_hi:[1,1]
    v_pk_mul_f32 v[148:149], v[148:149], v[44:45] op_sel:[0,1] op_sel_hi:[1,1]
    v_pk_mul_f32 v[126:127], v[126:127], v[28:29] op_sel:[0,1] op_sel_hi:[1,1]
    v_pk_mul_f32 v[150:151], v[150:151], v[44:45] op_sel:[0,1] op_sel_hi:[1,1]
    v_pk_mul_f32 v[20:21], v[20:21], v[28:29] op_sel_hi:[1,0]
    v_pk_mul_f32 v[36:37], v[36:37], v[44:45] op_sel_hi:[1,0]
    v_pk_mul_f32 v[22:23], v[22:23], v[28:29] op_sel_hi:[1,0]
    v_pk_mul_f32 v[38:39], v[38:39], v[44:45] op_sel_hi:[1,0]
    v_pk_mul_f32 v[24:25], v[24:25], v[28:29] op_sel_hi:[1,0]
    v_pk_mul_f32 v[40:41], v[40:41], v[44:45] op_sel_hi:[1,0]
    v_pk_mul_f32 v[26:27], v[26:27], v[28:29] op_sel_hi:[1,0]
    v_pk_mul_f32 v[42:43], v[42:43], v[44:45] op_sel_hi:[1,0]
    v_cvt_pk_bf16_f32 v120, v120, v121
    v_mfma_f32_16x16x32_bf16 v[168:171], v[48:51], v[16:19], 0
    v_cvt_pk_bf16_f32 v144, v144, v145
    v_cvt_pk_bf16_f32 v121, v122, v123
    v_mfma_f32_16x16x32_bf16 v[172:175], v[52:55], v[16:19], 0
    v_cvt_pk_bf16_f32 v145, v146, v147
    v_cvt_pk_bf16_f32 v122, v124, v125
    v_mfma_f32_16x16x32_bf16 v[192:195], v[48:51], v[32:35], 0
    v_cvt_pk_bf16_f32 v146, v148, v149
    v_cvt_pk_bf16_f32 v123, v126, v127
    v_mfma_f32_16x16x32_bf16 v[196:199], v[52:55], v[32:35], 0
    v_cvt_pk_bf16_f32 v147, v150, v151
    v_cvt_pk_bf16_f32 v124, v20, v21
    v_mfma_f32_16x16x32_bf16 v[128:131], v[120:123], a[196:199], 0
    v_cvt_pk_bf16_f32 v148, v36, v37
    v_cvt_pk_bf16_f32 v125, v22, v23
    v_mfma_f32_16x16x32_bf16 v[132:135], v[120:123], a[200:203], 0
    v_cvt_pk_bf16_f32 v149, v38, v39
    v_cvt_pk_bf16_f32 v126, v24, v25
    v_mfma_f32_16x16x32_bf16 v[152:155], v[144:147], a[196:199], 0
    v_cvt_pk_bf16_f32 v150, v40, v41
    v_cvt_pk_bf16_f32 v127, v26, v27
    v_mfma_f32_16x16x32_bf16 v[156:159], v[144:147], a[200:203], 0
    v_cvt_pk_bf16_f32 v151, v42, v43
    v_max3_f32 v28, v168, v169, v170
    v_max3_f32 v44, v192, v193, v194
    v_max3_f32 v29, -v168, -v169, -v170
    v_max3_f32 v45, -v192, -v193, -v194
    v_max3_f32 v28, v28, v171, v172
    v_max3_f32 v44, v44, v195, v196
    v_max3_f32 v29, v29, -v171, -v172
    v_max3_f32 v45, v45, -v195, -v196
    v_max3_f32 v28, v28, v173, v174
    v_max3_f32 v44, v44, v197, v198
    v_max3_f32 v29, v29, -v173, -v174
    v_max3_f32 v45, v45, -v197, -v198
    v_max_f32 v28, v28, v175
    v_max_f32 v44, v44, v199
    v_max_f32_e64 v29, v29, -v175
    v_max_f32_e64 v45, v45, -v199
    v_cvt_pk_bf16_f32 v120, v128, v129
    v_permlane32_swap_b32 v28, v29
    v_permlane32_swap_b32 v44, v45
    v_cvt_pk_bf16_f32 v121, v130, v131
    v_max_f32 v28, v28, v29
    v_max_f32 v44, v44, v45
    v_cvt_pk_bf16_f32 v144, v132, v133
    v_mov_b32 v29, v28
    v_mov_b32 v45, v44
    v_cvt_pk_bf16_f32 v145, v134, v135
    v_permlane16_swap_b32 v28, v29
    v_permlane16_swap_b32 v44, v45
    v_cvt_pk_bf16_f32 v122, v152, v153
    v_max_f32 v28, v28, v29
    v_max_f32 v44, v44, v45
    v_cvt_pk_bf16_f32 v123, v154, v155
    v_mul_f32 v28, s48, v28
    v_mul_f32 v44, s48, v44
    v_cvt_pk_bf16_f32 v146, v156, v157
    v_mov_b32 v29, v28
    v_mov_b32 v45, v44
    v_cvt_pk_bf16_f32 v147, v158, v159
    v_permlane32_swap_b32 v28, v29
    v_permlane32_swap_b32 v44, v45
    v_pk_fma_f32 v[20:21], v[168:169], s[50:51], v[28:29] op_sel_hi:[1,0,0]
    v_pk_fma_f32 v[36:37], v[192:193], s[50:51], v[44:45] op_sel_hi:[1,0,0]
    v_pk_fma_f32 v[22:23], v[170:171], s[50:51], v[28:29] op_sel_hi:[1,0,0]
    v_pk_fma_f32 v[38:39], v[194:195], s[50:51], v[44:45] op_sel_hi:[1,0,0]
    v_pk_fma_f32 v[24:25], v[172:173], s[50:51], v[28:29] op_sel_hi:[1,0,0]
    v_pk_fma_f32 v[40:41], v[196:197], s[50:51], v[44:45] op_sel_hi:[1,0,0]
    v_pk_fma_f32 v[26:27], v[174:175], s[50:51], v[28:29] op_sel_hi:[1,0,0]
    v_pk_fma_f32 v[42:43], v[198:199], s[50:51], v[44:45] op_sel_hi:[1,0,0]
    v_pk_fma_f32 v[168:169], v[168:169], s[48:49], v[28:29] op_sel:[0,0,1] op_sel_hi:[1,0,1]
    v_pk_fma_f32 v[192:193], v[192:193], s[48:49], v[44:45] op_sel:[0,0,1] op_sel_hi:[1,0,1]
    v_pk_fma_f32 v[170:171], v[170:171], s[48:49], v[28:29] op_sel:[0,0,1] op_sel_hi:[1,0,1]
    v_pk_fma_f32 v[194:195], v[194:195], s[48:49], v[44:45] op_sel:[0,0,1] op_sel_hi:[1,0,1]
    v_pk_fma_f32 v[172:173], v[172:173], s[48:49], v[28:29] op_sel:[0,0,1] op_sel_hi:[1,0,1]
    v_pk_fma_f32 v[196:197], v[196:197], s[48:49], v[44:45] op_sel:[0,0,1] op_sel_hi:[1,0,1]
    v_pk_fma_f32 v[174:175], v[174:175], s[48:49], v[28:29] op_sel:[0,0,1] op_sel_hi:[1,0,1]
    v_pk_fma_f32 v[198:199], v[198:199], s[48:49], v[44:45] op_sel:[0,0,1] op_sel_hi:[1,0,1]
    v_exp_f32 v20, v20
    v_mfma_f32_16x16x32_bf16 v[128:131], v[124:127], a[196:199], 0
    v_exp_f32 v36, v36
    v_mfma_f32_16x16x32_bf16 v[132:135], v[124:127], a[200:203], 0
    v_exp_f32 v21, v21
    v_mfma_f32_16x16x32_bf16 v[152:155], v[148:151], a[196:199], 0
    v_exp_f32 v37, v37
    v_mfma_f32_16x16x32_bf16 v[156:159], v[148:151], a[200:203], 0
    v_exp_f32 v22, v22
    v_mfma_f32_16x16x32_bf16 a[172:175], v[120:123], v[56:59], a[172:175]
    v_exp_f32 v38, v38
    v_mfma_f32_16x16x32_bf16 a[176:179], v[120:123], v[60:63], a[176:179]
    v_exp_f32 v23, v23
    v_mfma_f32_16x16x32_bf16 a[180:183], v[120:123], a[144:147], a[180:183]
    v_exp_f32 v39, v39
    v_mfma_f32_16x16x32_bf16 a[184:187], v[144:147], v[56:59], a[184:187]
    v_exp_f32 v24, v24
    v_mfma_f32_16x16x32_bf16 a[188:191], v[144:147], v[60:63], a[188:191]
    v_exp_f32 v40, v40
    v_mfma_f32_16x16x32_bf16 a[192:195], v[144:147], a[144:147], a[192:195]
    v_exp_f32 v25, v25
    v_exp_f32 v41, v41
    v_cvt_pk_bf16_f32 v124, v128, v129
    v_exp_f32 v26, v26
    v_cvt_pk_bf16_f32 v125, v130, v131
    v_exp_f32 v42, v42
    v_cvt_pk_bf16_f32 v148, v132, v133
    v_exp_f32 v27, v27
    v_cvt_pk_bf16_f32 v149, v134, v135
    v_exp_f32 v43, v43
    v_cvt_pk_bf16_f32 v126, v152, v153
    v_exp_f32 v168, v168
    v_cvt_pk_bf16_f32 v127, v154, v155
    v_exp_f32 v192, v192
    v_cvt_pk_bf16_f32 v150, v156, v157
    v_exp_f32 v169, v169
    v_cvt_pk_bf16_f32 v151, v158, v159
    v_exp_f32 v193, v193
    v_exp_f32 v170, v170
    v_mfma_f32_16x16x32_bf16 a[148:151], v[124:127], v[56:59], a[148:151]
    v_exp_f32 v194, v194
    v_mfma_f32_16x16x32_bf16 a[152:155], v[124:127], v[60:63], a[152:155]
    v_exp_f32 v171, v171
    v_mfma_f32_16x16x32_bf16 a[156:159], v[124:127], a[144:147], a[156:159]
    v_exp_f32 v195, v195
    v_mfma_f32_16x16x32_bf16 a[160:163], v[148:151], v[56:59], a[160:163]
    v_exp_f32 v172, v172
    v_mfma_f32_16x16x32_bf16 a[164:167], v[148:151], v[60:63], a[164:167]
    v_exp_f32 v196, v196
    v_mfma_f32_16x16x32_bf16 a[168:171], v[148:151], a[144:147], a[168:171]
    v_exp_f32 v173, v173
    v_exp_f32 v197, v197
    v_exp_f32 v174, v174
    v_cvt_pk_bf16_f32 v56, v176, v177
    v_cvt_pk_bf16_f32 v57, v178, v179
    v_cvt_pk_bf16_f32 v58, v200, v201
    v_cvt_pk_bf16_f32 v59, v202, v203
    v_cvt_pk_bf16_f32 v60, v180, v181
    v_cvt_pk_bf16_f32 v61, v182, v183
    v_cvt_pk_bf16_f32 v62, v204, v205
    v_cvt_pk_bf16_f32 v63, v206, v207
    v_exp_f32 v198, v198
    v_exp_f32 v175, v175
    v_exp_f32 v199, v199
    v_pk_add_f32 v[16:17], v[20:21], v[22:23]
    v_pk_add_f32 v[32:33], v[36:37], v[38:39]
    v_pk_add_f32 v[18:19], v[24:25], v[26:27]
    v_pk_add_f32 v[34:35], v[40:41], v[42:43]
    v_pk_add_f32 v[28:29], v[168:169], v[170:171]
    v_pk_add_f32 v[44:45], v[192:193], v[194:195]
    v_pk_add_f32 v[30:31], v[172:173], v[174:175]
    v_pk_add_f32 v[46:47], v[196:197], v[198:199]
    v_pk_add_f32 v[16:17], v[16:17], v[18:19]
    v_pk_add_f32 v[32:33], v[32:33], v[34:35]
    v_pk_add_f32 v[30:31], v[28:29], v[30:31]
    v_pk_add_f32 v[46:47], v[44:45], v[46:47]
    v_add_f32 v28, v16, v17
    v_add_f32 v44, v32, v33
    v_add_f32 v29, v30, v31
    v_add_f32 v45, v46, v47
    v_cvt_pk_bf16_f32 v16, v216, v217
    v_permlane32_swap_b32 v28, v29
    v_permlane32_swap_b32 v44, v45
    v_cvt_pk_bf16_f32 v17, v218, v219
    v_add_f32 v28, v28, v29
    v_add_f32 v44, v44, v45
    v_cvt_pk_bf16_f32 v18, v220, v221
    v_mov_b32 v29, v28
    v_mov_b32 v45, v44
    v_cvt_pk_bf16_f32 v19, v222, v223
    v_permlane16_swap_b32 v28, v29
    v_permlane16_swap_b32 v44, v45
    v_cvt_pk_bf16_f32 v32, v240, v241
    v_add_f32 v28, v28, v29
    v_add_f32 v44, v44, v45
    v_cvt_pk_bf16_f32 v33, v242, v243
    v_rcp_f32 v28, v28
    v_rcp_f32 v44, v44
    v_cvt_pk_bf16_f32 v34, v244, v245
    v_mov_b32 v29, v28
    v_mov_b32 v45, v44
    v_cvt_pk_bf16_f32 v35, v246, v247
    v_permlane32_swap_b32 v28, v29
    v_permlane32_swap_b32 v44, v45
    v_pk_mul_f32 v[168:169], v[168:169], v[28:29] op_sel:[0,1] op_sel_hi:[1,1]
    v_pk_mul_f32 v[192:193], v[192:193], v[44:45] op_sel:[0,1] op_sel_hi:[1,1]
    v_pk_mul_f32 v[170:171], v[170:171], v[28:29] op_sel:[0,1] op_sel_hi:[1,1]
    v_pk_mul_f32 v[194:195], v[194:195], v[44:45] op_sel:[0,1] op_sel_hi:[1,1]
    v_pk_mul_f32 v[172:173], v[172:173], v[28:29] op_sel:[0,1] op_sel_hi:[1,1]
    v_pk_mul_f32 v[196:197], v[196:197], v[44:45] op_sel:[0,1] op_sel_hi:[1,1]
    v_pk_mul_f32 v[174:175], v[174:175], v[28:29] op_sel:[0,1] op_sel_hi:[1,1]
    v_pk_mul_f32 v[198:199], v[198:199], v[44:45] op_sel:[0,1] op_sel_hi:[1,1]
    v_pk_mul_f32 v[20:21], v[20:21], v[28:29] op_sel_hi:[1,0]
    v_pk_mul_f32 v[36:37], v[36:37], v[44:45] op_sel_hi:[1,0]
    v_pk_mul_f32 v[22:23], v[22:23], v[28:29] op_sel_hi:[1,0]
    v_pk_mul_f32 v[38:39], v[38:39], v[44:45] op_sel_hi:[1,0]
    v_pk_mul_f32 v[24:25], v[24:25], v[28:29] op_sel_hi:[1,0]
    v_pk_mul_f32 v[40:41], v[40:41], v[44:45] op_sel_hi:[1,0]
    v_pk_mul_f32 v[26:27], v[26:27], v[28:29] op_sel_hi:[1,0]
    v_pk_mul_f32 v[42:43], v[42:43], v[44:45] op_sel_hi:[1,0]
    v_cvt_pk_bf16_f32 v168, v168, v169
    v_mfma_f32_16x16x32_bf16 v[216:219], v[48:51], v[16:19], 0
    v_cvt_pk_bf16_f32 v192, v192, v193
    v_cvt_pk_bf16_f32 v169, v170, v171
    v_mfma_f32_16x16x32_bf16 v[220:223], v[52:55], v[16:19], 0
    v_cvt_pk_bf16_f32 v193, v194, v195
    v_cvt_pk_bf16_f32 v170, v172, v173
    v_mfma_f32_16x16x32_bf16 v[240:243], v[48:51], v[32:35], 0
    v_cvt_pk_bf16_f32 v194, v196, v197
    v_cvt_pk_bf16_f32 v171, v174, v175
    v_mfma_f32_16x16x32_bf16 v[244:247], v[52:55], v[32:35], 0
    v_cvt_pk_bf16_f32 v195, v198, v199
    v_cvt_pk_bf16_f32 v172, v20, v21
    v_mfma_f32_16x16x32_bf16 v[176:179], v[168:171], a[196:199], 0
    v_cvt_pk_bf16_f32 v196, v36, v37
    v_cvt_pk_bf16_f32 v173, v22, v23
    v_mfma_f32_16x16x32_bf16 v[180:183], v[168:171], a[200:203], 0
    v_cvt_pk_bf16_f32 v197, v38, v39
    v_cvt_pk_bf16_f32 v174, v24, v25
    v_mfma_f32_16x16x32_bf16 v[200:203], v[192:195], a[196:199], 0
    v_cvt_pk_bf16_f32 v198, v40, v41
    v_cvt_pk_bf16_f32 v175, v26, v27
    v_mfma_f32_16x16x32_bf16 v[204:207], v[192:195], a[200:203], 0
    v_cvt_pk_bf16_f32 v199, v42, v43
    v_max3_f32 v28, v216, v217, v218
    v_max3_f32 v44, v240, v241, v242
    v_max3_f32 v29, -v216, -v217, -v218
    v_max3_f32 v45, -v240, -v241, -v242
    v_max3_f32 v28, v28, v219, v220
    v_max3_f32 v44, v44, v243, v244
    v_max3_f32 v29, v29, -v219, -v220
    v_max3_f32 v45, v45, -v243, -v244
    v_max3_f32 v28, v28, v221, v222
    v_max3_f32 v44, v44, v245, v246
    v_max3_f32 v29, v29, -v221, -v222
    v_max3_f32 v45, v45, -v245, -v246
    v_max_f32 v28, v28, v223
    v_max_f32 v44, v44, v247
    v_max_f32_e64 v29, v29, -v223
    v_lshlrev_b32 v9, 4, v1
    s_lshr_b32 s44, s49, 5
    s_lshl_b32 s44, s44, 7
    s_lshl_b32 s45, s30, 6
    s_add_u32 s44, s44, s45
    s_add_u32 s44, s44, s27
    s_lshl_b32 s44, s44, 11
    v_max_f32_e64 v45, v45, -v247
    v_cvt_pk_bf16_f32 v168, v176, v177
    v_permlane32_swap_b32 v28, v29
    v_permlane32_swap_b32 v44, v45
    v_cvt_pk_bf16_f32 v169, v178, v179
    v_max_f32 v28, v28, v29
    v_max_f32 v44, v44, v45
    v_cvt_pk_bf16_f32 v192, v180, v181
    v_mov_b32 v29, v28
    v_mov_b32 v45, v44
    v_cvt_pk_bf16_f32 v193, v182, v183
    v_permlane16_swap_b32 v28, v29
    v_permlane16_swap_b32 v44, v45
    v_cvt_pk_bf16_f32 v170, v200, v201
    v_max_f32 v28, v28, v29
    v_max_f32 v44, v44, v45
    v_cvt_pk_bf16_f32 v171, v202, v203
    v_mul_f32 v28, s48, v28
    v_mul_f32 v44, s48, v44
    v_cvt_pk_bf16_f32 v194, v204, v205
    v_mov_b32 v29, v28
    v_mov_b32 v45, v44
    v_cvt_pk_bf16_f32 v195, v206, v207
    v_permlane32_swap_b32 v28, v29
    v_permlane32_swap_b32 v44, v45
    v_pk_fma_f32 v[20:21], v[216:217], s[50:51], v[28:29] op_sel_hi:[1,0,0]
    v_pk_fma_f32 v[36:37], v[240:241], s[50:51], v[44:45] op_sel_hi:[1,0,0]
    v_pk_fma_f32 v[22:23], v[218:219], s[50:51], v[28:29] op_sel_hi:[1,0,0]
    v_pk_fma_f32 v[38:39], v[242:243], s[50:51], v[44:45] op_sel_hi:[1,0,0]
    v_pk_fma_f32 v[24:25], v[220:221], s[50:51], v[28:29] op_sel_hi:[1,0,0]
    v_pk_fma_f32 v[40:41], v[244:245], s[50:51], v[44:45] op_sel_hi:[1,0,0]
    v_pk_fma_f32 v[26:27], v[222:223], s[50:51], v[28:29] op_sel_hi:[1,0,0]
    v_pk_fma_f32 v[42:43], v[246:247], s[50:51], v[44:45] op_sel_hi:[1,0,0]
    v_pk_fma_f32 v[216:217], v[216:217], s[48:49], v[28:29] op_sel:[0,0,1] op_sel_hi:[1,0,1]
    v_pk_fma_f32 v[240:241], v[240:241], s[48:49], v[44:45] op_sel:[0,0,1] op_sel_hi:[1,0,1]
    v_pk_fma_f32 v[218:219], v[218:219], s[48:49], v[28:29] op_sel:[0,0,1] op_sel_hi:[1,0,1]
    v_pk_fma_f32 v[242:243], v[242:243], s[48:49], v[44:45] op_sel:[0,0,1] op_sel_hi:[1,0,1]
    v_pk_fma_f32 v[220:221], v[220:221], s[48:49], v[28:29] op_sel:[0,0,1] op_sel_hi:[1,0,1]
    v_pk_fma_f32 v[244:245], v[244:245], s[48:49], v[44:45] op_sel:[0,0,1] op_sel_hi:[1,0,1]
    v_pk_fma_f32 v[222:223], v[222:223], s[48:49], v[28:29] op_sel:[0,0,1] op_sel_hi:[1,0,1]
    v_pk_fma_f32 v[246:247], v[246:247], s[48:49], v[44:45] op_sel:[0,0,1] op_sel_hi:[1,0,1]
    v_exp_f32 v20, v20
    v_mfma_f32_16x16x32_bf16 v[176:179], v[172:175], a[196:199], 0
    buffer_load_dwordx4 v[120:123], v9, s[92:95], 0 offen offset:0
    v_exp_f32 v36, v36
    v_mfma_f32_16x16x32_bf16 v[180:183], v[172:175], a[200:203], 0
    buffer_load_dwordx4 v[124:127], v9, s[92:95], 0 offen offset:1024
    v_exp_f32 v21, v21
    v_mfma_f32_16x16x32_bf16 v[200:203], v[196:199], a[196:199], 0
    buffer_load_dwordx4 v[72:75], v9, s[4:7], s44 offen offset:0
    v_exp_f32 v37, v37
    v_mfma_f32_16x16x32_bf16 v[204:207], v[196:199], a[200:203], 0
    buffer_load_dwordx4 v[76:79], v9, s[4:7], s44 offen offset:1024
    s_add_u32 s44, s44, 0x8000
    v_exp_f32 v22, v22
    v_mfma_f32_16x16x32_bf16 a[172:175], v[168:171], v[56:59], a[172:175]
    buffer_load_dwordx4 v[80:83], v9, s[4:7], s44 offen offset:0
    v_exp_f32 v38, v38
    v_mfma_f32_16x16x32_bf16 a[176:179], v[168:171], v[60:63], a[176:179]
    buffer_load_dwordx4 v[84:87], v9, s[4:7], s44 offen offset:1024
    s_add_u32 s44, s44, 0x8000
    v_exp_f32 v23, v23
    v_mfma_f32_16x16x32_bf16 a[180:183], v[168:171], a[144:147], a[180:183]
    buffer_load_dwordx4 v[96:99], v9, s[4:7], s44 offen offset:0
    v_exp_f32 v39, v39
    v_mfma_f32_16x16x32_bf16 a[184:187], v[192:195], v[56:59], a[184:187]
    buffer_load_dwordx4 v[100:103], v9, s[4:7], s44 offen offset:1024
    s_add_u32 s44, s44, 0x8000
    v_exp_f32 v24, v24
    v_mfma_f32_16x16x32_bf16 a[188:191], v[192:195], v[60:63], a[188:191]
    buffer_load_dwordx4 v[104:107], v9, s[4:7], s44 offen offset:0
    v_exp_f32 v40, v40
    v_mfma_f32_16x16x32_bf16 a[192:195], v[192:195], a[144:147], a[192:195]
    buffer_load_dwordx4 v[108:111], v9, s[4:7], s44 offen offset:1024
    s_add_u32 s44, s44, 0x8000
    v_exp_f32 v25, v25
    v_exp_f32 v41, v41
L_pg15:
    s_cbranch_execz L_tramp
    v_cvt_pk_bf16_f32 v172, v176, v177
    v_exp_f32 v26, v26
    v_cvt_pk_bf16_f32 v173, v178, v179
    v_exp_f32 v42, v42
    v_cvt_pk_bf16_f32 v196, v180, v181
    v_exp_f32 v27, v27
    v_cvt_pk_bf16_f32 v197, v182, v183
    v_exp_f32 v43, v43
    v_cvt_pk_bf16_f32 v174, v200, v201
    v_exp_f32 v216, v216
    v_cvt_pk_bf16_f32 v175, v202, v203
    v_exp_f32 v240, v240
    v_cvt_pk_bf16_f32 v198, v204, v205
    v_exp_f32 v217, v217
    v_cvt_pk_bf16_f32 v199, v206, v207
    v_exp_f32 v241, v241
    v_exp_f32 v218, v218
    v_mfma_f32_16x16x32_bf16 a[148:151], v[172:175], v[56:59], a[148:151]
    v_exp_f32 v242, v242
    v_mfma_f32_16x16x32_bf16 a[152:155], v[172:175], v[60:63], a[152:155]
    v_exp_f32 v219, v219
    v_mfma_f32_16x16x32_bf16 a[156:159], v[172:175], a[144:147], a[156:159]
    v_exp_f32 v243, v243
    v_mfma_f32_16x16x32_bf16 a[160:163], v[196:199], v[56:59], a[160:163]
    v_exp_f32 v220, v220
    v_mfma_f32_16x16x32_bf16 a[164:167], v[196:199], v[60:63], a[164:167]
    v_exp_f32 v244, v244
    v_mfma_f32_16x16x32_bf16 a[168:171], v[196:199], a[144:147], a[168:171]
    v_exp_f32 v221, v221
    v_exp_f32 v245, v245
    v_exp_f32 v222, v222
    v_cvt_pk_bf16_f32 v56, v224, v225
    v_cvt_pk_bf16_f32 v57, v226, v227
    v_cvt_pk_bf16_f32 v58, v248, v249
    v_cvt_pk_bf16_f32 v59, v250, v251
    v_cvt_pk_bf16_f32 v60, v228, v229
    v_cvt_pk_bf16_f32 v61, v230, v231
    v_cvt_pk_bf16_f32 v62, v252, v253
    v_cvt_pk_bf16_f32 v63, v254, v255
    v_exp_f32 v246, v246
    v_exp_f32 v223, v223
    v_exp_f32 v247, v247
    v_pk_add_f32 v[16:17], v[20:21], v[22:23]
    v_pk_add_f32 v[32:33], v[36:37], v[38:39]
    v_pk_add_f32 v[18:19], v[24:25], v[26:27]
    v_pk_add_f32 v[34:35], v[40:41], v[42:43]
    v_pk_add_f32 v[28:29], v[216:217], v[218:219]
    v_pk_add_f32 v[44:45], v[240:241], v[242:243]
    v_pk_add_f32 v[30:31], v[220:221], v[222:223]
    v_pk_add_f32 v[46:47], v[244:245], v[246:247]
    v_pk_add_f32 v[16:17], v[16:17], v[18:19]
    v_pk_add_f32 v[32:33], v[32:33], v[34:35]
    v_pk_add_f32 v[30:31], v[28:29], v[30:31]
    v_pk_add_f32 v[46:47], v[44:45], v[46:47]
    v_add_f32 v28, v16, v17
    v_add_f32 v44, v32, v33
    v_add_f32 v29, v30, v31
    v_add_f32 v45, v46, v47
    v_cvt_pk_bf16_f32 v16, v64, v65
    v_permlane32_swap_b32 v28, v29
    v_permlane32_swap_b32 v44, v45
    v_cvt_pk_bf16_f32 v17, v66, v67
    v_add_f32 v28, v28, v29
    v_add_f32 v44, v44, v45
    v_cvt_pk_bf16_f32 v18, v68, v69
    v_mov_b32 v29, v28
    v_mov_b32 v45, v44
    v_cvt_pk_bf16_f32 v19, v70, v71
    v_permlane16_swap_b32 v28, v29
    v_permlane16_swap_b32 v44, v45
    v_cvt_pk_bf16_f32 v32, v88, v89
    v_add_f32 v28, v28, v29
    v_add_f32 v44, v44, v45
    v_cvt_pk_bf16_f32 v33, v90, v91
    v_rcp_f32 v28, v28
    v_rcp_f32 v44, v44
    v_cvt_pk_bf16_f32 v34, v92, v93
    v_mov_b32 v29, v28
    v_mov_b32 v45, v44
    v_cvt_pk_bf16_f32 v35, v94, v95
    v_permlane32_swap_b32 v28, v29
    v_permlane32_swap_b32 v44, v45
    v_pk_mul_f32 v[216:217], v[216:217], v[28:29] op_sel:[0,1] op_sel_hi:[1,1]
    v_pk_mul_f32 v[240:241], v[240:241], v[44:45] op_sel:[0,1] op_sel_hi:[1,1]
    v_pk_mul_f32 v[218:219], v[218:219], v[28:29] op_sel:[0,1] op_sel_hi:[1,1]
    v_pk_mul_f32 v[242:243], v[242:243], v[44:45] op_sel:[0,1] op_sel_hi:[1,1]
    v_pk_mul_f32 v[220:221], v[220:221], v[28:29] op_sel:[0,1] op_sel_hi:[1,1]
    v_pk_mul_f32 v[244:245], v[244:245], v[44:45] op_sel:[0,1] op_sel_hi:[1,1]
    v_pk_mul_f32 v[222:223], v[222:223], v[28:29] op_sel:[0,1] op_sel_hi:[1,1]
    v_pk_mul_f32 v[246:247], v[246:247], v[44:45] op_sel:[0,1] op_sel_hi:[1,1]
    v_pk_mul_f32 v[20:21], v[20:21], v[28:29] op_sel_hi:[1,0]
    v_pk_mul_f32 v[36:37], v[36:37], v[44:45] op_sel_hi:[1,0]
    v_pk_mul_f32 v[22:23], v[22:23], v[28:29] op_sel_hi:[1,0]
    v_pk_mul_f32 v[38:39], v[38:39], v[44:45] op_sel_hi:[1,0]
    v_pk_mul_f32 v[24:25], v[24:25], v[28:29] op_sel_hi:[1,0]
    v_pk_mul_f32 v[40:41], v[40:41], v[44:45] op_sel_hi:[1,0]
    v_pk_mul_f32 v[26:27], v[26:27], v[28:29] op_sel_hi:[1,0]
    v_pk_mul_f32 v[42:43], v[42:43], v[44:45] op_sel_hi:[1,0]
    v_cvt_pk_bf16_f32 v216, v216, v217
    v_mfma_f32_16x16x32_bf16 v[64:67], v[48:51], v[16:19], 0
    v_cvt_pk_bf16_f32 v240, v240, v241
    v_cvt_pk_bf16_f32 v217, v218, v219
    v_mfma_f32_16x16x32_bf16 v[68:71], v[52:55], v[16:19], 0
    v_cvt_pk_bf16_f32 v241, v242, v243
    v_cvt_pk_bf16_f32 v218, v220, v221
    v_mfma_f32_16x16x32_bf16 v[88:91], v[48:51], v[32:35], 0
    v_cvt_pk_bf16_f32 v242, v244, v245
    v_cvt_pk_bf16_f32 v219, v222, v223
    v_mfma_f32_16x16x32_bf16 v[92:95], v[52:55], v[32:35], 0
    v_cvt_pk_bf16_f32 v243, v246, v247
    v_cvt_pk_bf16_f32 v220, v20, v21
    v_mfma_f32_16x16x32_bf16 v[224:227], v[216:219], a[196:199], 0
    v_cvt_pk_bf16_f32 v244, v36, v37
    v_cvt_pk_bf16_f32 v221, v22, v23
    v_mfma_f32_16x16x32_bf16 v[228:231], v[216:219], a[200:203], 0
    v_cvt_pk_bf16_f32 v245, v38, v39
    v_cvt_pk_bf16_f32 v222, v24, v25
    v_mfma_f32_16x16x32_bf16 v[248:251], v[240:243], a[196:199], 0
    v_cvt_pk_bf16_f32 v246, v40, v41
    v_cvt_pk_bf16_f32 v223, v26, v27
    v_mfma_f32_16x16x32_bf16 v[252:255], v[240:243], a[200:203], 0
    v_cvt_pk_bf16_f32 v247, v42, v43
    s_lshl_b32 s44, s26, 12
    s_add_u32 s44, s44, s76
    s_lshl_b32 s45, s26, 7
    s_add_u32 s45, s45, s77
    v_cmp_eq_u32 vcc, 1, v13
    v_lshl_add_u32 v9, v13, 6, v8
    v_cvt_pk_bf16_f32 v216, v224, v225
    v_cvt_pk_bf16_f32 v217, v226, v227
    v_cvt_pk_bf16_f32 v240, v228, v229
    v_cvt_pk_bf16_f32 v241, v230, v231
    v_mfma_f32_16x16x32_bf16 v[224:227], v[220:223], a[196:199], 0
    v_mfma_f32_16x16x32_bf16 v[228:231], v[220:223], a[200:203], 0
    v_cvt_pk_bf16_f32 v218, v248, v249
    v_cvt_pk_bf16_f32 v219, v250, v251
    v_cvt_pk_bf16_f32 v242, v252, v253
    v_cvt_pk_bf16_f32 v243, v254, v255
    v_mfma_f32_16x16x32_bf16 v[248:251], v[244:247], a[196:199], 0
    v_mfma_f32_16x16x32_bf16 v[252:255], v[244:247], a[200:203], 0
    v_mfma_f32_16x16x32_bf16 a[172:175], v[216:219], v[56:59], a[172:175]
    v_mfma_f32_16x16x32_bf16 a[176:179], v[216:219], v[60:63], a[176:179]
    v_mfma_f32_16x16x32_bf16 a[180:183], v[216:219], a[144:147], a[180:183]
    v_cvt_pk_bf16_f32 v220, v224, v225
    v_cvt_pk_bf16_f32 v221, v226, v227
    v_mfma_f32_16x16x32_bf16 a[184:187], v[240:243], v[56:59], a[184:187]
    v_cvt_pk_bf16_f32 v244, v228, v229
    v_cvt_pk_bf16_f32 v245, v230, v231
    v_mfma_f32_16x16x32_bf16 a[188:191], v[240:243], v[60:63], a[188:191]
    v_cvt_pk_bf16_f32 v222, v248, v249
    v_cvt_pk_bf16_f32 v223, v250, v251
    v_mfma_f32_16x16x32_bf16 a[192:195], v[240:243], a[144:147], a[192:195]
    v_cvt_pk_bf16_f32 v246, v252, v253
    v_cvt_pk_bf16_f32 v247, v254, v255
    v_mfma_f32_16x16x32_bf16 a[148:151], v[220:223], v[56:59], a[148:151]
    ds_write_b128 v6, a[172:175] offset:0
    v_mfma_f32_16x16x32_bf16 a[152:155], v[220:223], v[60:63], a[152:155]
    ds_write_b128 v6, a[176:179] offset:1024
    v_mfma_f32_16x16x32_bf16 a[156:159], v[220:223], a[144:147], a[156:159]
    ds_write_b128 v6, a[180:183] offset:2048
    v_mfma_f32_16x16x32_bf16 a[160:163], v[244:247], v[56:59], a[160:163]
    ds_write_b128 v6, a[184:187] offset:3072
    v_mfma_f32_16x16x32_bf16 a[164:167], v[244:247], v[60:63], a[164:167]
    ds_write_b128 v6, a[188:191] offset:4096
    v_mfma_f32_16x16x32_bf16 a[168:171], v[244:247], a[144:147], a[168:171]
    ds_write_b128 v6, a[192:195] offset:5120
    s_waitcnt lgkmcnt(0)
    s_barrier
    ds_read_b128 v[176:179], v7 offset:0
    ds_read_b128 v[180:183], v7 offset:1024
    ds_read_b128 v[192:195], v7 offset:2048
    ds_read_b128 v[196:199], v7 offset:3072
    ds_read_b128 v[200:203], v7 offset:4096
    ds_read_b128 v[204:207], v7 offset:5120
    v_accvgpr_read_b32 v144, a148
    v_accvgpr_read_b32 v145, a149
    v_accvgpr_read_b32 v146, a150
    v_accvgpr_read_b32 v147, a151
    v_accvgpr_read_b32 v148, a152
    v_accvgpr_read_b32 v149, a153
    v_accvgpr_read_b32 v150, a154
    v_accvgpr_read_b32 v151, a155
    v_accvgpr_read_b32 v152, a156
    v_accvgpr_read_b32 v153, a157
    v_accvgpr_read_b32 v154, a158
    v_accvgpr_read_b32 v155, a159
    v_accvgpr_read_b32 v156, a160
    v_accvgpr_read_b32 v157, a161
    v_accvgpr_read_b32 v158, a162
    v_accvgpr_read_b32 v159, a163
    v_accvgpr_read_b32 v168, a164
    v_accvgpr_read_b32 v169, a165
    v_accvgpr_read_b32 v170, a166
    v_accvgpr_read_b32 v171, a167
    v_accvgpr_read_b32 v172, a168
    v_accvgpr_read_b32 v173, a169
    v_accvgpr_read_b32 v174, a170
    v_accvgpr_read_b32 v175, a171
    s_waitcnt lgkmcnt(0)
    v_pk_add_f32 v[144:145], v[144:145], v[176:177]
    v_pk_add_f32 v[146:147], v[146:147], v[178:179]
    v_pk_add_f32 v[156:157], v[156:157], v[196:197]
    v_pk_add_f32 v[158:159], v[158:159], v[198:199]
    v_pk_add_f32 v[148:149], v[148:149], v[180:181]
    v_pk_add_f32 v[150:151], v[150:151], v[182:183]
    v_pk_add_f32 v[168:169], v[168:169], v[200:201]
    v_pk_add_f32 v[170:171], v[170:171], v[202:203]
    v_pk_add_f32 v[152:153], v[152:153], v[192:193]
    v_pk_add_f32 v[154:155], v[154:155], v[194:195]
    v_pk_add_f32 v[172:173], v[172:173], v[204:205]
    v_pk_add_f32 v[174:175], v[174:175], v[206:207]
    v_cvt_pk_bf16_f32 v224, v144, v145
    v_cvt_pk_bf16_f32 v225, v146, v147
    v_cvt_pk_bf16_f32 v226, v156, v157
    v_cvt_pk_bf16_f32 v227, v158, v159
    v_cvt_pk_bf16_f32 v228, v148, v149
    v_cvt_pk_bf16_f32 v229, v150, v151
    v_cvt_pk_bf16_f32 v230, v168, v169
    v_cvt_pk_bf16_f32 v231, v170, v171
    v_cndmask_b32 v152, v152, v172, vcc
    v_cndmask_b32 v153, v153, v173, vcc
    v_cndmask_b32 v154, v154, v174, vcc
    v_cndmask_b32 v155, v155, v175, vcc
    buffer_store_dwordx4 v[224:227], v12, s[12:15], s44 offen offset:0 sc1
    buffer_store_dwordx4 v[228:231], v12, s[12:15], s44 offen offset:2048 sc1
    s_mov_b32 s78, 0x00030003
    s_mov_b32 s79, 0x00030003
    s_mov_b64 exec, s[78:79]
    buffer_store_dwordx4 v[152:155], v9, s[12:15], s45 offen sc1
    s_mov_b64 exec, -1
    s_waitcnt vmcnt(3)
    v_mov_b32 v56, 0
    v_mov_b32 v57, 0
    v_mov_b32 v58, 0
    v_mov_b32 v59, 0
    v_dot2c_f32_bf16 v56, v72, v120
    v_dot2c_f32_bf16 v57, v80, v120
    v_dot2c_f32_bf16 v58, v96, v120
    v_dot2c_f32_bf16 v59, v104, v120
    v_dot2c_f32_bf16 v56, v73, v121
    v_dot2c_f32_bf16 v57, v81, v121
    v_dot2c_f32_bf16 v58, v97, v121
    v_dot2c_f32_bf16 v59, v105, v121
    v_dot2c_f32_bf16 v56, v74, v122
    v_dot2c_f32_bf16 v57, v82, v122
    v_dot2c_f32_bf16 v58, v98, v122
    v_dot2c_f32_bf16 v59, v106, v122
    v_dot2c_f32_bf16 v56, v75, v123
    v_dot2c_f32_bf16 v57, v83, v123
    v_dot2c_f32_bf16 v58, v99, v123
    v_dot2c_f32_bf16 v59, v107, v123
    v_dot2c_f32_bf16 v56, v76, v124
    v_dot2c_f32_bf16 v57, v84, v124
    v_dot2c_f32_bf16 v58, v100, v124
    v_dot2c_f32_bf16 v59, v108, v124
    v_dot2c_f32_bf16 v56, v77, v125
    v_dot2c_f32_bf16 v57, v85, v125
    v_dot2c_f32_bf16 v58, v101, v125
    v_dot2c_f32_bf16 v59, v109, v125
    v_dot2c_f32_bf16 v56, v78, v126
    v_dot2c_f32_bf16 v57, v86, v126
    v_dot2c_f32_bf16 v58, v102, v126
    v_dot2c_f32_bf16 v59, v110, v126
    v_dot2c_f32_bf16 v56, v79, v127
    v_dot2c_f32_bf16 v57, v87, v127
    v_dot2c_f32_bf16 v58, v103, v127
    v_dot2c_f32_bf16 v59, v111, v127
    v_and_b32 v13, 7, v1
    v_lshlrev_b32 v63, 4, v13
    v_lshlrev_b32 v13, 7, v13
    v_permlane32_swap_b32 v56, v58
    v_permlane32_swap_b32 v57, v59
    v_add_f32 v56, v56, v58
    v_add_f32 v57, v57, v59
    v_and_b32 v62, 8, v1
    v_lshl_add_u32 v13, v62, 3, v13
    v_permlane16_swap_b32 v56, v57
    v_add_f32 v62, v56, v57
    v_max3_f32 v28, v64, v65, v66
    v_max3_f32 v44, v88, v89, v90
    v_max3_f32 v29, -v64, -v65, -v66
    v_add_f32_dpp v62, v62, v62 quad_perm:[1,0,3,2] row_mask:0xf bank_mask:0xf
    v_max3_f32 v45, -v88, -v89, -v90
    v_max3_f32 v28, v28, v67, v68
    v_max3_f32 v44, v44, v91, v92
    v_add_f32_dpp v62, v62, v62 quad_perm:[2,3,0,1] row_mask:0xf bank_mask:0xf
    v_max3_f32 v29, v29, -v67, -v68
    v_max3_f32 v45, v45, -v91, -v92
    v_max3_f32 v28, v28, v69, v70
    v_add_f32_dpp v62, v62, v62 row_half_mirror row_mask:0xf bank_mask:0xf
    v_max3_f32 v44, v44, v93, v94
    v_max3_f32 v29, v29, -v69, -v70
    v_max3_f32 v45, v45, -v93, -v94
    v_add_f32_dpp v62, v62, v62 row_mirror row_mask:0xf bank_mask:0xf
    v_max_f32 v28, v28, v71
    v_max_f32 v44, v44, v95
    v_max_f32_e64 v29, v29, -v71
    v_mul_f32 v62, s48, v62
    v_max_f32_e64 v45, v45, -v95
    v_permlane32_swap_b32 v28, v29
    v_nop
    v_permlane32_swap_b32 v44, v45
    v_exp_f32 v62, v62
    v_max_f32 v28, v28, v29
    v_max_f32 v44, v44, v45
    v_mov_b32 v29, v28
    v_add_f32 v62, 1.0, v62
    v_mov_b32 v45, v44
    v_permlane16_swap_b32 v28, v29
    v_nop
    v_permlane16_swap_b32 v44, v45
    v_rcp_f32 v62, v62
    v_max_f32 v28, v28, v29
    v_max_f32 v44, v44, v45
    v_mul_f32 v28, s48, v28
    v_lshrrev_b32 v60, 2, v8
    v_add_u32 v63, v63, v60
    v_add_u32 v13, v13, v8
    v_mul_f32 v44, s48, v44
    v_mov_b32 v29, v28
    v_mov_b32 v45, v44
    s_lshl_b32 s44, s49, 7
    s_add_u32 s44, s44, 0x2500000
    v_permlane32_swap_b32 v28, v29
    v_permlane32_swap_b32 v44, v45
    v_pk_fma_f32 v[20:21], v[64:65], s[50:51], v[28:29] op_sel_hi:[1,0,0]
    buffer_store_dword v62, v63, s[12:15], s44 offen sc1
    v_pk_fma_f32 v[36:37], v[88:89], s[50:51], v[44:45] op_sel_hi:[1,0,0]
    v_pk_fma_f32 v[22:23], v[66:67], s[50:51], v[28:29] op_sel_hi:[1,0,0]
    v_pk_fma_f32 v[38:39], v[90:91], s[50:51], v[44:45] op_sel_hi:[1,0,0]
    v_pk_fma_f32 v[24:25], v[68:69], s[50:51], v[28:29] op_sel_hi:[1,0,0]
    v_pk_fma_f32 v[40:41], v[92:93], s[50:51], v[44:45] op_sel_hi:[1,0,0]
    v_pk_fma_f32 v[26:27], v[70:71], s[50:51], v[28:29] op_sel_hi:[1,0,0]
    v_pk_fma_f32 v[42:43], v[94:95], s[50:51], v[44:45] op_sel_hi:[1,0,0]
    v_pk_fma_f32 v[64:65], v[64:65], s[48:49], v[28:29] op_sel:[0,0,1] op_sel_hi:[1,0,1]
    v_pk_fma_f32 v[88:89], v[88:89], s[48:49], v[44:45] op_sel:[0,0,1] op_sel_hi:[1,0,1]
    v_pk_fma_f32 v[66:67], v[66:67], s[48:49], v[28:29] op_sel:[0,0,1] op_sel_hi:[1,0,1]
    v_pk_fma_f32 v[90:91], v[90:91], s[48:49], v[44:45] op_sel:[0,0,1] op_sel_hi:[1,0,1]
    v_pk_fma_f32 v[68:69], v[68:69], s[48:49], v[28:29] op_sel:[0,0,1] op_sel_hi:[1,0,1]
    v_pk_fma_f32 v[92:93], v[92:93], s[48:49], v[44:45] op_sel:[0,0,1] op_sel_hi:[1,0,1]
    v_pk_fma_f32 v[70:71], v[70:71], s[48:49], v[28:29] op_sel:[0,0,1] op_sel_hi:[1,0,1]
    v_pk_fma_f32 v[94:95], v[94:95], s[48:49], v[44:45] op_sel:[0,0,1] op_sel_hi:[1,0,1]
    v_exp_f32 v20, v20
    v_exp_f32 v36, v36
    v_exp_f32 v21, v21
    v_exp_f32 v37, v37
    v_exp_f32 v22, v22
    v_exp_f32 v38, v38
    v_exp_f32 v23, v23
    v_exp_f32 v39, v39
    v_exp_f32 v24, v24
    v_exp_f32 v40, v40
    v_exp_f32 v25, v25
    v_exp_f32 v41, v41
    v_exp_f32 v26, v26
    s_waitcnt vmcnt(1)
    s_add_u32 s78, s32, s33
    s_mov_b64 exec, 1
    buffer_store_dword v15, v11, s[12:15], s78 offen sc1
    s_mov_b64 exec, -1
    v_exp_f32 v42, v42
    v_exp_f32 v27, v27
    v_exp_f32 v43, v43
    v_exp_f32 v64, v64
    v_exp_f32 v88, v88
    v_exp_f32 v65, v65
    v_exp_f32 v89, v89
    v_exp_f32 v66, v66
    v_exp_f32 v90, v90
    v_exp_f32 v67, v67
    v_exp_f32 v91, v91
    v_exp_f32 v68, v68
    v_exp_f32 v92, v92
    v_exp_f32 v69, v69
    v_exp_f32 v93, v93
    v_exp_f32 v70, v70
    v_exp_f32 v94, v94
    v_exp_f32 v71, v71
    v_exp_f32 v95, v95
    v_pk_add_f32 v[16:17], v[20:21], v[22:23]
    v_pk_add_f32 v[32:33], v[36:37], v[38:39]
    v_pk_add_f32 v[18:19], v[24:25], v[26:27]
    v_pk_add_f32 v[34:35], v[40:41], v[42:43]
    v_pk_add_f32 v[28:29], v[64:65], v[66:67]
    v_pk_add_f32 v[44:45], v[88:89], v[90:91]
    v_pk_add_f32 v[30:31], v[68:69], v[70:71]
    v_pk_add_f32 v[46:47], v[92:93], v[94:95]
    v_pk_add_f32 v[16:17], v[16:17], v[18:19]
    v_pk_add_f32 v[32:33], v[32:33], v[34:35]
    v_pk_add_f32 v[30:31], v[28:29], v[30:31]
    v_pk_add_f32 v[46:47], v[44:45], v[46:47]
    v_add_f32 v28, v16, v17
    v_add_f32 v44, v32, v33
    v_add_f32 v29, v30, v31
    v_add_f32 v45, v46, v47
    v_cvt_pk_bf16_f32 v16, v112, v113
    v_permlane32_swap_b32 v28, v29
    v_permlane32_swap_b32 v44, v45
    v_cvt_pk_bf16_f32 v17, v114, v115
    v_add_f32 v28, v28, v29
    v_add_f32 v44, v44, v45
    v_cvt_pk_bf16_f32 v18, v116, v117
    v_mov_b32 v29, v28
    v_mov_b32 v45, v44
    v_cvt_pk_bf16_f32 v19, v118, v119
    v_permlane16_swap_b32 v28, v29
    v_permlane16_swap_b32 v44, v45
    v_cvt_pk_bf16_f32 v32, v136, v137
    v_add_f32 v28, v28, v29
    v_add_f32 v44, v44, v45
    v_cvt_pk_bf16_f32 v33, v138, v139
    v_rcp_f32 v28, v28
    v_rcp_f32 v44, v44
    v_cvt_pk_bf16_f32 v34, v140, v141
    v_mov_b32 v29, v28
    v_mov_b32 v45, v44
    v_cvt_pk_bf16_f32 v35, v142, v143
    v_permlane32_swap_b32 v28, v29
    v_permlane32_swap_b32 v44, v45
    v_pk_mul_f32 v[64:65], v[64:65], v[28:29] op_sel:[0,1] op_sel_hi:[1,1]
    v_pk_mul_f32 v[88:89], v[88:89], v[44:45] op_sel:[0,1] op_sel_hi:[1,1]
    v_pk_mul_f32 v[66:67], v[66:67], v[28:29] op_sel:[0,1] op_sel_hi:[1,1]
    v_pk_mul_f32 v[90:91], v[90:91], v[44:45] op_sel:[0,1] op_sel_hi:[1,1]
    v_pk_mul_f32 v[68:69], v[68:69], v[28:29] op_sel:[0,1] op_sel_hi:[1,1]
    v_pk_mul_f32 v[92:93], v[92:93], v[44:45] op_sel:[0,1] op_sel_hi:[1,1]
    v_pk_mul_f32 v[70:71], v[70:71], v[28:29] op_sel:[0,1] op_sel_hi:[1,1]
    v_pk_mul_f32 v[94:95], v[94:95], v[44:45] op_sel:[0,1] op_sel_hi:[1,1]
    v_pk_mul_f32 v[20:21], v[20:21], v[28:29] op_sel_hi:[1,0]
    v_pk_mul_f32 v[36:37], v[36:37], v[44:45] op_sel_hi:[1,0]
    v_pk_mul_f32 v[22:23], v[22:23], v[28:29] op_sel_hi:[1,0]
    v_pk_mul_f32 v[38:39], v[38:39], v[44:45] op_sel_hi:[1,0]
    v_pk_mul_f32 v[24:25], v[24:25], v[28:29] op_sel_hi:[1,0]
    v_pk_mul_f32 v[40:41], v[40:41], v[44:45] op_sel_hi:[1,0]
    v_pk_mul_f32 v[26:27], v[26:27], v[28:29] op_sel_hi:[1,0]
    v_pk_mul_f32 v[42:43], v[42:43], v[44:45] op_sel_hi:[1,0]
    v_cvt_pk_bf16_f32 v64, v64, v65
    v_mfma_f32_16x16x32_bf16 v[112:115], v[48:51], v[16:19], 0
    v_cvt_pk_bf16_f32 v88, v88, v89
    v_cvt_pk_bf16_f32 v65, v66, v67
    v_mfma_f32_16x16x32_bf16 v[116:119], v[52:55], v[16:19], 0
    v_cvt_pk_bf16_f32 v89, v90, v91
    v_cvt_pk_bf16_f32 v66, v68, v69
    v_mfma_f32_16x16x32_bf16 v[136:139], v[48:51], v[32:35], 0
    v_cvt_pk_bf16_f32 v90, v92, v93
    v_cvt_pk_bf16_f32 v67, v70, v71
    v_mfma_f32_16x16x32_bf16 v[140:143], v[52:55], v[32:35], 0
    v_cvt_pk_bf16_f32 v91, v94, v95
    v_cvt_pk_bf16_f32 v68, v20, v21
    v_cvt_pk_bf16_f32 v92, v36, v37
    v_cvt_pk_bf16_f32 v69, v22, v23
    v_cvt_pk_bf16_f32 v93, v38, v39
    v_cvt_pk_bf16_f32 v70, v24, v25
    v_cvt_pk_bf16_f32 v94, v40, v41
    v_cvt_pk_bf16_f32 v71, v26, v27
    v_cvt_pk_bf16_f32 v95, v42, v43
    v_max3_f32 v28, v112, v113, v114
    v_max3_f32 v44, v136, v137, v138
    v_max3_f32 v29, -v112, -v113, -v114
    v_max3_f32 v45, -v136, -v137, -v138
    v_max3_f32 v28, v28, v115, v116
    v_max3_f32 v44, v44, v139, v140
    v_max3_f32 v29, v29, -v115, -v116
    v_max3_f32 v45, v45, -v139, -v140
    v_max3_f32 v28, v28, v117, v118
    v_max3_f32 v44, v44, v141, v142
    v_max3_f32 v29, v29, -v117, -v118
    v_max3_f32 v45, v45, -v141, -v142
    v_max_f32 v28, v28, v119
    v_max_f32 v44, v44, v143
    v_max_f32_e64 v29, v29, -v119
    v_max_f32_e64 v45, v45, -v143
    v_nop
    v_permlane32_swap_b32 v28, v29
    s_waitcnt vmcnt(1)
    s_add_u32 s78, s52, s53
    s_mov_b64 exec, 1
    buffer_store_dword v15, v11, s[12:15], s78 offen sc1
    s_mov_b64 exec, -1
    v_permlane32_swap_b32 v44, v45
    v_max_f32 v28, v28, v29
    v_max_f32 v44, v44, v45
    v_mov_b32 v29, v28
    v_mov_b32 v45, v44
    v_nop
    v_permlane16_swap_b32 v28, v29
    v_permlane16_swap_b32 v44, v45
    v_max_f32 v28, v28, v29
    v_max_f32 v44, v44, v45
    v_mul_f32 v28, s48, v28
    v_mul_f32 v44, s48, v44
    v_mov_b32 v29, v28
    v_mov_b32 v45, v44
    v_nop
    v_permlane32_swap_b32 v28, v29
    v_permlane32_swap_b32 v44, v45
    v_pk_fma_f32 v[20:21], v[112:113], s[50:51], v[28:29] op_sel_hi:[1,0,0]
    v_pk_fma_f32 v[36:37], v[136:137], s[50:51], v[44:45] op_sel_hi:[1,0,0]
    v_pk_fma_f32 v[22:23], v[114:115], s[50:51], v[28:29] op_sel_hi:[1,0,0]
    v_pk_fma_f32 v[38:39], v[138:139], s[50:51], v[44:45] op_sel_hi:[1,0,0]
    v_pk_fma_f32 v[24:25], v[116:117], s[50:51], v[28:29] op_sel_hi:[1,0,0]
    v_pk_fma_f32 v[40:41], v[140:141], s[50:51], v[44:45] op_sel_hi:[1,0,0]
    v_pk_fma_f32 v[26:27], v[118:119], s[50:51], v[28:29] op_sel_hi:[1,0,0]
    v_pk_fma_f32 v[42:43], v[142:143], s[50:51], v[44:45] op_sel_hi:[1,0,0]
    v_pk_fma_f32 v[112:113], v[112:113], s[48:49], v[28:29] op_sel:[0,0,1] op_sel_hi:[1,0,1]
    v_pk_fma_f32 v[136:137], v[136:137], s[48:49], v[44:45] op_sel:[0,0,1] op_sel_hi:[1,0,1]
    v_pk_fma_f32 v[114:115], v[114:115], s[48:49], v[28:29] op_sel:[0,0,1] op_sel_hi:[1,0,1]
    v_pk_fma_f32 v[138:139], v[138:139], s[48:49], v[44:45] op_sel:[0,0,1] op_sel_hi:[1,0,1]
    v_pk_fma_f32 v[116:117], v[116:117], s[48:49], v[28:29] op_sel:[0,0,1] op_sel_hi:[1,0,1]
    v_pk_fma_f32 v[140:141], v[140:141], s[48:49], v[44:45] op_sel:[0,0,1] op_sel_hi:[1,0,1]
    v_pk_fma_f32 v[118:119], v[118:119], s[48:49], v[28:29] op_sel:[0,0,1] op_sel_hi:[1,0,1]
    v_pk_fma_f32 v[142:143], v[142:143], s[48:49], v[44:45] op_sel:[0,0,1] op_sel_hi:[1,0,1]
    v_exp_f32 v20, v20
    v_exp_f32 v36, v36
    v_exp_f32 v21, v21
    v_exp_f32 v37, v37
    v_exp_f32 v22, v22
    v_exp_f32 v38, v38
    v_exp_f32 v23, v23
    v_exp_f32 v39, v39
    v_exp_f32 v24, v24
    v_exp_f32 v40, v40
    v_exp_f32 v25, v25
    v_exp_f32 v41, v41
    v_exp_f32 v26, v26
    v_exp_f32 v42, v42
    v_exp_f32 v27, v27
    v_exp_f32 v43, v43
    v_exp_f32 v112, v112
    v_exp_f32 v136, v136
    v_exp_f32 v113, v113
    v_exp_f32 v137, v137
    v_exp_f32 v114, v114
    v_exp_f32 v138, v138
    v_exp_f32 v115, v115
    buffer_load_dword v9, v14, s[12:15], s32 offen offset:0 sc1
    v_exp_f32 v139, v139
    v_exp_f32 v116, v116
    v_exp_f32 v140, v140
    v_exp_f32 v117, v117
    v_exp_f32 v141, v141
    v_exp_f32 v118, v118
    v_exp_f32 v142, v142
    v_exp_f32 v119, v119
    v_exp_f32 v143, v143
    v_pk_add_f32 v[16:17], v[20:21], v[22:23]
    v_pk_add_f32 v[32:33], v[36:37], v[38:39]
    v_pk_add_f32 v[18:19], v[24:25], v[26:27]
    v_pk_add_f32 v[34:35], v[40:41], v[42:43]
    v_pk_add_f32 v[28:29], v[112:113], v[114:115]
    v_pk_add_f32 v[44:45], v[136:137], v[138:139]
    v_pk_add_f32 v[30:31], v[116:117], v[118:119]
    v_pk_add_f32 v[46:47], v[140:141], v[142:143]
    v_pk_add_f32 v[16:17], v[16:17], v[18:19]
    v_pk_add_f32 v[32:33], v[32:33], v[34:35]
    v_pk_add_f32 v[30:31], v[28:29], v[30:31]
    v_pk_add_f32 v[46:47], v[44:45], v[46:47]
    v_add_f32 v28, v16, v17
    v_add_f32 v44, v32, v33
    v_add_f32 v29, v30, v31
    v_add_f32 v45, v46, v47
    v_cvt_pk_bf16_f32 v16, v160, v161
    v_permlane32_swap_b32 v28, v29
    v_permlane32_swap_b32 v44, v45
    v_cvt_pk_bf16_f32 v17, v162, v163
    v_add_f32 v28, v28, v29
    v_add_f32 v44, v44, v45
    v_cvt_pk_bf16_f32 v18, v164, v165
    v_mov_b32 v29, v28
    v_mov_b32 v45, v44
    v_cvt_pk_bf16_f32 v19, v166, v167
    v_permlane16_swap_b32 v28, v29
    v_permlane16_swap_b32 v44, v45
    v_cvt_pk_bf16_f32 v32, v184, v185
    v_add_f32 v28, v28, v29
    v_add_f32 v44, v44, v45
    v_cvt_pk_bf16_f32 v33, v186, v187
    v_rcp_f32 v28, v28
    v_rcp_f32 v44, v44
    v_cvt_pk_bf16_f32 v34, v188, v189
    v_mov_b32 v29, v28
    v_mov_b32 v45, v44
    v_cvt_pk_bf16_f32 v35, v190, v191
    v_permlane32_swap_b32 v28, v29
    v_permlane32_swap_b32 v44, v45
    v_pk_mul_f32 v[112:113], v[112:113], v[28:29] op_sel:[0,1] op_sel_hi:[1,1]
    v_pk_mul_f32 v[136:137], v[136:137], v[44:45] op_sel:[0,1] op_sel_hi:[1,1]
    v_pk_mul_f32 v[114:115], v[114:115], v[28:29] op_sel:[0,1] op_sel_hi:[1,1]
    v_pk_mul_f32 v[138:139], v[138:139], v[44:45] op_sel:[0,1] op_sel_hi:[1,1]
    v_pk_mul_f32 v[116:117], v[116:117], v[28:29] op_sel:[0,1] op_sel_hi:[1,1]
    v_pk_mul_f32 v[140:141], v[140:141], v[44:45] op_sel:[0,1] op_sel_hi:[1,1]
    v_pk_mul_f32 v[118:119], v[118:119], v[28:29] op_sel:[0,1] op_sel_hi:[1,1]
    v_pk_mul_f32 v[142:143], v[142:143], v[44:45] op_sel:[0,1] op_sel_hi:[1,1]
    v_pk_mul_f32 v[20:21], v[20:21], v[28:29] op_sel_hi:[1,0]
    v_pk_mul_f32 v[36:37], v[36:37], v[44:45] op_sel_hi:[1,0]
    v_pk_mul_f32 v[22:23], v[22:23], v[28:29] op_sel_hi:[1,0]
    v_pk_mul_f32 v[38:39], v[38:39], v[44:45] op_sel_hi:[1,0]
    v_pk_mul_f32 v[24:25], v[24:25], v[28:29] op_sel_hi:[1,0]
    v_pk_mul_f32 v[40:41], v[40:41], v[44:45] op_sel_hi:[1,0]
    v_pk_mul_f32 v[26:27], v[26:27], v[28:29] op_sel_hi:[1,0]
    v_pk_mul_f32 v[42:43], v[42:43], v[44:45] op_sel_hi:[1,0]
    v_cvt_pk_bf16_f32 v112, v112, v113
    v_mfma_f32_16x16x32_bf16 v[160:163], v[48:51], v[16:19], 0
    v_cvt_pk_bf16_f32 v136, v136, v137
    v_cvt_pk_bf16_f32 v113, v114, v115
    v_mfma_f32_16x16x32_bf16 v[164:167], v[52:55], v[16:19], 0
    v_cvt_pk_bf16_f32 v137, v138, v139
    v_cvt_pk_bf16_f32 v114, v116, v117
    v_mfma_f32_16x16x32_bf16 v[184:187], v[48:51], v[32:35], 0
    v_cvt_pk_bf16_f32 v138, v140, v141
    v_cvt_pk_bf16_f32 v115, v118, v119
    v_mfma_f32_16x16x32_bf16 v[188:191], v[52:55], v[32:35], 0
    v_cvt_pk_bf16_f32 v139, v142, v143
    v_cvt_pk_bf16_f32 v116, v20, v21
    v_cvt_pk_bf16_f32 v140, v36, v37
    v_cvt_pk_bf16_f32 v117, v22, v23
    v_cvt_pk_bf16_f32 v141, v38, v39
    v_cvt_pk_bf16_f32 v118, v24, v25
    v_cvt_pk_bf16_f32 v142, v40, v41
    v_cvt_pk_bf16_f32 v119, v26, v27
    v_cvt_pk_bf16_f32 v143, v42, v43
    v_max3_f32 v28, v160, v161, v162
    v_max3_f32 v44, v184, v185, v186
    v_max3_f32 v29, -v160, -v161, -v162
    v_max3_f32 v45, -v184, -v185, -v186
    v_max3_f32 v28, v28, v163, v164
    v_max3_f32 v44, v44, v187, v188
    v_max3_f32 v29, v29, -v163, -v164
    v_max3_f32 v45, v45, -v187, -v188
    v_max3_f32 v28, v28, v165, v166
    v_max3_f32 v44, v44, v189, v190
    v_max3_f32 v29, v29, -v165, -v166
    v_max3_f32 v45, v45, -v189, -v190
    v_max_f32 v28, v28, v167
    v_max_f32 v44, v44, v191
    v_max_f32_e64 v29, v29, -v167
    v_max_f32_e64 v45, v45, -v191
    v_nop
    v_permlane32_swap_b32 v28, v29
    v_permlane32_swap_b32 v44, v45
    v_max_f32 v28, v28, v29
    v_max_f32 v44, v44, v45
    v_mov_b32 v29, v28
    v_mov_b32 v45, v44
    v_nop
    v_permlane16_swap_b32 v28, v29
    v_permlane16_swap_b32 v44, v45
    v_max_f32 v28, v28, v29
    v_max_f32 v44, v44, v45
    v_mul_f32 v28, s48, v28
    v_mul_f32 v44, s48, v44
    v_mov_b32 v29, v28
L_pg16:
    s_cbranch_execz L_tramp
    v_mov_b32 v45, v44
    v_nop
    v_permlane32_swap_b32 v28, v29
    v_permlane32_swap_b32 v44, v45
    v_pk_fma_f32 v[20:21], v[160:161], s[50:51], v[28:29] op_sel_hi:[1,0,0]
    v_pk_fma_f32 v[36:37], v[184:185], s[50:51], v[44:45] op_sel_hi:[1,0,0]
    v_pk_fma_f32 v[22:23], v[162:163], s[50:51], v[28:29] op_sel_hi:[1,0,0]
    v_pk_fma_f32 v[38:39], v[186:187], s[50:51], v[44:45] op_sel_hi:[1,0,0]
    v_pk_fma_f32 v[24:25], v[164:165], s[50:51], v[28:29] op_sel_hi:[1,0,0]
    v_pk_fma_f32 v[40:41], v[188:189], s[50:51], v[44:45] op_sel_hi:[1,0,0]
    v_pk_fma_f32 v[26:27], v[166:167], s[50:51], v[28:29] op_sel_hi:[1,0,0]
    v_pk_fma_f32 v[42:43], v[190:191], s[50:51], v[44:45] op_sel_hi:[1,0,0]
    v_pk_fma_f32 v[160:161], v[160:161], s[48:49], v[28:29] op_sel:[0,0,1] op_sel_hi:[1,0,1]
    v_pk_fma_f32 v[184:185], v[184:185], s[48:49], v[44:45] op_sel:[0,0,1] op_sel_hi:[1,0,1]
    v_pk_fma_f32 v[162:163], v[162:163], s[48:49], v[28:29] op_sel:[0,0,1] op_sel_hi:[1,0,1]
    v_pk_fma_f32 v[186:187], v[186:187], s[48:49], v[44:45] op_sel:[0,0,1] op_sel_hi:[1,0,1]
    v_pk_fma_f32 v[164:165], v[164:165], s[48:49], v[28:29] op_sel:[0,0,1] op_sel_hi:[1,0,1]
    v_pk_fma_f32 v[188:189], v[188:189], s[48:49], v[44:45] op_sel:[0,0,1] op_sel_hi:[1,0,1]
    v_pk_fma_f32 v[166:167], v[166:167], s[48:49], v[28:29] op_sel:[0,0,1] op_sel_hi:[1,0,1]
    v_pk_fma_f32 v[190:191], v[190:191], s[48:49], v[44:45] op_sel:[0,0,1] op_sel_hi:[1,0,1]
    v_exp_f32 v20, v20
    v_exp_f32 v36, v36
    s_waitcnt vmcnt(0)
    v_cmp_eq_u32 vcc, 1, v9
    s_nop 0
    s_bcnt1_i32_b32 s78, vcc_lo
    s_cmp_ge_u32 s78, 8
    s_cbranch_scc1 L_got17
    s_mov_b32 s79, 0
L_spinl17:
    buffer_load_dword v9, v14, s[12:15], s32 offen offset:0 sc1
    s_waitcnt vmcnt(0)
    v_cmp_eq_u32 vcc, 1, v9
    s_nop 0
    s_bcnt1_i32_b32 s78, vcc_lo
    s_add_u32 s79, s79, 1
    s_cmp_ge_u32 s78, 8
    s_cbranch_scc1 L_got17
    s_cmp_lt_u32 s79, 0x80000
    s_cbranch_scc1 L_spinl17
L_got17:
    buffer_load_dwordx4 v[56:59], v13, s[12:15], s77 offen sc1
    buffer_load_dwordx4 v[72:75], v12, s[12:15], s76 offen offset:0 sc1
    buffer_load_dwordx4 v[76:79], v12, s[12:15], s76 offen offset:2048 sc1
    s_add_u32 s76, s76, 4096
    buffer_load_dwordx4 v[96:99], v12, s[12:15], s76 offen offset:0 sc1
    buffer_load_dwordx4 v[100:103], v12, s[12:15], s76 offen offset:2048 sc1
    s_add_u32 s76, s76, 4096
    buffer_load_dwordx4 v[120:123], v12, s[12:15], s76 offen offset:0 sc1
    buffer_load_dwordx4 v[124:127], v12, s[12:15], s76 offen offset:2048 sc1
    s_add_u32 s76, s76, 4096
    v_exp_f32 v21, v21
    v_exp_f32 v37, v37
    v_exp_f32 v22, v22
    v_exp_f32 v38, v38
    v_exp_f32 v23, v23
    v_exp_f32 v39, v39
    v_exp_f32 v24, v24
    v_exp_f32 v40, v40
    v_exp_f32 v25, v25
    v_exp_f32 v41, v41
    v_exp_f32 v26, v26
    v_exp_f32 v42, v42
    v_exp_f32 v27, v27
    v_exp_f32 v43, v43
    v_exp_f32 v160, v160
    v_exp_f32 v184, v184
    v_exp_f32 v161, v161
    v_exp_f32 v185, v185
    v_exp_f32 v162, v162
    v_exp_f32 v186, v186
    v_exp_f32 v163, v163
    buffer_load_dword v62, v14, s[12:15], s52 offen offset:0 sc1
    v_exp_f32 v187, v187
    v_exp_f32 v164, v164
    v_exp_f32 v188, v188
    v_exp_f32 v165, v165
    v_exp_f32 v189, v189
    v_exp_f32 v166, v166
    v_exp_f32 v190, v190
    v_exp_f32 v167, v167
    v_exp_f32 v191, v191
    v_pk_add_f32 v[16:17], v[20:21], v[22:23]
    buffer_load_dwordx4 v[144:147], v12, s[12:15], s76 offen offset:0 sc1
    v_pk_add_f32 v[32:33], v[36:37], v[38:39]
    v_pk_add_f32 v[18:19], v[24:25], v[26:27]
    v_pk_add_f32 v[34:35], v[40:41], v[42:43]
    v_pk_add_f32 v[28:29], v[160:161], v[162:163]
    v_pk_add_f32 v[44:45], v[184:185], v[186:187]
    v_pk_add_f32 v[30:31], v[164:165], v[166:167]
    v_pk_add_f32 v[46:47], v[188:189], v[190:191]
    v_pk_add_f32 v[16:17], v[16:17], v[18:19]
    v_pk_add_f32 v[32:33], v[32:33], v[34:35]
    v_pk_add_f32 v[30:31], v[28:29], v[30:31]
    v_pk_add_f32 v[46:47], v[44:45], v[46:47]
    v_add_f32 v28, v16, v17
    buffer_load_dwordx4 v[148:151], v12, s[12:15], s76 offen offset:2048 sc1
    s_add_u32 s76, s76, 4096
    v_add_f32 v44, v32, v33
    v_add_f32 v29, v30, v31
    v_add_f32 v45, v46, v47
    v_cvt_pk_bf16_f32 v16, v208, v209
    v_permlane32_swap_b32 v28, v29
    v_permlane32_swap_b32 v44, v45
    v_cvt_pk_bf16_f32 v17, v210, v211
    v_add_f32 v28, v28, v29
    v_add_f32 v44, v44, v45
    v_cvt_pk_bf16_f32 v18, v212, v213
    v_mov_b32 v29, v28
    v_mov_b32 v45, v44
    buffer_load_dwordx4 v[168:171], v12, s[12:15], s76 offen offset:0 sc1
    v_cvt_pk_bf16_f32 v19, v214, v215
    v_permlane16_swap_b32 v28, v29
    v_permlane16_swap_b32 v44, v45
    v_cvt_pk_bf16_f32 v32, v232, v233
    v_add_f32 v28, v28, v29
    v_add_f32 v44, v44, v45
    v_and_b32 v63, 15, v1
    v_lshlrev_b32 v63, 8, v63
    v_add_u32 v13, 295936, v12
    s_andn2_b32 s44, s49, 31
    s_lshl_b32 s44, s44, 7
    s_add_u32 s44, s44, 0x2500000
    s_mov_b32 s46, 0x358637bd
    v_cvt_pk_bf16_f32 v33, v234, v235
    v_rcp_f32 v28, v28
    v_rcp_f32 v44, v44
    v_cvt_pk_bf16_f32 v34, v236, v237
    v_mov_b32 v29, v28
    v_mov_b32 v45, v44
    v_cvt_pk_bf16_f32 v35, v238, v239
    v_permlane32_swap_b32 v28, v29
    v_permlane32_swap_b32 v44, v45
    v_pk_mul_f32 v[160:161], v[160:161], v[28:29] op_sel:[0,1] op_sel_hi:[1,1]
    v_pk_mul_f32 v[184:185], v[184:185], v[44:45] op_sel:[0,1] op_sel_hi:[1,1]
    v_pk_mul_f32 v[162:163], v[162:163], v[28:29] op_sel:[0,1] op_sel_hi:[1,1]
    v_pk_mul_f32 v[186:187], v[186:187], v[44:45] op_sel:[0,1] op_sel_hi:[1,1]
    v_pk_mul_f32 v[164:165], v[164:165], v[28:29] op_sel:[0,1] op_sel_hi:[1,1]
    v_pk_mul_f32 v[188:189], v[188:189], v[44:45] op_sel:[0,1] op_sel_hi:[1,1]
    v_pk_mul_f32 v[166:167], v[166:167], v[28:29] op_sel:[0,1] op_sel_hi:[1,1]
    v_pk_mul_f32 v[190:191], v[190:191], v[44:45] op_sel:[0,1] op_sel_hi:[1,1]
    v_pk_mul_f32 v[20:21], v[20:21], v[28:29] op_sel_hi:[1,0]
    v_pk_mul_f32 v[36:37], v[36:37], v[44:45] op_sel_hi:[1,0]
    v_pk_mul_f32 v[22:23], v[22:23], v[28:29] op_sel_hi:[1,0]
    v_pk_mul_f32 v[38:39], v[38:39], v[44:45] op_sel_hi:[1,0]
    v_pk_mul_f32 v[24:25], v[24:25], v[28:29] op_sel_hi:[1,0]
    v_pk_mul_f32 v[40:41], v[40:41], v[44:45] op_sel_hi:[1,0]
    v_pk_mul_f32 v[26:27], v[26:27], v[28:29] op_sel_hi:[1,0]
    v_pk_mul_f32 v[42:43], v[42:43], v[44:45] op_sel_hi:[1,0]
    v_cvt_pk_bf16_f32 v160, v160, v161
    v_mfma_f32_16x16x32_bf16 v[208:211], v[48:51], v[16:19], 0
    v_cvt_pk_bf16_f32 v184, v184, v185
    v_cvt_pk_bf16_f32 v161, v162, v163
    v_mfma_f32_16x16x32_bf16 v[212:215], v[52:55], v[16:19], 0
    v_cvt_pk_bf16_f32 v185, v186, v187
    v_cvt_pk_bf16_f32 v162, v164, v165
    v_mfma_f32_16x16x32_bf16 v[232:235], v[48:51], v[32:35], 0
    v_cvt_pk_bf16_f32 v186, v188, v189
    v_cvt_pk_bf16_f32 v163, v166, v167
    v_mfma_f32_16x16x32_bf16 v[236:239], v[52:55], v[32:35], 0
    v_cvt_pk_bf16_f32 v187, v190, v191
    v_cvt_pk_bf16_f32 v164, v20, v21
    v_cvt_pk_bf16_f32 v188, v36, v37
    v_cvt_pk_bf16_f32 v165, v22, v23
    v_cvt_pk_bf16_f32 v189, v38, v39
    v_cvt_pk_bf16_f32 v166, v24, v25
    v_cvt_pk_bf16_f32 v190, v40, v41
    v_cvt_pk_bf16_f32 v167, v26, v27
    v_cvt_pk_bf16_f32 v191, v42, v43
    v_max3_f32 v28, v208, v209, v210
    buffer_load_dwordx4 v[172:175], v12, s[12:15], s76 offen offset:2048 sc1
    s_add_u32 s76, s76, 4096
    v_max3_f32 v44, v232, v233, v234
    v_max3_f32 v29, -v208, -v209, -v210
    v_max3_f32 v45, -v232, -v233, -v234
    v_max3_f32 v28, v28, v211, v212
    v_max3_f32 v44, v44, v235, v236
    v_max3_f32 v29, v29, -v211, -v212
    buffer_load_dwordx4 v[192:195], v12, s[12:15], s76 offen offset:0 sc1
    v_max3_f32 v45, v45, -v235, -v236
    v_max3_f32 v28, v28, v213, v214
    v_max3_f32 v44, v44, v237, v238
    v_max3_f32 v29, v29, -v213, -v214
    v_max3_f32 v45, v45, -v237, -v238
    v_max_f32 v28, v28, v215
    buffer_load_dwordx4 v[196:199], v12, s[12:15], s76 offen offset:2048 sc1
    s_add_u32 s76, s76, 4096
    v_max_f32 v44, v44, v239
    v_max_f32_e64 v29, v29, -v215
    v_max_f32_e64 v45, v45, -v239
    v_nop
    v_permlane32_swap_b32 v28, v29
    v_permlane32_swap_b32 v44, v45
    v_max_f32 v28, v28, v29
    buffer_load_dwordx4 v[216:219], v12, s[12:15], s76 offen offset:0 sc1
    v_max_f32 v44, v44, v45
    v_mov_b32 v29, v28
    v_mov_b32 v45, v44
    v_nop
    v_permlane16_swap_b32 v28, v29
    v_permlane16_swap_b32 v44, v45
    v_max_f32 v28, v28, v29
    buffer_load_dwordx4 v[220:223], v12, s[12:15], s76 offen offset:2048 sc1
    s_add_u32 s76, s76, 4096
    v_max_f32 v44, v44, v45
    v_mul_f32 v28, s48, v28
    v_mul_f32 v44, s48, v44
    v_mov_b32 v29, v28
    v_mov_b32 v45, v44
    v_nop
    v_permlane32_swap_b32 v28, v29
    buffer_load_dwordx4 v[240:243], v12, s[12:15], s76 offen offset:0 sc1
    v_permlane32_swap_b32 v44, v45
    v_pk_fma_f32 v[20:21], v[208:209], s[50:51], v[28:29] op_sel_hi:[1,0,0]
    v_pk_fma_f32 v[36:37], v[232:233], s[50:51], v[44:45] op_sel_hi:[1,0,0]
    v_pk_fma_f32 v[22:23], v[210:211], s[50:51], v[28:29] op_sel_hi:[1,0,0]
    v_pk_fma_f32 v[38:39], v[234:235], s[50:51], v[44:45] op_sel_hi:[1,0,0]
    v_pk_fma_f32 v[24:25], v[212:213], s[50:51], v[28:29] op_sel_hi:[1,0,0]
    buffer_load_dwordx4 v[244:247], v12, s[12:15], s76 offen offset:2048 sc1
    s_add_u32 s76, s76, 4096
    v_pk_fma_f32 v[40:41], v[236:237], s[50:51], v[44:45] op_sel_hi:[1,0,0]
    v_pk_fma_f32 v[26:27], v[214:215], s[50:51], v[28:29] op_sel_hi:[1,0,0]
    v_pk_fma_f32 v[42:43], v[238:239], s[50:51], v[44:45] op_sel_hi:[1,0,0]
    v_pk_fma_f32 v[208:209], v[208:209], s[48:49], v[28:29] op_sel:[0,0,1] op_sel_hi:[1,0,1]
    buffer_load_dword v9, v14, s[12:15], s38 offen offset:0 sc1
    v_pk_fma_f32 v[232:233], v[232:233], s[48:49], v[44:45] op_sel:[0,0,1] op_sel_hi:[1,0,1]
    v_pk_fma_f32 v[210:211], v[210:211], s[48:49], v[28:29] op_sel:[0,0,1] op_sel_hi:[1,0,1]
    v_pk_fma_f32 v[234:235], v[234:235], s[48:49], v[44:45] op_sel:[0,0,1] op_sel_hi:[1,0,1]
    v_pk_fma_f32 v[212:213], v[212:213], s[48:49], v[28:29] op_sel:[0,0,1] op_sel_hi:[1,0,1]
    v_pk_fma_f32 v[236:237], v[236:237], s[48:49], v[44:45] op_sel:[0,0,1] op_sel_hi:[1,0,1]
    v_pk_fma_f32 v[214:215], v[214:215], s[48:49], v[28:29] op_sel:[0,0,1] op_sel_hi:[1,0,1]
    v_pk_fma_f32 v[238:239], v[238:239], s[48:49], v[44:45] op_sel:[0,0,1] op_sel_hi:[1,0,1]
    v_exp_f32 v20, v20
    v_exp_f32 v36, v36
    v_exp_f32 v21, v21
    v_exp_f32 v37, v37
    v_exp_f32 v22, v22
    v_exp_f32 v38, v38
    v_exp_f32 v23, v23
    v_exp_f32 v39, v39
    v_exp_f32 v24, v24
    v_exp_f32 v40, v40
    v_exp_f32 v25, v25
    v_exp_f32 v41, v41
    v_exp_f32 v26, v26
    v_exp_f32 v42, v42
    v_exp_f32 v27, v27
    v_exp_f32 v43, v43
    s_waitcnt vmcnt(11)
    v_mfma_f32_16x16x32_bf16 v[80:83], a[196:199], v[72:75], 0
    v_cmp_eq_u32 vcc, 1, v62
    v_exp_f32 v208, v208
    v_mfma_f32_16x16x32_bf16 v[84:87], a[200:203], v[72:75], 0
    s_bcnt1_i32_b32 s78, vcc_lo
    v_exp_f32 v232, v232
    v_mfma_f32_16x16x32_bf16 v[104:107], a[196:199], v[76:79], 0
    s_cmp_lt_u32 s78, 32
    s_cbranch_scc1 L_spin18
L_got18:
    v_exp_f32 v209, v209
    v_mfma_f32_16x16x32_bf16 v[108:111], a[200:203], v[76:79], 0
    buffer_load_dwordx4 v[132:135], v63, s[12:15], s44 offen offset:0 sc1
    v_exp_f32 v233, v233
    v_mfma_f32_16x16x32_bf16 v[80:83], a[196:199], v[96:99], v[80:83]
    buffer_load_dwordx4 v[156:159], v63, s[12:15], s44 offen offset:128 sc1
    v_exp_f32 v210, v210
    v_mfma_f32_16x16x32_bf16 v[84:87], a[200:203], v[96:99], v[84:87]
    v_exp_f32 v234, v234
    v_mfma_f32_16x16x32_bf16 v[104:107], a[196:199], v[100:103], v[104:107]
    v_exp_f32 v211, v211
    v_mfma_f32_16x16x32_bf16 v[108:111], a[200:203], v[100:103], v[108:111]
    v_exp_f32 v235, v235
    v_mfma_f32_16x16x32_bf16 v[80:83], a[196:199], v[120:123], v[80:83]
    v_exp_f32 v212, v212
    v_mfma_f32_16x16x32_bf16 v[84:87], a[200:203], v[120:123], v[84:87]
    v_exp_f32 v236, v236
    v_mfma_f32_16x16x32_bf16 v[104:107], a[196:199], v[124:127], v[104:107]
    v_exp_f32 v213, v213
    v_mfma_f32_16x16x32_bf16 v[108:111], a[200:203], v[124:127], v[108:111]
    v_exp_f32 v237, v237
    v_exp_f32 v214, v214
    v_exp_f32 v238, v238
    v_exp_f32 v215, v215
    v_exp_f32 v239, v239
    v_pk_add_f32 v[16:17], v[20:21], v[22:23]
    v_pk_add_f32 v[32:33], v[36:37], v[38:39]
    v_pk_add_f32 v[18:19], v[24:25], v[26:27]
    v_pk_add_f32 v[34:35], v[40:41], v[42:43]
    v_pk_add_f32 v[28:29], v[208:209], v[210:211]
    v_pk_add_f32 v[44:45], v[232:233], v[234:235]
    v_pk_add_f32 v[30:31], v[212:213], v[214:215]
    v_pk_add_f32 v[46:47], v[236:237], v[238:239]
    v_pk_add_f32 v[16:17], v[16:17], v[18:19]
    v_pk_add_f32 v[32:33], v[32:33], v[34:35]
    v_pk_add_f32 v[30:31], v[28:29], v[30:31]
    v_pk_add_f32 v[46:47], v[44:45], v[46:47]
    v_add_f32 v28, v16, v17
    v_add_f32 v44, v32, v33
    v_add_f32 v29, v30, v31
    v_add_f32 v45, v46, v47
    v_add_f32_dpp v56, v56, v56 quad_perm:[1,0,3,2] row_mask:0xf bank_mask:0xf
    v_permlane32_swap_b32 v28, v29
    v_permlane32_swap_b32 v44, v45
    v_add_f32_dpp v57, v57, v57 quad_perm:[1,0,3,2] row_mask:0xf bank_mask:0xf
    v_add_f32 v28, v28, v29
    v_add_f32 v44, v44, v45
    v_add_f32_dpp v58, v58, v58 quad_perm:[1,0,3,2] row_mask:0xf bank_mask:0xf
    v_mov_b32 v29, v28
    v_mov_b32 v45, v44
    v_add_f32_dpp v59, v59, v59 quad_perm:[1,0,3,2] row_mask:0xf bank_mask:0xf
    v_permlane16_swap_b32 v28, v29
    v_permlane16_swap_b32 v44, v45
    v_add_f32_dpp v56, v56, v56 quad_perm:[2,3,0,1] row_mask:0xf bank_mask:0xf
    v_add_f32 v28, v28, v29
    v_add_f32 v44, v44, v45
    v_add_f32_dpp v57, v57, v57 quad_perm:[2,3,0,1] row_mask:0xf bank_mask:0xf
    v_rcp_f32 v28, v28
    v_rcp_f32 v44, v44
    v_add_f32_dpp v58, v58, v58 quad_perm:[2,3,0,1] row_mask:0xf bank_mask:0xf
    v_mov_b32 v29, v28
    v_mov_b32 v45, v44
    v_add_f32_dpp v59, v59, v59 quad_perm:[2,3,0,1] row_mask:0xf bank_mask:0xf
    v_permlane32_swap_b32 v28, v29
    v_permlane32_swap_b32 v44, v45
    v_pk_mul_f32 v[208:209], v[208:209], v[28:29] op_sel:[0,1] op_sel_hi:[1,1]
    v_pk_mul_f32 v[232:233], v[232:233], v[44:45] op_sel:[0,1] op_sel_hi:[1,1]
    v_pk_mul_f32 v[210:211], v[210:211], v[28:29] op_sel:[0,1] op_sel_hi:[1,1]
    v_pk_mul_f32 v[234:235], v[234:235], v[44:45] op_sel:[0,1] op_sel_hi:[1,1]
    v_pk_mul_f32 v[212:213], v[212:213], v[28:29] op_sel:[0,1] op_sel_hi:[1,1]
    v_pk_mul_f32 v[236:237], v[236:237], v[44:45] op_sel:[0,1] op_sel_hi:[1,1]
    v_pk_mul_f32 v[214:215], v[214:215], v[28:29] op_sel:[0,1] op_sel_hi:[1,1]
    v_pk_mul_f32 v[238:239], v[238:239], v[44:45] op_sel:[0,1] op_sel_hi:[1,1]
    v_pk_mul_f32 v[20:21], v[20:21], v[28:29] op_sel_hi:[1,0]
    v_pk_mul_f32 v[36:37], v[36:37], v[44:45] op_sel_hi:[1,0]
    v_pk_mul_f32 v[22:23], v[22:23], v[28:29] op_sel_hi:[1,0]
    v_pk_mul_f32 v[38:39], v[38:39], v[44:45] op_sel_hi:[1,0]
    s_waitcnt vmcnt(2)
    v_cmp_eq_u32 vcc, 1, v9
    v_pk_mul_f32 v[24:25], v[24:25], v[28:29] op_sel_hi:[1,0]
    s_bcnt1_i32_b32 s78, vcc_lo
    v_pk_mul_f32 v[40:41], v[40:41], v[44:45] op_sel_hi:[1,0]
    s_cmp_lt_u32 s78, 16
    s_cbranch_scc1 L_spin19
L_got19:
    v_pk_mul_f32 v[26:27], v[26:27], v[28:29] op_sel_hi:[1,0]
    v_pk_mul_f32 v[42:43], v[42:43], v[44:45] op_sel_hi:[1,0]
    v_mfma_f32_16x16x32_bf16 v[80:83], a[196:199], v[144:147], v[80:83]
    buffer_load_dwordx4 a[0:3], v12, s[12:15], s43 offen offset:0 sc1
    v_cvt_pk_bf16_f32 v208, v208, v209
    v_cvt_pk_bf16_f32 v232, v232, v233
    v_mfma_f32_16x16x32_bf16 v[84:87], a[200:203], v[144:147], v[84:87]
    buffer_load_dwordx4 a[4:7], v12, s[12:15], s43 offen offset:2048 sc1
    v_cvt_pk_bf16_f32 v209, v210, v211
    v_cvt_pk_bf16_f32 v233, v234, v235
    v_mfma_f32_16x16x32_bf16 v[104:107], a[196:199], v[148:151], v[104:107]
    buffer_load_dwordx4 a[8:11], v13, s[12:15], s43 offen offset:0 sc1
    v_cvt_pk_bf16_f32 v210, v212, v213
    v_cvt_pk_bf16_f32 v234, v236, v237
    v_mfma_f32_16x16x32_bf16 v[108:111], a[200:203], v[148:151], v[108:111]
    buffer_load_dwordx4 a[12:15], v13, s[12:15], s43 offen offset:2048 sc1
    s_add_u32 s43, s43, 4096
    v_cvt_pk_bf16_f32 v211, v214, v215
    v_cvt_pk_bf16_f32 v235, v238, v239
    v_mfma_f32_16x16x32_bf16 v[80:83], a[196:199], v[168:171], v[80:83]
    buffer_load_dwordx4 a[16:19], v12, s[12:15], s42 offen offset:0 sc1
    v_cvt_pk_bf16_f32 v212, v20, v21
    v_cvt_pk_bf16_f32 v236, v36, v37
    v_mfma_f32_16x16x32_bf16 v[84:87], a[200:203], v[168:171], v[84:87]
    buffer_load_dwordx4 a[20:23], v12, s[12:15], s42 offen offset:2048 sc1
    v_cvt_pk_bf16_f32 v213, v22, v23
    v_cvt_pk_bf16_f32 v237, v38, v39
    v_mfma_f32_16x16x32_bf16 v[104:107], a[196:199], v[172:175], v[104:107]
    buffer_load_dwordx4 a[24:27], v13, s[12:15], s42 offen offset:0 sc1
    v_cvt_pk_bf16_f32 v214, v24, v25
    v_cvt_pk_bf16_f32 v238, v40, v41
    v_mfma_f32_16x16x32_bf16 v[108:111], a[200:203], v[172:175], v[108:111]
    buffer_load_dwordx4 a[28:31], v13, s[12:15], s42 offen offset:2048 sc1
    s_add_u32 s42, s42, 4096
    v_cvt_pk_bf16_f32 v215, v26, v27
    v_cvt_pk_bf16_f32 v239, v42, v43
    v_mfma_f32_16x16x32_bf16 v[80:83], a[196:199], v[192:195], v[80:83]
    v_add_f32_dpp v56, v56, v56 row_half_mirror row_mask:0xf bank_mask:0xf
    v_add_f32_dpp v57, v57, v57 row_half_mirror row_mask:0xf bank_mask:0xf
    v_mfma_f32_16x16x32_bf16 v[84:87], a[200:203], v[192:195], v[84:87]
    v_add_f32_dpp v58, v58, v58 row_half_mirror row_mask:0xf bank_mask:0xf
    v_add_f32_dpp v59, v59, v59 row_half_mirror row_mask:0xf bank_mask:0xf
    v_mfma_f32_16x16x32_bf16 v[104:107], a[196:199], v[196:199], v[104:107]
    v_cvt_pk_bf16_f32 v60, v56, v57
    v_cvt_pk_bf16_f32 v61, v58, v59
    v_mfma_f32_16x16x32_bf16 v[108:111], a[200:203], v[196:199], v[108:111]
    v_mov_b32 v48, v60
    v_mov_b32 v49, v61
    v_mfma_f32_16x16x32_bf16 v[80:83], a[196:199], v[216:219], v[80:83]
    v_mov_b32 v50, v60
    v_mov_b32 v51, v61
    v_mfma_f32_16x16x32_bf16 v[84:87], a[200:203], v[216:219], v[84:87]
    v_mov_b32_dpp v48, v60 row_ror:8 row_mask:0xf bank_mask:0xc
    v_mov_b32_dpp v49, v61 row_ror:8 row_mask:0xf bank_mask:0xc
    v_mfma_f32_16x16x32_bf16 v[104:107], a[196:199], v[220:223], v[104:107]
    v_mov_b32_dpp v50, v60 row_ror:8 row_mask:0xf bank_mask:0x3
    v_mov_b32_dpp v51, v61 row_ror:8 row_mask:0xf bank_mask:0x3
    v_mfma_f32_16x16x32_bf16 v[108:111], a[200:203], v[220:223], v[108:111]
    v_mfma_f32_16x16x32_bf16 v[80:83], a[196:199], v[240:243], v[80:83]
    v_mfma_f32_16x16x32_bf16 v[84:87], a[200:203], v[240:243], v[84:87]
    ds_write_b128 v6, v[48:51] offset:2048
    v_mfma_f32_16x16x32_bf16 v[104:107], a[196:199], v[244:247], v[104:107]
    v_mfma_f32_16x16x32_bf16 v[108:111], a[200:203], v[244:247], v[108:111]
    v_mfma_f32_16x16x32_bf16 v[128:131], v[48:51], v[116:119], 0
    v_mfma_f32_16x16x32_bf16 v[152:155], v[48:51], v[140:143], 0
    v_mfma_f32_16x16x32_bf16 v[176:179], v[48:51], v[164:167], 0
    v_mfma_f32_16x16x32_bf16 v[200:203], v[48:51], v[188:191], 0
    v_mfma_f32_16x16x32_bf16 v[224:227], v[48:51], v[212:215], 0
    v_mfma_f32_16x16x32_bf16 v[248:251], v[48:51], v[236:239], 0
    v_cvt_pk_bf16_f32 v20, v80, v81
    v_cvt_pk_bf16_f32 v21, v82, v83
    v_cvt_pk_bf16_f32 v22, v84, v85
    v_cvt_pk_bf16_f32 v23, v86, v87
    v_cvt_pk_bf16_f32 v24, v104, v105
    v_cvt_pk_bf16_f32 v25, v106, v107
    v_cvt_pk_bf16_f32 v26, v108, v109
    v_cvt_pk_bf16_f32 v27, v110, v111
    ds_write_b128 v6, v[20:23] offset:0
    ds_write_b128 v6, v[24:27] offset:1024
    v_mfma_f32_16x16x32_bf16 v[80:83], v[48:51], v[68:71], 0
    v_mfma_f32_16x16x32_bf16 v[72:75], v[20:23], v[68:71], 0
    v_mfma_f32_16x16x32_bf16 v[76:79], v[24:27], v[68:71], 0
    v_mfma_f32_16x16x32_bf16 v[104:107], v[48:51], v[92:95], 0
    s_waitcnt lgkmcnt(0)
    s_barrier
    ds_read_b128 v[40:43], v7 offset:2048
    ds_read_b128 v[32:35], v7 offset:0
    ds_read_b128 v[36:39], v7 offset:1024
    v_mfma_f32_16x16x32_bf16 v[96:99], v[20:23], v[92:95], 0
    buffer_load_dwordx4 a[32:35], v12, s[12:15], s43 offen offset:0 sc1
    v_mfma_f32_16x16x32_bf16 v[100:103], v[24:27], v[92:95], 0
    v_mfma_f32_16x16x32_bf16 v[120:123], v[20:23], v[116:119], 0
    buffer_load_dwordx4 a[36:39], v12, s[12:15], s43 offen offset:2048 sc1
    v_mfma_f32_16x16x32_bf16 v[124:127], v[24:27], v[116:119], 0
    v_mfma_f32_16x16x32_bf16 v[144:147], v[20:23], v[140:143], 0
    buffer_load_dwordx4 a[40:43], v13, s[12:15], s43 offen offset:0 sc1
    v_mfma_f32_16x16x32_bf16 v[148:151], v[24:27], v[140:143], 0
    v_mfma_f32_16x16x32_bf16 v[168:171], v[20:23], v[164:167], 0
    buffer_load_dwordx4 a[44:47], v13, s[12:15], s43 offen offset:2048 sc1
    s_add_u32 s43, s43, 4096
    v_mfma_f32_16x16x32_bf16 v[172:175], v[24:27], v[164:167], 0
    s_waitcnt lgkmcnt(0)
    v_mfma_f32_16x16x32_bf16 v[80:83], v[40:43], v[64:67], v[80:83]
    buffer_load_dwordx4 a[48:51], v12, s[12:15], s42 offen offset:0 sc1
    v_mfma_f32_16x16x32_bf16 v[72:75], v[32:35], v[64:67], v[72:75]
    v_mfma_f32_16x16x32_bf16 v[76:79], v[36:39], v[64:67], v[76:79]
    buffer_load_dwordx4 a[52:55], v12, s[12:15], s42 offen offset:2048 sc1
    v_mfma_f32_16x16x32_bf16 v[104:107], v[40:43], v[88:91], v[104:107]
    v_mfma_f32_16x16x32_bf16 v[96:99], v[32:35], v[88:91], v[96:99]
    buffer_load_dwordx4 a[56:59], v13, s[12:15], s42 offen offset:0 sc1
    v_mfma_f32_16x16x32_bf16 v[100:103], v[36:39], v[88:91], v[100:103]
    v_mfma_f32_16x16x32_bf16 v[192:195], v[20:23], v[188:191], 0
    buffer_load_dwordx4 a[60:63], v13, s[12:15], s42 offen offset:2048 sc1
    s_add_u32 s42, s42, 4096
    s_waitcnt vmcnt(16)
    v_add_f32 v80, s46, v80
    v_rcp_f32 v80, v80
    v_mfma_f32_16x16x32_bf16 v[196:199], v[24:27], v[188:191], 0
    v_mul_f32 v80, v80, v132
    v_mul_f32 v72, v72, v80
    v_mfma_f32_16x16x32_bf16 v[128:131], v[40:43], v[112:115], v[128:131]
    v_mul_f32 v73, v73, v80
    v_mul_f32 v74, v74, v80
    v_mfma_f32_16x16x32_bf16 v[120:123], v[32:35], v[112:115], v[120:123]
    v_mul_f32 v75, v75, v80
    v_mul_f32 v76, v76, v80
    v_mfma_f32_16x16x32_bf16 v[124:127], v[36:39], v[112:115], v[124:127]
    v_mul_f32 v77, v77, v80
    v_mul_f32 v78, v78, v80
    v_mfma_f32_16x16x32_bf16 v[216:219], v[20:23], v[212:215], 0
    v_mul_f32 v79, v79, v80
    v_cvt_pk_bf16_f32 v72, v72, v73
    v_mfma_f32_16x16x32_bf16 v[220:223], v[24:27], v[212:215], 0
    v_cvt_pk_bf16_f32 v73, v74, v75
    v_cvt_pk_bf16_f32 v74, v76, v77
    v_mfma_f32_16x16x32_bf16 v[152:155], v[40:43], v[136:139], v[152:155]
    v_cvt_pk_bf16_f32 v75, v78, v79
    v_add_f32 v104, s46, v104
    v_mfma_f32_16x16x32_bf16 v[144:147], v[32:35], v[136:139], v[144:147]
    v_rcp_f32 v104, v104
    v_nop
    v_mul_f32 v104, v104, v133
    v_mfma_f32_16x16x32_bf16 v[148:151], v[36:39], v[136:139], v[148:151]
    v_mul_f32 v96, v96, v104
    v_mul_f32 v97, v97, v104
    v_mfma_f32_16x16x32_bf16 v[240:243], v[20:23], v[236:239], 0
    v_mul_f32 v98, v98, v104
    v_mul_f32 v99, v99, v104
    buffer_store_dwordx4 v[72:75], v12, s[12:15], s31 offen sc1
    s_add_u32 s31, s31, 295936
    v_mfma_f32_16x16x32_bf16 v[244:247], v[24:27], v[236:239], 0
    v_mul_f32 v100, v100, v104
    v_mul_f32 v101, v101, v104
    v_mfma_f32_16x16x32_bf16 v[176:179], v[40:43], v[160:163], v[176:179]
    v_mul_f32 v102, v102, v104
    v_mul_f32 v103, v103, v104
    v_mfma_f32_16x16x32_bf16 v[168:171], v[32:35], v[160:163], v[168:171]
    v_cvt_pk_bf16_f32 v96, v96, v97
    v_cvt_pk_bf16_f32 v97, v98, v99
    v_mfma_f32_16x16x32_bf16 v[172:175], v[36:39], v[160:163], v[172:175]
    v_cvt_pk_bf16_f32 v98, v100, v101
    v_cvt_pk_bf16_f32 v99, v102, v103
    v_mfma_f32_16x16x32_bf16 v[200:203], v[40:43], v[184:187], v[200:203]
    v_add_f32 v128, s46, v128
    v_rcp_f32 v128, v128
    v_mfma_f32_16x16x32_bf16 v[192:195], v[32:35], v[184:187], v[192:195]
    v_mul_f32 v128, v128, v134
    v_mul_f32 v120, v120, v128
    v_mfma_f32_16x16x32_bf16 v[196:199], v[36:39], v[184:187], v[196:199]
    v_mul_f32 v121, v121, v128
    v_mul_f32 v122, v122, v128
    v_mfma_f32_16x16x32_bf16 v[224:227], v[40:43], v[208:211], v[224:227]
    v_mul_f32 v123, v123, v128
    v_mul_f32 v124, v124, v128
    buffer_store_dwordx4 v[96:99], v12, s[12:15], s31 offen sc1
    s_add_u32 s31, s31, 295936
    v_mfma_f32_16x16x32_bf16 v[216:219], v[32:35], v[208:211], v[216:219]
    v_mul_f32 v125, v125, v128
    v_mul_f32 v126, v126, v128
    v_mfma_f32_16x16x32_bf16 v[220:223], v[36:39], v[208:211], v[220:223]
    v_mul_f32 v127, v127, v128
    v_cvt_pk_bf16_f32 v120, v120, v121
    v_mfma_f32_16x16x32_bf16 v[248:251], v[40:43], v[232:235], v[248:251]
    v_cvt_pk_bf16_f32 v121, v122, v123
    v_cvt_pk_bf16_f32 v122, v124, v125
    v_mfma_f32_16x16x32_bf16 v[240:243], v[32:35], v[232:235], v[240:243]
    v_cvt_pk_bf16_f32 v123, v126, v127
    v_mfma_f32_16x16x32_bf16 v[244:247], v[36:39], v[232:235], v[244:247]
    buffer_store_dwordx4 v[120:123], v12, s[12:15], s31 offen sc1
    s_add_u32 s31, s31, 295936
    v_add_f32 v152, s46, v152
    v_add_f32 v176, s46, v176
    v_add_f32 v200, s46, v200
    v_rcp_f32 v152, v152
    v_rcp_f32 v176, v176
    v_rcp_f32 v200, v200
    v_mul_f32 v152, v152, v135
    v_mul_f32 v176, v176, v156
    v_mul_f32 v200, v200, v157
    v_pk_mul_f32 v[144:145], v[144:145], v[152:153] op_sel_hi:[1,0]
    v_pk_mul_f32 v[168:169], v[168:169], v[176:177] op_sel_hi:[1,0]
    v_pk_mul_f32 v[192:193], v[192:193], v[200:201] op_sel_hi:[1,0]
    v_pk_mul_f32 v[146:147], v[146:147], v[152:153] op_sel_hi:[1,0]
    v_pk_mul_f32 v[170:171], v[170:171], v[176:177] op_sel_hi:[1,0]
    v_pk_mul_f32 v[194:195], v[194:195], v[200:201] op_sel_hi:[1,0]
    v_pk_mul_f32 v[148:149], v[148:149], v[152:153] op_sel_hi:[1,0]
    v_pk_mul_f32 v[172:173], v[172:173], v[176:177] op_sel_hi:[1,0]
    v_pk_mul_f32 v[196:197], v[196:197], v[200:201] op_sel_hi:[1,0]
    v_pk_mul_f32 v[150:151], v[150:151], v[152:153] op_sel_hi:[1,0]
    v_pk_mul_f32 v[174:175], v[174:175], v[176:177] op_sel_hi:[1,0]
    v_pk_mul_f32 v[198:199], v[198:199], v[200:201] op_sel_hi:[1,0]
    v_cvt_pk_bf16_f32 v144, v144, v145
    v_cvt_pk_bf16_f32 v168, v168, v169
    v_cvt_pk_bf16_f32 v192, v192, v193
    v_cvt_pk_bf16_f32 v145, v146, v147
    v_cvt_pk_bf16_f32 v169, v170, v171
    v_cvt_pk_bf16_f32 v193, v194, v195
    v_cvt_pk_bf16_f32 v146, v148, v149
    v_cvt_pk_bf16_f32 v170, v172, v173
    v_cvt_pk_bf16_f32 v194, v196, v197
    v_cvt_pk_bf16_f32 v147, v150, v151
    v_cvt_pk_bf16_f32 v171, v174, v175
    v_cvt_pk_bf16_f32 v195, v198, v199
    buffer_store_dwordx4 v[144:147], v12, s[12:15], s31 offen sc1
    s_add_u32 s31, s31, 295936
    buffer_store_dwordx4 v[168:171], v12, s[12:15], s31 offen sc1
    s_add_u32 s31, s31, 295936
    buffer_store_dwordx4 v[192:195], v12, s[12:15], s31 offen sc1
    s_add_u32 s31, s31, 295936
    v_add_f32 v224, s46, v224
    v_add_f32 v248, s46, v248
    v_rcp_f32 v224, v224
    v_rcp_f32 v248, v248
    v_mul_f32 v224, v224, v158
    v_mul_f32 v248, v248, v159
    v_pk_mul_f32 v[216:217], v[216:217], v[224:225] op_sel_hi:[1,0]
    v_pk_mul_f32 v[240:241], v[240:241], v[248:249] op_sel_hi:[1,0]
    v_pk_mul_f32 v[218:219], v[218:219], v[224:225] op_sel_hi:[1,0]
    v_pk_mul_f32 v[242:243], v[242:243], v[248:249] op_sel_hi:[1,0]
    v_pk_mul_f32 v[220:221], v[220:221], v[224:225] op_sel_hi:[1,0]
    v_pk_mul_f32 v[244:245], v[244:245], v[248:249] op_sel_hi:[1,0]
    v_pk_mul_f32 v[222:223], v[222:223], v[224:225] op_sel_hi:[1,0]
    v_pk_mul_f32 v[246:247], v[246:247], v[248:249] op_sel_hi:[1,0]
    v_cvt_pk_bf16_f32 v216, v216, v217
    v_cvt_pk_bf16_f32 v240, v240, v241
    v_cvt_pk_bf16_f32 v217, v218, v219
    v_cvt_pk_bf16_f32 v241, v242, v243
    v_cvt_pk_bf16_f32 v218, v220, v221
    v_cvt_pk_bf16_f32 v242, v244, v245
    v_cvt_pk_bf16_f32 v219, v222, v223
    v_cvt_pk_bf16_f32 v243, v246, v247
    buffer_store_dwordx4 v[216:219], v12, s[12:15], s31 offen sc1
    s_add_u32 s31, s31, 295936
    buffer_store_dwordx4 v[240:243], v12, s[12:15], s31 offen sc1
    s_add_u32 s31, s31, 295936
    s_waitcnt vmcnt(16)
L_phase2Q:
    v_xor_b32 v24, 0, v10
    v_xor_b32 v25, 32, v10
    v_xor_b32 v26, 64, v10
    v_xor_b32 v27, 96, v10
    v_xor_b32 v28, 128, v10
    v_xor_b32 v29, 160, v10
    v_xor_b32 v30, 192, v10
    v_xor_b32 v31, 224, v10
    s_barrier
    ds_read_b64_tr_b16 a[96:97], v24 offset:32768
    ds_read_b64_tr_b16 a[98:99], v24 offset:36864
    ds_read_b64_tr_b16 a[100:101], v24 offset:40960
    ds_read_b64_tr_b16 a[102:103], v24 offset:45056
    ds_read_b64_tr_b16 a[104:105], v25 offset:32768
    ds_read_b64_tr_b16 a[106:107], v25 offset:36864
    ds_read_b64_tr_b16 a[108:109], v25 offset:40960
    ds_read_b64_tr_b16 a[110:111], v25 offset:45056
    s_waitcnt lgkmcnt(4)
    v_mfma_f32_16x16x32_bf16 v[96:99], a[96:99], a[0:3], 0
    ds_read_b64_tr_b16 a[128:129], v26 offset:32768
    v_mfma_f32_16x16x32_bf16 v[96:99], a[100:103], a[4:7], v[96:99]
    buffer_load_dwordx4 a[64:67], v12, s[12:15], s43 offen offset:0 sc1
    v_mfma_f32_16x16x32_bf16 v[100:103], a[100:103], a[12:15], 0
    ds_read_b64_tr_b16 a[130:131], v26 offset:36864
    v_mfma_f32_16x16x32_bf16 v[100:103], a[96:99], a[8:11], v[100:103]
    v_add_u32 v32, 0x10000, v24
L_pg17:
    s_cbranch_execz L_tramp
    v_mfma_f32_16x16x32_bf16 v[64:67], a[96:99], a[16:19], 0
    ds_read_b64_tr_b16 a[132:133], v26 offset:40960
    v_mfma_f32_16x16x32_bf16 v[64:67], a[100:103], a[20:23], v[64:67]
    v_mfma_f32_16x16x32_bf16 v[68:71], a[100:103], a[28:31], 0
    ds_read_b64_tr_b16 a[134:135], v26 offset:45056
    v_mfma_f32_16x16x32_bf16 v[68:71], a[96:99], a[24:27], v[68:71]
    s_waitcnt lgkmcnt(4)
    v_mfma_f32_16x16x32_bf16 v[76:79], a[104:107], a[24:27], 0
    ds_read_b64_tr_b16 a[136:137], v27 offset:32768
    v_mfma_f32_16x16x32_bf16 v[76:79], a[108:111], a[28:31], v[76:79]
    buffer_load_dwordx4 a[68:71], v12, s[12:15], s43 offen offset:2048 sc1
    v_mfma_f32_16x16x32_bf16 v[72:75], a[108:111], a[20:23], 0
    ds_read_b64_tr_b16 a[138:139], v27 offset:36864
    v_mfma_f32_16x16x32_bf16 v[72:75], a[104:107], a[16:19], v[72:75]
    v_add_u32 v33, 0x10000, v25
    v_mfma_f32_16x16x32_bf16 v[108:111], a[104:107], a[8:11], 0
    ds_read_b64_tr_b16 a[140:141], v27 offset:40960
    v_mfma_f32_16x16x32_bf16 v[108:111], a[108:111], a[12:15], v[108:111]
    v_mfma_f32_16x16x32_bf16 v[104:107], a[108:111], a[4:7], 0
    ds_read_b64_tr_b16 a[142:143], v27 offset:45056
    v_mfma_f32_16x16x32_bf16 v[104:107], a[104:107], a[0:3], v[104:107]
    s_waitcnt lgkmcnt(4)
    v_mfma_f32_16x16x32_bf16 v[112:115], a[128:131], a[0:3], 0
    ds_read_b64_tr_b16 a[96:97], v28 offset:32768
    v_mfma_f32_16x16x32_bf16 v[112:115], a[132:135], a[4:7], v[112:115]
    buffer_load_dwordx4 a[72:75], v13, s[12:15], s43 offen offset:0 sc1
    v_mfma_f32_16x16x32_bf16 v[116:119], a[132:135], a[12:15], 0
    ds_read_b64_tr_b16 a[98:99], v28 offset:36864
    v_mfma_f32_16x16x32_bf16 v[116:119], a[128:131], a[8:11], v[116:119]
    v_add_u32 v34, 0x10000, v26
    v_mfma_f32_16x16x32_bf16 v[80:83], a[128:131], a[16:19], 0
    ds_read_b64_tr_b16 a[100:101], v28 offset:40960
    v_mfma_f32_16x16x32_bf16 v[80:83], a[132:135], a[20:23], v[80:83]
    v_mfma_f32_16x16x32_bf16 v[84:87], a[132:135], a[28:31], 0
    ds_read_b64_tr_b16 a[102:103], v28 offset:45056
    v_mfma_f32_16x16x32_bf16 v[84:87], a[128:131], a[24:27], v[84:87]
    s_waitcnt lgkmcnt(4)
    v_mfma_f32_16x16x32_bf16 v[92:95], a[136:139], a[24:27], 0
    ds_read_b64_tr_b16 a[104:105], v29 offset:32768
    v_mfma_f32_16x16x32_bf16 v[92:95], a[140:143], a[28:31], v[92:95]
    buffer_load_dwordx4 a[76:79], v13, s[12:15], s43 offen offset:2048 sc1
    s_add_u32 s43, s43, 4096
    v_mfma_f32_16x16x32_bf16 v[88:91], a[140:143], a[20:23], 0
    ds_read_b64_tr_b16 a[106:107], v29 offset:36864
    v_mfma_f32_16x16x32_bf16 v[88:91], a[136:139], a[16:19], v[88:91]
    v_add_u32 v35, 0x10000, v27
    v_mfma_f32_16x16x32_bf16 v[124:127], a[136:139], a[8:11], 0
    ds_read_b64_tr_b16 a[108:109], v29 offset:40960
    v_mfma_f32_16x16x32_bf16 v[124:127], a[140:143], a[12:15], v[124:127]
    v_mfma_f32_16x16x32_bf16 v[120:123], a[140:143], a[4:7], 0
    ds_read_b64_tr_b16 a[110:111], v29 offset:45056
    v_mfma_f32_16x16x32_bf16 v[120:123], a[136:139], a[0:3], v[120:123]
    s_waitcnt lgkmcnt(4)
    v_mfma_f32_16x16x32_bf16 v[160:163], a[96:99], a[0:3], 0
    ds_read_b64_tr_b16 a[128:129], v30 offset:32768
    v_mfma_f32_16x16x32_bf16 v[160:163], a[100:103], a[4:7], v[160:163]
    buffer_load_dwordx4 a[80:83], v12, s[12:15], s42 offen offset:0 sc1
    v_mfma_f32_16x16x32_bf16 v[164:167], a[100:103], a[12:15], 0
    ds_read_b64_tr_b16 a[130:131], v30 offset:36864
    v_mfma_f32_16x16x32_bf16 v[164:167], a[96:99], a[8:11], v[164:167]
    v_add_u32 v36, 0x10000, v28
    v_mfma_f32_16x16x32_bf16 v[128:131], a[96:99], a[16:19], 0
    ds_read_b64_tr_b16 a[132:133], v30 offset:40960
    v_mfma_f32_16x16x32_bf16 v[128:131], a[100:103], a[20:23], v[128:131]
    v_mfma_f32_16x16x32_bf16 v[132:135], a[100:103], a[28:31], 0
    ds_read_b64_tr_b16 a[134:135], v30 offset:45056
    v_mfma_f32_16x16x32_bf16 v[132:135], a[96:99], a[24:27], v[132:135]
    s_waitcnt lgkmcnt(4)
    v_mfma_f32_16x16x32_bf16 v[140:143], a[104:107], a[24:27], 0
    ds_read_b64_tr_b16 a[136:137], v31 offset:32768
    v_mfma_f32_16x16x32_bf16 v[140:143], a[108:111], a[28:31], v[140:143]
    buffer_load_dwordx4 a[84:87], v12, s[12:15], s42 offen offset:2048 sc1
    v_mfma_f32_16x16x32_bf16 v[136:139], a[108:111], a[20:23], 0
    ds_read_b64_tr_b16 a[138:139], v31 offset:36864
    v_mfma_f32_16x16x32_bf16 v[136:139], a[104:107], a[16:19], v[136:139]
    v_add_u32 v37, 0x10000, v29
    v_mfma_f32_16x16x32_bf16 v[172:175], a[104:107], a[8:11], 0
    ds_read_b64_tr_b16 a[140:141], v31 offset:40960
    v_mfma_f32_16x16x32_bf16 v[172:175], a[108:111], a[12:15], v[172:175]
    v_mfma_f32_16x16x32_bf16 v[168:171], a[108:111], a[4:7], 0
    ds_read_b64_tr_b16 a[142:143], v31 offset:45056
    v_mfma_f32_16x16x32_bf16 v[168:171], a[104:107], a[0:3], v[168:171]
    s_barrier
    s_waitcnt lgkmcnt(4)
    v_mfma_f32_16x16x32_bf16 v[176:179], a[128:131], a[0:3], 0
    ds_read_b64_tr_b16 a[96:97], v24 offset:49152
    v_mfma_f32_16x16x32_bf16 v[176:179], a[132:135], a[4:7], v[176:179]
    buffer_load_dwordx4 a[88:91], v13, s[12:15], s42 offen offset:0 sc1
    v_mfma_f32_16x16x32_bf16 v[180:183], a[132:135], a[12:15], 0
    ds_read_b64_tr_b16 a[98:99], v24 offset:53248
    v_mfma_f32_16x16x32_bf16 v[180:183], a[128:131], a[8:11], v[180:183]
    v_add_u32 v38, 0x10000, v30
    v_mfma_f32_16x16x32_bf16 v[144:147], a[128:131], a[16:19], 0
    ds_read_b64_tr_b16 a[100:101], v24 offset:57344
    v_mfma_f32_16x16x32_bf16 v[144:147], a[132:135], a[20:23], v[144:147]
    v_mfma_f32_16x16x32_bf16 v[148:151], a[132:135], a[28:31], 0
    ds_read_b64_tr_b16 a[102:103], v24 offset:61440
    v_mfma_f32_16x16x32_bf16 v[148:151], a[128:131], a[24:27], v[148:151]
    s_waitcnt lgkmcnt(4)
    v_mfma_f32_16x16x32_bf16 v[156:159], a[136:139], a[24:27], 0
    ds_read_b64_tr_b16 a[104:105], v25 offset:49152
    v_mfma_f32_16x16x32_bf16 v[156:159], a[140:143], a[28:31], v[156:159]
    buffer_load_dwordx4 a[92:95], v13, s[12:15], s42 offen offset:2048 sc1
    s_add_u32 s42, s42, 4096
    v_mfma_f32_16x16x32_bf16 v[152:155], a[140:143], a[20:23], 0
    ds_read_b64_tr_b16 a[106:107], v25 offset:53248
    v_mfma_f32_16x16x32_bf16 v[152:155], a[136:139], a[16:19], v[152:155]
    v_add_u32 v39, 0x10000, v31
    v_mfma_f32_16x16x32_bf16 v[188:191], a[136:139], a[8:11], 0
    ds_read_b64_tr_b16 a[108:109], v25 offset:57344
    v_mfma_f32_16x16x32_bf16 v[188:191], a[140:143], a[12:15], v[188:191]
    v_mfma_f32_16x16x32_bf16 v[184:187], a[140:143], a[4:7], 0
    ds_read_b64_tr_b16 a[110:111], v25 offset:61440
    v_mfma_f32_16x16x32_bf16 v[184:187], a[136:139], a[0:3], v[184:187]
    s_waitcnt vmcnt(16) lgkmcnt(4)
    v_mfma_f32_16x16x32_bf16 v[96:99], a[96:99], a[32:35], v[96:99]
    ds_read_b64_tr_b16 a[128:129], v26 offset:49152
    v_mfma_f32_16x16x32_bf16 v[96:99], a[100:103], a[36:39], v[96:99]
    buffer_load_dwordx4 a[160:163], v12, s[12:15], s43 offen offset:0 sc1
    v_mfma_f32_16x16x32_bf16 v[100:103], a[100:103], a[44:47], v[100:103]
    ds_read_b64_tr_b16 a[130:131], v26 offset:53248
    v_mfma_f32_16x16x32_bf16 v[100:103], a[96:99], a[40:43], v[100:103]
    v_mfma_f32_16x16x32_bf16 v[64:67], a[96:99], a[48:51], v[64:67]
    ds_read_b64_tr_b16 a[132:133], v26 offset:57344
    v_mfma_f32_16x16x32_bf16 v[64:67], a[100:103], a[52:55], v[64:67]
    buffer_load_dwordx4 a[164:167], v12, s[12:15], s43 offen offset:2048 sc1
    v_mfma_f32_16x16x32_bf16 v[68:71], a[100:103], a[60:63], v[68:71]
    ds_read_b64_tr_b16 a[134:135], v26 offset:61440
    v_mfma_f32_16x16x32_bf16 v[68:71], a[96:99], a[56:59], v[68:71]
    s_waitcnt lgkmcnt(4)
    v_mfma_f32_16x16x32_bf16 v[76:79], a[104:107], a[56:59], v[76:79]
    ds_read_b64_tr_b16 a[136:137], v27 offset:49152
    v_mfma_f32_16x16x32_bf16 v[76:79], a[108:111], a[60:63], v[76:79]
    v_mfma_f32_16x16x32_bf16 v[72:75], a[108:111], a[52:55], v[72:75]
    ds_read_b64_tr_b16 a[138:139], v27 offset:53248
    v_mfma_f32_16x16x32_bf16 v[72:75], a[104:107], a[48:51], v[72:75]
    buffer_load_dwordx4 a[168:171], v13, s[12:15], s43 offen offset:0 sc1
    v_mfma_f32_16x16x32_bf16 v[108:111], a[104:107], a[40:43], v[108:111]
    ds_read_b64_tr_b16 a[140:141], v27 offset:57344
    v_mfma_f32_16x16x32_bf16 v[108:111], a[108:111], a[44:47], v[108:111]
    v_mfma_f32_16x16x32_bf16 v[104:107], a[108:111], a[36:39], v[104:107]
    ds_read_b64_tr_b16 a[142:143], v27 offset:61440
    v_mfma_f32_16x16x32_bf16 v[104:107], a[104:107], a[32:35], v[104:107]
    v_lshlrev_b32 v7, 2, v1
    s_lshr_b32 s40, s59, 2
    s_lshl_b32 s40, s40, 7
    s_add_u32 s40, s40, 0x2524000
    s_lshl_b32 s99, s56, 8
    s_add_u32 s99, s99, 0x2525000
    s_lshl3_add_u32 s98, s58, s29
    s_add_u32 s98, s98, 2
    s_lshl_b32 s98, s98, 16
    s_lshl_b32 s44, s56, 3
    s_add_u32 s44, s44, s57
    s_lshl_b32 s44, s44, 2
    s_add_u32 s44, s44, s58
    s_lshl_b32 s44, s44, 2
    s_add_u32 s44, s44, s28
    s_lshl_b32 s34, s44, 12
    s_lshl_b32 s35, s44, 8
    s_mul_i32 s36, s58, 40960
    s_sub_u32 s36, 180224, s36
    s_lshr_b32 s44, s3, 5
    s_lshl_b32 s44, s44, 2
    s_add_u32 s44, s44, s28
    s_lshl_b32 s44, s44, 7
    s_add_u32 s44, s44, L_p2midQ-gated_mix__linear_kernel_hedgehog__dense_activation_mish__prompt_kernel
    s_min_u32 s44, s44, L_end-gated_mix__linear_kernel_hedgehog__dense_activation_mish__prompt_kernel-8
    v_mov_b32 v8, s44
    v_add_u32 v40, 0x20000, v24
    v_add_u32 v41, 0x20000, v25
    v_add_u32 v42, 0x20000, v26
    v_add_u32 v43, 0x20000, v27
    v_add_u32 v44, 0x20000, v28
    v_add_u32 v45, 0x20000, v29
    v_add_u32 v46, 0x20000, v30
    v_add_u32 v47, 0x20000, v31
    v_and_b32 v20, 15, v1
    v_lshlrev_b32 v20, 8, v20
    s_lshr_b32 s33, s59, 2
    s_lshl_b32 s33, s33, 12
    s_lshl_b32 s44, s29, 7
    s_add_u32 s33, s33, s44
    s_lshl_b32 s44, s30, 3
    s_add_u32 s33, s33, s44
    s_add_u32 s33, s33, 0x2500000
    s_xor_b32 s49, s33, 0x1000
    s_waitcnt lgkmcnt(4)
    v_mfma_f32_16x16x32_bf16 v[112:115], a[128:131], a[32:35], v[112:115]
    ds_read_b64_tr_b16 a[96:97], v28 offset:49152
    v_mfma_f32_16x16x32_bf16 v[112:115], a[132:135], a[36:39], v[112:115]
    buffer_load_dwordx4 a[172:175], v13, s[12:15], s43 offen offset:2048 sc1
    s_add_u32 s43, s43, 4096
    v_mfma_f32_16x16x32_bf16 v[116:119], a[132:135], a[44:47], v[116:119]
    ds_read_b64_tr_b16 a[98:99], v28 offset:53248
    s_waitcnt vmcnt(12)
    s_add_u32 s78, s51, s41
    s_mov_b64 exec, 1
    buffer_store_dword v15, v11, s[12:15], s78 offen sc1
    s_mov_b64 exec, -1
    v_mfma_f32_16x16x32_bf16 v[116:119], a[128:131], a[40:43], v[116:119]
    v_mfma_f32_16x16x32_bf16 v[80:83], a[128:131], a[48:51], v[80:83]
    ds_read_b64_tr_b16 a[100:101], v28 offset:57344
    v_mfma_f32_16x16x32_bf16 v[80:83], a[132:135], a[52:55], v[80:83]
    v_mfma_f32_16x16x32_bf16 v[84:87], a[132:135], a[60:63], v[84:87]
    ds_read_b64_tr_b16 a[102:103], v28 offset:61440
    v_mfma_f32_16x16x32_bf16 v[84:87], a[128:131], a[56:59], v[84:87]
    s_waitcnt lgkmcnt(4)
    v_mfma_f32_16x16x32_bf16 v[92:95], a[136:139], a[56:59], v[92:95]
    ds_read_b64_tr_b16 a[104:105], v29 offset:49152
    v_mfma_f32_16x16x32_bf16 v[92:95], a[140:143], a[60:63], v[92:95]
    buffer_load_dwordx4 a[176:179], v12, s[12:15], s42 offen offset:0 sc1
    v_mfma_f32_16x16x32_bf16 v[88:91], a[140:143], a[52:55], v[88:91]
    ds_read_b64_tr_b16 a[106:107], v29 offset:53248
    v_mfma_f32_16x16x32_bf16 v[88:91], a[136:139], a[48:51], v[88:91]
    v_mfma_f32_16x16x32_bf16 v[124:127], a[136:139], a[40:43], v[124:127]
    ds_read_b64_tr_b16 a[108:109], v29 offset:57344
    v_mfma_f32_16x16x32_bf16 v[124:127], a[140:143], a[44:47], v[124:127]
    v_mfma_f32_16x16x32_bf16 v[120:123], a[140:143], a[36:39], v[120:123]
    ds_read_b64_tr_b16 a[110:111], v29 offset:61440
    v_mfma_f32_16x16x32_bf16 v[120:123], a[136:139], a[32:35], v[120:123]
    s_waitcnt lgkmcnt(4)
    v_mfma_f32_16x16x32_bf16 v[160:163], a[96:99], a[32:35], v[160:163]
    ds_read_b64_tr_b16 a[128:129], v30 offset:49152
    v_mfma_f32_16x16x32_bf16 v[160:163], a[100:103], a[36:39], v[160:163]
    buffer_load_dwordx4 a[180:183], v12, s[12:15], s42 offen offset:2048 sc1
    v_mfma_f32_16x16x32_bf16 v[164:167], a[100:103], a[44:47], v[164:167]
    ds_read_b64_tr_b16 a[130:131], v30 offset:53248
    v_mfma_f32_16x16x32_bf16 v[164:167], a[96:99], a[40:43], v[164:167]
    v_mfma_f32_16x16x32_bf16 v[128:131], a[96:99], a[48:51], v[128:131]
    ds_read_b64_tr_b16 a[132:133], v30 offset:57344
    v_mfma_f32_16x16x32_bf16 v[128:131], a[100:103], a[52:55], v[128:131]
    buffer_load_dwordx4 a[184:187], v13, s[12:15], s42 offen offset:0 sc1
    v_mfma_f32_16x16x32_bf16 v[132:135], a[100:103], a[60:63], v[132:135]
    ds_read_b64_tr_b16 a[134:135], v30 offset:61440
    v_mfma_f32_16x16x32_bf16 v[132:135], a[96:99], a[56:59], v[132:135]
    s_waitcnt lgkmcnt(4)
    v_mfma_f32_16x16x32_bf16 v[140:143], a[104:107], a[56:59], v[140:143]
    ds_read_b64_tr_b16 a[136:137], v31 offset:49152
    v_mfma_f32_16x16x32_bf16 v[140:143], a[108:111], a[60:63], v[140:143]
    v_mfma_f32_16x16x32_bf16 v[136:139], a[108:111], a[52:55], v[136:139]
    ds_read_b64_tr_b16 a[138:139], v31 offset:53248
    v_mfma_f32_16x16x32_bf16 v[136:139], a[104:107], a[48:51], v[136:139]
    buffer_load_dwordx4 a[188:191], v13, s[12:15], s42 offen offset:2048 sc1
    s_add_u32 s42, s42, 4096
    v_mfma_f32_16x16x32_bf16 v[172:175], a[104:107], a[40:43], v[172:175]
    ds_read_b64_tr_b16 a[140:141], v31 offset:57344
    v_mfma_f32_16x16x32_bf16 v[172:175], a[108:111], a[44:47], v[172:175]
    v_mfma_f32_16x16x32_bf16 v[168:171], a[108:111], a[36:39], v[168:171]
    ds_read_b64_tr_b16 a[142:143], v31 offset:61440
    v_mfma_f32_16x16x32_bf16 v[168:171], a[104:107], a[32:35], v[168:171]
    s_barrier
    s_waitcnt lgkmcnt(4)
    v_mfma_f32_16x16x32_bf16 v[176:179], a[128:131], a[32:35], v[176:179]
    ds_read_b64_tr_b16 a[96:97], v32 offset:0
    v_mfma_f32_16x16x32_bf16 v[176:179], a[132:135], a[36:39], v[176:179]
    buffer_load_dwordx4 a[192:195], v12, s[12:15], s43 offen offset:0 sc1
    v_mfma_f32_16x16x32_bf16 v[180:183], a[132:135], a[44:47], v[180:183]
    ds_read_b64_tr_b16 a[98:99], v32 offset:4096
    v_mfma_f32_16x16x32_bf16 v[180:183], a[128:131], a[40:43], v[180:183]
    v_mfma_f32_16x16x32_bf16 v[144:147], a[128:131], a[48:51], v[144:147]
    ds_read_b64_tr_b16 a[100:101], v32 offset:8192
    v_mfma_f32_16x16x32_bf16 v[144:147], a[132:135], a[52:55], v[144:147]
    v_mfma_f32_16x16x32_bf16 v[148:151], a[132:135], a[60:63], v[148:151]
    ds_read_b64_tr_b16 a[102:103], v32 offset:12288
    v_mfma_f32_16x16x32_bf16 v[148:151], a[128:131], a[56:59], v[148:151]
    s_waitcnt lgkmcnt(4)
    v_mfma_f32_16x16x32_bf16 v[156:159], a[136:139], a[56:59], v[156:159]
    ds_read_b64_tr_b16 a[104:105], v33 offset:0
    v_mfma_f32_16x16x32_bf16 v[156:159], a[140:143], a[60:63], v[156:159]
    buffer_load_dwordx4 a[196:199], v12, s[12:15], s43 offen offset:2048 sc1
    v_mfma_f32_16x16x32_bf16 v[152:155], a[140:143], a[52:55], v[152:155]
    ds_read_b64_tr_b16 a[106:107], v33 offset:4096
    v_mfma_f32_16x16x32_bf16 v[152:155], a[136:139], a[48:51], v[152:155]
    v_mfma_f32_16x16x32_bf16 v[188:191], a[136:139], a[40:43], v[188:191]
    ds_read_b64_tr_b16 a[108:109], v33 offset:8192
    v_mfma_f32_16x16x32_bf16 v[188:191], a[140:143], a[44:47], v[188:191]
    v_mfma_f32_16x16x32_bf16 v[184:187], a[140:143], a[36:39], v[184:187]
    ds_read_b64_tr_b16 a[110:111], v33 offset:12288
    v_mfma_f32_16x16x32_bf16 v[184:187], a[136:139], a[32:35], v[184:187]
    s_waitcnt vmcnt(11) lgkmcnt(4)
    v_mfma_f32_16x16x32_bf16 v[96:99], a[96:99], a[64:67], v[96:99]
    ds_read_b64_tr_b16 a[128:129], v34 offset:0
    v_mfma_f32_16x16x32_bf16 v[96:99], a[100:103], a[68:71], v[96:99]
    buffer_load_dwordx4 a[200:203], v13, s[12:15], s43 offen offset:0 sc1
    v_mfma_f32_16x16x32_bf16 v[100:103], a[100:103], a[76:79], v[100:103]
    ds_read_b64_tr_b16 a[130:131], v34 offset:4096
    v_mfma_f32_16x16x32_bf16 v[100:103], a[96:99], a[72:75], v[100:103]
    v_mfma_f32_16x16x32_bf16 v[64:67], a[96:99], a[80:83], v[64:67]
    ds_read_b64_tr_b16 a[132:133], v34 offset:8192
    v_mfma_f32_16x16x32_bf16 v[64:67], a[100:103], a[84:87], v[64:67]
    buffer_load_dwordx4 a[204:207], v13, s[12:15], s43 offen offset:2048 sc1
    s_add_u32 s43, s43, 4096
    v_mfma_f32_16x16x32_bf16 v[68:71], a[100:103], a[92:95], v[68:71]
    ds_read_b64_tr_b16 a[134:135], v34 offset:12288
    v_mfma_f32_16x16x32_bf16 v[68:71], a[96:99], a[88:91], v[68:71]
    s_waitcnt lgkmcnt(4)
    v_mfma_f32_16x16x32_bf16 v[76:79], a[104:107], a[88:91], v[76:79]
    ds_read_b64_tr_b16 a[136:137], v35 offset:0
    v_mfma_f32_16x16x32_bf16 v[76:79], a[108:111], a[92:95], v[76:79]
    v_mfma_f32_16x16x32_bf16 v[72:75], a[108:111], a[84:87], v[72:75]
    ds_read_b64_tr_b16 a[138:139], v35 offset:4096
    v_mfma_f32_16x16x32_bf16 v[72:75], a[104:107], a[80:83], v[72:75]
    buffer_load_dwordx4 a[208:211], v12, s[12:15], s42 offen offset:0 sc1
    v_mfma_f32_16x16x32_bf16 v[108:111], a[104:107], a[72:75], v[108:111]
    ds_read_b64_tr_b16 a[140:141], v35 offset:8192
    v_mfma_f32_16x16x32_bf16 v[108:111], a[108:111], a[76:79], v[108:111]
    v_mfma_f32_16x16x32_bf16 v[104:107], a[108:111], a[68:71], v[104:107]
    ds_read_b64_tr_b16 a[142:143], v35 offset:12288
    v_mfma_f32_16x16x32_bf16 v[104:107], a[104:107], a[64:67], v[104:107]
    v_lshlrev_b32 v6, 4, v1
    v_mov_b32 v22, 0x3f80
    v_mov_b32 v23, 0x3f800000
    s_lshl_b32 s45, s59, 16
    s_lshl_b32 s31, s57, 8
    s_add_u32 s31, s31, s45
    s_lshl_b32 s45, s37, 7
    s_add_u32 s31, s31, s45
    s_add_u32 s32, s31, 0x8000
    v_lshrrev_b32 v21, 3, v1
    v_xor_b32 v19, v21, v1
    v_and_b32 v19, 7, v19
    v_lshlrev_b32 v19, 4, v19
    v_lshl_add_u32 v19, v21, 11, v19
    v_add_u32 v16, 0x4000, v19
    v_add_u32 v60, s63, v6
    v_lshrrev_b32 v21, 5, v1
    v_xor_b32 v21, v21, v1
    v_and_b32 v21, 7, v21
    v_lshlrev_b32 v56, 4, v21
    v_and_b32 v21, 15, v1
    v_lshl_add_u32 v56, v21, 7, v56
    v_bfe_u32 v21, v1, 4, 1
    v_lshl_add_u32 v56, v21, 3, v56
    v_add_u32 v56, s63, v56
    v_xor_b32 v57, 32, v56
    v_xor_b32 v58, 64, v56
    v_xor_b32 v59, 96, v56
    s_xor_b32 s52, s34, 0xc000
    s_add_u32 s52, s52, 0x2800000
    s_add_u32 s76, s34, 0x2800000
    s_xor_b32 s53, s34, 0x8000
    s_add_u32 s53, s53, 0x2c00000
    s_add_u32 s77, s34, 0x2c00000
    s_xor_b32 s54, s34, 0x4000
    s_add_u32 s54, s54, 0x3000000
    s_add_u32 s55, s34, 0x3000000
    v_sub_u32 v10, 3, v1
    v_and_b32 v10, 3, v10
    v_lshlrev_b32 v10, 10, v10
    v_xor_b32 v10, s35, v10
    v_add_u32 v10, 0x25c0000, v10
    v_add_u32 v10, v10, v14
    s_add_u32 s38, s35, 0x25c0000
    s_waitcnt lgkmcnt(4)
    v_mfma_f32_16x16x32_bf16 v[112:115], a[128:131], a[64:67], v[112:115]
    ds_read_b64_tr_b16 a[96:97], v36 offset:0
    v_mfma_f32_16x16x32_bf16 v[112:115], a[132:135], a[68:71], v[112:115]
    buffer_load_dwordx4 a[212:215], v12, s[12:15], s42 offen offset:2048 sc1
    v_mfma_f32_16x16x32_bf16 v[116:119], a[132:135], a[76:79], v[116:119]
    ds_read_b64_tr_b16 a[98:99], v36 offset:4096
    v_mfma_f32_16x16x32_bf16 v[116:119], a[128:131], a[72:75], v[116:119]
    v_mfma_f32_16x16x32_bf16 v[80:83], a[128:131], a[80:83], v[80:83]
    ds_read_b64_tr_b16 a[100:101], v36 offset:8192
    v_mfma_f32_16x16x32_bf16 v[80:83], a[132:135], a[84:87], v[80:83]
    buffer_load_dwordx4 a[216:219], v13, s[12:15], s42 offen offset:0 sc1
    v_mfma_f32_16x16x32_bf16 v[84:87], a[132:135], a[92:95], v[84:87]
    ds_read_b64_tr_b16 a[102:103], v36 offset:12288
    v_mfma_f32_16x16x32_bf16 v[84:87], a[128:131], a[88:91], v[84:87]
    s_waitcnt lgkmcnt(4)
    v_mfma_f32_16x16x32_bf16 v[92:95], a[136:139], a[88:91], v[92:95]
    ds_read_b64_tr_b16 a[104:105], v37 offset:0
    v_mfma_f32_16x16x32_bf16 v[92:95], a[140:143], a[92:95], v[92:95]
    v_mfma_f32_16x16x32_bf16 v[88:91], a[140:143], a[84:87], v[88:91]
    ds_read_b64_tr_b16 a[106:107], v37 offset:4096
    v_mfma_f32_16x16x32_bf16 v[88:91], a[136:139], a[80:83], v[88:91]
    buffer_load_dwordx4 a[220:223], v13, s[12:15], s42 offen offset:2048 sc1
    s_add_u32 s42, s42, 4096
    v_mfma_f32_16x16x32_bf16 v[124:127], a[136:139], a[72:75], v[124:127]
    ds_read_b64_tr_b16 a[108:109], v37 offset:8192
    v_mfma_f32_16x16x32_bf16 v[124:127], a[140:143], a[76:79], v[124:127]
    v_mfma_f32_16x16x32_bf16 v[120:123], a[140:143], a[68:71], v[120:123]
    ds_read_b64_tr_b16 a[110:111], v37 offset:12288
    v_mfma_f32_16x16x32_bf16 v[120:123], a[136:139], a[64:67], v[120:123]
    s_waitcnt lgkmcnt(4)
    v_mfma_f32_16x16x32_bf16 v[160:163], a[96:99], a[64:67], v[160:163]
    buffer_load_dword v18, v14, s[12:15], s39 offen offset:0 sc1
    ds_read_b64_tr_b16 a[128:129], v38 offset:0
    v_mfma_f32_16x16x32_bf16 v[160:163], a[100:103], a[68:71], v[160:163]
    buffer_load_dwordx4 a[224:227], v12, s[12:15], s43 offen offset:0 sc1
    v_mfma_f32_16x16x32_bf16 v[164:167], a[100:103], a[76:79], v[164:167]
    ds_read_b64_tr_b16 a[130:131], v38 offset:4096
    v_mfma_f32_16x16x32_bf16 v[164:167], a[96:99], a[72:75], v[164:167]
    v_mfma_f32_16x16x32_bf16 v[128:131], a[96:99], a[80:83], v[128:131]
    ds_read_b64_tr_b16 a[132:133], v38 offset:8192
    v_mfma_f32_16x16x32_bf16 v[128:131], a[100:103], a[84:87], v[128:131]
    v_mfma_f32_16x16x32_bf16 v[132:135], a[100:103], a[92:95], v[132:135]
    ds_read_b64_tr_b16 a[134:135], v38 offset:12288
    v_mfma_f32_16x16x32_bf16 v[132:135], a[96:99], a[88:91], v[132:135]
    s_waitcnt lgkmcnt(4)
    v_mfma_f32_16x16x32_bf16 v[140:143], a[104:107], a[88:91], v[140:143]
    ds_read_b64_tr_b16 a[136:137], v39 offset:0
    v_mfma_f32_16x16x32_bf16 v[140:143], a[108:111], a[92:95], v[140:143]
    buffer_load_dwordx4 a[228:231], v12, s[12:15], s43 offen offset:2048 sc1
    v_mfma_f32_16x16x32_bf16 v[136:139], a[108:111], a[84:87], v[136:139]
    ds_read_b64_tr_b16 a[138:139], v39 offset:4096
    v_mfma_f32_16x16x32_bf16 v[136:139], a[104:107], a[80:83], v[136:139]
    v_mfma_f32_16x16x32_bf16 v[172:175], a[104:107], a[72:75], v[172:175]
    ds_read_b64_tr_b16 a[140:141], v39 offset:8192
    v_mfma_f32_16x16x32_bf16 v[172:175], a[108:111], a[76:79], v[172:175]
    v_mfma_f32_16x16x32_bf16 v[168:171], a[108:111], a[68:71], v[168:171]
    ds_read_b64_tr_b16 a[142:143], v39 offset:12288
    v_mfma_f32_16x16x32_bf16 v[168:171], a[104:107], a[64:67], v[168:171]
    s_barrier
    s_waitcnt lgkmcnt(4)
    v_mfma_f32_16x16x32_bf16 v[176:179], a[128:131], a[64:67], v[176:179]
    ds_read_b64_tr_b16 a[96:97], v32 offset:16384
    v_mfma_f32_16x16x32_bf16 v[176:179], a[132:135], a[68:71], v[176:179]
    buffer_load_dwordx4 a[232:235], v13, s[12:15], s43 offen offset:0 sc1
    v_mfma_f32_16x16x32_bf16 v[180:183], a[132:135], a[76:79], v[180:183]
    ds_read_b64_tr_b16 a[98:99], v32 offset:20480
    v_mfma_f32_16x16x32_bf16 v[180:183], a[128:131], a[72:75], v[180:183]
    v_mfma_f32_16x16x32_bf16 v[144:147], a[128:131], a[80:83], v[144:147]
    ds_read_b64_tr_b16 a[100:101], v32 offset:24576
    v_mfma_f32_16x16x32_bf16 v[144:147], a[132:135], a[84:87], v[144:147]
    buffer_load_dwordx4 a[236:239], v13, s[12:15], s43 offen offset:2048 sc1
    s_add_u32 s43, s43, 4096
    v_mfma_f32_16x16x32_bf16 v[148:151], a[132:135], a[92:95], v[148:151]
    ds_read_b64_tr_b16 a[102:103], v32 offset:28672
    v_mfma_f32_16x16x32_bf16 v[148:151], a[128:131], a[88:91], v[148:151]
    s_waitcnt lgkmcnt(4)
    v_mfma_f32_16x16x32_bf16 v[156:159], a[136:139], a[88:91], v[156:159]
    ds_read_b64_tr_b16 a[104:105], v33 offset:16384
    v_mfma_f32_16x16x32_bf16 v[156:159], a[140:143], a[92:95], v[156:159]
    v_mfma_f32_16x16x32_bf16 v[152:155], a[140:143], a[84:87], v[152:155]
    ds_read_b64_tr_b16 a[106:107], v33 offset:20480
    v_mfma_f32_16x16x32_bf16 v[152:155], a[136:139], a[80:83], v[152:155]
    buffer_load_dwordx4 a[240:243], v12, s[12:15], s42 offen offset:0 sc1
    v_mfma_f32_16x16x32_bf16 v[188:191], a[136:139], a[72:75], v[188:191]
    ds_read_b64_tr_b16 a[108:109], v33 offset:24576
    v_mfma_f32_16x16x32_bf16 v[188:191], a[140:143], a[76:79], v[188:191]
    v_mfma_f32_16x16x32_bf16 v[184:187], a[140:143], a[68:71], v[184:187]
    ds_read_b64_tr_b16 a[110:111], v33 offset:28672
    v_mfma_f32_16x16x32_bf16 v[184:187], a[136:139], a[64:67], v[184:187]
    s_waitcnt vmcnt(14) lgkmcnt(4)
    v_mfma_f32_16x16x32_bf16 v[96:99], a[96:99], a[160:163], v[96:99]
    ds_read_b64_tr_b16 a[128:129], v34 offset:16384
    v_mfma_f32_16x16x32_bf16 v[96:99], a[100:103], a[164:167], v[96:99]
    buffer_load_dwordx4 a[244:247], v12, s[12:15], s42 offen offset:2048 sc1
    v_mfma_f32_16x16x32_bf16 v[100:103], a[100:103], a[172:175], v[100:103]
    ds_read_b64_tr_b16 a[130:131], v34 offset:20480
    v_mfma_f32_16x16x32_bf16 v[100:103], a[96:99], a[168:171], v[100:103]
    v_mfma_f32_16x16x32_bf16 v[64:67], a[96:99], a[176:179], v[64:67]
    ds_read_b64_tr_b16 a[132:133], v34 offset:24576
    v_mfma_f32_16x16x32_bf16 v[64:67], a[100:103], a[180:183], v[64:67]
    v_mfma_f32_16x16x32_bf16 v[68:71], a[100:103], a[188:191], v[68:71]
    ds_read_b64_tr_b16 a[134:135], v34 offset:28672
    v_mfma_f32_16x16x32_bf16 v[68:71], a[96:99], a[184:187], v[68:71]
    s_waitcnt lgkmcnt(4)
    v_mfma_f32_16x16x32_bf16 v[76:79], a[104:107], a[184:187], v[76:79]
    ds_read_b64_tr_b16 a[136:137], v35 offset:16384
    v_mfma_f32_16x16x32_bf16 v[76:79], a[108:111], a[188:191], v[76:79]
    buffer_load_dwordx4 a[248:251], v13, s[12:15], s42 offen offset:0 sc1
    v_mfma_f32_16x16x32_bf16 v[72:75], a[108:111], a[180:183], v[72:75]
    ds_read_b64_tr_b16 a[138:139], v35 offset:20480
    v_mfma_f32_16x16x32_bf16 v[72:75], a[104:107], a[176:179], v[72:75]
    v_mfma_f32_16x16x32_bf16 v[108:111], a[104:107], a[168:171], v[108:111]
    ds_read_b64_tr_b16 a[140:141], v35 offset:24576
    v_mfma_f32_16x16x32_bf16 v[108:111], a[108:111], a[172:175], v[108:111]
    v_mfma_f32_16x16x32_bf16 v[104:107], a[108:111], a[164:167], v[104:107]
    ds_read_b64_tr_b16 a[142:143], v35 offset:28672
    v_mfma_f32_16x16x32_bf16 v[104:107], a[104:107], a[160:163], v[104:107]
    s_waitcnt lgkmcnt(4)
    v_mfma_f32_16x16x32_bf16 v[112:115], a[128:131], a[160:163], v[112:115]
    ds_read_b64_tr_b16 a[96:97], v36 offset:16384
    v_mfma_f32_16x16x32_bf16 v[112:115], a[132:135], a[164:167], v[112:115]
    buffer_load_dwordx4 a[252:255], v13, s[12:15], s42 offen offset:2048 sc1
    s_add_u32 s42, s42, 4096
    v_mfma_f32_16x16x32_bf16 v[116:119], a[132:135], a[172:175], v[116:119]
    ds_read_b64_tr_b16 a[98:99], v36 offset:20480
    v_mfma_f32_16x16x32_bf16 v[116:119], a[128:131], a[168:171], v[116:119]
    v_mfma_f32_16x16x32_bf16 v[80:83], a[128:131], a[176:179], v[80:83]
    ds_read_b64_tr_b16 a[100:101], v36 offset:24576
    v_mfma_f32_16x16x32_bf16 v[80:83], a[132:135], a[180:183], v[80:83]
    s_add_u32 m0, s63, 0
    s_add_u32 s47, s62, 0x80000
    buffer_load_dwordx4 v2, s[64:67], s47 offen offset:0 lds
    v_mfma_f32_16x16x32_bf16 v[84:87], a[132:135], a[188:191], v[84:87]
    ds_read_b64_tr_b16 a[102:103], v36 offset:28672
    v_mfma_f32_16x16x32_bf16 v[84:87], a[128:131], a[184:187], v[84:87]
    s_waitcnt lgkmcnt(4)
    v_mfma_f32_16x16x32_bf16 v[92:95], a[136:139], a[184:187], v[92:95]
    ds_read_b64_tr_b16 a[104:105], v37 offset:16384
    v_mfma_f32_16x16x32_bf16 v[92:95], a[140:143], a[188:191], v[92:95]
    v_mfma_f32_16x16x32_bf16 v[88:91], a[140:143], a[180:183], v[88:91]
    s_waitcnt vmcnt(9)
    v_cmp_eq_u32 vcc, 1, v18
    ds_read_b64_tr_b16 a[106:107], v37 offset:20480
    v_mfma_f32_16x16x32_bf16 v[88:91], a[136:139], a[176:179], v[88:91]
    buffer_load_dwordx4 v3, s[64:67], s47 offen offset:1024 lds
    v_mfma_f32_16x16x32_bf16 v[124:127], a[136:139], a[168:171], v[124:127]
    s_bcnt1_i32_b32 s78, vcc_lo
    ds_read_b64_tr_b16 a[108:109], v37 offset:24576
    v_mfma_f32_16x16x32_bf16 v[124:127], a[140:143], a[172:175], v[124:127]
    v_mfma_f32_16x16x32_bf16 v[120:123], a[140:143], a[164:167], v[120:123]
    s_cmp_lt_u32 s78, 16
    s_cbranch_scc1 L_spin20
L_got20:
    ds_read_b64_tr_b16 a[110:111], v37 offset:28672
    v_mfma_f32_16x16x32_bf16 v[120:123], a[136:139], a[160:163], v[120:123]
    s_waitcnt lgkmcnt(4)
    v_mfma_f32_16x16x32_bf16 v[160:163], a[96:99], a[160:163], v[160:163]
    ds_read_b64_tr_b16 a[128:129], v38 offset:16384
    v_mfma_f32_16x16x32_bf16 v[160:163], a[100:103], a[164:167], v[160:163]
    buffer_load_dwordx4 v[192:195], v12, s[12:15], s43 offen offset:0 sc1
    v_mfma_f32_16x16x32_bf16 v[164:167], a[100:103], a[172:175], v[164:167]
    ds_read_b64_tr_b16 a[130:131], v38 offset:20480
    v_mfma_f32_16x16x32_bf16 v[164:167], a[96:99], a[168:171], v[164:167]
    v_mfma_f32_16x16x32_bf16 v[128:131], a[96:99], a[176:179], v[128:131]
    ds_read_b64_tr_b16 a[132:133], v38 offset:24576
    v_mfma_f32_16x16x32_bf16 v[128:131], a[100:103], a[180:183], v[128:131]
    buffer_load_dwordx4 v[196:199], v12, s[12:15], s43 offen offset:2048 sc1
    v_mfma_f32_16x16x32_bf16 v[132:135], a[100:103], a[188:191], v[132:135]
    ds_read_b64_tr_b16 a[134:135], v38 offset:28672
    v_mfma_f32_16x16x32_bf16 v[132:135], a[96:99], a[184:187], v[132:135]
    s_waitcnt lgkmcnt(4)
    v_mfma_f32_16x16x32_bf16 v[140:143], a[104:107], a[184:187], v[140:143]
    ds_read_b64_tr_b16 a[136:137], v39 offset:16384
    v_mfma_f32_16x16x32_bf16 v[140:143], a[108:111], a[188:191], v[140:143]
    v_mfma_f32_16x16x32_bf16 v[136:139], a[108:111], a[180:183], v[136:139]
    ds_read_b64_tr_b16 a[138:139], v39 offset:20480
    v_mfma_f32_16x16x32_bf16 v[136:139], a[104:107], a[176:179], v[136:139]
    buffer_load_dwordx4 v[200:203], v13, s[12:15], s43 offen offset:0 sc1
    v_mfma_f32_16x16x32_bf16 v[172:175], a[104:107], a[168:171], v[172:175]
    ds_read_b64_tr_b16 a[140:141], v39 offset:24576
    v_mfma_f32_16x16x32_bf16 v[172:175], a[108:111], a[172:175], v[172:175]
    v_mfma_f32_16x16x32_bf16 v[168:171], a[108:111], a[164:167], v[168:171]
    ds_read_b64_tr_b16 a[142:143], v39 offset:28672
    v_mfma_f32_16x16x32_bf16 v[168:171], a[104:107], a[160:163], v[168:171]
    s_barrier
    s_waitcnt lgkmcnt(4)
    v_mfma_f32_16x16x32_bf16 v[176:179], a[128:131], a[160:163], v[176:179]
    ds_read_b64_tr_b16 a[96:97], v32 offset:32768
    v_mfma_f32_16x16x32_bf16 v[176:179], a[132:135], a[164:167], v[176:179]
    buffer_load_dwordx4 v[204:207], v13, s[12:15], s43 offen offset:2048 sc1
    s_add_u32 s43, s43, 4096
    v_mfma_f32_16x16x32_bf16 v[180:183], a[132:135], a[172:175], v[180:183]
    ds_read_b64_tr_b16 a[98:99], v32 offset:36864
    v_mfma_f32_16x16x32_bf16 v[180:183], a[128:131], a[168:171], v[180:183]
    v_mfma_f32_16x16x32_bf16 v[144:147], a[128:131], a[176:179], v[144:147]
    ds_read_b64_tr_b16 a[100:101], v32 offset:40960
    v_mfma_f32_16x16x32_bf16 v[144:147], a[132:135], a[180:183], v[144:147]
    buffer_load_dwordx4 v[208:211], v12, s[12:15], s42 offen offset:0 sc1
    v_mfma_f32_16x16x32_bf16 v[148:151], a[132:135], a[188:191], v[148:151]
    ds_read_b64_tr_b16 a[102:103], v32 offset:45056
    v_mfma_f32_16x16x32_bf16 v[148:151], a[128:131], a[184:187], v[148:151]
    s_waitcnt lgkmcnt(4)
    v_mfma_f32_16x16x32_bf16 v[156:159], a[136:139], a[184:187], v[156:159]
    ds_read_b64_tr_b16 a[104:105], v33 offset:32768
    v_mfma_f32_16x16x32_bf16 v[156:159], a[140:143], a[188:191], v[156:159]
    buffer_load_dwordx4 v[212:215], v12, s[12:15], s42 offen offset:2048 sc1
    v_mfma_f32_16x16x32_bf16 v[152:155], a[140:143], a[180:183], v[152:155]
L_pg18:
    s_cbranch_execz L_tramp
    ds_read_b64_tr_b16 a[106:107], v33 offset:36864
    v_mfma_f32_16x16x32_bf16 v[152:155], a[136:139], a[176:179], v[152:155]
    v_mfma_f32_16x16x32_bf16 v[188:191], a[136:139], a[168:171], v[188:191]
    ds_read_b64_tr_b16 a[108:109], v33 offset:40960
    v_mfma_f32_16x16x32_bf16 v[188:191], a[140:143], a[172:175], v[188:191]
    buffer_load_dwordx4 v[216:219], v13, s[12:15], s42 offen offset:0 sc1
    v_mfma_f32_16x16x32_bf16 v[184:187], a[140:143], a[164:167], v[184:187]
    ds_read_b64_tr_b16 a[110:111], v33 offset:45056
    v_mfma_f32_16x16x32_bf16 v[184:187], a[136:139], a[160:163], v[184:187]
    s_waitcnt lgkmcnt(4)
    v_mfma_f32_16x16x32_bf16 v[96:99], a[96:99], a[192:195], v[96:99]
    ds_read_b64_tr_b16 a[128:129], v34 offset:32768
    v_mfma_f32_16x16x32_bf16 v[96:99], a[100:103], a[196:199], v[96:99]
    buffer_load_dwordx4 v[220:223], v13, s[12:15], s42 offen offset:2048 sc1
    s_add_u32 s42, s42, 4096
    v_mfma_f32_16x16x32_bf16 v[100:103], a[100:103], a[204:207], v[100:103]
    ds_read_b64_tr_b16 a[130:131], v34 offset:36864
    v_mfma_f32_16x16x32_bf16 v[100:103], a[96:99], a[200:203], v[100:103]
    v_mfma_f32_16x16x32_bf16 v[64:67], a[96:99], a[208:211], v[64:67]
    ds_read_b64_tr_b16 a[132:133], v34 offset:40960
    v_mfma_f32_16x16x32_bf16 v[64:67], a[100:103], a[212:215], v[64:67]
    buffer_load_dwordx4 v[224:227], v12, s[12:15], s43 offen offset:0 sc1
    v_mfma_f32_16x16x32_bf16 v[68:71], a[100:103], a[220:223], v[68:71]
    ds_read_b64_tr_b16 a[134:135], v34 offset:45056
    v_mfma_f32_16x16x32_bf16 v[68:71], a[96:99], a[216:219], v[68:71]
    s_waitcnt lgkmcnt(4)
    v_mfma_f32_16x16x32_bf16 v[76:79], a[104:107], a[216:219], v[76:79]
    ds_read_b64_tr_b16 a[136:137], v35 offset:32768
    v_mfma_f32_16x16x32_bf16 v[76:79], a[108:111], a[220:223], v[76:79]
    v_mfma_f32_16x16x32_bf16 v[72:75], a[108:111], a[212:215], v[72:75]
    ds_read_b64_tr_b16 a[138:139], v35 offset:36864
    v_mfma_f32_16x16x32_bf16 v[72:75], a[104:107], a[208:211], v[72:75]
    buffer_load_dwordx4 v[228:231], v12, s[12:15], s43 offen offset:2048 sc1
    v_mfma_f32_16x16x32_bf16 v[108:111], a[104:107], a[200:203], v[108:111]
    ds_read_b64_tr_b16 a[140:141], v35 offset:40960
    v_mfma_f32_16x16x32_bf16 v[108:111], a[108:111], a[204:207], v[108:111]
    v_mfma_f32_16x16x32_bf16 v[104:107], a[108:111], a[196:199], v[104:107]
    ds_read_b64_tr_b16 a[142:143], v35 offset:45056
    v_mfma_f32_16x16x32_bf16 v[104:107], a[104:107], a[192:195], v[104:107]
    s_waitcnt lgkmcnt(4)
    v_mfma_f32_16x16x32_bf16 v[112:115], a[128:131], a[192:195], v[112:115]
    ds_read_b64_tr_b16 a[96:97], v36 offset:32768
    v_mfma_f32_16x16x32_bf16 v[112:115], a[132:135], a[196:199], v[112:115]
    buffer_load_dwordx4 v[232:235], v13, s[12:15], s43 offen offset:0 sc1
    v_mfma_f32_16x16x32_bf16 v[116:119], a[132:135], a[204:207], v[116:119]
    ds_read_b64_tr_b16 a[98:99], v36 offset:36864
    global_load_dword v9, v8, s[84:85]
    v_mfma_f32_16x16x32_bf16 v[116:119], a[128:131], a[200:203], v[116:119]
    v_mfma_f32_16x16x32_bf16 v[80:83], a[128:131], a[208:211], v[80:83]
    ds_read_b64_tr_b16 a[100:101], v36 offset:40960
    v_mfma_f32_16x16x32_bf16 v[80:83], a[132:135], a[212:215], v[80:83]
    buffer_load_dwordx4 v[236:239], v13, s[12:15], s43 offen offset:2048 sc1
    s_add_u32 s43, s43, 4096
    v_mfma_f32_16x16x32_bf16 v[84:87], a[132:135], a[220:223], v[84:87]
    ds_read_b64_tr_b16 a[102:103], v36 offset:45056
    v_mfma_f32_16x16x32_bf16 v[84:87], a[128:131], a[216:219], v[84:87]
    s_waitcnt lgkmcnt(4)
    v_mfma_f32_16x16x32_bf16 v[92:95], a[136:139], a[216:219], v[92:95]
    ds_read_b64_tr_b16 a[104:105], v37 offset:32768
    v_mfma_f32_16x16x32_bf16 v[92:95], a[140:143], a[220:223], v[92:95]
    buffer_load_dwordx4 v[240:243], v12, s[12:15], s42 offen offset:0 sc1
    v_mfma_f32_16x16x32_bf16 v[88:91], a[140:143], a[212:215], v[88:91]
    ds_read_b64_tr_b16 a[106:107], v37 offset:36864
    v_mfma_f32_16x16x32_bf16 v[88:91], a[136:139], a[208:211], v[88:91]
    v_mfma_f32_16x16x32_bf16 v[124:127], a[136:139], a[200:203], v[124:127]
    ds_read_b64_tr_b16 a[108:109], v37 offset:40960
    v_mfma_f32_16x16x32_bf16 v[124:127], a[140:143], a[204:207], v[124:127]
    buffer_load_dwordx4 v[244:247], v12, s[12:15], s42 offen offset:2048 sc1
    v_mfma_f32_16x16x32_bf16 v[120:123], a[140:143], a[196:199], v[120:123]
    ds_read_b64_tr_b16 a[110:111], v37 offset:45056
    v_mfma_f32_16x16x32_bf16 v[120:123], a[136:139], a[192:195], v[120:123]
    s_waitcnt lgkmcnt(4)
    v_mfma_f32_16x16x32_bf16 v[160:163], a[96:99], a[192:195], v[160:163]
    ds_read_b64_tr_b16 a[128:129], v38 offset:32768
    v_mfma_f32_16x16x32_bf16 v[160:163], a[100:103], a[196:199], v[160:163]
    buffer_load_dwordx4 v[248:251], v13, s[12:15], s42 offen offset:0 sc1
    v_mfma_f32_16x16x32_bf16 v[164:167], a[100:103], a[204:207], v[164:167]
    ds_read_b64_tr_b16 a[130:131], v38 offset:36864
    v_mfma_f32_16x16x32_bf16 v[164:167], a[96:99], a[200:203], v[164:167]
    v_mfma_f32_16x16x32_bf16 v[128:131], a[96:99], a[208:211], v[128:131]
    ds_read_b64_tr_b16 a[132:133], v38 offset:40960
    v_mfma_f32_16x16x32_bf16 v[128:131], a[100:103], a[212:215], v[128:131]
    buffer_load_dwordx4 v[252:255], v13, s[12:15], s42 offen offset:2048 sc1
    s_add_u32 s42, s42, 4096
    v_mfma_f32_16x16x32_bf16 v[132:135], a[100:103], a[220:223], v[132:135]
    ds_read_b64_tr_b16 a[134:135], v38 offset:45056
    v_mfma_f32_16x16x32_bf16 v[132:135], a[96:99], a[216:219], v[132:135]
    s_waitcnt lgkmcnt(4)
    v_mfma_f32_16x16x32_bf16 v[140:143], a[104:107], a[216:219], v[140:143]
    ds_read_b64_tr_b16 a[136:137], v39 offset:32768
    v_mfma_f32_16x16x32_bf16 v[140:143], a[108:111], a[220:223], v[140:143]
    v_mfma_f32_16x16x32_bf16 v[136:139], a[108:111], a[212:215], v[136:139]
    ds_read_b64_tr_b16 a[138:139], v39 offset:36864
    v_mfma_f32_16x16x32_bf16 v[136:139], a[104:107], a[208:211], v[136:139]
    buffer_load_dwordx4 v4, s[64:67], s47 offen offset:2048 lds
    v_mfma_f32_16x16x32_bf16 v[172:175], a[104:107], a[200:203], v[172:175]
    ds_read_b64_tr_b16 a[140:141], v39 offset:40960
    v_mfma_f32_16x16x32_bf16 v[172:175], a[108:111], a[204:207], v[172:175]
    v_mfma_f32_16x16x32_bf16 v[168:171], a[108:111], a[196:199], v[168:171]
    ds_read_b64_tr_b16 a[142:143], v39 offset:45056
    v_mfma_f32_16x16x32_bf16 v[168:171], a[104:107], a[192:195], v[168:171]
    s_barrier
    s_waitcnt lgkmcnt(4)
    v_mfma_f32_16x16x32_bf16 v[176:179], a[128:131], a[192:195], v[176:179]
    ds_read_b64_tr_b16 a[96:97], v32 offset:49152
    v_mfma_f32_16x16x32_bf16 v[176:179], a[132:135], a[196:199], v[176:179]
    buffer_load_dwordx4 v5, s[64:67], s47 offen offset:3072 lds
    v_mfma_f32_16x16x32_bf16 v[180:183], a[132:135], a[204:207], v[180:183]
    ds_read_b64_tr_b16 a[98:99], v32 offset:53248
    v_mfma_f32_16x16x32_bf16 v[180:183], a[128:131], a[200:203], v[180:183]
    v_mfma_f32_16x16x32_bf16 v[144:147], a[128:131], a[208:211], v[144:147]
    ds_read_b64_tr_b16 a[100:101], v32 offset:57344
    v_mfma_f32_16x16x32_bf16 v[144:147], a[132:135], a[212:215], v[144:147]
    buffer_load_dwordx4 a[0:3], v12, s[12:15], s43 offen offset:0 sc1
    v_mfma_f32_16x16x32_bf16 v[148:151], a[132:135], a[220:223], v[148:151]
    ds_read_b64_tr_b16 a[102:103], v32 offset:61440
    v_mfma_f32_16x16x32_bf16 v[148:151], a[128:131], a[216:219], v[148:151]
    s_waitcnt lgkmcnt(4)
    v_mfma_f32_16x16x32_bf16 v[156:159], a[136:139], a[216:219], v[156:159]
    ds_read_b64_tr_b16 a[104:105], v33 offset:49152
    v_mfma_f32_16x16x32_bf16 v[156:159], a[140:143], a[220:223], v[156:159]
    buffer_load_dwordx4 a[4:7], v12, s[12:15], s43 offen offset:2048 sc1
    v_mfma_f32_16x16x32_bf16 v[152:155], a[140:143], a[212:215], v[152:155]
    ds_read_b64_tr_b16 a[106:107], v33 offset:53248
    v_mfma_f32_16x16x32_bf16 v[152:155], a[136:139], a[208:211], v[152:155]
    v_mfma_f32_16x16x32_bf16 v[188:191], a[136:139], a[200:203], v[188:191]
    ds_read_b64_tr_b16 a[108:109], v33 offset:57344
    v_mfma_f32_16x16x32_bf16 v[188:191], a[140:143], a[204:207], v[188:191]
    buffer_load_dwordx4 a[8:11], v13, s[12:15], s43 offen offset:0 sc1
    v_mfma_f32_16x16x32_bf16 v[184:187], a[140:143], a[196:199], v[184:187]
    ds_read_b64_tr_b16 a[110:111], v33 offset:61440
    v_mfma_f32_16x16x32_bf16 v[184:187], a[136:139], a[192:195], v[184:187]
L_p2midQ:
    s_waitcnt vmcnt(24) lgkmcnt(4)
    v_mfma_f32_16x16x32_bf16 v[96:99], a[96:99], a[224:227], v[96:99]
    buffer_load_dword v17, v7, s[12:15], s99 offen offset:0 sc1
    ds_read_b64_tr_b16 a[128:129], v34 offset:49152
    v_mfma_f32_16x16x32_bf16 v[96:99], a[100:103], a[228:231], v[96:99]
    buffer_load_dwordx4 a[12:15], v13, s[12:15], s43 offen offset:2048 sc1
    s_add_u32 s43, s43, 4096
    v_mfma_f32_16x16x32_bf16 v[100:103], a[100:103], a[236:239], v[100:103]
    ds_read_b64_tr_b16 a[130:131], v34 offset:53248
    v_mfma_f32_16x16x32_bf16 v[100:103], a[96:99], a[232:235], v[100:103]
    v_mfma_f32_16x16x32_bf16 v[64:67], a[96:99], a[240:243], v[64:67]
    ds_read_b64_tr_b16 a[132:133], v34 offset:57344
    v_mfma_f32_16x16x32_bf16 v[64:67], a[100:103], a[244:247], v[64:67]
    buffer_load_dwordx4 a[16:19], v12, s[12:15], s42 offen offset:0 sc1
    v_mfma_f32_16x16x32_bf16 v[68:71], a[100:103], a[252:255], v[68:71]
    ds_read_b64_tr_b16 a[134:135], v34 offset:61440
    v_mfma_f32_16x16x32_bf16 v[68:71], a[96:99], a[248:251], v[68:71]
    s_waitcnt lgkmcnt(4)
    v_mfma_f32_16x16x32_bf16 v[76:79], a[104:107], a[248:251], v[76:79]
    ds_read_b64_tr_b16 a[136:137], v35 offset:49152
    v_mfma_f32_16x16x32_bf16 v[76:79], a[108:111], a[252:255], v[76:79]
    v_mfma_f32_16x16x32_bf16 v[72:75], a[108:111], a[244:247], v[72:75]
    ds_read_b64_tr_b16 a[138:139], v35 offset:53248
    v_mfma_f32_16x16x32_bf16 v[72:75], a[104:107], a[240:243], v[72:75]
    buffer_load_dwordx4 a[20:23], v12, s[12:15], s42 offen offset:2048 sc1
    v_mfma_f32_16x16x32_bf16 v[108:111], a[104:107], a[232:235], v[108:111]
    ds_read_b64_tr_b16 a[140:141], v35 offset:57344
    v_mfma_f32_16x16x32_bf16 v[108:111], a[108:111], a[236:239], v[108:111]
    v_mfma_f32_16x16x32_bf16 v[104:107], a[108:111], a[228:231], v[104:107]
    ds_read_b64_tr_b16 a[142:143], v35 offset:61440
    v_mfma_f32_16x16x32_bf16 v[104:107], a[104:107], a[224:227], v[104:107]
    s_waitcnt lgkmcnt(4)
    v_mfma_f32_16x16x32_bf16 v[112:115], a[128:131], a[224:227], v[112:115]
    ds_read_b64_tr_b16 a[96:97], v36 offset:49152
    v_mfma_f32_16x16x32_bf16 v[112:115], a[132:135], a[228:231], v[112:115]
    buffer_load_dwordx4 a[24:27], v13, s[12:15], s42 offen offset:0 sc1
    v_mfma_f32_16x16x32_bf16 v[116:119], a[132:135], a[236:239], v[116:119]
    ds_read_b64_tr_b16 a[98:99], v36 offset:53248
    v_mfma_f32_16x16x32_bf16 v[116:119], a[128:131], a[232:235], v[116:119]
    v_mfma_f32_16x16x32_bf16 v[80:83], a[128:131], a[240:243], v[80:83]
    ds_read_b64_tr_b16 a[100:101], v36 offset:57344
    v_mfma_f32_16x16x32_bf16 v[80:83], a[132:135], a[244:247], v[80:83]
    buffer_load_dwordx4 a[28:31], v13, s[12:15], s42 offen offset:2048 sc1
    s_add_u32 s42, s42, 4096
    v_mfma_f32_16x16x32_bf16 v[84:87], a[132:135], a[252:255], v[84:87]
    ds_read_b64_tr_b16 a[102:103], v36 offset:61440
    v_mfma_f32_16x16x32_bf16 v[84:87], a[128:131], a[248:251], v[84:87]
    s_waitcnt lgkmcnt(4)
    v_mfma_f32_16x16x32_bf16 v[92:95], a[136:139], a[248:251], v[92:95]
    ds_read_b64_tr_b16 a[104:105], v37 offset:49152
    v_mfma_f32_16x16x32_bf16 v[92:95], a[140:143], a[252:255], v[92:95]
    s_add_u32 m0, s63, 16384
    s_add_u32 s47, s62, 0xc0000
    buffer_load_dwordx4 v2, s[64:67], s47 offen offset:0 lds
    v_mfma_f32_16x16x32_bf16 v[88:91], a[140:143], a[244:247], v[88:91]
    ds_read_b64_tr_b16 a[106:107], v37 offset:53248
    v_mfma_f32_16x16x32_bf16 v[88:91], a[136:139], a[240:243], v[88:91]
    v_mfma_f32_16x16x32_bf16 v[124:127], a[136:139], a[232:235], v[124:127]
    ds_read_b64_tr_b16 a[108:109], v37 offset:57344
    v_mfma_f32_16x16x32_bf16 v[124:127], a[140:143], a[236:239], v[124:127]
    buffer_load_dwordx4 v3, s[64:67], s47 offen offset:1024 lds
    v_mfma_f32_16x16x32_bf16 v[120:123], a[140:143], a[228:231], v[120:123]
    ds_read_b64_tr_b16 a[110:111], v37 offset:61440
    v_mfma_f32_16x16x32_bf16 v[120:123], a[136:139], a[224:227], v[120:123]
    s_waitcnt lgkmcnt(4)
    v_mfma_f32_16x16x32_bf16 v[160:163], a[96:99], a[224:227], v[160:163]
    ds_read_b64_tr_b16 a[128:129], v38 offset:49152
    v_mfma_f32_16x16x32_bf16 v[160:163], a[100:103], a[228:231], v[160:163]
    buffer_load_dwordx4 v4, s[64:67], s47 offen offset:2048 lds
    v_mfma_f32_16x16x32_bf16 v[164:167], a[100:103], a[236:239], v[164:167]
    ds_read_b64_tr_b16 a[130:131], v38 offset:53248
    v_mfma_f32_16x16x32_bf16 v[164:167], a[96:99], a[232:235], v[164:167]
    v_mfma_f32_16x16x32_bf16 v[128:131], a[96:99], a[240:243], v[128:131]
    ds_read_b64_tr_b16 a[132:133], v38 offset:57344
    v_mfma_f32_16x16x32_bf16 v[128:131], a[100:103], a[244:247], v[128:131]
    buffer_load_dwordx4 v5, s[64:67], s47 offen offset:3072 lds
    v_mfma_f32_16x16x32_bf16 v[132:135], a[100:103], a[252:255], v[132:135]
    ds_read_b64_tr_b16 a[134:135], v38 offset:61440
    v_mfma_f32_16x16x32_bf16 v[132:135], a[96:99], a[248:251], v[132:135]
    s_waitcnt lgkmcnt(4)
    v_mfma_f32_16x16x32_bf16 v[140:143], a[104:107], a[248:251], v[140:143]
    ds_read_b64_tr_b16 a[136:137], v39 offset:49152
    v_mfma_f32_16x16x32_bf16 v[140:143], a[108:111], a[252:255], v[140:143]
    v_mfma_f32_16x16x32_bf16 v[136:139], a[108:111], a[244:247], v[136:139]
    ds_read_b64_tr_b16 a[138:139], v39 offset:53248
    v_mfma_f32_16x16x32_bf16 v[136:139], a[104:107], a[240:243], v[136:139]
    buffer_load_dwordx4 a[32:35], v12, s[12:15], s43 offen offset:0 sc1
    v_mfma_f32_16x16x32_bf16 v[172:175], a[104:107], a[232:235], v[172:175]
    ds_read_b64_tr_b16 a[140:141], v39 offset:57344
    v_mfma_f32_16x16x32_bf16 v[172:175], a[108:111], a[236:239], v[172:175]
    v_mfma_f32_16x16x32_bf16 v[168:171], a[108:111], a[228:231], v[168:171]
    ds_read_b64_tr_b16 a[142:143], v39 offset:61440
    v_mfma_f32_16x16x32_bf16 v[168:171], a[104:107], a[224:227], v[168:171]
    s_barrier
    s_waitcnt lgkmcnt(4)
    v_mfma_f32_16x16x32_bf16 v[176:179], a[128:131], a[224:227], v[176:179]
    ds_read_b64_tr_b16 a[96:97], v40 offset:0
    v_mfma_f32_16x16x32_bf16 v[176:179], a[132:135], a[228:231], v[176:179]
    buffer_load_dwordx4 a[36:39], v12, s[12:15], s43 offen offset:2048 sc1
    v_mfma_f32_16x16x32_bf16 v[180:183], a[132:135], a[236:239], v[180:183]
    ds_read_b64_tr_b16 a[98:99], v40 offset:4096
    v_mfma_f32_16x16x32_bf16 v[180:183], a[128:131], a[232:235], v[180:183]
    v_mfma_f32_16x16x32_bf16 v[144:147], a[128:131], a[240:243], v[144:147]
    ds_read_b64_tr_b16 a[100:101], v40 offset:8192
    v_mfma_f32_16x16x32_bf16 v[144:147], a[132:135], a[244:247], v[144:147]
    buffer_load_dwordx4 a[40:43], v13, s[12:15], s43 offen offset:0 sc1
    v_mfma_f32_16x16x32_bf16 v[148:151], a[132:135], a[252:255], v[148:151]
    ds_read_b64_tr_b16 a[102:103], v40 offset:12288
    v_mfma_f32_16x16x32_bf16 v[148:151], a[128:131], a[248:251], v[148:151]
    s_waitcnt lgkmcnt(4)
    v_mfma_f32_16x16x32_bf16 v[156:159], a[136:139], a[248:251], v[156:159]
    ds_read_b64_tr_b16 a[104:105], v41 offset:0
    v_mfma_f32_16x16x32_bf16 v[156:159], a[140:143], a[252:255], v[156:159]
    v_mfma_f32_16x16x32_bf16 v[152:155], a[140:143], a[244:247], v[152:155]
    s_waitcnt vmcnt(12)
    v_cmp_eq_u32 vcc, 1, v17
    ds_read_b64_tr_b16 a[106:107], v41 offset:4096
    v_mfma_f32_16x16x32_bf16 v[152:155], a[136:139], a[240:243], v[152:155]
    buffer_load_dwordx4 a[44:47], v13, s[12:15], s43 offen offset:2048 sc1
    s_add_u32 s43, s43, 4096
    v_mfma_f32_16x16x32_bf16 v[188:191], a[136:139], a[232:235], v[188:191]
    s_bcnt1_i32_b64 s78, vcc
    ds_read_b64_tr_b16 a[108:109], v41 offset:8192
    v_mfma_f32_16x16x32_bf16 v[188:191], a[140:143], a[236:239], v[188:191]
    v_mfma_f32_16x16x32_bf16 v[184:187], a[140:143], a[228:231], v[184:187]
    s_cmp_lt_u32 s78, 64
    s_cbranch_scc1 L_spin21
L_got21:
    ds_read_b64_tr_b16 a[110:111], v41 offset:12288
    v_mfma_f32_16x16x32_bf16 v[184:187], a[136:139], a[224:227], v[184:187]
    s_waitcnt lgkmcnt(4)
    v_mfma_f32_16x16x32_bf16 v[96:99], a[96:99], v[192:195], v[96:99]
    buffer_load_dword v18, v14, s[12:15], s40 offen offset:0 sc1
    ds_read_b64_tr_b16 a[128:129], v42 offset:0
    v_mfma_f32_16x16x32_bf16 v[96:99], a[100:103], v[196:199], v[96:99]
    buffer_load_dwordx2 v[48:49], v20, s[12:15], s33 offen sc1
    v_mfma_f32_16x16x32_bf16 v[100:103], a[100:103], v[204:207], v[100:103]
    ds_read_b64_tr_b16 a[130:131], v42 offset:4096
    v_mfma_f32_16x16x32_bf16 v[100:103], a[96:99], v[200:203], v[100:103]
    v_mfma_f32_16x16x32_bf16 v[64:67], a[96:99], v[208:211], v[64:67]
    ds_read_b64_tr_b16 a[132:133], v42 offset:8192
    v_mfma_f32_16x16x32_bf16 v[64:67], a[100:103], v[212:215], v[64:67]
    buffer_load_dwordx2 v[50:51], v20, s[12:15], s49 offen sc1
    v_mfma_f32_16x16x32_bf16 v[68:71], a[100:103], v[220:223], v[68:71]
    ds_read_b64_tr_b16 a[134:135], v42 offset:12288
    v_mfma_f32_16x16x32_bf16 v[68:71], a[96:99], v[216:219], v[68:71]
    s_waitcnt lgkmcnt(4)
    v_mfma_f32_16x16x32_bf16 v[76:79], a[104:107], v[216:219], v[76:79]
    ds_read_b64_tr_b16 a[136:137], v43 offset:0
    v_mfma_f32_16x16x32_bf16 v[76:79], a[108:111], v[220:223], v[76:79]
    s_add_u32 m0, s63, 32768
    s_add_u32 s47, s62, 0xf0000
    buffer_load_dwordx4 v2, s[64:67], s47 offen offset:0 lds
    v_mfma_f32_16x16x32_bf16 v[72:75], a[108:111], v[212:215], v[72:75]
    ds_read_b64_tr_b16 a[138:139], v43 offset:4096
    v_mfma_f32_16x16x32_bf16 v[72:75], a[104:107], v[208:211], v[72:75]
    v_mfma_f32_16x16x32_bf16 v[108:111], a[104:107], v[200:203], v[108:111]
    ds_read_b64_tr_b16 a[140:141], v43 offset:8192
    v_mfma_f32_16x16x32_bf16 v[108:111], a[108:111], v[204:207], v[108:111]
    buffer_load_dwordx4 v3, s[64:67], s47 offen offset:1024 lds
    v_mfma_f32_16x16x32_bf16 v[104:107], a[108:111], v[196:199], v[104:107]
    ds_read_b64_tr_b16 a[142:143], v43 offset:12288
    v_mfma_f32_16x16x32_bf16 v[104:107], a[104:107], v[192:195], v[104:107]
    s_waitcnt lgkmcnt(4)
    v_mfma_f32_16x16x32_bf16 v[112:115], a[128:131], v[192:195], v[112:115]
    ds_read_b64_tr_b16 a[96:97], v44 offset:0
    v_mfma_f32_16x16x32_bf16 v[112:115], a[132:135], v[196:199], v[112:115]
    buffer_load_dwordx4 v4, s[64:67], s47 offen offset:2048 lds
    v_mfma_f32_16x16x32_bf16 v[116:119], a[132:135], v[204:207], v[116:119]
    ds_read_b64_tr_b16 a[98:99], v44 offset:4096
    v_mfma_f32_16x16x32_bf16 v[116:119], a[128:131], v[200:203], v[116:119]
    v_mfma_f32_16x16x32_bf16 v[80:83], a[128:131], v[208:211], v[80:83]
    ds_read_b64_tr_b16 a[100:101], v44 offset:8192
    v_mfma_f32_16x16x32_bf16 v[80:83], a[132:135], v[212:215], v[80:83]
    buffer_load_dwordx4 v5, s[64:67], s47 offen offset:3072 lds
    v_mfma_f32_16x16x32_bf16 v[84:87], a[132:135], v[220:223], v[84:87]
    ds_read_b64_tr_b16 a[102:103], v44 offset:12288
    v_mfma_f32_16x16x32_bf16 v[84:87], a[128:131], v[216:219], v[84:87]
    s_waitcnt lgkmcnt(4)
    v_mfma_f32_16x16x32_bf16 v[92:95], a[136:139], v[216:219], v[92:95]
    ds_read_b64_tr_b16 a[104:105], v45 offset:0
    v_mfma_f32_16x16x32_bf16 v[92:95], a[140:143], v[220:223], v[92:95]
    v_mfma_f32_16x16x32_bf16 v[88:91], a[140:143], v[212:215], v[88:91]
    ds_read_b64_tr_b16 a[106:107], v45 offset:4096
    v_mfma_f32_16x16x32_bf16 v[88:91], a[136:139], v[208:211], v[88:91]
    s_add_u32 m0, s63, 49152
    s_add_u32 s47, s62, 0x130000
    buffer_load_dwordx4 v2, s[64:67], s47 offen offset:0 lds
    v_mfma_f32_16x16x32_bf16 v[124:127], a[136:139], v[200:203], v[124:127]
    ds_read_b64_tr_b16 a[108:109], v45 offset:8192
    v_mfma_f32_16x16x32_bf16 v[124:127], a[140:143], v[204:207], v[124:127]
    v_mfma_f32_16x16x32_bf16 v[120:123], a[140:143], v[196:199], v[120:123]
    ds_read_b64_tr_b16 a[110:111], v45 offset:12288
    v_mfma_f32_16x16x32_bf16 v[120:123], a[136:139], v[192:195], v[120:123]
    s_waitcnt lgkmcnt(4)
    v_mfma_f32_16x16x32_bf16 v[160:163], a[96:99], v[192:195], v[160:163]
    ds_read_b64_tr_b16 a[128:129], v46 offset:0
    v_mfma_f32_16x16x32_bf16 v[160:163], a[100:103], v[196:199], v[160:163]
    buffer_load_dwordx4 v3, s[64:67], s47 offen offset:1024 lds
    v_mfma_f32_16x16x32_bf16 v[164:167], a[100:103], v[204:207], v[164:167]
    ds_read_b64_tr_b16 a[130:131], v46 offset:4096
    v_mfma_f32_16x16x32_bf16 v[164:167], a[96:99], v[200:203], v[164:167]
    v_mfma_f32_16x16x32_bf16 v[128:131], a[96:99], v[208:211], v[128:131]
    ds_read_b64_tr_b16 a[132:133], v46 offset:8192
    v_mfma_f32_16x16x32_bf16 v[128:131], a[100:103], v[212:215], v[128:131]
    buffer_load_dwordx4 v4, s[64:67], s47 offen offset:2048 lds
    v_mfma_f32_16x16x32_bf16 v[132:135], a[100:103], v[220:223], v[132:135]
    ds_read_b64_tr_b16 a[134:135], v46 offset:12288
    v_mfma_f32_16x16x32_bf16 v[132:135], a[96:99], v[216:219], v[132:135]
    s_waitcnt lgkmcnt(4)
    v_mfma_f32_16x16x32_bf16 v[140:143], a[104:107], v[216:219], v[140:143]
    ds_read_b64_tr_b16 a[136:137], v47 offset:0
    v_mfma_f32_16x16x32_bf16 v[140:143], a[108:111], v[220:223], v[140:143]
    buffer_load_dwordx4 v5, s[64:67], s47 offen offset:3072 lds
    v_mfma_f32_16x16x32_bf16 v[136:139], a[108:111], v[212:215], v[136:139]
    ds_read_b64_tr_b16 a[138:139], v47 offset:4096
    v_mfma_f32_16x16x32_bf16 v[136:139], a[104:107], v[208:211], v[136:139]
    v_mfma_f32_16x16x32_bf16 v[172:175], a[104:107], v[200:203], v[172:175]
    ds_read_b64_tr_b16 a[140:141], v47 offset:8192
    v_mfma_f32_16x16x32_bf16 v[172:175], a[108:111], v[204:207], v[172:175]
    buffer_load_dwordx4 a[48:51], v12, s[12:15], s43 offen offset:0 sc1
    v_mfma_f32_16x16x32_bf16 v[168:171], a[108:111], v[196:199], v[168:171]
    ds_read_b64_tr_b16 a[142:143], v47 offset:12288
    v_mfma_f32_16x16x32_bf16 v[168:171], a[104:107], v[192:195], v[168:171]
    s_barrier
    s_waitcnt lgkmcnt(4)
    v_mfma_f32_16x16x32_bf16 v[176:179], a[128:131], v[192:195], v[176:179]
    ds_read_b64_tr_b16 a[96:97], v40 offset:16384
    v_mfma_f32_16x16x32_bf16 v[176:179], a[132:135], v[196:199], v[176:179]
    buffer_load_dwordx4 a[52:55], v12, s[12:15], s43 offen offset:2048 sc1
    v_mfma_f32_16x16x32_bf16 v[180:183], a[132:135], v[204:207], v[180:183]
    ds_read_b64_tr_b16 a[98:99], v40 offset:20480
    v_mfma_f32_16x16x32_bf16 v[180:183], a[128:131], v[200:203], v[180:183]
    v_mfma_f32_16x16x32_bf16 v[144:147], a[128:131], v[208:211], v[144:147]
    ds_read_b64_tr_b16 a[100:101], v40 offset:24576
    v_mfma_f32_16x16x32_bf16 v[144:147], a[132:135], v[212:215], v[144:147]
    buffer_load_dwordx4 a[56:59], v13, s[12:15], s43 offen offset:0 sc1
    v_mfma_f32_16x16x32_bf16 v[148:151], a[132:135], v[220:223], v[148:151]
    ds_read_b64_tr_b16 a[102:103], v40 offset:28672
    v_mfma_f32_16x16x32_bf16 v[148:151], a[128:131], v[216:219], v[148:151]
    s_waitcnt lgkmcnt(4)
    v_mfma_f32_16x16x32_bf16 v[156:159], a[136:139], v[216:219], v[156:159]
    ds_read_b64_tr_b16 a[104:105], v41 offset:16384
    v_mfma_f32_16x16x32_bf16 v[156:159], a[140:143], v[220:223], v[156:159]
    v_mfma_f32_16x16x32_bf16 v[152:155], a[140:143], v[212:215], v[152:155]
    s_waitcnt vmcnt(13)
    v_cmp_eq_u32 vcc, 1, v18
    ds_read_b64_tr_b16 a[106:107], v41 offset:20480
    v_mfma_f32_16x16x32_bf16 v[152:155], a[136:139], v[208:211], v[152:155]
    buffer_load_dwordx4 a[60:63], v13, s[12:15], s43 offen offset:2048 sc1
    s_add_u32 s43, s43, 4096
    v_mfma_f32_16x16x32_bf16 v[188:191], a[136:139], v[200:203], v[188:191]
    s_bcnt1_i32_b32 s78, vcc_lo
    ds_read_b64_tr_b16 a[108:109], v41 offset:24576
    v_mfma_f32_16x16x32_bf16 v[188:191], a[140:143], v[204:207], v[188:191]
    v_mfma_f32_16x16x32_bf16 v[184:187], a[140:143], v[196:199], v[184:187]
    s_cmp_lt_u32 s78, 32
    s_cbranch_scc1 L_spin22
L_got22:
    ds_read_b64_tr_b16 a[110:111], v41 offset:28672
    v_mfma_f32_16x16x32_bf16 v[184:187], a[136:139], v[192:195], v[184:187]
    s_waitcnt lgkmcnt(4)
    v_mfma_f32_16x16x32_bf16 v[96:99], a[96:99], v[224:227], v[96:99]
    ds_read_b64_tr_b16 a[128:129], v42 offset:16384
    v_mfma_f32_16x16x32_bf16 v[96:99], a[100:103], v[228:231], v[96:99]
    buffer_load_dwordx4 a[64:67], v12, s[12:15], s43 offen offset:0 sc1
    v_mfma_f32_16x16x32_bf16 v[100:103], a[100:103], v[236:239], v[100:103]
    ds_read_b64_tr_b16 a[130:131], v42 offset:20480
    v_mfma_f32_16x16x32_bf16 v[100:103], a[96:99], v[232:235], v[100:103]
    v_mfma_f32_16x16x32_bf16 v[64:67], a[96:99], v[240:243], v[64:67]
    ds_read_b64_tr_b16 a[132:133], v42 offset:24576
    v_mfma_f32_16x16x32_bf16 v[64:67], a[100:103], v[244:247], v[64:67]
    buffer_load_dwordx4 a[68:71], v12, s[12:15], s43 offen offset:2048 sc1
    v_mfma_f32_16x16x32_bf16 v[68:71], a[100:103], v[252:255], v[68:71]
    ds_read_b64_tr_b16 a[134:135], v42 offset:28672
    v_mfma_f32_16x16x32_bf16 v[68:71], a[96:99], v[248:251], v[68:71]
    s_waitcnt lgkmcnt(4)
    v_mfma_f32_16x16x32_bf16 v[76:79], a[104:107], v[248:251], v[76:79]
    ds_read_b64_tr_b16 a[136:137], v43 offset:16384
    v_mfma_f32_16x16x32_bf16 v[76:79], a[108:111], v[252:255], v[76:79]
    buffer_load_dwordx4 a[72:75], v13, s[12:15], s43 offen offset:0 sc1
    v_mfma_f32_16x16x32_bf16 v[72:75], a[108:111], v[244:247], v[72:75]
    ds_read_b64_tr_b16 a[138:139], v43 offset:20480
    v_mfma_f32_16x16x32_bf16 v[72:75], a[104:107], v[240:243], v[72:75]
    v_mfma_f32_16x16x32_bf16 v[108:111], a[104:107], v[232:235], v[108:111]
    ds_read_b64_tr_b16 a[140:141], v43 offset:24576
    v_mfma_f32_16x16x32_bf16 v[108:111], a[108:111], v[236:239], v[108:111]
    buffer_load_dwordx4 a[76:79], v13, s[12:15], s43 offen offset:2048 sc1
    s_add_u32 s43, s43, 4096
    v_mfma_f32_16x16x32_bf16 v[104:107], a[108:111], v[228:231], v[104:107]
    ds_read_b64_tr_b16 a[142:143], v43 offset:28672
    v_mfma_f32_16x16x32_bf16 v[104:107], a[104:107], v[224:227], v[104:107]
    s_waitcnt lgkmcnt(4)
    v_mfma_f32_16x16x32_bf16 v[112:115], a[128:131], v[224:227], v[112:115]
    ds_read_b64_tr_b16 a[96:97], v44 offset:16384
    v_mfma_f32_16x16x32_bf16 v[112:115], a[132:135], v[228:231], v[112:115]
    s_add_u32 m0, s63, 65536
    s_add_u32 s47, s62, 0x160000
    buffer_load_dwordx4 v2, s[64:67], s47 offen offset:0 lds
    v_mfma_f32_16x16x32_bf16 v[116:119], a[132:135], v[236:239], v[116:119]
    ds_read_b64_tr_b16 a[98:99], v44 offset:20480
    v_mfma_f32_16x16x32_bf16 v[116:119], a[128:131], v[232:235], v[116:119]
    v_mfma_f32_16x16x32_bf16 v[80:83], a[128:131], v[240:243], v[80:83]
    ds_read_b64_tr_b16 a[100:101], v44 offset:24576
    v_mfma_f32_16x16x32_bf16 v[80:83], a[132:135], v[244:247], v[80:83]
    buffer_load_dwordx4 v3, s[64:67], s47 offen offset:1024 lds
    v_mfma_f32_16x16x32_bf16 v[84:87], a[132:135], v[252:255], v[84:87]
    ds_read_b64_tr_b16 a[102:103], v44 offset:28672
    v_mfma_f32_16x16x32_bf16 v[84:87], a[128:131], v[248:251], v[84:87]
    s_waitcnt lgkmcnt(4)
    v_mfma_f32_16x16x32_bf16 v[92:95], a[136:139], v[248:251], v[92:95]
    ds_read_b64_tr_b16 a[104:105], v45 offset:16384
    v_mfma_f32_16x16x32_bf16 v[92:95], a[140:143], v[252:255], v[92:95]
    v_mfma_f32_16x16x32_bf16 v[88:91], a[140:143], v[244:247], v[88:91]
    ds_read_b64_tr_b16 a[106:107], v45 offset:20480
    v_mfma_f32_16x16x32_bf16 v[88:91], a[136:139], v[240:243], v[88:91]
    buffer_load_dwordx4 v4, s[64:67], s47 offen offset:2048 lds
    v_mfma_f32_16x16x32_bf16 v[124:127], a[136:139], v[232:235], v[124:127]
    ds_read_b64_tr_b16 a[108:109], v45 offset:24576
    v_mfma_f32_16x16x32_bf16 v[124:127], a[140:143], v[236:239], v[124:127]
    v_mfma_f32_16x16x32_bf16 v[120:123], a[140:143], v[228:231], v[120:123]
    ds_read_b64_tr_b16 a[110:111], v45 offset:28672
    v_mfma_f32_16x16x32_bf16 v[120:123], a[136:139], v[224:227], v[120:123]
    s_waitcnt lgkmcnt(4)
    v_mfma_f32_16x16x32_bf16 v[160:163], a[96:99], v[224:227], v[160:163]
    ds_read_b64_tr_b16 a[128:129], v46 offset:16384
    v_mfma_f32_16x16x32_bf16 v[160:163], a[100:103], v[228:231], v[160:163]
    buffer_load_dwordx4 v5, s[64:67], s47 offen offset:3072 lds
    v_mfma_f32_16x16x32_bf16 v[164:167], a[100:103], v[236:239], v[164:167]
    ds_read_b64_tr_b16 a[130:131], v46 offset:20480
    v_mfma_f32_16x16x32_bf16 v[164:167], a[96:99], v[232:235], v[164:167]
    v_mfma_f32_16x16x32_bf16 v[128:131], a[96:99], v[240:243], v[128:131]
    ds_read_b64_tr_b16 a[132:133], v46 offset:24576
    v_mfma_f32_16x16x32_bf16 v[128:131], a[100:103], v[244:247], v[128:131]
    s_add_u32 m0, s63, 81920
    s_add_u32 s47, s62, 0x1a0000
    buffer_load_dwordx4 v2, s[64:67], s47 offen offset:0 lds
    v_mfma_f32_16x16x32_bf16 v[132:135], a[100:103], v[252:255], v[132:135]
    ds_read_b64_tr_b16 a[134:135], v46 offset:28672
    v_mfma_f32_16x16x32_bf16 v[132:135], a[96:99], v[248:251], v[132:135]
    s_waitcnt lgkmcnt(4)
    v_mfma_f32_16x16x32_bf16 v[140:143], a[104:107], v[248:251], v[140:143]
    ds_read_b64_tr_b16 a[136:137], v47 offset:16384
    v_mfma_f32_16x16x32_bf16 v[140:143], a[108:111], v[252:255], v[140:143]
    buffer_load_dwordx4 v3, s[64:67], s47 offen offset:1024 lds
    v_mfma_f32_16x16x32_bf16 v[136:139], a[108:111], v[244:247], v[136:139]
    ds_read_b64_tr_b16 a[138:139], v47 offset:20480
    v_mfma_f32_16x16x32_bf16 v[136:139], a[104:107], v[240:243], v[136:139]
    v_mfma_f32_16x16x32_bf16 v[172:175], a[104:107], v[232:235], v[172:175]
    ds_read_b64_tr_b16 a[140:141], v47 offset:24576
    v_mfma_f32_16x16x32_bf16 v[172:175], a[108:111], v[236:239], v[172:175]
    buffer_load_dwordx4 v4, s[64:67], s47 offen offset:2048 lds
    v_mfma_f32_16x16x32_bf16 v[168:171], a[108:111], v[228:231], v[168:171]
    ds_read_b64_tr_b16 a[142:143], v47 offset:28672
    v_mfma_f32_16x16x32_bf16 v[168:171], a[104:107], v[224:227], v[168:171]
    s_barrier
    s_waitcnt lgkmcnt(4)
    v_mfma_f32_16x16x32_bf16 v[176:179], a[128:131], v[224:227], v[176:179]
    ds_read_b64_tr_b16 a[96:97], v24 offset:0
    v_mfma_f32_16x16x32_bf16 v[176:179], a[132:135], v[228:231], v[176:179]
    buffer_load_dwordx4 v5, s[64:67], s47 offen offset:3072 lds
    v_mfma_f32_16x16x32_bf16 v[180:183], a[132:135], v[236:239], v[180:183]
    ds_read_b64_tr_b16 a[98:99], v24 offset:4096
    v_mfma_f32_16x16x32_bf16 v[180:183], a[128:131], v[232:235], v[180:183]
    v_mfma_f32_16x16x32_bf16 v[144:147], a[128:131], v[240:243], v[144:147]
    ds_read_b64_tr_b16 a[100:101], v24 offset:8192
    v_mfma_f32_16x16x32_bf16 v[144:147], a[132:135], v[244:247], v[144:147]
    buffer_load_dwordx4 a[80:83], v12, s[12:15], s43 offen offset:0 sc1
    v_mfma_f32_16x16x32_bf16 v[148:151], a[132:135], v[252:255], v[148:151]
    ds_read_b64_tr_b16 a[102:103], v24 offset:12288
    v_mfma_f32_16x16x32_bf16 v[148:151], a[128:131], v[248:251], v[148:151]
    s_waitcnt lgkmcnt(4)
    v_mfma_f32_16x16x32_bf16 v[156:159], a[136:139], v[248:251], v[156:159]
    ds_read_b64_tr_b16 a[104:105], v25 offset:0
    v_mfma_f32_16x16x32_bf16 v[156:159], a[140:143], v[252:255], v[156:159]
    v_mfma_f32_16x16x32_bf16 v[152:155], a[140:143], v[244:247], v[152:155]
    ds_read_b64_tr_b16 a[106:107], v25 offset:4096
    v_mfma_f32_16x16x32_bf16 v[152:155], a[136:139], v[240:243], v[152:155]
    buffer_load_dwordx4 a[84:87], v12, s[12:15], s43 offen offset:2048 sc1
    v_mfma_f32_16x16x32_bf16 v[188:191], a[136:139], v[232:235], v[188:191]
    ds_read_b64_tr_b16 a[108:109], v25 offset:8192
    v_mfma_f32_16x16x32_bf16 v[188:191], a[140:143], v[236:239], v[188:191]
    v_mfma_f32_16x16x32_bf16 v[184:187], a[140:143], v[228:231], v[184:187]
    ds_read_b64_tr_b16 a[110:111], v25 offset:12288
    v_mfma_f32_16x16x32_bf16 v[184:187], a[136:139], v[224:227], v[184:187]
    s_barrier
    s_waitcnt lgkmcnt(4)
    v_mfma_f32_16x16x32_bf16 v[96:99], a[96:99], a[0:3], v[96:99]
    ds_read_b64_tr_b16 a[128:129], v26 offset:0
    v_mfma_f32_16x16x32_bf16 v[96:99], a[100:103], a[4:7], v[96:99]
    buffer_load_dwordx4 a[88:91], v13, s[12:15], s43 offen offset:0 sc1
    v_mfma_f32_16x16x32_bf16 v[100:103], a[100:103], a[12:15], v[100:103]
    ds_read_b64_tr_b16 a[130:131], v26 offset:4096
    v_mfma_f32_16x16x32_bf16 v[100:103], a[96:99], a[8:11], v[100:103]
    v_mfma_f32_16x16x32_bf16 v[64:67], a[96:99], a[16:19], v[64:67]
    ds_read_b64_tr_b16 a[132:133], v26 offset:8192
    v_mfma_f32_16x16x32_bf16 v[64:67], a[100:103], a[20:23], v[64:67]
    buffer_load_dwordx4 a[92:95], v13, s[12:15], s43 offen offset:2048 sc1
    s_add_u32 s43, s43, 4096
    v_mfma_f32_16x16x32_bf16 v[68:71], a[100:103], a[28:31], v[68:71]
    ds_read_b64_tr_b16 a[134:135], v26 offset:12288
    v_mfma_f32_16x16x32_bf16 v[68:71], a[96:99], a[24:27], v[68:71]
    s_waitcnt lgkmcnt(4)
    v_mfma_f32_16x16x32_bf16 v[76:79], a[104:107], a[24:27], v[76:79]
    ds_read_b64_tr_b16 a[136:137], v27 offset:0
    v_mfma_f32_16x16x32_bf16 v[76:79], a[108:111], a[28:31], v[76:79]
L_pg19:
    s_cbranch_execz L_tramp
    v_mfma_f32_16x16x32_bf16 v[72:75], a[108:111], a[20:23], v[72:75]
    ds_read_b64_tr_b16 a[138:139], v27 offset:4096
    v_mfma_f32_16x16x32_bf16 v[72:75], a[104:107], a[16:19], v[72:75]
    buffer_load_dwordx4 a[160:163], v12, s[12:15], s43 offen offset:0 sc1
    v_mfma_f32_16x16x32_bf16 v[108:111], a[104:107], a[8:11], v[108:111]
    ds_read_b64_tr_b16 a[140:141], v27 offset:8192
    v_mfma_f32_16x16x32_bf16 v[108:111], a[108:111], a[12:15], v[108:111]
    v_mfma_f32_16x16x32_bf16 v[104:107], a[108:111], a[4:7], v[104:107]
    ds_read_b64_tr_b16 a[142:143], v27 offset:12288
    v_mfma_f32_16x16x32_bf16 v[104:107], a[104:107], a[0:3], v[104:107]
    s_waitcnt lgkmcnt(4)
    v_mfma_f32_16x16x32_bf16 v[112:115], a[128:131], a[0:3], v[112:115]
    ds_read_b64_tr_b16 a[96:97], v28 offset:0
    v_mfma_f32_16x16x32_bf16 v[112:115], a[132:135], a[4:7], v[112:115]
    buffer_load_dwordx4 a[164:167], v12, s[12:15], s43 offen offset:2048 sc1
    v_mfma_f32_16x16x32_bf16 v[116:119], a[132:135], a[12:15], v[116:119]
    ds_read_b64_tr_b16 a[98:99], v28 offset:4096
    v_mfma_f32_16x16x32_bf16 v[116:119], a[128:131], a[8:11], v[116:119]
    v_mfma_f32_16x16x32_bf16 v[80:83], a[128:131], a[16:19], v[80:83]
    ds_read_b64_tr_b16 a[100:101], v28 offset:8192
    v_mfma_f32_16x16x32_bf16 v[80:83], a[132:135], a[20:23], v[80:83]
    buffer_load_dwordx4 a[168:171], v13, s[12:15], s43 offen offset:0 sc1
    v_mfma_f32_16x16x32_bf16 v[84:87], a[132:135], a[28:31], v[84:87]
    ds_read_b64_tr_b16 a[102:103], v28 offset:12288
    v_mfma_f32_16x16x32_bf16 v[84:87], a[128:131], a[24:27], v[84:87]
    s_waitcnt lgkmcnt(4)
    v_mfma_f32_16x16x32_bf16 v[92:95], a[136:139], a[24:27], v[92:95]
    ds_read_b64_tr_b16 a[104:105], v29 offset:0
    v_mfma_f32_16x16x32_bf16 v[92:95], a[140:143], a[28:31], v[92:95]
    buffer_load_dwordx4 a[172:175], v13, s[12:15], s43 offen offset:2048 sc1
    s_add_u32 s43, s43, s36
    v_mfma_f32_16x16x32_bf16 v[88:91], a[140:143], a[20:23], v[88:91]
    ds_read_b64_tr_b16 a[106:107], v29 offset:4096
    v_mfma_f32_16x16x32_bf16 v[88:91], a[136:139], a[16:19], v[88:91]
    v_mfma_f32_16x16x32_bf16 v[124:127], a[136:139], a[8:11], v[124:127]
    ds_read_b64_tr_b16 a[108:109], v29 offset:8192
    v_mfma_f32_16x16x32_bf16 v[124:127], a[140:143], a[12:15], v[124:127]
    s_add_u32 m0, s63, 98304
    s_add_u32 s47, s98, 0x0
    buffer_load_dwordx4 v2, s[68:71], s47 offen offset:0 lds
    v_mfma_f32_16x16x32_bf16 v[120:123], a[140:143], a[4:7], v[120:123]
    ds_read_b64_tr_b16 a[110:111], v29 offset:12288
    v_mfma_f32_16x16x32_bf16 v[120:123], a[136:139], a[0:3], v[120:123]
    s_barrier
    s_waitcnt lgkmcnt(4)
    v_mfma_f32_16x16x32_bf16 v[160:163], a[96:99], a[0:3], v[160:163]
    ds_read_b64_tr_b16 a[128:129], v30 offset:0
    v_mfma_f32_16x16x32_bf16 v[160:163], a[100:103], a[4:7], v[160:163]
    buffer_load_dwordx4 v3, s[68:71], s47 offen offset:1024 lds
    v_mfma_f32_16x16x32_bf16 v[164:167], a[100:103], a[12:15], v[164:167]
    ds_read_b64_tr_b16 a[130:131], v30 offset:4096
    v_mfma_f32_16x16x32_bf16 v[164:167], a[96:99], a[8:11], v[164:167]
    v_mfma_f32_16x16x32_bf16 v[128:131], a[96:99], a[16:19], v[128:131]
    ds_read_b64_tr_b16 a[132:133], v30 offset:8192
    s_waitcnt vmcnt(34)
    v_mfma_f32_16x16x32_bf16 v[128:131], a[100:103], a[20:23], v[128:131]
    buffer_load_dwordx4 v4, s[68:71], s47 offen offset:2048 lds
    v_sub_f32 v48, 1.0, v48
    v_mfma_f32_16x16x32_bf16 v[132:135], a[100:103], a[28:31], v[132:135]
    ds_read_b64_tr_b16 a[134:135], v30 offset:12288
    v_mfma_f32_16x16x32_bf16 v[132:135], a[96:99], a[24:27], v[132:135]
    s_waitcnt lgkmcnt(4)
    v_sub_f32 v49, 1.0, v49
    v_mfma_f32_16x16x32_bf16 v[140:143], a[104:107], a[24:27], v[140:143]
    ds_read_b64_tr_b16 a[136:137], v31 offset:0
    v_mfma_f32_16x16x32_bf16 v[140:143], a[108:111], a[28:31], v[140:143]
    v_sub_f32 v50, 1.0, v50
    v_mfma_f32_16x16x32_bf16 v[136:139], a[108:111], a[20:23], v[136:139]
    ds_read_b64_tr_b16 a[138:139], v31 offset:4096
    v_mfma_f32_16x16x32_bf16 v[136:139], a[104:107], a[16:19], v[136:139]
    buffer_load_dwordx4 v5, s[68:71], s47 offen offset:3072 lds
    v_sub_f32 v51, 1.0, v51
    v_mfma_f32_16x16x32_bf16 v[172:175], a[104:107], a[8:11], v[172:175]
    ds_read_b64_tr_b16 a[140:141], v31 offset:8192
    v_mfma_f32_16x16x32_bf16 v[172:175], a[108:111], a[12:15], v[172:175]
    v_mfma_f32_16x16x32_bf16 v[168:171], a[108:111], a[4:7], v[168:171]
    ds_read_b64_tr_b16 a[142:143], v31 offset:12288
    v_mfma_f32_16x16x32_bf16 v[168:171], a[104:107], a[0:3], v[168:171]
    s_waitcnt lgkmcnt(4)
    v_mfma_f32_16x16x32_bf16 v[176:179], a[128:131], a[0:3], v[176:179]
    ds_read_b64_tr_b16 a[96:97], v28 offset:16384
    ds_read_b64_tr_b16 a[98:99], v28 offset:20480
    v_mfma_f32_16x16x32_bf16 v[176:179], a[132:135], a[4:7], v[176:179]
    s_add_u32 m0, s63, 114688
    s_add_u32 s47, s98, 0x20000
    buffer_load_dwordx4 v2, s[68:71], s47 offen offset:0 lds
    v_mfma_f32_16x16x32_bf16 v[180:183], a[132:135], a[12:15], v[180:183]
    ds_read_b64_tr_b16 a[100:101], v28 offset:24576
    ds_read_b64_tr_b16 a[102:103], v28 offset:28672
    v_mfma_f32_16x16x32_bf16 v[180:183], a[128:131], a[8:11], v[180:183]
    v_mfma_f32_16x16x32_bf16 v[144:147], a[128:131], a[16:19], v[144:147]
    ds_read_b64_tr_b16 a[104:105], v29 offset:16384
    ds_read_b64_tr_b16 a[106:107], v29 offset:20480
    v_mfma_f32_16x16x32_bf16 v[144:147], a[132:135], a[20:23], v[144:147]
    buffer_load_dwordx4 v3, s[68:71], s47 offen offset:1024 lds
    v_mfma_f32_16x16x32_bf16 v[148:151], a[132:135], a[28:31], v[148:151]
    ds_read_b64_tr_b16 a[108:109], v29 offset:24576
    ds_read_b64_tr_b16 a[110:111], v29 offset:28672
    v_mfma_f32_16x16x32_bf16 v[148:151], a[128:131], a[24:27], v[148:151]
    s_waitcnt lgkmcnt(8)
    v_mfma_f32_16x16x32_bf16 v[156:159], a[136:139], a[24:27], v[156:159]
    ds_read_b64_tr_b16 a[112:113], v30 offset:16384
    ds_read_b64_tr_b16 a[114:115], v30 offset:20480
    v_mfma_f32_16x16x32_bf16 v[156:159], a[140:143], a[28:31], v[156:159]
    buffer_load_dwordx4 v4, s[68:71], s47 offen offset:2048 lds
    v_mfma_f32_16x16x32_bf16 v[152:155], a[140:143], a[20:23], v[152:155]
    ds_read_b64_tr_b16 a[116:117], v30 offset:24576
    ds_read_b64_tr_b16 a[118:119], v30 offset:28672
    v_mfma_f32_16x16x32_bf16 v[152:155], a[136:139], a[16:19], v[152:155]
    v_mfma_f32_16x16x32_bf16 v[188:191], a[136:139], a[8:11], v[188:191]
    ds_read_b64_tr_b16 a[120:121], v31 offset:16384
    ds_read_b64_tr_b16 a[122:123], v31 offset:20480
    v_mfma_f32_16x16x32_bf16 v[188:191], a[140:143], a[12:15], v[188:191]
    buffer_load_dwordx4 v5, s[68:71], s47 offen offset:3072 lds
    v_mfma_f32_16x16x32_bf16 v[184:187], a[140:143], a[4:7], v[184:187]
    ds_read_b64_tr_b16 a[124:125], v31 offset:24576
    ds_read_b64_tr_b16 a[126:127], v31 offset:28672
    v_mfma_f32_16x16x32_bf16 v[184:187], a[136:139], a[0:3], v[184:187]
    s_waitcnt vmcnt(32)
    s_barrier
    s_waitcnt lgkmcnt(12)
    v_mfma_f32_16x16x32_bf16 v[160:163], a[96:99], a[32:35], v[160:163]
    ds_read_b64_tr_b16 a[128:129], v28 offset:32768
    ds_read_b64_tr_b16 a[130:131], v28 offset:36864
    v_mfma_f32_16x16x32_bf16 v[160:163], a[100:103], a[36:39], v[160:163]
    buffer_load_dwordx4 a[176:179], v12, s[12:15], s43 offen offset:0 sc1
    v_mfma_f32_16x16x32_bf16 v[164:167], a[100:103], a[44:47], v[164:167]
    ds_read_b64_tr_b16 a[132:133], v28 offset:40960
    ds_read_b64_tr_b16 a[134:135], v28 offset:45056
    v_mfma_f32_16x16x32_bf16 v[164:167], a[96:99], a[40:43], v[164:167]
    s_waitcnt lgkmcnt(12)
    v_mfma_f32_16x16x32_bf16 v[172:175], a[104:107], a[40:43], v[172:175]
    ds_read_b64_tr_b16 a[136:137], v29 offset:32768
    ds_read_b64_tr_b16 a[138:139], v29 offset:36864
    v_mfma_f32_16x16x32_bf16 v[172:175], a[108:111], a[44:47], v[172:175]
    buffer_load_dwordx4 a[180:183], v12, s[12:15], s43 offen offset:2048 sc1
    v_mfma_f32_16x16x32_bf16 v[168:171], a[108:111], a[36:39], v[168:171]
    ds_read_b64_tr_b16 a[140:141], v29 offset:40960
    ds_read_b64_tr_b16 a[142:143], v29 offset:45056
    v_mfma_f32_16x16x32_bf16 v[168:171], a[104:107], a[32:35], v[168:171]
    s_waitcnt lgkmcnt(12)
    v_mfma_f32_16x16x32_bf16 v[176:179], a[112:115], a[32:35], v[176:179]
    ds_read_b64_tr_b16 a[144:145], v30 offset:32768
    ds_read_b64_tr_b16 a[146:147], v30 offset:36864
    v_mfma_f32_16x16x32_bf16 v[176:179], a[116:119], a[36:39], v[176:179]
    v_mfma_f32_16x16x32_bf16 v[180:183], a[116:119], a[44:47], v[180:183]
    ds_read_b64_tr_b16 a[148:149], v30 offset:40960
    ds_read_b64_tr_b16 a[150:151], v30 offset:45056
    v_mfma_f32_16x16x32_bf16 v[180:183], a[112:115], a[40:43], v[180:183]
    s_waitcnt lgkmcnt(12)
    buffer_load_dwordx4 a[184:187], v13, s[12:15], s43 offen offset:0 sc1
    v_mfma_f32_16x16x32_bf16 v[188:191], a[120:123], a[40:43], v[188:191]
    ds_read_b64_tr_b16 a[152:153], v31 offset:32768
    ds_read_b64_tr_b16 a[154:155], v31 offset:36864
    v_mfma_f32_16x16x32_bf16 v[188:191], a[124:127], a[44:47], v[188:191]
    v_mfma_f32_16x16x32_bf16 v[184:187], a[124:127], a[36:39], v[184:187]
    ds_read_b64_tr_b16 a[156:157], v31 offset:40960
    ds_read_b64_tr_b16 a[158:159], v31 offset:45056
    v_mfma_f32_16x16x32_bf16 v[184:187], a[120:123], a[32:35], v[184:187]
    s_waitcnt vmcnt(31) lgkmcnt(12)
    v_mfma_f32_16x16x32_bf16 v[160:163], a[128:131], a[48:51], v[160:163]
    ds_read_b64_tr_b16 a[96:97], v28 offset:49152
    ds_read_b64_tr_b16 a[98:99], v28 offset:53248
    v_mfma_f32_16x16x32_bf16 v[160:163], a[132:135], a[52:55], v[160:163]
    buffer_load_dwordx4 a[188:191], v13, s[12:15], s43 offen offset:2048 sc1
    s_add_u32 s43, s43, 4096
    v_mfma_f32_16x16x32_bf16 v[164:167], a[132:135], a[60:63], v[164:167]
    ds_read_b64_tr_b16 a[100:101], v28 offset:57344
    ds_read_b64_tr_b16 a[102:103], v28 offset:61440
    v_mfma_f32_16x16x32_bf16 v[164:167], a[128:131], a[56:59], v[164:167]
    s_waitcnt lgkmcnt(12)
    v_mfma_f32_16x16x32_bf16 v[172:175], a[136:139], a[56:59], v[172:175]
    ds_read_b64_tr_b16 a[104:105], v29 offset:49152
    ds_read_b64_tr_b16 a[106:107], v29 offset:53248
    v_mfma_f32_16x16x32_bf16 v[172:175], a[140:143], a[60:63], v[172:175]
    buffer_load_dwordx4 a[192:195], v12, s[12:15], s43 offen offset:0 sc1
    v_mfma_f32_16x16x32_bf16 v[168:171], a[140:143], a[52:55], v[168:171]
    ds_read_b64_tr_b16 a[108:109], v29 offset:57344
    ds_read_b64_tr_b16 a[110:111], v29 offset:61440
    v_mfma_f32_16x16x32_bf16 v[168:171], a[136:139], a[48:51], v[168:171]
    s_waitcnt lgkmcnt(12)
    v_mfma_f32_16x16x32_bf16 v[176:179], a[144:147], a[48:51], v[176:179]
    ds_read_b64_tr_b16 a[112:113], v30 offset:49152
    ds_read_b64_tr_b16 a[114:115], v30 offset:53248
    v_mfma_f32_16x16x32_bf16 v[176:179], a[148:151], a[52:55], v[176:179]
    buffer_load_dwordx4 a[196:199], v12, s[12:15], s43 offen offset:2048 sc1
    v_mfma_f32_16x16x32_bf16 v[180:183], a[148:151], a[60:63], v[180:183]
    ds_read_b64_tr_b16 a[116:117], v30 offset:57344
    ds_read_b64_tr_b16 a[118:119], v30 offset:61440
    v_mfma_f32_16x16x32_bf16 v[180:183], a[144:147], a[56:59], v[180:183]
    s_waitcnt lgkmcnt(12)
    v_mfma_f32_16x16x32_bf16 v[188:191], a[152:155], a[56:59], v[188:191]
    ds_read_b64_tr_b16 a[120:121], v31 offset:49152
    ds_read_b64_tr_b16 a[122:123], v31 offset:53248
    v_mfma_f32_16x16x32_bf16 v[188:191], a[156:159], a[60:63], v[188:191]
    buffer_load_dwordx4 a[200:203], v13, s[12:15], s43 offen offset:0 sc1
    v_mfma_f32_16x16x32_bf16 v[184:187], a[156:159], a[52:55], v[184:187]
    ds_read_b64_tr_b16 a[124:125], v31 offset:57344
    ds_read_b64_tr_b16 a[126:127], v31 offset:61440
    v_mfma_f32_16x16x32_bf16 v[184:187], a[152:155], a[48:51], v[184:187]
    s_waitcnt vmcnt(23)
    s_barrier
    s_waitcnt lgkmcnt(12)
    v_mfma_f32_16x16x32_bf16 v[160:163], a[96:99], a[64:67], v[160:163]
    ds_read_b64_tr_b16 a[128:129], v36 offset:0
    ds_read_b64_tr_b16 a[130:131], v36 offset:4096
    v_mfma_f32_16x16x32_bf16 v[160:163], a[100:103], a[68:71], v[160:163]
    buffer_load_dwordx4 a[204:207], v13, s[12:15], s43 offen offset:2048 sc1
    s_add_u32 s43, s43, 4096
    v_mfma_f32_16x16x32_bf16 v[164:167], a[100:103], a[76:79], v[164:167]
    ds_read_b64_tr_b16 a[132:133], v36 offset:8192
    ds_read_b64_tr_b16 a[134:135], v36 offset:12288
    v_mfma_f32_16x16x32_bf16 v[164:167], a[96:99], a[72:75], v[164:167]
    s_waitcnt lgkmcnt(12)
    v_mfma_f32_16x16x32_bf16 v[172:175], a[104:107], a[72:75], v[172:175]
    ds_read_b64_tr_b16 a[136:137], v37 offset:0
    ds_read_b64_tr_b16 a[138:139], v37 offset:4096
    v_mfma_f32_16x16x32_bf16 v[172:175], a[108:111], a[76:79], v[172:175]
    s_add_u32 m0, s63, 131072
    s_add_u32 s47, s98, 0x40000
    buffer_load_dwordx4 v2, s[68:71], s47 offen offset:0 lds
    v_mfma_f32_16x16x32_bf16 v[168:171], a[108:111], a[68:71], v[168:171]
    ds_read_b64_tr_b16 a[140:141], v37 offset:8192
    ds_read_b64_tr_b16 a[142:143], v37 offset:12288
    v_mfma_f32_16x16x32_bf16 v[168:171], a[104:107], a[64:67], v[168:171]
    s_waitcnt lgkmcnt(12)
    v_mfma_f32_16x16x32_bf16 v[176:179], a[112:115], a[64:67], v[176:179]
    ds_read_b64_tr_b16 a[144:145], v38 offset:0
    ds_read_b64_tr_b16 a[146:147], v38 offset:4096
    v_mfma_f32_16x16x32_bf16 v[176:179], a[116:119], a[68:71], v[176:179]
    v_mfma_f32_16x16x32_bf16 v[180:183], a[116:119], a[76:79], v[180:183]
    ds_read_b64_tr_b16 a[148:149], v38 offset:8192
    ds_read_b64_tr_b16 a[150:151], v38 offset:12288
    v_mfma_f32_16x16x32_bf16 v[180:183], a[112:115], a[72:75], v[180:183]
    s_waitcnt lgkmcnt(12)
    buffer_load_dwordx4 v3, s[68:71], s47 offen offset:1024 lds
    v_mfma_f32_16x16x32_bf16 v[188:191], a[120:123], a[72:75], v[188:191]
    ds_read_b64_tr_b16 a[152:153], v39 offset:0
    ds_read_b64_tr_b16 a[154:155], v39 offset:4096
    v_mfma_f32_16x16x32_bf16 v[188:191], a[124:127], a[76:79], v[188:191]
    v_mfma_f32_16x16x32_bf16 v[184:187], a[124:127], a[68:71], v[184:187]
    ds_read_b64_tr_b16 a[156:157], v39 offset:8192
    ds_read_b64_tr_b16 a[158:159], v39 offset:12288
    v_mfma_f32_16x16x32_bf16 v[184:187], a[120:123], a[64:67], v[184:187]
    s_waitcnt vmcnt(22) lgkmcnt(12)
    v_mfma_f32_16x16x32_bf16 v[160:163], a[128:131], a[80:83], v[160:163]
    ds_read_b64_tr_b16 a[96:97], v36 offset:16384
    ds_read_b64_tr_b16 a[98:99], v36 offset:20480
    v_mfma_f32_16x16x32_bf16 v[160:163], a[132:135], a[84:87], v[160:163]
    buffer_load_dwordx4 v4, s[68:71], s47 offen offset:2048 lds
    v_mfma_f32_16x16x32_bf16 v[164:167], a[132:135], a[92:95], v[164:167]
    ds_read_b64_tr_b16 a[100:101], v36 offset:24576
    ds_read_b64_tr_b16 a[102:103], v36 offset:28672
    v_mfma_f32_16x16x32_bf16 v[164:167], a[128:131], a[88:91], v[164:167]
    s_waitcnt lgkmcnt(12)
    v_mfma_f32_16x16x32_bf16 v[172:175], a[136:139], a[88:91], v[172:175]
    ds_read_b64_tr_b16 a[104:105], v37 offset:16384
    ds_read_b64_tr_b16 a[106:107], v37 offset:20480
    v_mfma_f32_16x16x32_bf16 v[172:175], a[140:143], a[92:95], v[172:175]
    buffer_load_dwordx4 v5, s[68:71], s47 offen offset:3072 lds
    v_mfma_f32_16x16x32_bf16 v[168:171], a[140:143], a[84:87], v[168:171]
    ds_read_b64_tr_b16 a[108:109], v37 offset:24576
    ds_read_b64_tr_b16 a[110:111], v37 offset:28672
    v_mfma_f32_16x16x32_bf16 v[168:171], a[136:139], a[80:83], v[168:171]
    s_waitcnt lgkmcnt(12)
    v_mfma_f32_16x16x32_bf16 v[176:179], a[144:147], a[80:83], v[176:179]
    ds_read_b64_tr_b16 a[112:113], v38 offset:16384
    ds_read_b64_tr_b16 a[114:115], v38 offset:20480
    v_mfma_f32_16x16x32_bf16 v[176:179], a[148:151], a[84:87], v[176:179]
    buffer_load_dwordx4 a[208:211], v12, s[12:15], s43 offen offset:0 sc1
    v_mfma_f32_16x16x32_bf16 v[180:183], a[148:151], a[92:95], v[180:183]
    ds_read_b64_tr_b16 a[116:117], v38 offset:24576
    ds_read_b64_tr_b16 a[118:119], v38 offset:28672
    v_mfma_f32_16x16x32_bf16 v[180:183], a[144:147], a[88:91], v[180:183]
    s_waitcnt lgkmcnt(12)
    v_mfma_f32_16x16x32_bf16 v[188:191], a[152:155], a[88:91], v[188:191]
    ds_read_b64_tr_b16 a[120:121], v39 offset:16384
    ds_read_b64_tr_b16 a[122:123], v39 offset:20480
    v_mfma_f32_16x16x32_bf16 v[188:191], a[156:159], a[92:95], v[188:191]
    buffer_load_dwordx4 a[212:215], v12, s[12:15], s43 offen offset:2048 sc1
    v_mfma_f32_16x16x32_bf16 v[184:187], a[156:159], a[84:87], v[184:187]
    ds_read_b64_tr_b16 a[124:125], v39 offset:24576
    ds_read_b64_tr_b16 a[126:127], v39 offset:28672
    v_mfma_f32_16x16x32_bf16 v[184:187], a[152:155], a[80:83], v[184:187]
    s_waitcnt vmcnt(14)
    s_barrier
    s_waitcnt lgkmcnt(12)
    v_mfma_f32_16x16x32_bf16 v[160:163], a[96:99], a[160:163], v[160:163]
    ds_read_b64_tr_b16 a[128:129], v36 offset:32768
    ds_read_b64_tr_b16 a[130:131], v36 offset:36864
    v_mfma_f32_16x16x32_bf16 v[160:163], a[100:103], a[164:167], v[160:163]
    buffer_load_dwordx4 a[216:219], v13, s[12:15], s43 offen offset:0 sc1
    v_mfma_f32_16x16x32_bf16 v[164:167], a[100:103], a[172:175], v[164:167]
    ds_read_b64_tr_b16 a[132:133], v36 offset:40960
    ds_read_b64_tr_b16 a[134:135], v36 offset:45056
    v_mfma_f32_16x16x32_bf16 v[164:167], a[96:99], a[168:171], v[164:167]
    s_waitcnt lgkmcnt(12)
    v_mfma_f32_16x16x32_bf16 v[172:175], a[104:107], a[168:171], v[172:175]
    ds_read_b64_tr_b16 a[136:137], v37 offset:32768
    ds_read_b64_tr_b16 a[138:139], v37 offset:36864
    v_mfma_f32_16x16x32_bf16 v[172:175], a[108:111], a[172:175], v[172:175]
    buffer_load_dwordx4 a[220:223], v13, s[12:15], s43 offen offset:2048 sc1
    s_add_u32 s43, s43, 4096
    v_mfma_f32_16x16x32_bf16 v[168:171], a[108:111], a[164:167], v[168:171]
    ds_read_b64_tr_b16 a[140:141], v37 offset:40960
    ds_read_b64_tr_b16 a[142:143], v37 offset:45056
    v_mul_f32 v160, v50, v160
    v_mfma_f32_16x16x32_bf16 v[168:171], a[104:107], a[160:163], v[168:171]
    s_waitcnt lgkmcnt(12)
    v_mul_f32 v161, v50, v161
    v_mfma_f32_16x16x32_bf16 v[176:179], a[112:115], a[160:163], v[176:179]
    ds_read_b64_tr_b16 a[144:145], v38 offset:32768
    ds_read_b64_tr_b16 a[146:147], v38 offset:36864
    v_mul_f32 v162, v50, v162
    v_mfma_f32_16x16x32_bf16 v[176:179], a[116:119], a[164:167], v[176:179]
    v_mul_f32 v163, v50, v163
    v_mfma_f32_16x16x32_bf16 v[180:183], a[116:119], a[172:175], v[180:183]
    ds_read_b64_tr_b16 a[148:149], v38 offset:40960
    ds_read_b64_tr_b16 a[150:151], v38 offset:45056
    v_mul_f32 v164, v51, v164
    v_mul_f32 v168, v50, v168
    v_mfma_f32_16x16x32_bf16 v[180:183], a[112:115], a[168:171], v[180:183]
    s_waitcnt lgkmcnt(12)
    buffer_load_dwordx4 a[224:227], v12, s[12:15], s42 offen offset:0 sc1
    v_mul_f32 v165, v51, v165
    v_mul_f32 v169, v50, v169
    v_mfma_f32_16x16x32_bf16 v[188:191], a[120:123], a[168:171], v[188:191]
    ds_read_b64_tr_b16 a[152:153], v39 offset:32768
    ds_read_b64_tr_b16 a[154:155], v39 offset:36864
    v_mul_f32 v166, v51, v166
    v_mul_f32 v170, v50, v170
    v_mfma_f32_16x16x32_bf16 v[188:191], a[124:127], a[172:175], v[188:191]
    v_mul_f32 v167, v51, v167
    v_mul_f32 v171, v50, v171
    v_mfma_f32_16x16x32_bf16 v[184:187], a[124:127], a[164:167], v[184:187]
    ds_read_b64_tr_b16 a[156:157], v39 offset:40960
    ds_read_b64_tr_b16 a[158:159], v39 offset:45056
    v_mul_f32 v172, v51, v172
    v_mul_f32 v176, v50, v176
    v_mfma_f32_16x16x32_bf16 v[184:187], a[120:123], a[160:163], v[184:187]
    v_mul_f32 v173, v51, v173
    v_mul_f32 v177, v50, v177
    s_waitcnt vmcnt(13) lgkmcnt(12)
    v_mfma_f32_16x16x32_bf16 v[160:163], a[128:131], a[176:179], v[160:163]
    ds_read_b64_tr_b16 a[96:97], v36 offset:49152
    ds_read_b64_tr_b16 a[98:99], v36 offset:53248
    v_mul_f32 v174, v51, v174
    v_mul_f32 v178, v50, v178
    v_mfma_f32_16x16x32_bf16 v[160:163], a[132:135], a[180:183], v[160:163]
    buffer_load_dwordx4 a[228:231], v12, s[12:15], s42 offen offset:2048 sc1
    v_mul_f32 v175, v51, v175
    v_mul_f32 v179, v50, v179
    v_mfma_f32_16x16x32_bf16 v[164:167], a[132:135], a[188:191], v[164:167]
    ds_read_b64_tr_b16 a[100:101], v36 offset:57344
    ds_read_b64_tr_b16 a[102:103], v36 offset:61440
    v_mul_f32 v180, v51, v180
    v_mul_f32 v184, v50, v184
    v_mfma_f32_16x16x32_bf16 v[164:167], a[128:131], a[184:187], v[164:167]
    s_waitcnt lgkmcnt(12)
    v_mul_f32 v181, v51, v181
    v_mul_f32 v185, v50, v185
    v_mfma_f32_16x16x32_bf16 v[172:175], a[136:139], a[184:187], v[172:175]
    ds_read_b64_tr_b16 a[104:105], v37 offset:49152
    ds_read_b64_tr_b16 a[106:107], v37 offset:53248
    v_mul_f32 v182, v51, v182
    v_mul_f32 v186, v50, v186
    v_mfma_f32_16x16x32_bf16 v[172:175], a[140:143], a[188:191], v[172:175]
    buffer_load_dwordx4 a[232:235], v13, s[12:15], s42 offen offset:0 sc1
    v_mul_f32 v183, v51, v183
    v_mul_f32 v187, v50, v187
    v_mfma_f32_16x16x32_bf16 v[168:171], a[140:143], a[180:183], v[168:171]
    ds_read_b64_tr_b16 a[108:109], v37 offset:57344
    ds_read_b64_tr_b16 a[110:111], v37 offset:61440
    v_mul_f32 v188, v51, v188
    v_mfma_f32_16x16x32_bf16 v[168:171], a[136:139], a[176:179], v[168:171]
    s_waitcnt lgkmcnt(12)
    v_mul_f32 v189, v51, v189
    v_mfma_f32_16x16x32_bf16 v[176:179], a[144:147], a[176:179], v[176:179]
    ds_read_b64_tr_b16 a[112:113], v38 offset:49152
    ds_read_b64_tr_b16 a[114:115], v38 offset:53248
    v_mul_f32 v190, v51, v190
    v_mfma_f32_16x16x32_bf16 v[176:179], a[148:151], a[180:183], v[176:179]
    buffer_load_dwordx4 a[236:239], v13, s[12:15], s42 offen offset:2048 sc1
    s_add_u32 s42, s42, 4096
    v_mul_f32 v191, v51, v191
    v_mfma_f32_16x16x32_bf16 v[180:183], a[148:151], a[188:191], v[180:183]
    ds_read_b64_tr_b16 a[116:117], v38 offset:57344
    ds_read_b64_tr_b16 a[118:119], v38 offset:61440
    v_mfma_f32_16x16x32_bf16 v[180:183], a[144:147], a[184:187], v[180:183]
    s_waitcnt lgkmcnt(12)
    v_mfma_f32_16x16x32_bf16 v[188:191], a[152:155], a[184:187], v[188:191]
    ds_read_b64_tr_b16 a[120:121], v39 offset:49152
    ds_read_b64_tr_b16 a[122:123], v39 offset:53248
    v_mfma_f32_16x16x32_bf16 v[188:191], a[156:159], a[188:191], v[188:191]
    buffer_load_dwordx4 a[240:243], v12, s[12:15], s42 offen offset:0 sc1
    v_mfma_f32_16x16x32_bf16 v[184:187], a[156:159], a[180:183], v[184:187]
    ds_read_b64_tr_b16 a[124:125], v39 offset:57344
    ds_read_b64_tr_b16 a[126:127], v39 offset:61440
    v_mfma_f32_16x16x32_bf16 v[184:187], a[152:155], a[176:179], v[184:187]
    s_waitcnt vmcnt(9)
    s_barrier
    s_waitcnt lgkmcnt(12)
    v_mfma_f32_16x16x32_bf16 v[160:163], a[96:99], a[192:195], v[160:163]
    ds_read_b64_tr_b16 a[128:129], v44 offset:0
    ds_read_b64_tr_b16 a[130:131], v44 offset:4096
    v_mfma_f32_16x16x32_bf16 v[160:163], a[100:103], a[196:199], v[160:163]
    buffer_load_dwordx4 a[244:247], v12, s[12:15], s42 offen offset:2048 sc1
    v_mfma_f32_16x16x32_bf16 v[164:167], a[100:103], a[204:207], v[164:167]
    ds_read_b64_tr_b16 a[132:133], v44 offset:8192
    ds_read_b64_tr_b16 a[134:135], v44 offset:12288
    v_mfma_f32_16x16x32_bf16 v[164:167], a[96:99], a[200:203], v[164:167]
    s_waitcnt lgkmcnt(12)
    v_mfma_f32_16x16x32_bf16 v[172:175], a[104:107], a[200:203], v[172:175]
    ds_read_b64_tr_b16 a[136:137], v45 offset:0
    ds_read_b64_tr_b16 a[138:139], v45 offset:4096
    v_mfma_f32_16x16x32_bf16 v[172:175], a[108:111], a[204:207], v[172:175]
    buffer_load_dwordx4 a[248:251], v13, s[12:15], s42 offen offset:0 sc1
    v_mfma_f32_16x16x32_bf16 v[168:171], a[108:111], a[196:199], v[168:171]
    ds_read_b64_tr_b16 a[140:141], v45 offset:8192
    ds_read_b64_tr_b16 a[142:143], v45 offset:12288
    v_mfma_f32_16x16x32_bf16 v[168:171], a[104:107], a[192:195], v[168:171]
    s_waitcnt lgkmcnt(12)
    v_mfma_f32_16x16x32_bf16 v[176:179], a[112:115], a[192:195], v[176:179]
    ds_read_b64_tr_b16 a[144:145], v46 offset:0
    ds_read_b64_tr_b16 a[146:147], v46 offset:4096
    v_mfma_f32_16x16x32_bf16 v[176:179], a[116:119], a[196:199], v[176:179]
    v_mfma_f32_16x16x32_bf16 v[180:183], a[116:119], a[204:207], v[180:183]
    ds_read_b64_tr_b16 a[148:149], v46 offset:8192
    ds_read_b64_tr_b16 a[150:151], v46 offset:12288
    v_mfma_f32_16x16x32_bf16 v[180:183], a[112:115], a[200:203], v[180:183]
    s_waitcnt lgkmcnt(12)
    buffer_load_dwordx4 a[252:255], v13, s[12:15], s42 offen offset:2048 sc1
    s_add_u32 s42, s42, 4096
    v_mfma_f32_16x16x32_bf16 v[188:191], a[120:123], a[200:203], v[188:191]
    ds_read_b64_tr_b16 a[152:153], v47 offset:0
    ds_read_b64_tr_b16 a[154:155], v47 offset:4096
    v_mfma_f32_16x16x32_bf16 v[188:191], a[124:127], a[204:207], v[188:191]
    v_mfma_f32_16x16x32_bf16 v[184:187], a[124:127], a[196:199], v[184:187]
    ds_read_b64_tr_b16 a[156:157], v47 offset:8192
    ds_read_b64_tr_b16 a[158:159], v47 offset:12288
    v_mfma_f32_16x16x32_bf16 v[184:187], a[120:123], a[192:195], v[184:187]
    s_waitcnt vmcnt(8) lgkmcnt(12)
    v_mfma_f32_16x16x32_bf16 v[160:163], a[128:131], a[208:211], v[160:163]
    ds_read_b64_tr_b16 a[96:97], v24 offset:16384
    ds_read_b64_tr_b16 a[98:99], v24 offset:20480
    v_mfma_f32_16x16x32_bf16 v[160:163], a[132:135], a[212:215], v[160:163]
    buffer_load_dwordx4 v[192:195], v12, s[12:15], s42 offen offset:0 sc1
    v_mfma_f32_16x16x32_bf16 v[164:167], a[132:135], a[220:223], v[164:167]
    ds_read_b64_tr_b16 a[100:101], v24 offset:24576
    ds_read_b64_tr_b16 a[102:103], v24 offset:28672
    v_mfma_f32_16x16x32_bf16 v[164:167], a[128:131], a[216:219], v[164:167]
    s_waitcnt lgkmcnt(12)
    v_mfma_f32_16x16x32_bf16 v[172:175], a[136:139], a[216:219], v[172:175]
    ds_read_b64_tr_b16 a[104:105], v25 offset:16384
    ds_read_b64_tr_b16 a[106:107], v25 offset:20480
    v_mfma_f32_16x16x32_bf16 v[172:175], a[140:143], a[220:223], v[172:175]
    buffer_load_dwordx4 v[196:199], v12, s[12:15], s42 offen offset:2048 sc1
    v_mfma_f32_16x16x32_bf16 v[168:171], a[140:143], a[212:215], v[168:171]
    ds_read_b64_tr_b16 a[108:109], v25 offset:24576
    ds_read_b64_tr_b16 a[110:111], v25 offset:28672
    v_mfma_f32_16x16x32_bf16 v[168:171], a[136:139], a[208:211], v[168:171]
    s_waitcnt lgkmcnt(12)
    v_mfma_f32_16x16x32_bf16 v[176:179], a[144:147], a[208:211], v[176:179]
    ds_read_b64_tr_b16 a[112:113], v26 offset:16384
    ds_read_b64_tr_b16 a[114:115], v26 offset:20480
    v_mfma_f32_16x16x32_bf16 v[176:179], a[148:151], a[212:215], v[176:179]
    v_mfma_f32_16x16x32_bf16 v[180:183], a[148:151], a[220:223], v[180:183]
    ds_read_b64_tr_b16 a[116:117], v26 offset:24576
    ds_read_b64_tr_b16 a[118:119], v26 offset:28672
    v_mfma_f32_16x16x32_bf16 v[180:183], a[144:147], a[216:219], v[180:183]
    s_waitcnt lgkmcnt(12)
    buffer_load_dwordx4 v[200:203], v13, s[12:15], s42 offen offset:0 sc1
    v_mfma_f32_16x16x32_bf16 v[188:191], a[152:155], a[216:219], v[188:191]
    ds_read_b64_tr_b16 a[120:121], v27 offset:16384
    ds_read_b64_tr_b16 a[122:123], v27 offset:20480
    v_mfma_f32_16x16x32_bf16 v[188:191], a[156:159], a[220:223], v[188:191]
    v_mfma_f32_16x16x32_bf16 v[184:187], a[156:159], a[212:215], v[184:187]
    ds_read_b64_tr_b16 a[124:125], v27 offset:24576
    ds_read_b64_tr_b16 a[126:127], v27 offset:28672
    v_mfma_f32_16x16x32_bf16 v[184:187], a[152:155], a[208:211], v[184:187]
    s_waitcnt lgkmcnt(12)
    v_mfma_f32_16x16x32_bf16 v[96:99], a[96:99], a[32:35], v[96:99]
    ds_read_b64_tr_b16 a[128:129], v24 offset:32768
    ds_read_b64_tr_b16 a[130:131], v24 offset:36864
    v_cvt_pk_bf16_f32 v160, v160, v161
    v_mfma_f32_16x16x32_bf16 v[96:99], a[100:103], a[36:39], v[96:99]
    v_cvt_pk_bf16_f32 v161, v162, v163
    v_mfma_f32_16x16x32_bf16 v[100:103], a[100:103], a[44:47], v[100:103]
    ds_read_b64_tr_b16 a[132:133], v24 offset:40960
    ds_read_b64_tr_b16 a[134:135], v24 offset:45056
    v_cvt_pk_bf16_f32 v162, v164, v165
    v_mfma_f32_16x16x32_bf16 v[100:103], a[96:99], a[40:43], v[100:103]
    s_waitcnt lgkmcnt(12)
    v_cvt_pk_bf16_f32 v163, v166, v167
    buffer_store_dwordx4 v[160:163], v6, s[12:15], s52 offen offset:0 sc1
    v_mfma_f32_16x16x32_bf16 v[108:111], a[104:107], a[40:43], v[108:111]
    ds_read_b64_tr_b16 a[136:137], v25 offset:32768
    ds_read_b64_tr_b16 a[138:139], v25 offset:36864
    v_cvt_pk_bf16_f32 v164, v168, v169
    v_mfma_f32_16x16x32_bf16 v[108:111], a[108:111], a[44:47], v[108:111]
    v_cvt_pk_bf16_f32 v165, v170, v171
    v_mfma_f32_16x16x32_bf16 v[104:107], a[108:111], a[36:39], v[104:107]
    ds_read_b64_tr_b16 a[140:141], v25 offset:40960
    ds_read_b64_tr_b16 a[142:143], v25 offset:45056
    v_cvt_pk_bf16_f32 v166, v172, v173
    v_mfma_f32_16x16x32_bf16 v[104:107], a[104:107], a[32:35], v[104:107]
    s_waitcnt lgkmcnt(12)
    v_cvt_pk_bf16_f32 v167, v174, v175
    buffer_store_dwordx4 v[164:167], v6, s[12:15], s52 offen offset:1024 sc1
    v_mfma_f32_16x16x32_bf16 v[112:115], a[112:115], a[32:35], v[112:115]
    ds_read_b64_tr_b16 a[144:145], v26 offset:32768
    ds_read_b64_tr_b16 a[146:147], v26 offset:36864
    v_cvt_pk_bf16_f32 v168, v176, v177
    v_mfma_f32_16x16x32_bf16 v[112:115], a[116:119], a[36:39], v[112:115]
    v_cvt_pk_bf16_f32 v169, v178, v179
    v_mfma_f32_16x16x32_bf16 v[116:119], a[116:119], a[44:47], v[116:119]
    ds_read_b64_tr_b16 a[148:149], v26 offset:40960
    ds_read_b64_tr_b16 a[150:151], v26 offset:45056
    v_cvt_pk_bf16_f32 v170, v180, v181
    v_mfma_f32_16x16x32_bf16 v[116:119], a[112:115], a[40:43], v[116:119]
    s_waitcnt lgkmcnt(12)
    v_cvt_pk_bf16_f32 v171, v182, v183
    buffer_store_dwordx4 v[168:171], v6, s[12:15], s52 offen offset:2048 sc1
    v_mfma_f32_16x16x32_bf16 v[124:127], a[120:123], a[40:43], v[124:127]
    ds_read_b64_tr_b16 a[152:153], v27 offset:32768
    ds_read_b64_tr_b16 a[154:155], v27 offset:36864
    v_cvt_pk_bf16_f32 v172, v184, v185
    v_mfma_f32_16x16x32_bf16 v[124:127], a[124:127], a[44:47], v[124:127]
    v_cvt_pk_bf16_f32 v173, v186, v187
    v_mfma_f32_16x16x32_bf16 v[120:123], a[124:127], a[36:39], v[120:123]
    ds_read_b64_tr_b16 a[156:157], v27 offset:40960
    ds_read_b64_tr_b16 a[158:159], v27 offset:45056
    v_cvt_pk_bf16_f32 v174, v188, v189
    v_mfma_f32_16x16x32_bf16 v[120:123], a[120:123], a[32:35], v[120:123]
    v_cvt_pk_bf16_f32 v175, v190, v191
    buffer_store_dwordx4 v[172:175], v6, s[12:15], s52 offen offset:3072 sc1
    s_waitcnt lgkmcnt(12)
    v_mfma_f32_16x16x32_bf16 v[96:99], a[128:131], a[48:51], v[96:99]
    ds_read_b64_tr_b16 a[96:97], v24 offset:49152
    ds_read_b64_tr_b16 a[98:99], v24 offset:53248
    v_mfma_f32_16x16x32_bf16 v[96:99], a[132:135], a[52:55], v[96:99]
    v_mfma_f32_16x16x32_bf16 v[100:103], a[132:135], a[60:63], v[100:103]
    ds_read_b64_tr_b16 a[100:101], v24 offset:57344
    ds_read_b64_tr_b16 a[102:103], v24 offset:61440
    v_mfma_f32_16x16x32_bf16 v[100:103], a[128:131], a[56:59], v[100:103]
    s_waitcnt lgkmcnt(12)
    v_mfma_f32_16x16x32_bf16 v[108:111], a[136:139], a[56:59], v[108:111]
    ds_read_b64_tr_b16 a[104:105], v25 offset:49152
    ds_read_b64_tr_b16 a[106:107], v25 offset:53248
    v_mfma_f32_16x16x32_bf16 v[108:111], a[140:143], a[60:63], v[108:111]
    v_mfma_f32_16x16x32_bf16 v[104:107], a[140:143], a[52:55], v[104:107]
    ds_read_b64_tr_b16 a[108:109], v25 offset:57344
    ds_read_b64_tr_b16 a[110:111], v25 offset:61440
    v_mfma_f32_16x16x32_bf16 v[104:107], a[136:139], a[48:51], v[104:107]
    s_waitcnt lgkmcnt(12)
    v_mfma_f32_16x16x32_bf16 v[112:115], a[144:147], a[48:51], v[112:115]
    ds_read_b64_tr_b16 a[112:113], v26 offset:49152
    ds_read_b64_tr_b16 a[114:115], v26 offset:53248
L_pg20:
    s_cbranch_execz L_tramp
    v_mfma_f32_16x16x32_bf16 v[112:115], a[148:151], a[52:55], v[112:115]
    v_mfma_f32_16x16x32_bf16 v[116:119], a[148:151], a[60:63], v[116:119]
    ds_read_b64_tr_b16 a[116:117], v26 offset:57344
    ds_read_b64_tr_b16 a[118:119], v26 offset:61440
    v_mfma_f32_16x16x32_bf16 v[116:119], a[144:147], a[56:59], v[116:119]
    s_waitcnt lgkmcnt(12)
    v_mfma_f32_16x16x32_bf16 v[124:127], a[152:155], a[56:59], v[124:127]
    ds_read_b64_tr_b16 a[120:121], v27 offset:49152
    ds_read_b64_tr_b16 a[122:123], v27 offset:53248
    v_mfma_f32_16x16x32_bf16 v[124:127], a[156:159], a[60:63], v[124:127]
    v_mfma_f32_16x16x32_bf16 v[120:123], a[156:159], a[52:55], v[120:123]
    ds_read_b64_tr_b16 a[124:125], v27 offset:57344
    ds_read_b64_tr_b16 a[126:127], v27 offset:61440
    v_mfma_f32_16x16x32_bf16 v[120:123], a[152:155], a[48:51], v[120:123]
    s_waitcnt lgkmcnt(12)
    v_mfma_f32_16x16x32_bf16 v[96:99], a[96:99], a[64:67], v[96:99]
    ds_read_b64_tr_b16 a[128:129], v32 offset:0
    ds_read_b64_tr_b16 a[130:131], v32 offset:4096
    v_mfma_f32_16x16x32_bf16 v[96:99], a[100:103], a[68:71], v[96:99]
    buffer_load_dwordx4 v[204:207], v13, s[12:15], s42 offen offset:2048 sc1
    s_add_u32 s42, s42, 4096
    v_mfma_f32_16x16x32_bf16 v[100:103], a[100:103], a[76:79], v[100:103]
    ds_read_b64_tr_b16 a[132:133], v32 offset:8192
    ds_read_b64_tr_b16 a[134:135], v32 offset:12288
    v_mfma_f32_16x16x32_bf16 v[100:103], a[96:99], a[72:75], v[100:103]
    s_waitcnt lgkmcnt(12)
    v_mfma_f32_16x16x32_bf16 v[108:111], a[104:107], a[72:75], v[108:111]
    ds_read_b64_tr_b16 a[136:137], v33 offset:0
    ds_read_b64_tr_b16 a[138:139], v33 offset:4096
    v_mfma_f32_16x16x32_bf16 v[108:111], a[108:111], a[76:79], v[108:111]
    buffer_load_dwordx4 v[208:211], v12, s[12:15], s42 offen offset:0 sc1
    v_mfma_f32_16x16x32_bf16 v[104:107], a[108:111], a[68:71], v[104:107]
    ds_read_b64_tr_b16 a[140:141], v33 offset:8192
    ds_read_b64_tr_b16 a[142:143], v33 offset:12288
    v_mfma_f32_16x16x32_bf16 v[104:107], a[104:107], a[64:67], v[104:107]
    s_waitcnt lgkmcnt(12)
    v_mfma_f32_16x16x32_bf16 v[112:115], a[112:115], a[64:67], v[112:115]
    ds_read_b64_tr_b16 a[144:145], v34 offset:0
    ds_read_b64_tr_b16 a[146:147], v34 offset:4096
    v_mfma_f32_16x16x32_bf16 v[112:115], a[116:119], a[68:71], v[112:115]
    v_mfma_f32_16x16x32_bf16 v[116:119], a[116:119], a[76:79], v[116:119]
    ds_read_b64_tr_b16 a[148:149], v34 offset:8192
    ds_read_b64_tr_b16 a[150:151], v34 offset:12288
    v_mfma_f32_16x16x32_bf16 v[116:119], a[112:115], a[72:75], v[116:119]
    s_waitcnt lgkmcnt(12)
    buffer_load_dwordx4 v[212:215], v12, s[12:15], s42 offen offset:2048 sc1
    v_mfma_f32_16x16x32_bf16 v[124:127], a[120:123], a[72:75], v[124:127]
    ds_read_b64_tr_b16 a[152:153], v35 offset:0
    ds_read_b64_tr_b16 a[154:155], v35 offset:4096
    v_mfma_f32_16x16x32_bf16 v[124:127], a[124:127], a[76:79], v[124:127]
    v_mfma_f32_16x16x32_bf16 v[120:123], a[124:127], a[68:71], v[120:123]
    ds_read_b64_tr_b16 a[156:157], v35 offset:8192
    ds_read_b64_tr_b16 a[158:159], v35 offset:12288
    v_mfma_f32_16x16x32_bf16 v[120:123], a[120:123], a[64:67], v[120:123]
    s_waitcnt lgkmcnt(12)
    v_mfma_f32_16x16x32_bf16 v[96:99], a[128:131], a[80:83], v[96:99]
    ds_read_b64_tr_b16 a[96:97], v32 offset:16384
    ds_read_b64_tr_b16 a[98:99], v32 offset:20480
    v_mfma_f32_16x16x32_bf16 v[96:99], a[132:135], a[84:87], v[96:99]
    buffer_load_dwordx4 v[216:219], v13, s[12:15], s42 offen offset:0 sc1
    v_mfma_f32_16x16x32_bf16 v[100:103], a[132:135], a[92:95], v[100:103]
    ds_read_b64_tr_b16 a[100:101], v32 offset:24576
    ds_read_b64_tr_b16 a[102:103], v32 offset:28672
    v_mfma_f32_16x16x32_bf16 v[100:103], a[128:131], a[88:91], v[100:103]
    s_waitcnt lgkmcnt(12)
    v_mfma_f32_16x16x32_bf16 v[108:111], a[136:139], a[88:91], v[108:111]
    ds_read_b64_tr_b16 a[104:105], v33 offset:16384
    ds_read_b64_tr_b16 a[106:107], v33 offset:20480
    v_mfma_f32_16x16x32_bf16 v[108:111], a[140:143], a[92:95], v[108:111]
    buffer_load_dwordx4 v[220:223], v13, s[12:15], s42 offen offset:2048 sc1
    s_add_u32 s42, s42, 4096
    v_mfma_f32_16x16x32_bf16 v[104:107], a[140:143], a[84:87], v[104:107]
    ds_read_b64_tr_b16 a[108:109], v33 offset:24576
    ds_read_b64_tr_b16 a[110:111], v33 offset:28672
    v_mfma_f32_16x16x32_bf16 v[104:107], a[136:139], a[80:83], v[104:107]
    s_waitcnt lgkmcnt(12)
    v_mfma_f32_16x16x32_bf16 v[112:115], a[144:147], a[80:83], v[112:115]
    ds_read_b64_tr_b16 a[112:113], v34 offset:16384
    ds_read_b64_tr_b16 a[114:115], v34 offset:20480
    v_mfma_f32_16x16x32_bf16 v[112:115], a[148:151], a[84:87], v[112:115]
    v_mfma_f32_16x16x32_bf16 v[116:119], a[148:151], a[92:95], v[116:119]
    ds_read_b64_tr_b16 a[116:117], v34 offset:24576
    ds_read_b64_tr_b16 a[118:119], v34 offset:28672
    v_mfma_f32_16x16x32_bf16 v[116:119], a[144:147], a[88:91], v[116:119]
    s_waitcnt lgkmcnt(12)
    buffer_load_dwordx4 v[224:227], v12, s[12:15], s42 offen offset:0 sc1
    v_mfma_f32_16x16x32_bf16 v[124:127], a[152:155], a[88:91], v[124:127]
    ds_read_b64_tr_b16 a[120:121], v35 offset:16384
    ds_read_b64_tr_b16 a[122:123], v35 offset:20480
    v_mfma_f32_16x16x32_bf16 v[124:127], a[156:159], a[92:95], v[124:127]
    v_mfma_f32_16x16x32_bf16 v[120:123], a[156:159], a[84:87], v[120:123]
    ds_read_b64_tr_b16 a[124:125], v35 offset:24576
    ds_read_b64_tr_b16 a[126:127], v35 offset:28672
    v_mfma_f32_16x16x32_bf16 v[120:123], a[152:155], a[80:83], v[120:123]
    s_waitcnt lgkmcnt(12)
    v_mfma_f32_16x16x32_bf16 v[96:99], a[96:99], a[160:163], v[96:99]
    ds_read_b64_tr_b16 a[128:129], v32 offset:32768
    ds_read_b64_tr_b16 a[130:131], v32 offset:36864
    v_mfma_f32_16x16x32_bf16 v[96:99], a[100:103], a[164:167], v[96:99]
    buffer_load_dwordx4 v[228:231], v12, s[12:15], s42 offen offset:2048 sc1
    v_mfma_f32_16x16x32_bf16 v[100:103], a[100:103], a[172:175], v[100:103]
    ds_read_b64_tr_b16 a[132:133], v32 offset:40960
    ds_read_b64_tr_b16 a[134:135], v32 offset:45056
    s_waitcnt vmcnt(7)
    s_mov_b64 exec, 1
    buffer_store_dword v15, v10, s[12:15], 0 offen sc1
    s_mov_b64 exec, -1
    v_mfma_f32_16x16x32_bf16 v[100:103], a[96:99], a[168:171], v[100:103]
    s_waitcnt lgkmcnt(12)
    v_mfma_f32_16x16x32_bf16 v[108:111], a[104:107], a[168:171], v[108:111]
    ds_read_b64_tr_b16 a[136:137], v33 offset:32768
    ds_read_b64_tr_b16 a[138:139], v33 offset:36864
    v_mfma_f32_16x16x32_bf16 v[108:111], a[108:111], a[172:175], v[108:111]
    buffer_load_dwordx4 v[232:235], v13, s[12:15], s42 offen offset:0 sc1
    v_mfma_f32_16x16x32_bf16 v[104:107], a[108:111], a[164:167], v[104:107]
    ds_read_b64_tr_b16 a[140:141], v33 offset:40960
    ds_read_b64_tr_b16 a[142:143], v33 offset:45056
    v_mul_f32 v96, v50, v96
    v_mfma_f32_16x16x32_bf16 v[104:107], a[104:107], a[160:163], v[104:107]
    s_waitcnt lgkmcnt(12)
    v_mul_f32 v97, v50, v97
    v_mfma_f32_16x16x32_bf16 v[112:115], a[112:115], a[160:163], v[112:115]
    ds_read_b64_tr_b16 a[144:145], v34 offset:32768
    ds_read_b64_tr_b16 a[146:147], v34 offset:36864
    v_mul_f32 v98, v50, v98
    v_mfma_f32_16x16x32_bf16 v[112:115], a[116:119], a[164:167], v[112:115]
    buffer_load_dwordx4 v[236:239], v13, s[12:15], s42 offen offset:2048 sc1
    s_add_u32 s42, s42, s36
    v_mul_f32 v99, v50, v99
    v_mfma_f32_16x16x32_bf16 v[116:119], a[116:119], a[172:175], v[116:119]
    ds_read_b64_tr_b16 a[148:149], v34 offset:40960
    ds_read_b64_tr_b16 a[150:151], v34 offset:45056
    v_mul_f32 v100, v51, v100
    v_mul_f32 v104, v50, v104
    v_mfma_f32_16x16x32_bf16 v[116:119], a[112:115], a[168:171], v[116:119]
    s_waitcnt lgkmcnt(12)
    v_mul_f32 v101, v51, v101
    v_mul_f32 v105, v50, v105
    v_mfma_f32_16x16x32_bf16 v[124:127], a[120:123], a[168:171], v[124:127]
    ds_read_b64_tr_b16 a[152:153], v35 offset:32768
    ds_read_b64_tr_b16 a[154:155], v35 offset:36864
    v_mul_f32 v102, v51, v102
    v_mul_f32 v106, v50, v106
    v_mfma_f32_16x16x32_bf16 v[124:127], a[124:127], a[172:175], v[124:127]
    buffer_load_dwordx4 v[240:243], v12, s[12:15], s42 offen offset:0 sc1
    v_mul_f32 v103, v51, v103
    v_mul_f32 v107, v50, v107
    v_mfma_f32_16x16x32_bf16 v[120:123], a[124:127], a[164:167], v[120:123]
    ds_read_b64_tr_b16 a[156:157], v35 offset:40960
    ds_read_b64_tr_b16 a[158:159], v35 offset:45056
    v_mul_f32 v108, v51, v108
    v_mul_f32 v112, v50, v112
    v_mfma_f32_16x16x32_bf16 v[120:123], a[120:123], a[160:163], v[120:123]
    v_mul_f32 v109, v51, v109
    v_mul_f32 v113, v50, v113
    s_waitcnt lgkmcnt(12)
    v_mfma_f32_16x16x32_bf16 v[96:99], a[128:131], a[176:179], v[96:99]
    ds_read_b64_tr_b16 a[96:97], v32 offset:49152
    ds_read_b64_tr_b16 a[98:99], v32 offset:53248
    v_mul_f32 v110, v51, v110
    v_mul_f32 v114, v50, v114
    v_mfma_f32_16x16x32_bf16 v[96:99], a[132:135], a[180:183], v[96:99]
    buffer_load_dwordx4 v[244:247], v12, s[12:15], s42 offen offset:2048 sc1
    v_mul_f32 v111, v51, v111
    v_mul_f32 v115, v50, v115
    v_mfma_f32_16x16x32_bf16 v[100:103], a[132:135], a[188:191], v[100:103]
    ds_read_b64_tr_b16 a[100:101], v32 offset:57344
    ds_read_b64_tr_b16 a[102:103], v32 offset:61440
    v_mul_f32 v116, v51, v116
    v_mul_f32 v120, v50, v120
    v_mfma_f32_16x16x32_bf16 v[100:103], a[128:131], a[184:187], v[100:103]
    s_waitcnt lgkmcnt(12)
    v_mul_f32 v117, v51, v117
    v_mul_f32 v121, v50, v121
    v_mfma_f32_16x16x32_bf16 v[108:111], a[136:139], a[184:187], v[108:111]
    ds_read_b64_tr_b16 a[104:105], v33 offset:49152
    ds_read_b64_tr_b16 a[106:107], v33 offset:53248
    v_mul_f32 v118, v51, v118
    v_mul_f32 v122, v50, v122
    v_mfma_f32_16x16x32_bf16 v[108:111], a[140:143], a[188:191], v[108:111]
    buffer_load_dwordx4 v[248:251], v13, s[12:15], s42 offen offset:0 sc1
    v_mul_f32 v119, v51, v119
    v_mul_f32 v123, v50, v123
    v_mfma_f32_16x16x32_bf16 v[104:107], a[140:143], a[180:183], v[104:107]
    ds_read_b64_tr_b16 a[108:109], v33 offset:57344
    ds_read_b64_tr_b16 a[110:111], v33 offset:61440
    v_mul_f32 v124, v51, v124
    v_mfma_f32_16x16x32_bf16 v[104:107], a[136:139], a[176:179], v[104:107]
    s_waitcnt lgkmcnt(12)
    v_mul_f32 v125, v51, v125
    v_mfma_f32_16x16x32_bf16 v[112:115], a[144:147], a[176:179], v[112:115]
    ds_read_b64_tr_b16 a[112:113], v34 offset:49152
    ds_read_b64_tr_b16 a[114:115], v34 offset:53248
    v_mul_f32 v126, v51, v126
    v_mfma_f32_16x16x32_bf16 v[112:115], a[148:151], a[180:183], v[112:115]
    v_mul_f32 v127, v51, v127
    v_mfma_f32_16x16x32_bf16 v[116:119], a[148:151], a[188:191], v[116:119]
    ds_read_b64_tr_b16 a[116:117], v34 offset:57344
    ds_read_b64_tr_b16 a[118:119], v34 offset:61440
    v_mfma_f32_16x16x32_bf16 v[116:119], a[144:147], a[184:187], v[116:119]
    s_waitcnt lgkmcnt(12)
    buffer_load_dwordx4 v[252:255], v13, s[12:15], s42 offen offset:2048 sc1
    s_add_u32 s42, s42, 4096
    v_mfma_f32_16x16x32_bf16 v[124:127], a[152:155], a[184:187], v[124:127]
    ds_read_b64_tr_b16 a[120:121], v35 offset:49152
    ds_read_b64_tr_b16 a[122:123], v35 offset:53248
    v_mfma_f32_16x16x32_bf16 v[124:127], a[156:159], a[188:191], v[124:127]
    v_mfma_f32_16x16x32_bf16 v[120:123], a[156:159], a[180:183], v[120:123]
    ds_read_b64_tr_b16 a[124:125], v35 offset:57344
    ds_read_b64_tr_b16 a[126:127], v35 offset:61440
    v_mfma_f32_16x16x32_bf16 v[120:123], a[152:155], a[176:179], v[120:123]
    s_waitcnt lgkmcnt(12)
    v_mfma_f32_16x16x32_bf16 v[96:99], a[96:99], a[192:195], v[96:99]
    ds_read_b64_tr_b16 a[128:129], v40 offset:0
    ds_read_b64_tr_b16 a[130:131], v40 offset:4096
    v_mfma_f32_16x16x32_bf16 v[96:99], a[100:103], a[196:199], v[96:99]
    buffer_load_dwordx4 a[0:3], v12, s[12:15], s42 offen offset:0 sc1
    v_mfma_f32_16x16x32_bf16 v[100:103], a[100:103], a[204:207], v[100:103]
    ds_read_b64_tr_b16 a[132:133], v40 offset:8192
    ds_read_b64_tr_b16 a[134:135], v40 offset:12288
    v_mfma_f32_16x16x32_bf16 v[100:103], a[96:99], a[200:203], v[100:103]
    s_waitcnt lgkmcnt(12)
    v_mfma_f32_16x16x32_bf16 v[108:111], a[104:107], a[200:203], v[108:111]
    ds_read_b64_tr_b16 a[136:137], v41 offset:0
    ds_read_b64_tr_b16 a[138:139], v41 offset:4096
    v_mfma_f32_16x16x32_bf16 v[108:111], a[108:111], a[204:207], v[108:111]
    buffer_load_dwordx4 a[4:7], v12, s[12:15], s42 offen offset:2048 sc1
    v_mfma_f32_16x16x32_bf16 v[104:107], a[108:111], a[196:199], v[104:107]
    ds_read_b64_tr_b16 a[140:141], v41 offset:8192
    ds_read_b64_tr_b16 a[142:143], v41 offset:12288
    v_mfma_f32_16x16x32_bf16 v[104:107], a[104:107], a[192:195], v[104:107]
    s_waitcnt lgkmcnt(12)
    v_mfma_f32_16x16x32_bf16 v[112:115], a[112:115], a[192:195], v[112:115]
    ds_read_b64_tr_b16 a[144:145], v42 offset:0
    ds_read_b64_tr_b16 a[146:147], v42 offset:4096
    v_mfma_f32_16x16x32_bf16 v[112:115], a[116:119], a[196:199], v[112:115]
    buffer_load_dwordx4 a[8:11], v13, s[12:15], s42 offen offset:0 sc1
    v_mfma_f32_16x16x32_bf16 v[116:119], a[116:119], a[204:207], v[116:119]
    ds_read_b64_tr_b16 a[148:149], v42 offset:8192
    ds_read_b64_tr_b16 a[150:151], v42 offset:12288
    v_mfma_f32_16x16x32_bf16 v[116:119], a[112:115], a[200:203], v[116:119]
    s_waitcnt lgkmcnt(12)
    v_mfma_f32_16x16x32_bf16 v[124:127], a[120:123], a[200:203], v[124:127]
    ds_read_b64_tr_b16 a[152:153], v43 offset:0
    ds_read_b64_tr_b16 a[154:155], v43 offset:4096
    v_mfma_f32_16x16x32_bf16 v[124:127], a[124:127], a[204:207], v[124:127]
    buffer_load_dwordx4 a[12:15], v13, s[12:15], s42 offen offset:2048 sc1
    s_add_u32 s42, s42, 4096
    v_mfma_f32_16x16x32_bf16 v[120:123], a[124:127], a[196:199], v[120:123]
    ds_read_b64_tr_b16 a[156:157], v43 offset:8192
    ds_read_b64_tr_b16 a[158:159], v43 offset:12288
    v_mfma_f32_16x16x32_bf16 v[120:123], a[120:123], a[192:195], v[120:123]
    s_waitcnt lgkmcnt(12)
    v_mfma_f32_16x16x32_bf16 v[96:99], a[128:131], a[208:211], v[96:99]
    ds_read_b64_tr_b16 a[96:97], v28 offset:16384
    ds_read_b64_tr_b16 a[98:99], v28 offset:20480
    v_mfma_f32_16x16x32_bf16 v[96:99], a[132:135], a[212:215], v[96:99]
    buffer_load_dwordx4 a[16:19], v12, s[12:15], s42 offen offset:0 sc1
    v_mfma_f32_16x16x32_bf16 v[100:103], a[132:135], a[220:223], v[100:103]
    ds_read_b64_tr_b16 a[100:101], v28 offset:24576
    ds_read_b64_tr_b16 a[102:103], v28 offset:28672
    v_mfma_f32_16x16x32_bf16 v[100:103], a[128:131], a[216:219], v[100:103]
    s_waitcnt lgkmcnt(12)
    v_mfma_f32_16x16x32_bf16 v[108:111], a[136:139], a[216:219], v[108:111]
    ds_read_b64_tr_b16 a[104:105], v29 offset:16384
    ds_read_b64_tr_b16 a[106:107], v29 offset:20480
    v_mfma_f32_16x16x32_bf16 v[108:111], a[140:143], a[220:223], v[108:111]
    buffer_load_dwordx4 a[20:23], v12, s[12:15], s42 offen offset:2048 sc1
    v_mfma_f32_16x16x32_bf16 v[104:107], a[140:143], a[212:215], v[104:107]
    ds_read_b64_tr_b16 a[108:109], v29 offset:24576
    ds_read_b64_tr_b16 a[110:111], v29 offset:28672
    v_mfma_f32_16x16x32_bf16 v[104:107], a[136:139], a[208:211], v[104:107]
    s_waitcnt lgkmcnt(12)
    v_mfma_f32_16x16x32_bf16 v[112:115], a[144:147], a[208:211], v[112:115]
    ds_read_b64_tr_b16 a[112:113], v30 offset:16384
    ds_read_b64_tr_b16 a[114:115], v30 offset:20480
    v_mfma_f32_16x16x32_bf16 v[112:115], a[148:151], a[212:215], v[112:115]
    v_mfma_f32_16x16x32_bf16 v[116:119], a[148:151], a[220:223], v[116:119]
    ds_read_b64_tr_b16 a[116:117], v30 offset:24576
    ds_read_b64_tr_b16 a[118:119], v30 offset:28672
    v_mfma_f32_16x16x32_bf16 v[116:119], a[144:147], a[216:219], v[116:119]
    s_waitcnt lgkmcnt(12)
    buffer_load_dwordx4 a[24:27], v13, s[12:15], s42 offen offset:0 sc1
    v_mfma_f32_16x16x32_bf16 v[124:127], a[152:155], a[216:219], v[124:127]
    ds_read_b64_tr_b16 a[120:121], v31 offset:16384
    ds_read_b64_tr_b16 a[122:123], v31 offset:20480
    v_mfma_f32_16x16x32_bf16 v[124:127], a[156:159], a[220:223], v[124:127]
    v_mfma_f32_16x16x32_bf16 v[120:123], a[156:159], a[212:215], v[120:123]
    ds_read_b64_tr_b16 a[124:125], v31 offset:24576
    ds_read_b64_tr_b16 a[126:127], v31 offset:28672
    v_mfma_f32_16x16x32_bf16 v[120:123], a[152:155], a[208:211], v[120:123]
    s_waitcnt lgkmcnt(12)
    v_mfma_f32_16x16x32_bf16 v[128:131], a[96:99], a[224:227], v[128:131]
    ds_read_b64_tr_b16 a[128:129], v28 offset:32768
    ds_read_b64_tr_b16 a[130:131], v28 offset:36864
    v_cvt_pk_bf16_f32 v96, v96, v97
    v_mfma_f32_16x16x32_bf16 v[128:131], a[100:103], a[228:231], v[128:131]
    v_cvt_pk_bf16_f32 v97, v98, v99
    v_mfma_f32_16x16x32_bf16 v[132:135], a[100:103], a[236:239], v[132:135]
    ds_read_b64_tr_b16 a[132:133], v28 offset:40960
    ds_read_b64_tr_b16 a[134:135], v28 offset:45056
    v_cvt_pk_bf16_f32 v98, v100, v101
    v_mfma_f32_16x16x32_bf16 v[132:135], a[96:99], a[232:235], v[132:135]
    s_waitcnt lgkmcnt(12)
    v_cvt_pk_bf16_f32 v99, v102, v103
    buffer_store_dwordx4 v[96:99], v6, s[12:15], s53 offen offset:0 sc1
    v_mfma_f32_16x16x32_bf16 v[140:143], a[104:107], a[232:235], v[140:143]
    ds_read_b64_tr_b16 a[136:137], v29 offset:32768
    ds_read_b64_tr_b16 a[138:139], v29 offset:36864
    v_cvt_pk_bf16_f32 v100, v104, v105
    v_mfma_f32_16x16x32_bf16 v[140:143], a[108:111], a[236:239], v[140:143]
    v_cvt_pk_bf16_f32 v101, v106, v107
    v_mfma_f32_16x16x32_bf16 v[136:139], a[108:111], a[228:231], v[136:139]
    ds_read_b64_tr_b16 a[140:141], v29 offset:40960
    ds_read_b64_tr_b16 a[142:143], v29 offset:45056
    v_cvt_pk_bf16_f32 v102, v108, v109
    v_mfma_f32_16x16x32_bf16 v[136:139], a[104:107], a[224:227], v[136:139]
    s_waitcnt lgkmcnt(12)
    v_cvt_pk_bf16_f32 v103, v110, v111
    buffer_store_dwordx4 v[100:103], v6, s[12:15], s53 offen offset:1024 sc1
    v_mfma_f32_16x16x32_bf16 v[144:147], a[112:115], a[224:227], v[144:147]
    ds_read_b64_tr_b16 a[144:145], v30 offset:32768
    ds_read_b64_tr_b16 a[146:147], v30 offset:36864
    v_cvt_pk_bf16_f32 v104, v112, v113
    v_mfma_f32_16x16x32_bf16 v[144:147], a[116:119], a[228:231], v[144:147]
    v_cvt_pk_bf16_f32 v105, v114, v115
    v_mfma_f32_16x16x32_bf16 v[148:151], a[116:119], a[236:239], v[148:151]
    ds_read_b64_tr_b16 a[148:149], v30 offset:40960
    ds_read_b64_tr_b16 a[150:151], v30 offset:45056
    v_cvt_pk_bf16_f32 v106, v116, v117
    v_mfma_f32_16x16x32_bf16 v[148:151], a[112:115], a[232:235], v[148:151]
    s_waitcnt lgkmcnt(12)
    v_cvt_pk_bf16_f32 v107, v118, v119
    buffer_store_dwordx4 v[104:107], v6, s[12:15], s53 offen offset:2048 sc1
    v_mfma_f32_16x16x32_bf16 v[156:159], a[120:123], a[232:235], v[156:159]
    ds_read_b64_tr_b16 a[152:153], v31 offset:32768
    ds_read_b64_tr_b16 a[154:155], v31 offset:36864
    v_cvt_pk_bf16_f32 v108, v120, v121
    v_mfma_f32_16x16x32_bf16 v[156:159], a[124:127], a[236:239], v[156:159]
    v_cvt_pk_bf16_f32 v109, v122, v123
    v_mfma_f32_16x16x32_bf16 v[152:155], a[124:127], a[228:231], v[152:155]
    ds_read_b64_tr_b16 a[156:157], v31 offset:40960
    ds_read_b64_tr_b16 a[158:159], v31 offset:45056
    v_cvt_pk_bf16_f32 v110, v124, v125
    v_mfma_f32_16x16x32_bf16 v[152:155], a[120:123], a[224:227], v[152:155]
    v_cvt_pk_bf16_f32 v111, v126, v127
    buffer_store_dwordx4 v[108:111], v6, s[12:15], s53 offen offset:3072 sc1
    s_waitcnt lgkmcnt(12)
    v_mfma_f32_16x16x32_bf16 v[128:131], a[128:131], a[240:243], v[128:131]
    v_mov_b32 v18, 0
    s_mov_b64 exec, 1
    buffer_atomic_or v18, v14, s[12:15], s38 offen offset:0 sc0 sc1
    s_mov_b64 exec, -1
    ds_read_b64_tr_b16 a[96:97], v28 offset:49152
    ds_read_b64_tr_b16 a[98:99], v28 offset:53248
    v_mfma_f32_16x16x32_bf16 v[128:131], a[132:135], a[244:247], v[128:131]
    v_mfma_f32_16x16x32_bf16 v[132:135], a[132:135], a[252:255], v[132:135]
    ds_read_b64_tr_b16 a[100:101], v28 offset:57344
    ds_read_b64_tr_b16 a[102:103], v28 offset:61440
    v_mfma_f32_16x16x32_bf16 v[132:135], a[128:131], a[248:251], v[132:135]
    s_waitcnt lgkmcnt(12)
    v_mfma_f32_16x16x32_bf16 v[140:143], a[136:139], a[248:251], v[140:143]
    ds_read_b64_tr_b16 a[104:105], v29 offset:49152
    ds_read_b64_tr_b16 a[106:107], v29 offset:53248
    v_mfma_f32_16x16x32_bf16 v[140:143], a[140:143], a[252:255], v[140:143]
    v_mfma_f32_16x16x32_bf16 v[136:139], a[140:143], a[244:247], v[136:139]
    ds_read_b64_tr_b16 a[108:109], v29 offset:57344
    ds_read_b64_tr_b16 a[110:111], v29 offset:61440
    v_mfma_f32_16x16x32_bf16 v[136:139], a[136:139], a[240:243], v[136:139]
    s_waitcnt lgkmcnt(12)
    v_mfma_f32_16x16x32_bf16 v[144:147], a[144:147], a[240:243], v[144:147]
    ds_read_b64_tr_b16 a[112:113], v30 offset:49152
    ds_read_b64_tr_b16 a[114:115], v30 offset:53248
    v_mfma_f32_16x16x32_bf16 v[144:147], a[148:151], a[244:247], v[144:147]
    v_mfma_f32_16x16x32_bf16 v[148:151], a[148:151], a[252:255], v[148:151]
    ds_read_b64_tr_b16 a[116:117], v30 offset:57344
    ds_read_b64_tr_b16 a[118:119], v30 offset:61440
    v_mfma_f32_16x16x32_bf16 v[148:151], a[144:147], a[248:251], v[148:151]
    s_waitcnt lgkmcnt(12)
    v_mfma_f32_16x16x32_bf16 v[156:159], a[152:155], a[248:251], v[156:159]
    ds_read_b64_tr_b16 a[120:121], v31 offset:49152
    ds_read_b64_tr_b16 a[122:123], v31 offset:53248
    v_mfma_f32_16x16x32_bf16 v[156:159], a[156:159], a[252:255], v[156:159]
    v_mfma_f32_16x16x32_bf16 v[152:155], a[156:159], a[244:247], v[152:155]
    ds_read_b64_tr_b16 a[124:125], v31 offset:57344
    ds_read_b64_tr_b16 a[126:127], v31 offset:61440
    v_mfma_f32_16x16x32_bf16 v[152:155], a[152:155], a[240:243], v[152:155]
    s_waitcnt vmcnt(25) lgkmcnt(12)
    v_mfma_f32_16x16x32_bf16 v[128:131], a[96:99], v[192:195], v[128:131]
    ds_read_b64_tr_b16 a[128:129], v36 offset:0
    ds_read_b64_tr_b16 a[130:131], v36 offset:4096
    v_mfma_f32_16x16x32_bf16 v[128:131], a[100:103], v[196:199], v[128:131]
    buffer_load_dwordx4 a[28:31], v13, s[12:15], s42 offen offset:2048 sc1
    s_add_u32 s42, s42, 4096
    v_mfma_f32_16x16x32_bf16 v[132:135], a[100:103], v[204:207], v[132:135]
    ds_read_b64_tr_b16 a[132:133], v36 offset:8192
    ds_read_b64_tr_b16 a[134:135], v36 offset:12288
    v_mfma_f32_16x16x32_bf16 v[132:135], a[96:99], v[200:203], v[132:135]
    s_waitcnt lgkmcnt(12)
    v_mfma_f32_16x16x32_bf16 v[140:143], a[104:107], v[200:203], v[140:143]
    ds_read_b64_tr_b16 a[136:137], v37 offset:0
    ds_read_b64_tr_b16 a[138:139], v37 offset:4096
    v_mfma_f32_16x16x32_bf16 v[140:143], a[108:111], v[204:207], v[140:143]
    v_mfma_f32_16x16x32_bf16 v[136:139], a[108:111], v[196:199], v[136:139]
    ds_read_b64_tr_b16 a[140:141], v37 offset:8192
    ds_read_b64_tr_b16 a[142:143], v37 offset:12288
    v_mfma_f32_16x16x32_bf16 v[136:139], a[104:107], v[192:195], v[136:139]
    s_waitcnt lgkmcnt(12)
    v_mfma_f32_16x16x32_bf16 v[144:147], a[112:115], v[192:195], v[144:147]
    ds_read_b64_tr_b16 a[144:145], v38 offset:0
    ds_read_b64_tr_b16 a[146:147], v38 offset:4096
    v_mfma_f32_16x16x32_bf16 v[144:147], a[116:119], v[196:199], v[144:147]
    v_mfma_f32_16x16x32_bf16 v[148:151], a[116:119], v[204:207], v[148:151]
    ds_read_b64_tr_b16 a[148:149], v38 offset:8192
    ds_read_b64_tr_b16 a[150:151], v38 offset:12288
    v_mfma_f32_16x16x32_bf16 v[148:151], a[112:115], v[200:203], v[148:151]
    s_waitcnt lgkmcnt(12)
    v_mfma_f32_16x16x32_bf16 v[156:159], a[120:123], v[200:203], v[156:159]
    ds_read_b64_tr_b16 a[152:153], v39 offset:0
    ds_read_b64_tr_b16 a[154:155], v39 offset:4096
    v_mfma_f32_16x16x32_bf16 v[156:159], a[124:127], v[204:207], v[156:159]
    v_mfma_f32_16x16x32_bf16 v[152:155], a[124:127], v[196:199], v[152:155]
    ds_read_b64_tr_b16 a[156:157], v39 offset:8192
    ds_read_b64_tr_b16 a[158:159], v39 offset:12288
    v_mfma_f32_16x16x32_bf16 v[152:155], a[120:123], v[192:195], v[152:155]
    s_waitcnt vmcnt(22) lgkmcnt(12)
    v_mfma_f32_16x16x32_bf16 v[128:131], a[128:131], v[208:211], v[128:131]
    ds_read_b64_tr_b16 a[96:97], v36 offset:16384
    ds_read_b64_tr_b16 a[98:99], v36 offset:20480
    v_mfma_f32_16x16x32_bf16 v[128:131], a[132:135], v[212:215], v[128:131]
    v_mfma_f32_16x16x32_bf16 v[132:135], a[132:135], v[220:223], v[132:135]
    ds_read_b64_tr_b16 a[100:101], v36 offset:24576
    ds_read_b64_tr_b16 a[102:103], v36 offset:28672
    v_mfma_f32_16x16x32_bf16 v[132:135], a[128:131], v[216:219], v[132:135]
    s_waitcnt lgkmcnt(12)
    v_mfma_f32_16x16x32_bf16 v[140:143], a[136:139], v[216:219], v[140:143]
    ds_read_b64_tr_b16 a[104:105], v37 offset:16384
    ds_read_b64_tr_b16 a[106:107], v37 offset:20480
    v_mfma_f32_16x16x32_bf16 v[140:143], a[140:143], v[220:223], v[140:143]
    v_mfma_f32_16x16x32_bf16 v[136:139], a[140:143], v[212:215], v[136:139]
    ds_read_b64_tr_b16 a[108:109], v37 offset:24576
    ds_read_b64_tr_b16 a[110:111], v37 offset:28672
    v_mfma_f32_16x16x32_bf16 v[136:139], a[136:139], v[208:211], v[136:139]
    s_waitcnt lgkmcnt(12)
    v_mfma_f32_16x16x32_bf16 v[144:147], a[144:147], v[208:211], v[144:147]
    ds_read_b64_tr_b16 a[112:113], v38 offset:16384
    ds_read_b64_tr_b16 a[114:115], v38 offset:20480
    v_mfma_f32_16x16x32_bf16 v[144:147], a[148:151], v[212:215], v[144:147]
    v_mfma_f32_16x16x32_bf16 v[148:151], a[148:151], v[220:223], v[148:151]
    s_waitcnt vmcnt(1)
    v_cmp_eq_u32 vcc, 1, v18
    ds_read_b64_tr_b16 a[116:117], v38 offset:24576
    ds_read_b64_tr_b16 a[118:119], v38 offset:28672
    v_mfma_f32_16x16x32_bf16 v[148:151], a[144:147], v[216:219], v[148:151]
    s_waitcnt lgkmcnt(12)
    v_mfma_f32_16x16x32_bf16 v[156:159], a[152:155], v[216:219], v[156:159]
    s_bcnt1_i32_b32 s78, vcc_lo
    ds_read_b64_tr_b16 a[120:121], v39 offset:16384
    ds_read_b64_tr_b16 a[122:123], v39 offset:20480
    v_mfma_f32_16x16x32_bf16 v[156:159], a[156:159], v[220:223], v[156:159]
    v_mfma_f32_16x16x32_bf16 v[152:155], a[156:159], v[212:215], v[152:155]
    s_cmp_lt_u32 s78, 1
    s_cbranch_scc1 L_spin23
L_got23:
    ds_read_b64_tr_b16 a[124:125], v39 offset:24576
    ds_read_b64_tr_b16 a[126:127], v39 offset:28672
    v_mfma_f32_16x16x32_bf16 v[152:155], a[152:155], v[208:211], v[152:155]
    s_waitcnt lgkmcnt(12)
    v_mfma_f32_16x16x32_bf16 v[128:131], a[96:99], v[224:227], v[128:131]
    ds_read_b64_tr_b16 a[128:129], v36 offset:32768
    ds_read_b64_tr_b16 a[130:131], v36 offset:36864
    v_mfma_f32_16x16x32_bf16 v[128:131], a[100:103], v[228:231], v[128:131]
    buffer_load_dwordx4 v[176:179], v6, s[12:15], s76 offen offset:0 sc1
    v_mfma_f32_16x16x32_bf16 v[132:135], a[100:103], v[236:239], v[132:135]
    ds_read_b64_tr_b16 a[132:133], v36 offset:40960
    ds_read_b64_tr_b16 a[134:135], v36 offset:45056
    s_mov_b64 exec, 2
    buffer_store_dword v15, v10, s[12:15], 0 offen sc1
    s_mov_b64 exec, -1
    v_mfma_f32_16x16x32_bf16 v[132:135], a[96:99], v[232:235], v[132:135]
    s_waitcnt lgkmcnt(12)
    v_mfma_f32_16x16x32_bf16 v[140:143], a[104:107], v[232:235], v[140:143]
    ds_read_b64_tr_b16 a[136:137], v37 offset:32768
    ds_read_b64_tr_b16 a[138:139], v37 offset:36864
    v_mfma_f32_16x16x32_bf16 v[140:143], a[108:111], v[236:239], v[140:143]
    buffer_load_dwordx4 v[180:183], v6, s[12:15], s76 offen offset:1024 sc1
    v_mfma_f32_16x16x32_bf16 v[136:139], a[108:111], v[228:231], v[136:139]
    ds_read_b64_tr_b16 a[140:141], v37 offset:40960
    ds_read_b64_tr_b16 a[142:143], v37 offset:45056
    v_mul_f32 v128, v48, v128
    v_mfma_f32_16x16x32_bf16 v[136:139], a[104:107], v[224:227], v[136:139]
    s_waitcnt lgkmcnt(12)
    v_mul_f32 v129, v48, v129
    v_mfma_f32_16x16x32_bf16 v[144:147], a[112:115], v[224:227], v[144:147]
    ds_read_b64_tr_b16 a[144:145], v38 offset:32768
    ds_read_b64_tr_b16 a[146:147], v38 offset:36864
    v_mul_f32 v130, v48, v130
    v_mfma_f32_16x16x32_bf16 v[144:147], a[116:119], v[228:231], v[144:147]
    buffer_load_dwordx4 v[184:187], v6, s[12:15], s76 offen offset:2048 sc1
    v_mul_f32 v131, v48, v131
    v_mfma_f32_16x16x32_bf16 v[148:151], a[116:119], v[236:239], v[148:151]
    ds_read_b64_tr_b16 a[148:149], v38 offset:40960
    ds_read_b64_tr_b16 a[150:151], v38 offset:45056
    v_mul_f32 v132, v49, v132
    v_mul_f32 v136, v48, v136
    v_mfma_f32_16x16x32_bf16 v[148:151], a[112:115], v[232:235], v[148:151]
    s_waitcnt lgkmcnt(12)
    v_mul_f32 v133, v49, v133
    v_mul_f32 v137, v48, v137
    v_mfma_f32_16x16x32_bf16 v[156:159], a[120:123], v[232:235], v[156:159]
    ds_read_b64_tr_b16 a[152:153], v39 offset:32768
    ds_read_b64_tr_b16 a[154:155], v39 offset:36864
    v_mul_f32 v134, v49, v134
    v_mul_f32 v138, v48, v138
    v_mfma_f32_16x16x32_bf16 v[156:159], a[124:127], v[236:239], v[156:159]
    buffer_load_dwordx4 v[188:191], v6, s[12:15], s76 offen offset:3072 sc1
    v_mul_f32 v135, v49, v135
    v_mul_f32 v139, v48, v139
    v_mfma_f32_16x16x32_bf16 v[152:155], a[124:127], v[228:231], v[152:155]
    ds_read_b64_tr_b16 a[156:157], v39 offset:40960
    ds_read_b64_tr_b16 a[158:159], v39 offset:45056
    v_mul_f32 v140, v49, v140
    v_mul_f32 v144, v48, v144
    v_mfma_f32_16x16x32_bf16 v[152:155], a[120:123], v[224:227], v[152:155]
    v_mul_f32 v141, v49, v141
    v_mul_f32 v145, v48, v145
    s_waitcnt lgkmcnt(12)
    v_mfma_f32_16x16x32_bf16 v[128:131], a[128:131], v[240:243], v[128:131]
    ds_read_b64_tr_b16 a[96:97], v36 offset:49152
    ds_read_b64_tr_b16 a[98:99], v36 offset:53248
    v_mul_f32 v142, v49, v142
    v_mul_f32 v146, v48, v146
    v_mfma_f32_16x16x32_bf16 v[128:131], a[132:135], v[244:247], v[128:131]
    v_mul_f32 v143, v49, v143
    v_mul_f32 v147, v48, v147
    v_mfma_f32_16x16x32_bf16 v[132:135], a[132:135], v[252:255], v[132:135]
    ds_read_b64_tr_b16 a[100:101], v36 offset:57344
    ds_read_b64_tr_b16 a[102:103], v36 offset:61440
    v_mul_f32 v148, v49, v148
    v_mul_f32 v152, v48, v152
    v_mfma_f32_16x16x32_bf16 v[132:135], a[128:131], v[248:251], v[132:135]
    s_waitcnt lgkmcnt(12)
    v_mul_f32 v149, v49, v149
    v_mul_f32 v153, v48, v153
    v_mfma_f32_16x16x32_bf16 v[140:143], a[136:139], v[248:251], v[140:143]
    ds_read_b64_tr_b16 a[104:105], v37 offset:49152
    ds_read_b64_tr_b16 a[106:107], v37 offset:53248
    v_mul_f32 v150, v49, v150
    v_mul_f32 v154, v48, v154
    v_mfma_f32_16x16x32_bf16 v[140:143], a[140:143], v[252:255], v[140:143]
    v_mul_f32 v151, v49, v151
    v_mul_f32 v155, v48, v155
    v_mfma_f32_16x16x32_bf16 v[136:139], a[140:143], v[244:247], v[136:139]
    ds_read_b64_tr_b16 a[108:109], v37 offset:57344
    ds_read_b64_tr_b16 a[110:111], v37 offset:61440
    v_mul_f32 v156, v49, v156
    v_mfma_f32_16x16x32_bf16 v[136:139], a[136:139], v[240:243], v[136:139]
    s_waitcnt lgkmcnt(12)
    v_mul_f32 v157, v49, v157
    v_mfma_f32_16x16x32_bf16 v[144:147], a[144:147], v[240:243], v[144:147]
    ds_read_b64_tr_b16 a[112:113], v38 offset:49152
    ds_read_b64_tr_b16 a[114:115], v38 offset:53248
    v_mul_f32 v158, v49, v158
    v_mfma_f32_16x16x32_bf16 v[144:147], a[148:151], v[244:247], v[144:147]
    v_mul_f32 v159, v49, v159
    v_mfma_f32_16x16x32_bf16 v[148:151], a[148:151], v[252:255], v[148:151]
    ds_read_b64_tr_b16 a[116:117], v38 offset:57344
    ds_read_b64_tr_b16 a[118:119], v38 offset:61440
    v_mfma_f32_16x16x32_bf16 v[148:151], a[144:147], v[248:251], v[148:151]
    s_waitcnt lgkmcnt(12)
    v_mfma_f32_16x16x32_bf16 v[156:159], a[152:155], v[248:251], v[156:159]
    ds_read_b64_tr_b16 a[120:121], v39 offset:49152
    ds_read_b64_tr_b16 a[122:123], v39 offset:53248
    v_mfma_f32_16x16x32_bf16 v[156:159], a[156:159], v[252:255], v[156:159]
    v_mfma_f32_16x16x32_bf16 v[152:155], a[156:159], v[244:247], v[152:155]
    ds_read_b64_tr_b16 a[124:125], v39 offset:57344
L_pg21:
    s_cbranch_execz L_tramp
    ds_read_b64_tr_b16 a[126:127], v39 offset:61440
    v_mfma_f32_16x16x32_bf16 v[152:155], a[152:155], v[240:243], v[152:155]
    s_waitcnt lgkmcnt(12)
    v_mfma_f32_16x16x32_bf16 v[128:131], a[96:99], a[0:3], v[128:131]
    ds_read_b64_tr_b16 a[128:129], v44 offset:0
    ds_read_b64_tr_b16 a[130:131], v44 offset:4096
    v_mfma_f32_16x16x32_bf16 v[128:131], a[100:103], a[4:7], v[128:131]
    v_mfma_f32_16x16x32_bf16 v[132:135], a[100:103], a[12:15], v[132:135]
    ds_read_b64_tr_b16 a[132:133], v44 offset:8192
    ds_read_b64_tr_b16 a[134:135], v44 offset:12288
    v_mfma_f32_16x16x32_bf16 v[132:135], a[96:99], a[8:11], v[132:135]
    s_waitcnt lgkmcnt(12)
    v_mfma_f32_16x16x32_bf16 v[140:143], a[104:107], a[8:11], v[140:143]
    ds_read_b64_tr_b16 a[136:137], v45 offset:0
    ds_read_b64_tr_b16 a[138:139], v45 offset:4096
    v_mfma_f32_16x16x32_bf16 v[140:143], a[108:111], a[12:15], v[140:143]
    v_mfma_f32_16x16x32_bf16 v[136:139], a[108:111], a[4:7], v[136:139]
    ds_read_b64_tr_b16 a[140:141], v45 offset:8192
    ds_read_b64_tr_b16 a[142:143], v45 offset:12288
    v_mfma_f32_16x16x32_bf16 v[136:139], a[104:107], a[0:3], v[136:139]
    s_waitcnt lgkmcnt(12)
    v_mfma_f32_16x16x32_bf16 v[144:147], a[112:115], a[0:3], v[144:147]
    ds_read_b64_tr_b16 a[144:145], v46 offset:0
    ds_read_b64_tr_b16 a[146:147], v46 offset:4096
    v_mfma_f32_16x16x32_bf16 v[144:147], a[116:119], a[4:7], v[144:147]
    v_mfma_f32_16x16x32_bf16 v[148:151], a[116:119], a[12:15], v[148:151]
    ds_read_b64_tr_b16 a[148:149], v46 offset:8192
    ds_read_b64_tr_b16 a[150:151], v46 offset:12288
    v_mfma_f32_16x16x32_bf16 v[148:151], a[112:115], a[8:11], v[148:151]
    s_waitcnt lgkmcnt(12)
    v_mfma_f32_16x16x32_bf16 v[156:159], a[120:123], a[8:11], v[156:159]
    ds_read_b64_tr_b16 a[152:153], v47 offset:0
    ds_read_b64_tr_b16 a[154:155], v47 offset:4096
    v_mfma_f32_16x16x32_bf16 v[156:159], a[124:127], a[12:15], v[156:159]
    v_mfma_f32_16x16x32_bf16 v[152:155], a[124:127], a[4:7], v[152:155]
    ds_read_b64_tr_b16 a[156:157], v47 offset:8192
    ds_read_b64_tr_b16 a[158:159], v47 offset:12288
    v_mfma_f32_16x16x32_bf16 v[152:155], a[120:123], a[0:3], v[152:155]
    s_waitcnt vmcnt(5) lgkmcnt(12)
    v_mfma_f32_16x16x32_bf16 v[128:131], a[128:131], a[16:19], v[128:131]
    ds_read_b64_tr_b16 a[96:97], v24 offset:16384
    ds_read_b64_tr_b16 a[98:99], v24 offset:20480
    v_mfma_f32_16x16x32_bf16 v[128:131], a[132:135], a[20:23], v[128:131]
    v_mfma_f32_16x16x32_bf16 v[132:135], a[132:135], a[28:31], v[132:135]
    ds_read_b64_tr_b16 a[100:101], v24 offset:24576
    ds_read_b64_tr_b16 a[102:103], v24 offset:28672
    v_mfma_f32_16x16x32_bf16 v[132:135], a[128:131], a[24:27], v[132:135]
    s_waitcnt lgkmcnt(12)
    v_mfma_f32_16x16x32_bf16 v[140:143], a[136:139], a[24:27], v[140:143]
    ds_read_b64_tr_b16 a[104:105], v25 offset:16384
    ds_read_b64_tr_b16 a[106:107], v25 offset:20480
    v_mfma_f32_16x16x32_bf16 v[140:143], a[140:143], a[28:31], v[140:143]
    v_mfma_f32_16x16x32_bf16 v[136:139], a[140:143], a[20:23], v[136:139]
    ds_read_b64_tr_b16 a[108:109], v25 offset:24576
    ds_read_b64_tr_b16 a[110:111], v25 offset:28672
    v_mfma_f32_16x16x32_bf16 v[136:139], a[136:139], a[16:19], v[136:139]
    s_waitcnt lgkmcnt(12)
    v_mfma_f32_16x16x32_bf16 v[144:147], a[144:147], a[16:19], v[144:147]
    ds_read_b64_tr_b16 a[112:113], v26 offset:16384
    ds_read_b64_tr_b16 a[114:115], v26 offset:20480
    v_mfma_f32_16x16x32_bf16 v[144:147], a[148:151], a[20:23], v[144:147]
    v_mfma_f32_16x16x32_bf16 v[148:151], a[148:151], a[28:31], v[148:151]
    ds_read_b64_tr_b16 a[116:117], v26 offset:24576
    ds_read_b64_tr_b16 a[118:119], v26 offset:28672
    v_mfma_f32_16x16x32_bf16 v[148:151], a[144:147], a[24:27], v[148:151]
    s_waitcnt lgkmcnt(12)
    v_mfma_f32_16x16x32_bf16 v[156:159], a[152:155], a[24:27], v[156:159]
    ds_read_b64_tr_b16 a[120:121], v27 offset:16384
    ds_read_b64_tr_b16 a[122:123], v27 offset:20480
    v_mfma_f32_16x16x32_bf16 v[156:159], a[156:159], a[28:31], v[156:159]
    v_mfma_f32_16x16x32_bf16 v[152:155], a[156:159], a[20:23], v[152:155]
    ds_read_b64_tr_b16 a[124:125], v27 offset:24576
    ds_read_b64_tr_b16 a[126:127], v27 offset:28672
    v_mfma_f32_16x16x32_bf16 v[152:155], a[152:155], a[16:19], v[152:155]
    s_waitcnt lgkmcnt(12)
    v_mfma_f32_16x16x32_bf16 v[64:67], a[96:99], a[224:227], v[64:67]
    ds_read_b64_tr_b16 a[128:129], v24 offset:32768
    ds_read_b64_tr_b16 a[130:131], v24 offset:36864
    v_cvt_pk_bf16_f32 v128, v128, v129
    v_mfma_f32_16x16x32_bf16 v[64:67], a[100:103], a[228:231], v[64:67]
    v_cvt_pk_bf16_f32 v129, v130, v131
    v_mfma_f32_16x16x32_bf16 v[68:71], a[100:103], a[236:239], v[68:71]
    ds_read_b64_tr_b16 a[132:133], v24 offset:40960
    ds_read_b64_tr_b16 a[134:135], v24 offset:45056
    v_cvt_pk_bf16_f32 v130, v132, v133
    v_mfma_f32_16x16x32_bf16 v[68:71], a[96:99], a[232:235], v[68:71]
    s_waitcnt lgkmcnt(12)
    v_cvt_pk_bf16_f32 v131, v134, v135
    buffer_store_dwordx4 v[128:131], v6, s[12:15], s54 offen offset:0 sc1
    v_mfma_f32_16x16x32_bf16 v[76:79], a[104:107], a[232:235], v[76:79]
    ds_read_b64_tr_b16 a[136:137], v25 offset:32768
    ds_read_b64_tr_b16 a[138:139], v25 offset:36864
    v_cvt_pk_bf16_f32 v132, v136, v137
    v_mfma_f32_16x16x32_bf16 v[76:79], a[108:111], a[236:239], v[76:79]
    v_cvt_pk_bf16_f32 v133, v138, v139
    v_mfma_f32_16x16x32_bf16 v[72:75], a[108:111], a[228:231], v[72:75]
    ds_read_b64_tr_b16 a[140:141], v25 offset:40960
    ds_read_b64_tr_b16 a[142:143], v25 offset:45056
    v_cvt_pk_bf16_f32 v134, v140, v141
    v_mfma_f32_16x16x32_bf16 v[72:75], a[104:107], a[224:227], v[72:75]
    s_waitcnt lgkmcnt(12)
    v_cvt_pk_bf16_f32 v135, v142, v143
    buffer_store_dwordx4 v[132:135], v6, s[12:15], s54 offen offset:1024 sc1
    v_mfma_f32_16x16x32_bf16 v[80:83], a[112:115], a[224:227], v[80:83]
    ds_read_b64_tr_b16 a[144:145], v26 offset:32768
    ds_read_b64_tr_b16 a[146:147], v26 offset:36864
    v_cvt_pk_bf16_f32 v136, v144, v145
    v_mfma_f32_16x16x32_bf16 v[80:83], a[116:119], a[228:231], v[80:83]
    v_cvt_pk_bf16_f32 v137, v146, v147
    v_mfma_f32_16x16x32_bf16 v[84:87], a[116:119], a[236:239], v[84:87]
    ds_read_b64_tr_b16 a[148:149], v26 offset:40960
    ds_read_b64_tr_b16 a[150:151], v26 offset:45056
    v_cvt_pk_bf16_f32 v138, v148, v149
    v_mfma_f32_16x16x32_bf16 v[84:87], a[112:115], a[232:235], v[84:87]
    s_waitcnt lgkmcnt(12)
    v_cvt_pk_bf16_f32 v139, v150, v151
    buffer_store_dwordx4 v[136:139], v6, s[12:15], s54 offen offset:2048 sc1
    v_mfma_f32_16x16x32_bf16 v[92:95], a[120:123], a[232:235], v[92:95]
    ds_read_b64_tr_b16 a[152:153], v27 offset:32768
    ds_read_b64_tr_b16 a[154:155], v27 offset:36864
    v_cvt_pk_bf16_f32 v140, v152, v153
    v_mfma_f32_16x16x32_bf16 v[92:95], a[124:127], a[236:239], v[92:95]
    v_cvt_pk_bf16_f32 v141, v154, v155
    v_mfma_f32_16x16x32_bf16 v[88:91], a[124:127], a[228:231], v[88:91]
    ds_read_b64_tr_b16 a[156:157], v27 offset:40960
    ds_read_b64_tr_b16 a[158:159], v27 offset:45056
    v_cvt_pk_bf16_f32 v142, v156, v157
    v_mfma_f32_16x16x32_bf16 v[88:91], a[120:123], a[224:227], v[88:91]
    v_cvt_pk_bf16_f32 v143, v158, v159
    buffer_store_dwordx4 v[140:143], v6, s[12:15], s54 offen offset:3072 sc1
    s_waitcnt lgkmcnt(12)
    v_mfma_f32_16x16x32_bf16 v[64:67], a[128:131], a[240:243], v[64:67]
    v_mov_b32 v18, 0
    s_mov_b64 exec, 1
    buffer_atomic_or v18, v14, s[12:15], s38 offen offset:4 sc0 sc1
    s_mov_b64 exec, -1
    ds_read_b64_tr_b16 a[96:97], v24 offset:49152
    ds_read_b64_tr_b16 a[98:99], v24 offset:53248
    v_mfma_f32_16x16x32_bf16 v[64:67], a[132:135], a[244:247], v[64:67]
    v_mfma_f32_16x16x32_bf16 v[68:71], a[132:135], a[252:255], v[68:71]
    ds_read_b64_tr_b16 a[100:101], v24 offset:57344
    ds_read_b64_tr_b16 a[102:103], v24 offset:61440
    v_mfma_f32_16x16x32_bf16 v[68:71], a[128:131], a[248:251], v[68:71]
    s_waitcnt lgkmcnt(12)
    v_mfma_f32_16x16x32_bf16 v[76:79], a[136:139], a[248:251], v[76:79]
    ds_read_b64_tr_b16 a[104:105], v25 offset:49152
    ds_read_b64_tr_b16 a[106:107], v25 offset:53248
    v_mfma_f32_16x16x32_bf16 v[76:79], a[140:143], a[252:255], v[76:79]
    v_mfma_f32_16x16x32_bf16 v[72:75], a[140:143], a[244:247], v[72:75]
    ds_read_b64_tr_b16 a[108:109], v25 offset:57344
    ds_read_b64_tr_b16 a[110:111], v25 offset:61440
    v_mfma_f32_16x16x32_bf16 v[72:75], a[136:139], a[240:243], v[72:75]
    s_waitcnt lgkmcnt(12)
    v_mfma_f32_16x16x32_bf16 v[80:83], a[144:147], a[240:243], v[80:83]
    ds_read_b64_tr_b16 a[112:113], v26 offset:49152
    ds_read_b64_tr_b16 a[114:115], v26 offset:53248
    v_mfma_f32_16x16x32_bf16 v[80:83], a[148:151], a[244:247], v[80:83]
    v_mfma_f32_16x16x32_bf16 v[84:87], a[148:151], a[252:255], v[84:87]
    ds_read_b64_tr_b16 a[116:117], v26 offset:57344
    ds_read_b64_tr_b16 a[118:119], v26 offset:61440
    v_mfma_f32_16x16x32_bf16 v[84:87], a[144:147], a[248:251], v[84:87]
    s_waitcnt lgkmcnt(12)
    v_mfma_f32_16x16x32_bf16 v[92:95], a[152:155], a[248:251], v[92:95]
    ds_read_b64_tr_b16 a[120:121], v27 offset:49152
    ds_read_b64_tr_b16 a[122:123], v27 offset:53248
    v_mfma_f32_16x16x32_bf16 v[92:95], a[156:159], a[252:255], v[92:95]
    v_mfma_f32_16x16x32_bf16 v[88:91], a[156:159], a[244:247], v[88:91]
    ds_read_b64_tr_b16 a[124:125], v27 offset:57344
    ds_read_b64_tr_b16 a[126:127], v27 offset:61440
    v_mfma_f32_16x16x32_bf16 v[88:91], a[152:155], a[240:243], v[88:91]
    s_waitcnt lgkmcnt(12)
    v_mfma_f32_16x16x32_bf16 v[64:67], a[96:99], v[192:195], v[64:67]
    ds_read_b64_tr_b16 a[128:129], v32 offset:0
    ds_read_b64_tr_b16 a[130:131], v32 offset:4096
    v_mfma_f32_16x16x32_bf16 v[64:67], a[100:103], v[196:199], v[64:67]
    v_mfma_f32_16x16x32_bf16 v[68:71], a[100:103], v[204:207], v[68:71]
    ds_read_b64_tr_b16 a[132:133], v32 offset:8192
    ds_read_b64_tr_b16 a[134:135], v32 offset:12288
    v_mfma_f32_16x16x32_bf16 v[68:71], a[96:99], v[200:203], v[68:71]
    s_waitcnt lgkmcnt(12)
    v_mfma_f32_16x16x32_bf16 v[76:79], a[104:107], v[200:203], v[76:79]
    ds_read_b64_tr_b16 a[136:137], v33 offset:0
    ds_read_b64_tr_b16 a[138:139], v33 offset:4096
    v_mfma_f32_16x16x32_bf16 v[76:79], a[108:111], v[204:207], v[76:79]
    v_mfma_f32_16x16x32_bf16 v[72:75], a[108:111], v[196:199], v[72:75]
    ds_read_b64_tr_b16 a[140:141], v33 offset:8192
    ds_read_b64_tr_b16 a[142:143], v33 offset:12288
    v_mfma_f32_16x16x32_bf16 v[72:75], a[104:107], v[192:195], v[72:75]
    s_waitcnt lgkmcnt(12)
    v_mfma_f32_16x16x32_bf16 v[80:83], a[112:115], v[192:195], v[80:83]
    ds_read_b64_tr_b16 a[144:145], v34 offset:0
    ds_read_b64_tr_b16 a[146:147], v34 offset:4096
    v_mfma_f32_16x16x32_bf16 v[80:83], a[116:119], v[196:199], v[80:83]
    v_mfma_f32_16x16x32_bf16 v[84:87], a[116:119], v[204:207], v[84:87]
    ds_read_b64_tr_b16 a[148:149], v34 offset:8192
    ds_read_b64_tr_b16 a[150:151], v34 offset:12288
    v_mfma_f32_16x16x32_bf16 v[84:87], a[112:115], v[200:203], v[84:87]
    s_waitcnt lgkmcnt(12)
    v_mfma_f32_16x16x32_bf16 v[92:95], a[120:123], v[200:203], v[92:95]
    ds_read_b64_tr_b16 a[152:153], v35 offset:0
    ds_read_b64_tr_b16 a[154:155], v35 offset:4096
    v_mfma_f32_16x16x32_bf16 v[92:95], a[124:127], v[204:207], v[92:95]
    v_mfma_f32_16x16x32_bf16 v[88:91], a[124:127], v[196:199], v[88:91]
    ds_read_b64_tr_b16 a[156:157], v35 offset:8192
    ds_read_b64_tr_b16 a[158:159], v35 offset:12288
    v_mfma_f32_16x16x32_bf16 v[88:91], a[120:123], v[192:195], v[88:91]
    s_waitcnt lgkmcnt(12)
    v_mfma_f32_16x16x32_bf16 v[64:67], a[128:131], v[208:211], v[64:67]
    ds_read_b64_tr_b16 a[96:97], v32 offset:16384
    ds_read_b64_tr_b16 a[98:99], v32 offset:20480
    v_mfma_f32_16x16x32_bf16 v[64:67], a[132:135], v[212:215], v[64:67]
    v_mfma_f32_16x16x32_bf16 v[68:71], a[132:135], v[220:223], v[68:71]
    ds_read_b64_tr_b16 a[100:101], v32 offset:24576
    ds_read_b64_tr_b16 a[102:103], v32 offset:28672
    v_mfma_f32_16x16x32_bf16 v[68:71], a[128:131], v[216:219], v[68:71]
    s_waitcnt lgkmcnt(12)
    v_mfma_f32_16x16x32_bf16 v[76:79], a[136:139], v[216:219], v[76:79]
    ds_read_b64_tr_b16 a[104:105], v33 offset:16384
    ds_read_b64_tr_b16 a[106:107], v33 offset:20480
    v_mfma_f32_16x16x32_bf16 v[76:79], a[140:143], v[220:223], v[76:79]
    v_mfma_f32_16x16x32_bf16 v[72:75], a[140:143], v[212:215], v[72:75]
    ds_read_b64_tr_b16 a[108:109], v33 offset:24576
    ds_read_b64_tr_b16 a[110:111], v33 offset:28672
    v_mfma_f32_16x16x32_bf16 v[72:75], a[136:139], v[208:211], v[72:75]
    s_waitcnt lgkmcnt(12)
    v_mfma_f32_16x16x32_bf16 v[80:83], a[144:147], v[208:211], v[80:83]
    ds_read_b64_tr_b16 a[112:113], v34 offset:16384
    ds_read_b64_tr_b16 a[114:115], v34 offset:20480
    v_mfma_f32_16x16x32_bf16 v[80:83], a[148:151], v[212:215], v[80:83]
    v_mfma_f32_16x16x32_bf16 v[84:87], a[148:151], v[220:223], v[84:87]
    ds_read_b64_tr_b16 a[116:117], v34 offset:24576
    ds_read_b64_tr_b16 a[118:119], v34 offset:28672
    v_mfma_f32_16x16x32_bf16 v[84:87], a[144:147], v[216:219], v[84:87]
    s_waitcnt lgkmcnt(12)
    v_mfma_f32_16x16x32_bf16 v[92:95], a[152:155], v[216:219], v[92:95]
    ds_read_b64_tr_b16 a[120:121], v35 offset:16384
    ds_read_b64_tr_b16 a[122:123], v35 offset:20480
    v_mfma_f32_16x16x32_bf16 v[92:95], a[156:159], v[220:223], v[92:95]
    v_mfma_f32_16x16x32_bf16 v[88:91], a[156:159], v[212:215], v[88:91]
    ds_read_b64_tr_b16 a[124:125], v35 offset:24576
    ds_read_b64_tr_b16 a[126:127], v35 offset:28672
    v_mfma_f32_16x16x32_bf16 v[88:91], a[152:155], v[208:211], v[88:91]
    s_waitcnt vmcnt(1)
    s_mov_b64 exec, 4
    buffer_store_dword v15, v10, s[12:15], 0 offen sc1
    s_mov_b64 exec, -1
    s_waitcnt vmcnt(1)
    v_readfirstlane_b32 s78, v18
    s_nop 0
    s_cmp_ge_u32 s78, 1
    s_cbranch_scc1 L_got24
    s_mov_b32 s79, 0
L_spinl24:
    v_mov_b32 v18, 0
    s_mov_b64 exec, 1
    buffer_atomic_or v18, v14, s[12:15], s38 offen offset:4 sc0 sc1
    s_mov_b64 exec, -1
    s_waitcnt vmcnt(0)
    v_readfirstlane_b32 s78, v18
    s_add_u32 s79, s79, 1
    s_cmp_ge_u32 s78, 1
    s_cbranch_scc1 L_got24
    s_cmp_lt_u32 s79, 0x80000
    s_cbranch_scc1 L_spinl24
L_got24:
    s_waitcnt lgkmcnt(12)
    v_mfma_f32_16x16x32_bf16 v[64:67], a[96:99], v[224:227], v[64:67]
    ds_read_b64_tr_b16 a[128:129], v32 offset:32768
    ds_read_b64_tr_b16 a[130:131], v32 offset:36864
    v_mfma_f32_16x16x32_bf16 v[64:67], a[100:103], v[228:231], v[64:67]
    buffer_load_dwordx4 v[112:115], v6, s[12:15], s77 offen offset:0 sc1
    v_mfma_f32_16x16x32_bf16 v[68:71], a[100:103], v[236:239], v[68:71]
    ds_read_b64_tr_b16 a[132:133], v32 offset:40960
    ds_read_b64_tr_b16 a[134:135], v32 offset:45056
    v_mfma_f32_16x16x32_bf16 v[68:71], a[96:99], v[232:235], v[68:71]
    s_waitcnt lgkmcnt(12)
    v_mfma_f32_16x16x32_bf16 v[76:79], a[104:107], v[232:235], v[76:79]
    ds_read_b64_tr_b16 a[136:137], v33 offset:32768
    ds_read_b64_tr_b16 a[138:139], v33 offset:36864
    v_mfma_f32_16x16x32_bf16 v[76:79], a[108:111], v[236:239], v[76:79]
    buffer_load_dwordx4 v[116:119], v6, s[12:15], s77 offen offset:1024 sc1
    v_mfma_f32_16x16x32_bf16 v[72:75], a[108:111], v[228:231], v[72:75]
    ds_read_b64_tr_b16 a[140:141], v33 offset:40960
    ds_read_b64_tr_b16 a[142:143], v33 offset:45056
    v_mul_f32 v64, v48, v64
    v_mfma_f32_16x16x32_bf16 v[72:75], a[104:107], v[224:227], v[72:75]
    s_waitcnt lgkmcnt(12)
    v_mul_f32 v65, v48, v65
    v_mfma_f32_16x16x32_bf16 v[80:83], a[112:115], v[224:227], v[80:83]
    ds_read_b64_tr_b16 a[144:145], v34 offset:32768
    ds_read_b64_tr_b16 a[146:147], v34 offset:36864
    v_mul_f32 v66, v48, v66
    v_mfma_f32_16x16x32_bf16 v[80:83], a[116:119], v[228:231], v[80:83]
    buffer_load_dwordx4 v[120:123], v6, s[12:15], s77 offen offset:2048 sc1
    v_mul_f32 v67, v48, v67
    v_mfma_f32_16x16x32_bf16 v[84:87], a[116:119], v[236:239], v[84:87]
    ds_read_b64_tr_b16 a[148:149], v34 offset:40960
    ds_read_b64_tr_b16 a[150:151], v34 offset:45056
    v_mul_f32 v68, v49, v68
    v_mul_f32 v72, v48, v72
    v_mfma_f32_16x16x32_bf16 v[84:87], a[112:115], v[232:235], v[84:87]
    s_waitcnt lgkmcnt(12)
    v_mul_f32 v69, v49, v69
    v_mul_f32 v73, v48, v73
    v_mfma_f32_16x16x32_bf16 v[92:95], a[120:123], v[232:235], v[92:95]
    ds_read_b64_tr_b16 a[152:153], v35 offset:32768
    ds_read_b64_tr_b16 a[154:155], v35 offset:36864
    v_mul_f32 v70, v49, v70
    v_mul_f32 v74, v48, v74
    v_mfma_f32_16x16x32_bf16 v[92:95], a[124:127], v[236:239], v[92:95]
    buffer_load_dwordx4 v[124:127], v6, s[12:15], s77 offen offset:3072 sc1
    v_mul_f32 v71, v49, v71
    v_mul_f32 v75, v48, v75
    v_mfma_f32_16x16x32_bf16 v[88:91], a[124:127], v[228:231], v[88:91]
    ds_read_b64_tr_b16 a[156:157], v35 offset:40960
    ds_read_b64_tr_b16 a[158:159], v35 offset:45056
    v_mul_f32 v76, v49, v76
    v_mul_f32 v80, v48, v80
    v_mfma_f32_16x16x32_bf16 v[88:91], a[120:123], v[224:227], v[88:91]
    v_mul_f32 v77, v49, v77
    v_mul_f32 v81, v48, v81
    s_waitcnt lgkmcnt(12)
    v_mfma_f32_16x16x32_bf16 v[64:67], a[128:131], v[240:243], v[64:67]
    ds_read_b64_tr_b16 a[96:97], v32 offset:49152
    ds_read_b64_tr_b16 a[98:99], v32 offset:53248
    v_mul_f32 v78, v49, v78
    v_mul_f32 v82, v48, v82
    v_mfma_f32_16x16x32_bf16 v[64:67], a[132:135], v[244:247], v[64:67]
    v_mul_f32 v79, v49, v79
    v_mul_f32 v83, v48, v83
    v_mfma_f32_16x16x32_bf16 v[68:71], a[132:135], v[252:255], v[68:71]
    ds_read_b64_tr_b16 a[100:101], v32 offset:57344
    ds_read_b64_tr_b16 a[102:103], v32 offset:61440
    v_mul_f32 v84, v49, v84
    v_mul_f32 v88, v48, v88
    v_mfma_f32_16x16x32_bf16 v[68:71], a[128:131], v[248:251], v[68:71]
    s_waitcnt lgkmcnt(12)
    v_mul_f32 v85, v49, v85
    v_mul_f32 v89, v48, v89
    v_mfma_f32_16x16x32_bf16 v[76:79], a[136:139], v[248:251], v[76:79]
    ds_read_b64_tr_b16 a[104:105], v33 offset:49152
    ds_read_b64_tr_b16 a[106:107], v33 offset:53248
    v_mul_f32 v86, v49, v86
    v_mul_f32 v90, v48, v90
    v_mfma_f32_16x16x32_bf16 v[76:79], a[140:143], v[252:255], v[76:79]
    v_mul_f32 v87, v49, v87
    v_mul_f32 v91, v48, v91
    v_mfma_f32_16x16x32_bf16 v[72:75], a[140:143], v[244:247], v[72:75]
    ds_read_b64_tr_b16 a[108:109], v33 offset:57344
    ds_read_b64_tr_b16 a[110:111], v33 offset:61440
    v_mul_f32 v92, v49, v92
    v_mfma_f32_16x16x32_bf16 v[72:75], a[136:139], v[240:243], v[72:75]
    s_waitcnt lgkmcnt(12)
    v_mul_f32 v93, v49, v93
    v_mfma_f32_16x16x32_bf16 v[80:83], a[144:147], v[240:243], v[80:83]
    ds_read_b64_tr_b16 a[112:113], v34 offset:49152
    ds_read_b64_tr_b16 a[114:115], v34 offset:53248
    v_mul_f32 v94, v49, v94
    v_mfma_f32_16x16x32_bf16 v[80:83], a[148:151], v[244:247], v[80:83]
    v_mul_f32 v95, v49, v95
    v_mfma_f32_16x16x32_bf16 v[84:87], a[148:151], v[252:255], v[84:87]
    ds_read_b64_tr_b16 a[116:117], v34 offset:57344
    ds_read_b64_tr_b16 a[118:119], v34 offset:61440
    v_mfma_f32_16x16x32_bf16 v[84:87], a[144:147], v[248:251], v[84:87]
    s_waitcnt lgkmcnt(12)
    v_mfma_f32_16x16x32_bf16 v[92:95], a[152:155], v[248:251], v[92:95]
    ds_read_b64_tr_b16 a[120:121], v35 offset:49152
    ds_read_b64_tr_b16 a[122:123], v35 offset:53248
    v_mfma_f32_16x16x32_bf16 v[92:95], a[156:159], v[252:255], v[92:95]
    v_mfma_f32_16x16x32_bf16 v[88:91], a[156:159], v[244:247], v[88:91]
    ds_read_b64_tr_b16 a[124:125], v35 offset:57344
    ds_read_b64_tr_b16 a[126:127], v35 offset:61440
    v_mfma_f32_16x16x32_bf16 v[88:91], a[152:155], v[240:243], v[88:91]
    s_waitcnt lgkmcnt(12)
    v_mfma_f32_16x16x32_bf16 v[64:67], a[96:99], a[0:3], v[64:67]
    v_mov_b32 v18, 0
    s_mov_b64 exec, 1
    buffer_atomic_or v18, v14, s[12:15], s38 offen offset:8 sc0 sc1
    s_mov_b64 exec, -1
    ds_read_b64_tr_b16 a[128:129], v40 offset:0
    ds_read_b64_tr_b16 a[130:131], v40 offset:4096
    v_mfma_f32_16x16x32_bf16 v[64:67], a[100:103], a[4:7], v[64:67]
    v_mfma_f32_16x16x32_bf16 v[68:71], a[100:103], a[12:15], v[68:71]
    ds_read_b64_tr_b16 a[132:133], v40 offset:8192
    ds_read_b64_tr_b16 a[134:135], v40 offset:12288
    v_mfma_f32_16x16x32_bf16 v[68:71], a[96:99], a[8:11], v[68:71]
    s_waitcnt lgkmcnt(12)
    v_mfma_f32_16x16x32_bf16 v[76:79], a[104:107], a[8:11], v[76:79]
    ds_read_b64_tr_b16 a[136:137], v41 offset:0
    ds_read_b64_tr_b16 a[138:139], v41 offset:4096
    v_mfma_f32_16x16x32_bf16 v[76:79], a[108:111], a[12:15], v[76:79]
    v_mfma_f32_16x16x32_bf16 v[72:75], a[108:111], a[4:7], v[72:75]
    ds_read_b64_tr_b16 a[140:141], v41 offset:8192
    ds_read_b64_tr_b16 a[142:143], v41 offset:12288
    v_mfma_f32_16x16x32_bf16 v[72:75], a[104:107], a[0:3], v[72:75]
    s_waitcnt lgkmcnt(12)
    v_mfma_f32_16x16x32_bf16 v[80:83], a[112:115], a[0:3], v[80:83]
    ds_read_b64_tr_b16 a[144:145], v42 offset:0
    ds_read_b64_tr_b16 a[146:147], v42 offset:4096
    v_mfma_f32_16x16x32_bf16 v[80:83], a[116:119], a[4:7], v[80:83]
    v_mfma_f32_16x16x32_bf16 v[84:87], a[116:119], a[12:15], v[84:87]
    ds_read_b64_tr_b16 a[148:149], v42 offset:8192
    ds_read_b64_tr_b16 a[150:151], v42 offset:12288
    v_mfma_f32_16x16x32_bf16 v[84:87], a[112:115], a[8:11], v[84:87]
    s_waitcnt lgkmcnt(12)
    v_mfma_f32_16x16x32_bf16 v[92:95], a[120:123], a[8:11], v[92:95]
    ds_read_b64_tr_b16 a[152:153], v43 offset:0
    ds_read_b64_tr_b16 a[154:155], v43 offset:4096
    v_mfma_f32_16x16x32_bf16 v[92:95], a[124:127], a[12:15], v[92:95]
    v_mfma_f32_16x16x32_bf16 v[88:91], a[124:127], a[4:7], v[88:91]
    ds_read_b64_tr_b16 a[156:157], v43 offset:8192
    ds_read_b64_tr_b16 a[158:159], v43 offset:12288
    v_mfma_f32_16x16x32_bf16 v[88:91], a[120:123], a[0:3], v[88:91]
    s_waitcnt lgkmcnt(12)
    v_mfma_f32_16x16x32_bf16 v[64:67], a[128:131], a[16:19], v[64:67]
    v_mfma_f32_16x16x32_bf16 v[64:67], a[132:135], a[20:23], v[64:67]
    v_mfma_f32_16x16x32_bf16 v[68:71], a[132:135], a[28:31], v[68:71]
    v_mfma_f32_16x16x32_bf16 v[68:71], a[128:131], a[24:27], v[68:71]
    s_waitcnt lgkmcnt(8)
    v_mfma_f32_16x16x32_bf16 v[76:79], a[136:139], a[24:27], v[76:79]
    v_mfma_f32_16x16x32_bf16 v[76:79], a[140:143], a[28:31], v[76:79]
    v_mfma_f32_16x16x32_bf16 v[72:75], a[140:143], a[20:23], v[72:75]
    v_mfma_f32_16x16x32_bf16 v[72:75], a[136:139], a[16:19], v[72:75]
    s_waitcnt lgkmcnt(4)
    v_mfma_f32_16x16x32_bf16 v[80:83], a[144:147], a[16:19], v[80:83]
    v_mfma_f32_16x16x32_bf16 v[80:83], a[148:151], a[20:23], v[80:83]
    v_mfma_f32_16x16x32_bf16 v[84:87], a[148:151], a[28:31], v[84:87]
    v_mfma_f32_16x16x32_bf16 v[84:87], a[144:147], a[24:27], v[84:87]
    s_waitcnt lgkmcnt(0)
    v_mfma_f32_16x16x32_bf16 v[92:95], a[152:155], a[24:27], v[92:95]
    v_mfma_f32_16x16x32_bf16 v[92:95], a[156:159], a[28:31], v[92:95]
    v_mfma_f32_16x16x32_bf16 v[88:91], a[156:159], a[20:23], v[88:91]
    v_mfma_f32_16x16x32_bf16 v[88:91], a[152:155], a[16:19], v[88:91]
    s_waitcnt vmcnt(0)
    v_readfirstlane_b32 s78, v18
    s_nop 0
    s_cmp_ge_u32 s78, 1
    s_cbranch_scc1 L_got25
    s_mov_b32 s79, 0
L_spinl25:
    v_mov_b32 v18, 0
    s_mov_b64 exec, 1
    buffer_atomic_or v18, v14, s[12:15], s38 offen offset:8 sc0 sc1
    s_mov_b64 exec, -1
    s_waitcnt vmcnt(0)
    v_readfirstlane_b32 s78, v18
    s_add_u32 s79, s79, 1
    s_cmp_ge_u32 s78, 1
    s_cbranch_scc1 L_got25
    s_cmp_lt_u32 s79, 0x80000
    s_cbranch_scc1 L_spinl25
L_got25:
    buffer_load_dwordx4 v[144:147], v6, s[12:15], s55 offen offset:0 sc1
    buffer_load_dwordx4 v[148:151], v6, s[12:15], s55 offen offset:1024 sc1
    buffer_load_dwordx4 v[152:155], v6, s[12:15], s55 offen offset:2048 sc1
    buffer_load_dwordx4 v[156:159], v6, s[12:15], s55 offen offset:3072 sc1
    v_dot2c_f32_bf16 v64, v176, v22
    v_dot2c_f32_bf16 v65, v176, v23
    v_dot2c_f32_bf16 v66, v177, v22
    v_dot2c_f32_bf16 v67, v177, v23
    v_dot2c_f32_bf16 v68, v178, v22
    v_dot2c_f32_bf16 v69, v178, v23
    v_dot2c_f32_bf16 v70, v179, v22
    v_dot2c_f32_bf16 v71, v179, v23
    v_dot2c_f32_bf16 v72, v180, v22
    v_dot2c_f32_bf16 v73, v180, v23
    v_dot2c_f32_bf16 v74, v181, v22
    v_dot2c_f32_bf16 v75, v181, v23
    v_dot2c_f32_bf16 v76, v182, v22
    v_dot2c_f32_bf16 v77, v182, v23
    v_dot2c_f32_bf16 v78, v183, v22
    v_dot2c_f32_bf16 v79, v183, v23
    v_dot2c_f32_bf16 v80, v184, v22
    v_dot2c_f32_bf16 v81, v184, v23
    v_dot2c_f32_bf16 v82, v185, v22
    v_dot2c_f32_bf16 v83, v185, v23
    v_dot2c_f32_bf16 v84, v186, v22
    v_dot2c_f32_bf16 v85, v186, v23
    v_dot2c_f32_bf16 v86, v187, v22
    v_dot2c_f32_bf16 v87, v187, v23
    v_dot2c_f32_bf16 v88, v188, v22
    v_dot2c_f32_bf16 v89, v188, v23
    v_dot2c_f32_bf16 v90, v189, v22
    v_dot2c_f32_bf16 v91, v189, v23
    v_dot2c_f32_bf16 v92, v190, v22
    v_dot2c_f32_bf16 v93, v190, v23
    v_dot2c_f32_bf16 v94, v191, v22
    v_dot2c_f32_bf16 v95, v191, v23
    v_dot2c_f32_bf16 v64, v112, v22
    v_dot2c_f32_bf16 v65, v112, v23
    v_dot2c_f32_bf16 v66, v113, v22
    v_dot2c_f32_bf16 v67, v113, v23
    v_dot2c_f32_bf16 v68, v114, v22
    v_dot2c_f32_bf16 v69, v114, v23
    v_dot2c_f32_bf16 v70, v115, v22
    v_dot2c_f32_bf16 v71, v115, v23
    v_dot2c_f32_bf16 v72, v116, v22
    v_dot2c_f32_bf16 v73, v116, v23
    v_dot2c_f32_bf16 v74, v117, v22
    v_dot2c_f32_bf16 v75, v117, v23
    v_dot2c_f32_bf16 v76, v118, v22
    v_dot2c_f32_bf16 v77, v118, v23
    v_dot2c_f32_bf16 v78, v119, v22
    v_dot2c_f32_bf16 v79, v119, v23
    v_dot2c_f32_bf16 v80, v120, v22
    v_dot2c_f32_bf16 v81, v120, v23
    v_dot2c_f32_bf16 v82, v121, v22
    v_dot2c_f32_bf16 v83, v121, v23
    v_dot2c_f32_bf16 v84, v122, v22
    v_dot2c_f32_bf16 v85, v122, v23
    v_dot2c_f32_bf16 v86, v123, v22
    v_dot2c_f32_bf16 v87, v123, v23
    v_dot2c_f32_bf16 v88, v124, v22
    v_dot2c_f32_bf16 v89, v124, v23
    v_dot2c_f32_bf16 v90, v125, v22
    v_dot2c_f32_bf16 v91, v125, v23
    v_dot2c_f32_bf16 v92, v126, v22
    v_dot2c_f32_bf16 v93, v126, v23
    v_dot2c_f32_bf16 v94, v127, v22
    v_dot2c_f32_bf16 v95, v127, v23
    s_waitcnt vmcnt(0)
    v_dot2c_f32_bf16 v64, v144, v22
    v_dot2c_f32_bf16 v65, v144, v23
    v_dot2c_f32_bf16 v66, v145, v22
    v_dot2c_f32_bf16 v67, v145, v23
    v_dot2c_f32_bf16 v72, v148, v22
    v_dot2c_f32_bf16 v73, v148, v23
    v_dot2c_f32_bf16 v74, v149, v22
    v_dot2c_f32_bf16 v75, v149, v23
    v_dot2c_f32_bf16 v80, v152, v22
    v_dot2c_f32_bf16 v81, v152, v23
    v_dot2c_f32_bf16 v82, v153, v22
    v_dot2c_f32_bf16 v83, v153, v23
    v_dot2c_f32_bf16 v88, v156, v22
    v_dot2c_f32_bf16 v89, v156, v23
    v_dot2c_f32_bf16 v90, v157, v22
    v_dot2c_f32_bf16 v91, v157, v23
    v_cvt_pk_bf16_f32 v24, v64, v65
    v_cvt_pk_bf16_f32 v25, v66, v67
    v_cvt_pk_bf16_f32 v26, v72, v73
    v_cvt_pk_bf16_f32 v27, v74, v75
    v_cvt_pk_bf16_f32 v28, v80, v81
    v_cvt_pk_bf16_f32 v29, v82, v83
    v_cvt_pk_bf16_f32 v30, v88, v89
    v_cvt_pk_bf16_f32 v31, v90, v91
    ds_write_b64 v56, v[24:25] offset:0
    ds_write_b64 v57, v[26:27] offset:0
    ds_write_b64 v58, v[28:29] offset:0
    ds_write_b64 v59, v[30:31] offset:0
    ds_read_b128 v[160:163], v60 offset:0
    ds_read_b128 v[164:167], v60 offset:1024
    v_dot2c_f32_bf16 v68, v146, v22
    v_dot2c_f32_bf16 v69, v146, v23
    v_dot2c_f32_bf16 v70, v147, v22
    v_dot2c_f32_bf16 v71, v147, v23
    v_dot2c_f32_bf16 v76, v150, v22
    v_dot2c_f32_bf16 v77, v150, v23
    v_dot2c_f32_bf16 v78, v151, v22
    v_dot2c_f32_bf16 v79, v151, v23
    v_dot2c_f32_bf16 v84, v154, v22
    v_dot2c_f32_bf16 v85, v154, v23
    v_dot2c_f32_bf16 v86, v155, v22
    v_dot2c_f32_bf16 v87, v155, v23
    v_dot2c_f32_bf16 v92, v158, v22
    v_dot2c_f32_bf16 v93, v158, v23
    v_dot2c_f32_bf16 v94, v159, v22
    v_dot2c_f32_bf16 v95, v159, v23
    s_waitcnt lgkmcnt(1)
    buffer_store_dwordx4 v[160:163], v19, s[72:75], s31 offen sc1
    s_waitcnt lgkmcnt(0)
    buffer_store_dwordx4 v[164:167], v16, s[72:75], s31 offen sc1
    v_cvt_pk_bf16_f32 v32, v68, v69
    v_cvt_pk_bf16_f32 v33, v70, v71
    v_cvt_pk_bf16_f32 v34, v76, v77
    v_cvt_pk_bf16_f32 v35, v78, v79
    v_cvt_pk_bf16_f32 v36, v84, v85
    v_cvt_pk_bf16_f32 v37, v86, v87
    v_cvt_pk_bf16_f32 v38, v92, v93
    v_cvt_pk_bf16_f32 v39, v94, v95
    ds_write_b64 v56, v[32:33] offset:2048
    ds_write_b64 v57, v[34:35] offset:2048
    ds_write_b64 v58, v[36:37] offset:2048
    ds_write_b64 v59, v[38:39] offset:2048
    ds_read_b128 v[168:171], v60 offset:2048
    ds_read_b128 v[172:175], v60 offset:3072
    s_waitcnt lgkmcnt(1)
    buffer_store_dwordx4 v[168:171], v19, s[72:75], s32 offen sc1
    s_waitcnt lgkmcnt(0)
    buffer_store_dwordx4 v[172:175], v16, s[72:75], s32 offen sc1
    s_endpgm
L_spin16:
    s_mov_b32 s79, 0
L_spinl16:
    global_load_dword v29, v11, s[24:25] sc1
    s_waitcnt vmcnt(0)
    v_cmp_eq_u32 vcc, 1, v29
    s_nop 0
    s_bcnt1_i32_b32 s78, vcc_lo
    s_add_u32 s79, s79, 1
    s_cmp_ge_u32 s78, 1
    s_cbranch_scc1 L_got16
    s_cmp_lt_u32 s79, 0x80000
    s_cbranch_scc1 L_spinl16
    s_branch L_got16
L_spin18:
    s_mov_b32 s79, 0
L_spinl18:
    buffer_load_dword v62, v14, s[12:15], s52 offen offset:0 sc1
    s_waitcnt vmcnt(0)
    v_cmp_eq_u32 vcc, 1, v62
    s_nop 0
    s_bcnt1_i32_b32 s78, vcc_lo
    s_add_u32 s79, s79, 1
    s_cmp_ge_u32 s78, 32
    s_cbranch_scc1 L_got18
    s_cmp_lt_u32 s79, 0x80000
    s_cbranch_scc1 L_spinl18
    s_branch L_got18
L_spin19:
    s_mov_b32 s79, 0
L_spinl19:
    buffer_load_dword v9, v14, s[12:15], s38 offen offset:0 sc1
    s_waitcnt vmcnt(0)
    v_cmp_eq_u32 vcc, 1, v9
    s_nop 0
    s_bcnt1_i32_b32 s78, vcc_lo
    s_add_u32 s79, s79, 1
    s_cmp_ge_u32 s78, 16
    s_cbranch_scc1 L_got19
    s_cmp_lt_u32 s79, 0x80000
    s_cbranch_scc1 L_spinl19
    s_branch L_got19
L_spin20:
    s_mov_b32 s79, 0
L_spinl20:
    buffer_load_dword v18, v14, s[12:15], s39 offen offset:0 sc1
    s_waitcnt vmcnt(0)
    v_cmp_eq_u32 vcc, 1, v18
    s_nop 0
    s_bcnt1_i32_b32 s78, vcc_lo
    s_add_u32 s79, s79, 1
    s_cmp_ge_u32 s78, 16
    s_cbranch_scc1 L_got20
    s_cmp_lt_u32 s79, 0x80000
    s_cbranch_scc1 L_spinl20
    s_branch L_got20
L_spin21:
    s_mov_b32 s79, 0
L_spinl21:
    buffer_load_dword v17, v7, s[12:15], s99 offen offset:0 sc1
    s_waitcnt vmcnt(0)
    v_cmp_eq_u32 vcc, 1, v17
    s_nop 0
    s_bcnt1_i32_b64 s78, vcc
L_pg22:
    s_cbranch_execz L_tramp
    s_add_u32 s79, s79, 1
    s_cmp_ge_u32 s78, 64
    s_cbranch_scc1 L_got21
    s_cmp_lt_u32 s79, 0x80000
    s_cbranch_scc1 L_spinl21
    s_branch L_got21
L_spin22:
    s_mov_b32 s79, 0
L_spinl22:
    buffer_load_dword v18, v14, s[12:15], s40 offen offset:0 sc1
    s_waitcnt vmcnt(0)
    v_cmp_eq_u32 vcc, 1, v18
    s_nop 0
    s_bcnt1_i32_b32 s78, vcc_lo
    s_add_u32 s79, s79, 1
    s_cmp_ge_u32 s78, 32
    s_cbranch_scc1 L_got22
    s_cmp_lt_u32 s79, 0x80000
    s_cbranch_scc1 L_spinl22
    s_branch L_got22
L_spin23:
    s_mov_b32 s79, 0
L_spinl23:
    v_mov_b32 v18, 0
    s_mov_b64 exec, 1
    buffer_atomic_or v18, v14, s[12:15], s38 offen offset:0 sc0 sc1
    s_mov_b64 exec, -1
    s_waitcnt vmcnt(0)
    v_cmp_eq_u32 vcc, 1, v18
    s_nop 0
    s_bcnt1_i32_b32 s78, vcc_lo
    s_add_u32 s79, s79, 1
    s_cmp_ge_u32 s78, 1
    s_cbranch_scc1 L_got23
    s_cmp_lt_u32 s79, 0x80000
    s_cbranch_scc1 L_spinl23
    s_branch L_got23
.fill 1209, 4, 0xbf810000
L_end:
    s_endpgm
.section .rodata,"a"
.p2align 6
.amdhsa_kernel gated_mix__linear_kernel_hedgehog__dense_activation_mish__prompt_kernel
  .amdhsa_next_free_vgpr 512
  .amdhsa_next_free_sgpr 102
  .amdhsa_accum_offset 256
  .amdhsa_group_segment_fixed_size 0
  .amdhsa_kernarg_size 96
  .amdhsa_user_sgpr_count 2
  .amdhsa_user_sgpr_kernarg_segment_ptr 1
  .amdhsa_system_sgpr_workgroup_id_x 1
.end_amdhsa_kernel
```
